```python
import torch

def _softmax(x, axis=-1):
    return torch.softmax(x, dim=axis)

def _gelu(x):
    return torch.nn.functional.gelu(x, approximate='tanh')

def _silu(x):
    return torch.nn.functional.silu(x)

def _sigmoid(x):
    return torch.sigmoid(x)

def _layernorm(x, axis=-1, eps=1e-05):
    m = x.mean(dim=axis, keepdim=True)
    v = x.var(dim=axis, keepdim=True, unbiased=False)
    return (x - m) / torch.sqrt(v + eps)

def _scatter_add(tgt, idx, src, axis=0):
    return tgt.clone().index_add_(axis, idx, src)

def _segment_sum(src, seg, n):
    out = torch.zeros((n,) + src.shape[1:], dtype=src.dtype)
    return out.index_add_(0, seg, src)

def _pad(x, pw):
    flat = tuple((v for pair in reversed(pw) for v in pair))
    return torch.nn.functional.pad(x, flat)
kernel_name = 'recurrent_scan__memory_aug_recurrent_mem_tr__glu_gated_bilinear__prompt'

def setup_inputs():

    _w = lambda a: (lambda t: t.to(torch.bfloat16) if t.is_floating_point() else t)(torch.as_tensor(a))

    def _A_setup():
        B, S, Dm = (1, 2048, 512)
        H, Dh = (32, 128)
        M, seg = (8, 32)
        seg = min(seg, S)
        S = S // seg * seg
        return {'x': _w((lambda *s: torch.randn(*s, dtype=torch.bfloat16) * 0.1)(B, S, Dm)), 'mem0': _w((lambda *s: torch.randn(*s, dtype=torch.bfloat16) * 1.6)(B, M, Dm)), 'Wq': _w((lambda *s: torch.randn(*s, dtype=torch.bfloat16) * 0.8)(Dm, H, Dh) * Dm ** (-0.5)), 'Wk': _w((lambda *s: torch.randn(*s, dtype=torch.bfloat16) * 0.8)(Dm, H, Dh) * Dm ** (-0.5)), 'Wv': _w((lambda *s: torch.randn(*s, dtype=torch.bfloat16) * 1.6)(Dm, H, Dh) * Dm ** (-0.5)), 'Wo': _w((lambda *s: torch.randn(*s, dtype=torch.bfloat16) * 1.6)(H, Dh, Dm) * (H * Dh) ** (-0.5)), 'seg_len': seg}
    _A_in = _A_setup()

    def _B_setup():
        B, S, D, F = (1, 2048, 512, 1792)
        return {'x': _w((lambda *s: torch.randn(*s, dtype=torch.bfloat16) * 0.1)(B, S, D)), 'w_gate': _w((lambda *s: torch.randn(*s, dtype=torch.bfloat16) * 0.4)(D, F) * D ** (-0.5)), 'w_up': _w((lambda *s: torch.randn(*s, dtype=torch.bfloat16) * 0.4)(D, F) * D ** (-0.5)), 'w_down': _w((lambda *s: torch.randn(*s, dtype=torch.bfloat16) * 0.4)(F, D) * F ** (-0.5))}
    _B_in = _B_setup()
    return {'A_x': _A_in['x'], 'A_mem0': _A_in['mem0'], 'A_Wq': _A_in['Wq'], 'A_Wk': _A_in['Wk'], 'A_Wv': _A_in['Wv'], 'A_Wo': _A_in['Wo'], 'A_seg_len': _A_in['seg_len'], 'B_x': _B_in['x'], 'B_w_gate': _B_in['w_gate'], 'B_w_up': _B_in['w_up'], 'B_w_down': _B_in['w_down']}

def reference(A_x, A_mem0, A_Wq, A_Wk, A_Wv, A_Wo, A_seg_len, B_x, B_w_gate, B_w_up, B_w_down):

    def _A_ref(x, mem0, Wq, Wk, Wv, Wo, seg_len):
        B, S, Dm = x.shape
        H, Dh = (Wq.shape[1], Wq.shape[2])
        M = mem0.shape[1]
        scale = Dh ** (-0.5)
        n_seg = S // seg_len
        L = M + seg_len
        idx = torch.arange(L)
        mask = (idx[:, None] < M) | (idx[:, None] >= idx[None, :])
        mem = mem0
        outs = []
        for s in range(n_seg):
            xs = x[:, s * seg_len:(s + 1) * seg_len, :].clone()
            h = torch.concatenate([mem, xs], axis=1)
            q = torch.einsum('btd,dhe->bhte', h, Wq)
            k = torch.einsum('btd,dhe->bhte', h, Wk)
            v = torch.einsum('btd,dhe->bhte', h, Wv)
            scores = torch.einsum('bhqe,bhke->bhqk', q, k) * scale
            scores = torch.where(mask[None, None], scores, -1000000000.0)
            p = _softmax(scores, axis=-1)
            o = torch.einsum('bhqk,bhke->bhqe', p, v)
            o = torch.einsum('bhte,hed->btd', o, Wo)
            mem = o[:, :M, :].clone()
            outs.append(o[:, M:, :])
        return torch.concatenate(outs, axis=1)

    def _B_ref(x, w_gate, w_up, w_down):
        g = torch.einsum('bsd,df->bsf', x, w_gate)
        u = torch.einsum('bsd,df->bsf', x, w_up)
        h = g * u
        return torch.einsum('bsf,fd->bsd', h, w_down)
    x = A_x
    xn = _layernorm(x, axis=-1)
    s = _A_ref(xn, A_mem0, A_Wq, A_Wk, A_Wv, A_Wo, A_seg_len)
    g = _silu(_B_ref(xn, B_w_gate, B_w_up, B_w_down))
    return x + s * g
```

```asm
; @launch grid=(256,1,1) block=(256,1,1) lds=163840
.amdgcn_target "amdgcn-amd-amdhsa--gfx950"
.text
.globl recurrent_scan__memory_aug_recurrent_mem_tr__glu_gated_bilinear__prompt_kernel
.p2align 8
.type recurrent_scan__memory_aug_recurrent_mem_tr__glu_gated_bilinear__prompt_kernel,@function
recurrent_scan__memory_aug_recurrent_mem_tr__glu_gated_bilinear__prompt_kernel:
    s_cmp_ge_u32 s2, 256
    s_cbranch_scc1 L_end
    s_load_dwordx4 s[4:7], s[0:1], 0
    s_load_dwordx8 s[8:15], s[0:1], 16
    s_load_dwordx4 s[16:19], s[0:1], 64
    s_load_dwordx8 s[20:27], s[0:1], 80
    s_getreg_b32 s30, hwreg(HW_REG_XCC_ID)
    s_and_b32 s30, s30, 15
    s_and_b32 s97, s30, 7
    v_lshrrev_b32 v1, 6, v0
    s_nop 0
    v_readfirstlane_b32 s28, v1
    v_and_b32 v0, 63, v0
    s_mov_b32 s37, 0x05040100
    s_mov_b32 s38, 0x07060302
    s_mov_b32 s39, 0
    s_lshl_b32 s40, s97, 2
    s_cmp_eq_u32 s97, 0
    s_cselect_b32 s40, 128, s40
    v_mov_b32 v3, s40
    v_mov_b32 v4, 1
    v_mov_b32 v5, 0
    s_waitcnt lgkmcnt(0)
    s_cmp_lg_u32 s28, 0
    s_cbranch_scc1 L_norank
    s_mov_b64 exec, 1
    global_atomic_add v6, v3, v4, s[24:25] sc0
    s_mov_b64 exec, -1
L_norank:
    s_cmp_eq_u32 s97, 0
    s_cbranch_scc1 L_nopf
    s_lshl_b32 s40, s2, 2
    s_add_u32 s40, s40, s28
    s_lshl_b32 s40, s40, 12
    v_lshlrev_b32 v7, 4, v0
    v_add_u32 v7, s40, v7
    global_load_dwordx4 v[128:131], v7, s[8:9] offset:0
    global_load_dwordx4 v[132:135], v7, s[8:9] offset:1024
    global_load_dwordx4 v[136:139], v7, s[8:9] offset:2048
    global_load_dwordx4 v[140:143], v7, s[8:9] offset:3072
    global_load_dwordx4 v[144:147], v7, s[14:15] offset:0
    global_load_dwordx4 v[148:151], v7, s[14:15] offset:1024
    global_load_dwordx4 v[152:155], v7, s[14:15] offset:2048
    global_load_dwordx4 v[156:159], v7, s[14:15] offset:3072
    s_branch L_pfd
L_nopf:
L_pfd:
    s_cmp_lg_u32 s28, 0
    s_cbranch_scc1 L_norank2
    s_cmp_eq_u32 s97, 0
    s_cbranch_scc1 L_rk0
    s_waitcnt vmcnt(8)
    s_branch L_rk1
L_rk0:
    s_waitcnt vmcnt(0)
L_rk1:
    v_readfirstlane_b32 s29, v6
    s_mov_b32 s41, 0
    s_mov_b64 exec, 1
L_steal:
    s_cmp_lt_u32 s29, 32
    s_cbranch_scc1 L_gotrole
    s_add_u32 s41, s41, 1
    s_cmp_gt_u32 s41, 8
    s_cbranch_scc1 L_gotrole
    s_and_b32 s97, s41, 7
    s_lshl_b32 s40, s97, 2
    s_cmp_eq_u32 s97, 0
    s_cselect_b32 s40, 128, s40
    v_mov_b32 v3, s40
    global_atomic_add v6, v3, v4, s[24:25] sc0
    s_waitcnt vmcnt(0)
    v_readfirstlane_b32 s29, v6
    s_branch L_steal
L_gotrole:
    s_min_u32 s29, s29, 32
    s_lshl_b32 s40, s97, 8
    s_or_b32 s40, s40, s29
    v_mov_b32 v6, s40
    ds_write_b32 v5, v6
    s_waitcnt lgkmcnt(0)
    s_mov_b64 exec, -1
L_norank2:
    s_barrier
    ds_read_b32 v6, v5
    s_waitcnt lgkmcnt(0)
    v_readfirstlane_b32 s40, v6
    s_barrier
    s_and_b32 s29, s40, 0xff
    s_lshr_b32 s97, s40, 8
    s_cmp_ge_u32 s29, 32
    s_cbranch_scc1 L_fail
    s_lshl_b32 s96, s97, 5
    s_add_u32 s96, s96, s29
    s_cmp_lg_u32 s97, 0
    s_cbranch_scc1 L_worker
    v_mov_b32 v24, v0
    v_and_b32 v16, 15, v24
    v_lshrrev_b32 v17, 4, v24
    v_lshrrev_b32 v18, 5, v24
    v_and_b32 v19, 1, v17
    v_lshlrev_b32 v23, 4, v24
    v_and_b32 v21, 7, v24
    v_lshrrev_b32 v20, 3, v16
    v_lshlrev_b32 v20, 6, v20
    v_lshl_add_u32 v20, v18, 7, v20
    v_add_u32 v20, v20, v19
    v_and_b32 v22, 7, v16
    v_lshl_add_u32 v20, v22, 9, v20
    s_lshl_b32 s40, s28, 1
    v_add_u32 v20, s40, v20
    v_lshlrev_b32 v20, 1, v20
    global_load_ushort v96, v20, s[6:7] offset:0
    global_load_ushort v97, v20, s[6:7] offset:16
    global_load_ushort v98, v20, s[6:7] offset:32
    global_load_ushort v99, v20, s[6:7] offset:48
    global_load_ushort v100, v20, s[6:7] offset:64
    global_load_ushort v101, v20, s[6:7] offset:80
    global_load_ushort v102, v20, s[6:7] offset:96
    global_load_ushort v103, v20, s[6:7] offset:112
    global_load_ushort v104, v20, s[6:7] offset:512
    global_load_ushort v105, v20, s[6:7] offset:528
    global_load_ushort v106, v20, s[6:7] offset:544
    global_load_ushort v107, v20, s[6:7] offset:560
    global_load_ushort v108, v20, s[6:7] offset:576
    global_load_ushort v109, v20, s[6:7] offset:592
    global_load_ushort v110, v20, s[6:7] offset:608
    global_load_ushort v111, v20, s[6:7] offset:624
    s_mov_b32 s48, s8
    s_and_b32 s49, s9, 0xffff
    s_mov_b32 s50, 0x400000
    s_mov_b32 s51, 0x20000
    s_mov_b32 s52, s10
    s_and_b32 s53, s11, 0xffff
    s_mov_b32 s54, 0x400000
    s_mov_b32 s55, 0x20000
    s_mov_b32 s56, s12
    s_and_b32 s57, s13, 0xffff
    s_mov_b32 s58, 0x400000
    s_mov_b32 s59, 0x20000
    s_mov_b32 s60, s14
    s_and_b32 s61, s15, 0xffff
    s_mov_b32 s62, 0x400000
    s_mov_b32 s63, 0x20000
    s_lshl_b32 s40, s29, 8
    s_lshl_b32 s41, s28, 19
    s_add_u32 s40, s40, s41
    v_lshlrev_b32 v20, 13, v17
    v_lshl_add_u32 v20, v16, 4, v20
    v_add_u32 v112, s40, v20
    v_lshlrev_b32 v20, 5, v19
    v_add_u32 v20, v20, v18
    v_lshlrev_b32 v20, 8, v20
    v_lshl_add_u32 v20, v16, 2, v20
    s_lshl_b32 s40, s28, 6
    s_xor_b32 s41, s28, 0
    s_lshl_b32 s41, s41, 9
    s_add_u32 s41, s41, s40
    v_add_u32 v114, s41, v20
    v_add_u32 v115, 0x10000, v114
    s_xor_b32 s41, s28, 1
    s_lshl_b32 s41, s41, 9
    s_add_u32 s41, s41, s40
    v_add_u32 v116, s41, v20
    v_add_u32 v117, 0x10000, v116
    s_xor_b32 s41, s28, 2
    s_lshl_b32 s41, s41, 9
    s_add_u32 s41, s41, s40
    v_add_u32 v118, s41, v20
    v_add_u32 v119, 0x10000, v118
    s_xor_b32 s41, s28, 3
    s_lshl_b32 s41, s41, 9
    s_add_u32 s41, s41, s40
    v_add_u32 v120, s41, v20
    v_add_u32 v121, 0x10000, v120
    v_lshlrev_b32 v20, 12, v17
    v_lshl_add_u32 v20, v16, 4, v20
    s_lshl_b32 s40, s29, 17
    s_lshl_b32 s41, s28, 8
    s_add_u32 s40, s40, s41
    v_add_u32 v113, s40, v20
    s_lshl_b32 s40, s28, 14
    s_add_u32 m0, s40, 0x0
    s_mov_b32 s36, 0x0
    buffer_load_dwordx4 v112, s[48:51], s36 offen nt lds
    s_add_u32 m0, m0, 1024
    s_add_u32 s36, s36, 32768
    buffer_load_dwordx4 v112, s[48:51], s36 offen nt lds
    s_add_u32 m0, m0, 1024
    s_add_u32 s36, s36, 32768
    buffer_load_dwordx4 v112, s[48:51], s36 offen nt lds
    s_add_u32 m0, m0, 1024
    s_add_u32 s36, s36, 32768
    buffer_load_dwordx4 v112, s[48:51], s36 offen nt lds
    s_add_u32 m0, m0, 1024
    s_add_u32 s36, s36, 32768
    buffer_load_dwordx4 v112, s[48:51], s36 offen nt lds
    s_add_u32 m0, m0, 1024
    s_add_u32 s36, s36, 32768
    buffer_load_dwordx4 v112, s[48:51], s36 offen nt lds
    s_add_u32 m0, m0, 1024
    s_add_u32 s36, s36, 32768
    buffer_load_dwordx4 v112, s[48:51], s36 offen nt lds
    s_add_u32 m0, m0, 1024
    s_add_u32 s36, s36, 32768
    buffer_load_dwordx4 v112, s[48:51], s36 offen nt lds
    s_add_u32 m0, m0, 1024
    s_add_u32 s36, s36, 32768
    buffer_load_dwordx4 v112, s[48:51], s36 offen nt lds
    s_add_u32 m0, m0, 1024
    s_add_u32 s36, s36, 32768
    buffer_load_dwordx4 v112, s[48:51], s36 offen nt lds
    s_add_u32 m0, m0, 1024
    s_add_u32 s36, s36, 32768
    buffer_load_dwordx4 v112, s[48:51], s36 offen nt lds
    s_add_u32 m0, m0, 1024
    s_add_u32 s36, s36, 32768
    buffer_load_dwordx4 v112, s[48:51], s36 offen nt lds
    s_add_u32 m0, m0, 1024
    s_add_u32 s36, s36, 32768
    buffer_load_dwordx4 v112, s[48:51], s36 offen nt lds
    s_add_u32 m0, m0, 1024
    s_add_u32 s36, s36, 32768
    buffer_load_dwordx4 v112, s[48:51], s36 offen nt lds
    s_add_u32 m0, m0, 1024
    s_add_u32 s36, s36, 32768
    buffer_load_dwordx4 v112, s[48:51], s36 offen nt lds
    s_add_u32 m0, m0, 1024
    s_add_u32 s36, s36, 32768
    buffer_load_dwordx4 v112, s[48:51], s36 offen nt lds
    s_lshl_b32 s40, s28, 14
    s_add_u32 m0, s40, 0x10000
    s_mov_b32 s36, 0x200000
    buffer_load_dwordx4 v112, s[48:51], s36 offen nt lds
    s_add_u32 m0, m0, 1024
    s_add_u32 s36, s36, 32768
    buffer_load_dwordx4 v112, s[48:51], s36 offen nt lds
    s_add_u32 m0, m0, 1024
    s_add_u32 s36, s36, 32768
    buffer_load_dwordx4 v112, s[48:51], s36 offen nt lds
    s_add_u32 m0, m0, 1024
    s_add_u32 s36, s36, 32768
    buffer_load_dwordx4 v112, s[48:51], s36 offen nt lds
    s_add_u32 m0, m0, 1024
    s_add_u32 s36, s36, 32768
    buffer_load_dwordx4 v112, s[48:51], s36 offen nt lds
    s_add_u32 m0, m0, 1024
    s_add_u32 s36, s36, 32768
    buffer_load_dwordx4 v112, s[48:51], s36 offen nt lds
    s_add_u32 m0, m0, 1024
    s_add_u32 s36, s36, 32768
    buffer_load_dwordx4 v112, s[48:51], s36 offen nt lds
    s_add_u32 m0, m0, 1024
    s_add_u32 s36, s36, 32768
    buffer_load_dwordx4 v112, s[48:51], s36 offen nt lds
    s_add_u32 m0, m0, 1024
    s_add_u32 s36, s36, 32768
    buffer_load_dwordx4 v112, s[48:51], s36 offen nt lds
    s_add_u32 m0, m0, 1024
    s_add_u32 s36, s36, 32768
    buffer_load_dwordx4 v112, s[48:51], s36 offen nt lds
    s_add_u32 m0, m0, 1024
    s_add_u32 s36, s36, 32768
    buffer_load_dwordx4 v112, s[48:51], s36 offen nt lds
    s_add_u32 m0, m0, 1024
    s_add_u32 s36, s36, 32768
    buffer_load_dwordx4 v112, s[48:51], s36 offen nt lds
    s_add_u32 m0, m0, 1024
    s_add_u32 s36, s36, 32768
    buffer_load_dwordx4 v112, s[48:51], s36 offen nt lds
    s_add_u32 m0, m0, 1024
    s_add_u32 s36, s36, 32768
    buffer_load_dwordx4 v112, s[48:51], s36 offen nt lds
    s_add_u32 m0, m0, 1024
    s_add_u32 s36, s36, 32768
    buffer_load_dwordx4 v112, s[48:51], s36 offen nt lds
    s_add_u32 m0, m0, 1024
    s_add_u32 s36, s36, 32768
    buffer_load_dwordx4 v112, s[48:51], s36 offen nt lds
    v_mov_b32 v20, 0x4444
    v_mov_b32 v22, 0xeeee
    v_cmp_gt_u32 vcc, 8, v16
    s_nop 1
    v_cndmask_b32 v1, v22, v20, vcc
    v_lshrrev_b32 v20, 3, v16
    v_lshlrev_b32 v20, 1, v20
    v_lshl_add_u32 v20, v18, 2, v20
    v_add_u32 v20, v20, v19
    v_lshlrev_b32 v20, 13, v20
    v_lshl_add_u32 v20, v21, 3, v20
    s_lshl_b32 s40, s29, 6
    s_lshl_b32 s41, s28, 16
    s_add_u32 s41, s40, s41
    v_add_u32 v2, s41, v20
    v_and_b32 v20, 3, v16
    v_lshlrev_b32 v20, 4, v20
    v_lshl_add_u32 v20, v19, 3, v20
    v_lshl_add_u32 v20, v18, 2, v20
    s_lshl_b32 s41, s28, 11
    s_add_u32 s40, s40, s41
    v_add_u32 v3, s40, v20
    v_add_u32 v8, 0x22000, v23
    v_add_u32 v7, s41, v8
    v_lshrrev_b32 v20, 1, v21
    v_and_b32 v22, 1, v16
    v_lshlrev_b32 v22, 4, v22
    v_mov_b32 v25, 0x3f80
    v_lshlrev_b32 v25, v22, v25
    v_cmp_eq_u32 vcc, 0, v20
    s_nop 1
    v_cndmask_b32 v28, 0, v25, vcc
    v_cmp_eq_u32 vcc, 1, v20
    s_nop 1
    v_cndmask_b32 v29, 0, v25, vcc
    v_cmp_eq_u32 vcc, 2, v20
    s_nop 1
    v_cndmask_b32 v30, 0, v25, vcc
    v_cmp_eq_u32 vcc, 3, v20
    s_nop 1
    v_cndmask_b32 v31, 0, v25, vcc
    ds_write_b128 v8, v[28:31] offset:20480
    s_mul_i32 s40, s28, 34816
    v_add_u32 v4, s40, v23
    v_lshlrev_b32 v20, 5, v16
    v_lshl_add_u32 v20, v18, 4, v20
    v_lshl_add_u32 v20, v19, 3, v20
    s_lshl_b32 s40, s28, 9
    s_add_u32 s41, s40, 0x24000
    v_add_u32 v5, s41, v20
    v_lshrrev_b32 v20, 2, v16
    v_lshl_add_u32 v20, v17, 3, v20
    v_lshlrev_b32 v20, 4, v20
    v_and_b32 v22, 1, v16
    v_lshl_add_u32 v20, v22, 3, v20
    v_add_u32 v6, 0x24000, v20
    s_lshl_b32 s40, s29, 2
    s_add_u32 s40, s40, s28
    s_lshl_b32 s41, s40, 6
    s_add_u32 s41, s41, 0x302000
    v_mov_b32 v20, s41
    v_mov_b32 v21, 0x2000
    s_lshl_b32 s41, s28, 11
    s_lshl_b32 s40, s29, 13
    s_add_u32 s41, s41, s40
    s_add_u32 s41, s41, 0x2fc0000
    v_lshlrev_b32 v9, 6, v24
    v_add_u32 v9, s41, v9
    v_mov_b32 v10, 0x40000
    s_lshl_b32 s41, s29, 8
    s_add_u32 s41, s41, 0x400000
    v_mov_b32 v22, s41
    v_mov_b32 v21, 4
    v_cmp_le_u32 vcc, 2, v17
    s_nop 1
    v_cndmask_b32 v9, v9, v22, vcc
    v_cndmask_b32 v10, v10, v21, vcc
    s_mul_i32 s40, s29, 384
    s_add_u32 s40, s40, 0x4080fc
    v_mov_b32 v11, s40
    v_and_b32 v20, 1, v24
    v_bfe_u32 v21, v24, 1, 2
    v_lshl_add_u32 v20, v20, 2, v21
    v_lshlrev_b32 v20, 4, v20
    v_and_b32 v12, 0xffffff80, v7
    v_add_u32 v12, v12, v20
    s_add_u32 s72, s26, 0x1de000
    s_addc_u32 s73, s27, 0
    s_mov_b32 s100, 0xc0000
    s_lshl_b32 s101, s29, 13
    s_add_u32 s68, s72, s101
    s_addc_u32 s69, s73, 0
    s_add_u32 s68, s68, 0xc0000
    s_addc_u32 s69, s69, 0
    s_add_u32 s46, s26, 0x300000
    s_addc_u32 s47, s27, 0
    s_lshl_b32 s40, s29, 13
    s_add_u32 s78, s26, s40
    s_addc_u32 s79, s27, 0
    s_add_u32 s78, s78, 0x1fde000
    s_addc_u32 s79, s79, 0
    s_add_u32 s80, s26, s40
    s_addc_u32 s81, s27, 0
    s_add_u32 s80, s80, 0x2fde000
    s_addc_u32 s81, s81, 0
    s_add_u32 s82, s26, s40
    s_addc_u32 s83, s27, 0
    s_add_u32 s82, s82, 0x40de000
    s_addc_u32 s83, s83, 0
    s_mov_b32 s84, 0x3e0293ee
    s_mov_b32 s85, s84
    s_mov_b32 s86, 0x3f803f80
    s_mov_b32 s87, 0x3f803f80
    s_mov_b32 s98, 0x3f003f00
    s_mov_b32 s99, 0x3f003f00
    s_mov_b32 s44, 0x000f000f
    s_mov_b32 s45, 0x000f000f
    v_mov_b64 v[28:29], -1
    v_mov_b64 v[30:31], -1
    v_add_u32 v20, s101, v7
    global_store_dwordx4 v20, v[28:31], s[72:73] sc1
    global_store_dwordx4 v20, v[28:31], s[72:73] offset:1024 sc1
    v_add_u32 v20, 0x40000, v20
    global_store_dwordx4 v20, v[28:31], s[72:73] sc1
    global_store_dwordx4 v20, v[28:31], s[72:73] offset:1024 sc1
    v_add_u32 v20, 0x40000, v20
    global_store_dwordx4 v20, v[28:31], s[72:73] sc1
    global_store_dwordx4 v20, v[28:31], s[72:73] offset:1024 sc1
    v_add_u32 v20, 0x40000, v20
    global_store_dwordx4 v20, v[28:31], s[72:73] sc1
    global_store_dwordx4 v20, v[28:31], s[72:73] offset:1024 sc1
    v_add_u32 v20, 0x40000, v20
    v_mov_b32 v20, v3
    s_mov_b64 exec, s[44:45]
    global_store_dword v20, v28, s[46:47] sc1
    v_add_u32 v20, 0x2000, v20
    global_store_dword v20, v28, s[46:47] sc1
    v_add_u32 v20, 0x2000, v20
    global_store_dword v20, v28, s[46:47] sc1
    v_add_u32 v20, 0x2000, v20
    global_store_dword v20, v28, s[46:47] sc1
    v_add_u32 v20, 0x2000, v20
    s_mov_b64 exec, -1
    s_waitcnt vmcnt(28)
    s_barrier
    ds_read2st64_b32 v[20:21], v114 offset0:0 offset1:8
    ds_read2st64_b32 v[22:23], v114 offset0:64 offset1:72
    ds_read2st64_b32 v[24:25], v114 offset0:16 offset1:24
    ds_read2st64_b32 v[26:27], v114 offset0:80 offset1:88
    ds_read2st64_b32 v[28:29], v114 offset0:128 offset1:136
    ds_read2st64_b32 v[30:31], v114 offset0:192 offset1:200
    ds_read2st64_b32 v[32:33], v114 offset0:144 offset1:152
    ds_read2st64_b32 v[34:35], v114 offset0:208 offset1:216
    ds_read2st64_b32 v[36:37], v116 offset0:0 offset1:8
    ds_read2st64_b32 v[38:39], v116 offset0:64 offset1:72
    ds_read2st64_b32 v[40:41], v116 offset0:16 offset1:24
    ds_read2st64_b32 v[42:43], v116 offset0:80 offset1:88
    s_waitcnt lgkmcnt(11)
    v_perm_b32 v48, v21, v20, s37
    v_perm_b32 v56, v21, v20, s38
    ds_read2st64_b32 v[20:21], v116 offset0:128 offset1:136
    s_waitcnt lgkmcnt(11)
    v_perm_b32 v49, v23, v22, s37
    v_perm_b32 v57, v23, v22, s38
    ds_read2st64_b32 v[22:23], v116 offset0:192 offset1:200
    s_waitcnt lgkmcnt(11)
    v_perm_b32 v50, v25, v24, s37
    v_perm_b32 v58, v25, v24, s38
    ds_read2st64_b32 v[24:25], v116 offset0:144 offset1:152
    s_waitcnt lgkmcnt(11)
    v_perm_b32 v51, v27, v26, s37
    v_perm_b32 v59, v27, v26, s38
    ds_read2st64_b32 v[26:27], v116 offset0:208 offset1:216
    s_waitcnt lgkmcnt(11)
    v_perm_b32 v52, v29, v28, s37
    v_perm_b32 v60, v29, v28, s38
    ds_read2st64_b32 v[28:29], v118 offset0:0 offset1:8
    s_waitcnt lgkmcnt(11)
    v_perm_b32 v53, v31, v30, s37
    v_perm_b32 v61, v31, v30, s38
    ds_read2st64_b32 v[30:31], v118 offset0:64 offset1:72
    s_waitcnt lgkmcnt(11)
    v_perm_b32 v54, v33, v32, s37
    v_perm_b32 v62, v33, v32, s38
    ds_read2st64_b32 v[32:33], v118 offset0:16 offset1:24
    s_waitcnt lgkmcnt(11)
    v_perm_b32 v55, v35, v34, s37
    v_perm_b32 v63, v35, v34, s38
    ds_read2st64_b32 v[34:35], v118 offset0:80 offset1:88
    s_waitcnt lgkmcnt(11)
    v_perm_b32 v16, v37, v36, s37
    v_accvgpr_write_b32 a0, v16
    v_perm_b32 v17, v37, v36, s38
    v_accvgpr_write_b32 a8, v17
    ds_read2st64_b32 v[36:37], v118 offset0:128 offset1:136
    s_waitcnt lgkmcnt(11)
    v_perm_b32 v16, v39, v38, s37
    v_accvgpr_write_b32 a1, v16
    v_perm_b32 v17, v39, v38, s38
    v_accvgpr_write_b32 a9, v17
    ds_read2st64_b32 v[38:39], v118 offset0:192 offset1:200
    s_waitcnt lgkmcnt(11)
    v_perm_b32 v16, v41, v40, s37
    v_accvgpr_write_b32 a2, v16
    v_perm_b32 v17, v41, v40, s38
    v_accvgpr_write_b32 a10, v17
    ds_read2st64_b32 v[40:41], v118 offset0:144 offset1:152
    s_waitcnt lgkmcnt(11)
    v_perm_b32 v16, v43, v42, s37
    v_accvgpr_write_b32 a3, v16
    v_perm_b32 v17, v43, v42, s38
    v_accvgpr_write_b32 a11, v17
    ds_read2st64_b32 v[42:43], v118 offset0:208 offset1:216
    s_waitcnt lgkmcnt(11)
    v_perm_b32 v16, v21, v20, s37
    v_accvgpr_write_b32 a4, v16
    v_perm_b32 v17, v21, v20, s38
    v_accvgpr_write_b32 a12, v17
    ds_read2st64_b32 v[20:21], v120 offset0:0 offset1:8
    s_waitcnt lgkmcnt(11)
    v_perm_b32 v16, v23, v22, s37
    v_accvgpr_write_b32 a5, v16
    v_perm_b32 v17, v23, v22, s38
    v_accvgpr_write_b32 a13, v17
    ds_read2st64_b32 v[22:23], v120 offset0:64 offset1:72
    s_waitcnt lgkmcnt(11)
    v_perm_b32 v16, v25, v24, s37
    v_accvgpr_write_b32 a6, v16
    v_perm_b32 v17, v25, v24, s38
    v_accvgpr_write_b32 a14, v17
    ds_read2st64_b32 v[24:25], v120 offset0:16 offset1:24
    s_waitcnt lgkmcnt(11)
    v_perm_b32 v16, v27, v26, s37
    v_accvgpr_write_b32 a7, v16
    v_perm_b32 v17, v27, v26, s38
    v_accvgpr_write_b32 a15, v17
    ds_read2st64_b32 v[26:27], v120 offset0:80 offset1:88
    s_waitcnt lgkmcnt(11)
    v_perm_b32 v16, v29, v28, s37
    v_accvgpr_write_b32 a32, v16
    v_perm_b32 v17, v29, v28, s38
    v_accvgpr_write_b32 a40, v17
    ds_read2st64_b32 v[28:29], v120 offset0:128 offset1:136
    s_waitcnt lgkmcnt(11)
    v_perm_b32 v16, v31, v30, s37
    v_accvgpr_write_b32 a33, v16
    v_perm_b32 v17, v31, v30, s38
    v_accvgpr_write_b32 a41, v17
    ds_read2st64_b32 v[30:31], v120 offset0:192 offset1:200
    s_waitcnt lgkmcnt(11)
    v_perm_b32 v16, v33, v32, s37
    v_accvgpr_write_b32 a34, v16
    v_perm_b32 v17, v33, v32, s38
    v_accvgpr_write_b32 a42, v17
    ds_read2st64_b32 v[32:33], v120 offset0:144 offset1:152
    s_waitcnt lgkmcnt(11)
    v_perm_b32 v16, v35, v34, s37
    v_accvgpr_write_b32 a35, v16
    v_perm_b32 v17, v35, v34, s38
    v_accvgpr_write_b32 a43, v17
    ds_read2st64_b32 v[34:35], v120 offset0:208 offset1:216
    s_waitcnt lgkmcnt(11)
    v_perm_b32 v16, v37, v36, s37
    v_accvgpr_write_b32 a36, v16
    v_perm_b32 v17, v37, v36, s38
    v_accvgpr_write_b32 a44, v17
    s_waitcnt lgkmcnt(10)
    v_perm_b32 v16, v39, v38, s37
    v_accvgpr_write_b32 a37, v16
    v_perm_b32 v17, v39, v38, s38
    v_accvgpr_write_b32 a45, v17
    s_waitcnt lgkmcnt(9)
    v_perm_b32 v16, v41, v40, s37
    v_accvgpr_write_b32 a38, v16
    v_perm_b32 v17, v41, v40, s38
    v_accvgpr_write_b32 a46, v17
    s_waitcnt lgkmcnt(8)
    v_perm_b32 v16, v43, v42, s37
    v_accvgpr_write_b32 a39, v16
    v_perm_b32 v17, v43, v42, s38
    v_accvgpr_write_b32 a47, v17
    s_waitcnt lgkmcnt(7)
    v_perm_b32 v16, v21, v20, s37
    v_accvgpr_write_b32 a64, v16
    v_perm_b32 v17, v21, v20, s38
    v_accvgpr_write_b32 a72, v17
    s_waitcnt lgkmcnt(6)
    v_perm_b32 v16, v23, v22, s37
    v_accvgpr_write_b32 a65, v16
    v_perm_b32 v17, v23, v22, s38
    v_accvgpr_write_b32 a73, v17
    s_waitcnt lgkmcnt(5)
    v_perm_b32 v16, v25, v24, s37
    v_accvgpr_write_b32 a66, v16
    v_perm_b32 v17, v25, v24, s38
    v_accvgpr_write_b32 a74, v17
    s_waitcnt lgkmcnt(4)
    v_perm_b32 v16, v27, v26, s37
    v_accvgpr_write_b32 a67, v16
    v_perm_b32 v17, v27, v26, s38
    v_accvgpr_write_b32 a75, v17
    s_waitcnt lgkmcnt(3)
    v_perm_b32 v16, v29, v28, s37
    v_accvgpr_write_b32 a68, v16
    v_perm_b32 v17, v29, v28, s38
    v_accvgpr_write_b32 a76, v17
    s_waitcnt lgkmcnt(2)
    v_perm_b32 v16, v31, v30, s37
    v_accvgpr_write_b32 a69, v16
    v_perm_b32 v17, v31, v30, s38
    v_accvgpr_write_b32 a77, v17
    s_waitcnt lgkmcnt(1)
    v_perm_b32 v16, v33, v32, s37
    v_accvgpr_write_b32 a70, v16
    v_perm_b32 v17, v33, v32, s38
    v_accvgpr_write_b32 a78, v17
    s_waitcnt lgkmcnt(0)
    v_perm_b32 v16, v35, v34, s37
    v_accvgpr_write_b32 a71, v16
    v_perm_b32 v17, v35, v34, s38
    v_accvgpr_write_b32 a79, v17
    s_barrier
    s_lshl_b32 s40, s28, 14
    s_add_u32 m0, s40, 0x0
    s_mov_b32 s36, 0x0
    buffer_load_dwordx4 v112, s[52:55], s36 offen nt lds
    s_add_u32 m0, m0, 1024
    s_add_u32 s36, s36, 32768
    buffer_load_dwordx4 v112, s[52:55], s36 offen nt lds
    s_add_u32 m0, m0, 1024
    s_add_u32 s36, s36, 32768
    buffer_load_dwordx4 v112, s[52:55], s36 offen nt lds
    s_add_u32 m0, m0, 1024
    s_add_u32 s36, s36, 32768
    buffer_load_dwordx4 v112, s[52:55], s36 offen nt lds
    s_add_u32 m0, m0, 1024
    s_add_u32 s36, s36, 32768
    buffer_load_dwordx4 v112, s[52:55], s36 offen nt lds
    s_add_u32 m0, m0, 1024
    s_add_u32 s36, s36, 32768
    buffer_load_dwordx4 v112, s[52:55], s36 offen nt lds
    s_add_u32 m0, m0, 1024
    s_add_u32 s36, s36, 32768
    buffer_load_dwordx4 v112, s[52:55], s36 offen nt lds
    s_add_u32 m0, m0, 1024
    s_add_u32 s36, s36, 32768
    buffer_load_dwordx4 v112, s[52:55], s36 offen nt lds
    s_add_u32 m0, m0, 1024
    s_add_u32 s36, s36, 32768
    buffer_load_dwordx4 v112, s[52:55], s36 offen nt lds
    s_add_u32 m0, m0, 1024
    s_add_u32 s36, s36, 32768
    buffer_load_dwordx4 v112, s[52:55], s36 offen nt lds
    s_add_u32 m0, m0, 1024
    s_add_u32 s36, s36, 32768
    buffer_load_dwordx4 v112, s[52:55], s36 offen nt lds
    s_add_u32 m0, m0, 1024
    s_add_u32 s36, s36, 32768
    buffer_load_dwordx4 v112, s[52:55], s36 offen nt lds
    s_add_u32 m0, m0, 1024
    s_add_u32 s36, s36, 32768
    buffer_load_dwordx4 v112, s[52:55], s36 offen nt lds
    s_add_u32 m0, m0, 1024
    s_add_u32 s36, s36, 32768
    buffer_load_dwordx4 v112, s[52:55], s36 offen nt lds
    s_add_u32 m0, m0, 1024
    s_add_u32 s36, s36, 32768
    buffer_load_dwordx4 v112, s[52:55], s36 offen nt lds
    s_add_u32 m0, m0, 1024
    s_add_u32 s36, s36, 32768
    buffer_load_dwordx4 v112, s[52:55], s36 offen nt lds
    v_lshl_or_b32 v96, v97, 16, v96
    v_lshl_or_b32 v97, v99, 16, v98
    v_lshl_or_b32 v98, v101, 16, v100
    v_lshl_or_b32 v99, v103, 16, v102
    v_lshl_or_b32 v100, v105, 16, v104
    v_lshl_or_b32 v101, v107, 16, v106
    v_lshl_or_b32 v102, v109, 16, v108
    v_lshl_or_b32 v103, v111, 16, v110
    ds_write_b128 v7, v[96:99]
    ds_write_b128 v7, v[100:103] offset:1024
    s_waitcnt vmcnt(16)
    s_barrier
    ds_read2st64_b32 v[20:21], v115 offset0:0 offset1:8
    ds_read2st64_b32 v[22:23], v115 offset0:64 offset1:72
    ds_read2st64_b32 v[24:25], v115 offset0:16 offset1:24
    ds_read2st64_b32 v[26:27], v115 offset0:80 offset1:88
    ds_read2st64_b32 v[28:29], v115 offset0:128 offset1:136
    ds_read2st64_b32 v[30:31], v115 offset0:192 offset1:200
    ds_read2st64_b32 v[32:33], v115 offset0:144 offset1:152
    ds_read2st64_b32 v[34:35], v115 offset0:208 offset1:216
    ds_read2st64_b32 v[36:37], v117 offset0:0 offset1:8
    ds_read2st64_b32 v[38:39], v117 offset0:64 offset1:72
    ds_read2st64_b32 v[40:41], v117 offset0:16 offset1:24
    ds_read2st64_b32 v[42:43], v117 offset0:80 offset1:88
    s_waitcnt lgkmcnt(11)
    v_perm_b32 v64, v21, v20, s37
    v_perm_b32 v72, v21, v20, s38
    ds_read2st64_b32 v[20:21], v117 offset0:128 offset1:136
    s_waitcnt lgkmcnt(11)
    v_perm_b32 v65, v23, v22, s37
    v_perm_b32 v73, v23, v22, s38
    ds_read2st64_b32 v[22:23], v117 offset0:192 offset1:200
    s_waitcnt lgkmcnt(11)
    v_perm_b32 v66, v25, v24, s37
    v_perm_b32 v74, v25, v24, s38
    ds_read2st64_b32 v[24:25], v117 offset0:144 offset1:152
    s_waitcnt lgkmcnt(11)
    v_perm_b32 v67, v27, v26, s37
    v_perm_b32 v75, v27, v26, s38
    ds_read2st64_b32 v[26:27], v117 offset0:208 offset1:216
    s_waitcnt lgkmcnt(11)
    v_perm_b32 v68, v29, v28, s37
    v_perm_b32 v76, v29, v28, s38
    ds_read2st64_b32 v[28:29], v119 offset0:0 offset1:8
    s_waitcnt lgkmcnt(11)
    v_perm_b32 v69, v31, v30, s37
    v_perm_b32 v77, v31, v30, s38
    ds_read2st64_b32 v[30:31], v119 offset0:64 offset1:72
    s_waitcnt lgkmcnt(11)
    v_perm_b32 v70, v33, v32, s37
    v_perm_b32 v78, v33, v32, s38
    ds_read2st64_b32 v[32:33], v119 offset0:16 offset1:24
    s_waitcnt lgkmcnt(11)
    v_perm_b32 v71, v35, v34, s37
    v_perm_b32 v79, v35, v34, s38
    ds_read2st64_b32 v[34:35], v119 offset0:80 offset1:88
    s_waitcnt lgkmcnt(11)
    v_perm_b32 v16, v37, v36, s37
    v_accvgpr_write_b32 a16, v16
    v_perm_b32 v17, v37, v36, s38
    v_accvgpr_write_b32 a24, v17
    ds_read2st64_b32 v[36:37], v119 offset0:128 offset1:136
    s_waitcnt lgkmcnt(11)
    v_perm_b32 v16, v39, v38, s37
    v_accvgpr_write_b32 a17, v16
    v_perm_b32 v17, v39, v38, s38
    v_accvgpr_write_b32 a25, v17
    ds_read2st64_b32 v[38:39], v119 offset0:192 offset1:200
    s_waitcnt lgkmcnt(11)
    v_perm_b32 v16, v41, v40, s37
    v_accvgpr_write_b32 a18, v16
    v_perm_b32 v17, v41, v40, s38
    v_accvgpr_write_b32 a26, v17
    ds_read2st64_b32 v[40:41], v119 offset0:144 offset1:152
    s_waitcnt lgkmcnt(11)
    v_perm_b32 v16, v43, v42, s37
    v_accvgpr_write_b32 a19, v16
    v_perm_b32 v17, v43, v42, s38
    v_accvgpr_write_b32 a27, v17
    ds_read2st64_b32 v[42:43], v119 offset0:208 offset1:216
    s_waitcnt lgkmcnt(11)
    v_perm_b32 v16, v21, v20, s37
    v_accvgpr_write_b32 a20, v16
    v_perm_b32 v17, v21, v20, s38
    v_accvgpr_write_b32 a28, v17
    ds_read2st64_b32 v[20:21], v121 offset0:0 offset1:8
    s_waitcnt lgkmcnt(11)
    v_perm_b32 v16, v23, v22, s37
    v_accvgpr_write_b32 a21, v16
    v_perm_b32 v17, v23, v22, s38
    v_accvgpr_write_b32 a29, v17
    ds_read2st64_b32 v[22:23], v121 offset0:64 offset1:72
    s_waitcnt lgkmcnt(11)
    v_perm_b32 v16, v25, v24, s37
    v_accvgpr_write_b32 a22, v16
    v_perm_b32 v17, v25, v24, s38
    v_accvgpr_write_b32 a30, v17
    ds_read2st64_b32 v[24:25], v121 offset0:16 offset1:24
    s_waitcnt lgkmcnt(11)
    v_perm_b32 v16, v27, v26, s37
    v_accvgpr_write_b32 a23, v16
    v_perm_b32 v17, v27, v26, s38
    v_accvgpr_write_b32 a31, v17
    ds_read2st64_b32 v[26:27], v121 offset0:80 offset1:88
    s_waitcnt lgkmcnt(11)
    v_perm_b32 v16, v29, v28, s37
    v_accvgpr_write_b32 a48, v16
    v_perm_b32 v17, v29, v28, s38
    v_accvgpr_write_b32 a56, v17
    ds_read2st64_b32 v[28:29], v121 offset0:128 offset1:136
    s_waitcnt lgkmcnt(11)
    v_perm_b32 v16, v31, v30, s37
    v_accvgpr_write_b32 a49, v16
    v_perm_b32 v17, v31, v30, s38
    v_accvgpr_write_b32 a57, v17
    ds_read2st64_b32 v[30:31], v121 offset0:192 offset1:200
    s_waitcnt lgkmcnt(11)
    v_perm_b32 v16, v33, v32, s37
    v_accvgpr_write_b32 a50, v16
    v_perm_b32 v17, v33, v32, s38
    v_accvgpr_write_b32 a58, v17
    ds_read2st64_b32 v[32:33], v121 offset0:144 offset1:152
    s_waitcnt lgkmcnt(11)
    v_perm_b32 v16, v35, v34, s37
    v_accvgpr_write_b32 a51, v16
    v_perm_b32 v17, v35, v34, s38
    v_accvgpr_write_b32 a59, v17
    ds_read2st64_b32 v[34:35], v121 offset0:208 offset1:216
    s_waitcnt lgkmcnt(11)
    v_perm_b32 v16, v37, v36, s37
    v_accvgpr_write_b32 a52, v16
    v_perm_b32 v17, v37, v36, s38
    v_accvgpr_write_b32 a60, v17
    s_waitcnt lgkmcnt(10)
    v_perm_b32 v16, v39, v38, s37
    v_accvgpr_write_b32 a53, v16
    v_perm_b32 v17, v39, v38, s38
    v_accvgpr_write_b32 a61, v17
    s_waitcnt lgkmcnt(9)
    v_perm_b32 v16, v41, v40, s37
    v_accvgpr_write_b32 a54, v16
    v_perm_b32 v17, v41, v40, s38
    v_accvgpr_write_b32 a62, v17
    s_waitcnt lgkmcnt(8)
    v_perm_b32 v16, v43, v42, s37
    v_accvgpr_write_b32 a55, v16
    v_perm_b32 v17, v43, v42, s38
    v_accvgpr_write_b32 a63, v17
    s_waitcnt lgkmcnt(7)
    v_perm_b32 v16, v21, v20, s37
    v_accvgpr_write_b32 a80, v16
    v_perm_b32 v17, v21, v20, s38
    v_accvgpr_write_b32 a88, v17
    s_waitcnt lgkmcnt(6)
    v_perm_b32 v16, v23, v22, s37
    v_accvgpr_write_b32 a81, v16
    v_perm_b32 v17, v23, v22, s38
    v_accvgpr_write_b32 a89, v17
    s_waitcnt lgkmcnt(5)
    v_perm_b32 v16, v25, v24, s37
    v_accvgpr_write_b32 a82, v16
    v_perm_b32 v17, v25, v24, s38
    v_accvgpr_write_b32 a90, v17
    s_waitcnt lgkmcnt(4)
    v_perm_b32 v16, v27, v26, s37
    v_accvgpr_write_b32 a83, v16
    v_perm_b32 v17, v27, v26, s38
    v_accvgpr_write_b32 a91, v17
    s_waitcnt lgkmcnt(3)
    v_perm_b32 v16, v29, v28, s37
    v_accvgpr_write_b32 a84, v16
    v_perm_b32 v17, v29, v28, s38
    v_accvgpr_write_b32 a92, v17
    s_waitcnt lgkmcnt(2)
    v_perm_b32 v16, v31, v30, s37
    v_accvgpr_write_b32 a85, v16
    v_perm_b32 v17, v31, v30, s38
    v_accvgpr_write_b32 a93, v17
    s_waitcnt lgkmcnt(1)
    v_perm_b32 v16, v33, v32, s37
    v_accvgpr_write_b32 a86, v16
    v_perm_b32 v17, v33, v32, s38
    v_accvgpr_write_b32 a94, v17
    s_waitcnt lgkmcnt(0)
    v_perm_b32 v16, v35, v34, s37
    v_accvgpr_write_b32 a87, v16
    v_perm_b32 v17, v35, v34, s38
    v_accvgpr_write_b32 a95, v17
    s_barrier
    s_lshl_b32 s40, s28, 14
    s_add_u32 m0, s40, 0x10000
    s_mov_b32 s36, 0x200000
    buffer_load_dwordx4 v112, s[52:55], s36 offen nt lds
    s_add_u32 m0, m0, 1024
    s_add_u32 s36, s36, 32768
    buffer_load_dwordx4 v112, s[52:55], s36 offen nt lds
    s_add_u32 m0, m0, 1024
    s_add_u32 s36, s36, 32768
    buffer_load_dwordx4 v112, s[52:55], s36 offen nt lds
    s_add_u32 m0, m0, 1024
    s_add_u32 s36, s36, 32768
    buffer_load_dwordx4 v112, s[52:55], s36 offen nt lds
    s_add_u32 m0, m0, 1024
    s_add_u32 s36, s36, 32768
    buffer_load_dwordx4 v112, s[52:55], s36 offen nt lds
    s_add_u32 m0, m0, 1024
    s_add_u32 s36, s36, 32768
    buffer_load_dwordx4 v112, s[52:55], s36 offen nt lds
    s_add_u32 m0, m0, 1024
    s_add_u32 s36, s36, 32768
    buffer_load_dwordx4 v112, s[52:55], s36 offen nt lds
    s_add_u32 m0, m0, 1024
    s_add_u32 s36, s36, 32768
    buffer_load_dwordx4 v112, s[52:55], s36 offen nt lds
    s_add_u32 m0, m0, 1024
    s_add_u32 s36, s36, 32768
    buffer_load_dwordx4 v112, s[52:55], s36 offen nt lds
    s_add_u32 m0, m0, 1024
    s_add_u32 s36, s36, 32768
    buffer_load_dwordx4 v112, s[52:55], s36 offen nt lds
    s_add_u32 m0, m0, 1024
    s_add_u32 s36, s36, 32768
    buffer_load_dwordx4 v112, s[52:55], s36 offen nt lds
    s_add_u32 m0, m0, 1024
    s_add_u32 s36, s36, 32768
    buffer_load_dwordx4 v112, s[52:55], s36 offen nt lds
    s_add_u32 m0, m0, 1024
    s_add_u32 s36, s36, 32768
    buffer_load_dwordx4 v112, s[52:55], s36 offen nt lds
    s_add_u32 m0, m0, 1024
    s_add_u32 s36, s36, 32768
    buffer_load_dwordx4 v112, s[52:55], s36 offen nt lds
    s_add_u32 m0, m0, 1024
    s_add_u32 s36, s36, 32768
    buffer_load_dwordx4 v112, s[52:55], s36 offen nt lds
    s_add_u32 m0, m0, 1024
    s_add_u32 s36, s36, 32768
    buffer_load_dwordx4 v112, s[52:55], s36 offen nt lds
    s_waitcnt vmcnt(16)
    s_barrier
    ds_read2st64_b32 v[20:21], v114 offset0:0 offset1:8
    ds_read2st64_b32 v[22:23], v114 offset0:64 offset1:72
    ds_read2st64_b32 v[24:25], v114 offset0:16 offset1:24
    ds_read2st64_b32 v[26:27], v114 offset0:80 offset1:88
    ds_read2st64_b32 v[28:29], v114 offset0:128 offset1:136
    ds_read2st64_b32 v[30:31], v114 offset0:192 offset1:200
    ds_read2st64_b32 v[32:33], v114 offset0:144 offset1:152
    ds_read2st64_b32 v[34:35], v114 offset0:208 offset1:216
    ds_read2st64_b32 v[36:37], v116 offset0:0 offset1:8
    ds_read2st64_b32 v[38:39], v116 offset0:64 offset1:72
    ds_read2st64_b32 v[40:41], v116 offset0:16 offset1:24
    ds_read2st64_b32 v[42:43], v116 offset0:80 offset1:88
    s_waitcnt lgkmcnt(11)
    v_perm_b32 v16, v21, v20, s37
    v_accvgpr_write_b32 a96, v16
    v_perm_b32 v17, v21, v20, s38
    v_accvgpr_write_b32 a104, v17
    ds_read2st64_b32 v[20:21], v116 offset0:128 offset1:136
    s_waitcnt lgkmcnt(11)
    v_perm_b32 v16, v23, v22, s37
    v_accvgpr_write_b32 a97, v16
    v_perm_b32 v17, v23, v22, s38
    v_accvgpr_write_b32 a105, v17
    ds_read2st64_b32 v[22:23], v116 offset0:192 offset1:200
    s_waitcnt lgkmcnt(11)
    v_perm_b32 v16, v25, v24, s37
    v_accvgpr_write_b32 a98, v16
    v_perm_b32 v17, v25, v24, s38
    v_accvgpr_write_b32 a106, v17
    ds_read2st64_b32 v[24:25], v116 offset0:144 offset1:152
    s_waitcnt lgkmcnt(11)
    v_perm_b32 v16, v27, v26, s37
    v_accvgpr_write_b32 a99, v16
    v_perm_b32 v17, v27, v26, s38
    v_accvgpr_write_b32 a107, v17
    ds_read2st64_b32 v[26:27], v116 offset0:208 offset1:216
    s_waitcnt lgkmcnt(11)
    v_perm_b32 v16, v29, v28, s37
    v_accvgpr_write_b32 a100, v16
    v_perm_b32 v17, v29, v28, s38
    v_accvgpr_write_b32 a108, v17
    ds_read2st64_b32 v[28:29], v118 offset0:0 offset1:8
    s_waitcnt lgkmcnt(11)
    v_perm_b32 v16, v31, v30, s37
    v_accvgpr_write_b32 a101, v16
    v_perm_b32 v17, v31, v30, s38
    v_accvgpr_write_b32 a109, v17
    ds_read2st64_b32 v[30:31], v118 offset0:64 offset1:72
    s_waitcnt lgkmcnt(11)
    v_perm_b32 v16, v33, v32, s37
    v_accvgpr_write_b32 a102, v16
    v_perm_b32 v17, v33, v32, s38
    v_accvgpr_write_b32 a110, v17
    ds_read2st64_b32 v[32:33], v118 offset0:16 offset1:24
    s_waitcnt lgkmcnt(11)
    v_perm_b32 v16, v35, v34, s37
    v_accvgpr_write_b32 a103, v16
    v_perm_b32 v17, v35, v34, s38
    v_accvgpr_write_b32 a111, v17
    ds_read2st64_b32 v[34:35], v118 offset0:80 offset1:88
    s_waitcnt lgkmcnt(11)
    v_perm_b32 v80, v37, v36, s37
    v_perm_b32 v88, v37, v36, s38
    ds_read2st64_b32 v[36:37], v118 offset0:128 offset1:136
    s_waitcnt lgkmcnt(11)
    v_perm_b32 v81, v39, v38, s37
    v_perm_b32 v89, v39, v38, s38
    ds_read2st64_b32 v[38:39], v118 offset0:192 offset1:200
    s_waitcnt lgkmcnt(11)
    v_perm_b32 v82, v41, v40, s37
    v_perm_b32 v90, v41, v40, s38
    ds_read2st64_b32 v[40:41], v118 offset0:144 offset1:152
    s_waitcnt lgkmcnt(11)
    v_perm_b32 v83, v43, v42, s37
    v_perm_b32 v91, v43, v42, s38
    ds_read2st64_b32 v[42:43], v118 offset0:208 offset1:216
    s_waitcnt lgkmcnt(11)
    v_perm_b32 v84, v21, v20, s37
    v_perm_b32 v92, v21, v20, s38
    ds_read2st64_b32 v[20:21], v120 offset0:0 offset1:8
    s_waitcnt lgkmcnt(11)
    v_perm_b32 v85, v23, v22, s37
    v_perm_b32 v93, v23, v22, s38
    ds_read2st64_b32 v[22:23], v120 offset0:64 offset1:72
    s_waitcnt lgkmcnt(11)
    v_perm_b32 v86, v25, v24, s37
    v_perm_b32 v94, v25, v24, s38
    ds_read2st64_b32 v[24:25], v120 offset0:16 offset1:24
    s_waitcnt lgkmcnt(11)
    v_perm_b32 v87, v27, v26, s37
    v_perm_b32 v95, v27, v26, s38
    ds_read2st64_b32 v[26:27], v120 offset0:80 offset1:88
    s_waitcnt lgkmcnt(11)
    v_perm_b32 v16, v29, v28, s37
    v_accvgpr_write_b32 a128, v16
    v_perm_b32 v17, v29, v28, s38
    v_accvgpr_write_b32 a136, v17
    ds_read2st64_b32 v[28:29], v120 offset0:128 offset1:136
    s_waitcnt lgkmcnt(11)
    v_perm_b32 v16, v31, v30, s37
    v_accvgpr_write_b32 a129, v16
    v_perm_b32 v17, v31, v30, s38
    v_accvgpr_write_b32 a137, v17
    ds_read2st64_b32 v[30:31], v120 offset0:192 offset1:200
    s_waitcnt lgkmcnt(11)
    v_perm_b32 v16, v33, v32, s37
    v_accvgpr_write_b32 a130, v16
    v_perm_b32 v17, v33, v32, s38
    v_accvgpr_write_b32 a138, v17
    ds_read2st64_b32 v[32:33], v120 offset0:144 offset1:152
    s_waitcnt lgkmcnt(11)
    v_perm_b32 v16, v35, v34, s37
    v_accvgpr_write_b32 a131, v16
    v_perm_b32 v17, v35, v34, s38
    v_accvgpr_write_b32 a139, v17
    ds_read2st64_b32 v[34:35], v120 offset0:208 offset1:216
    s_waitcnt lgkmcnt(11)
    v_perm_b32 v16, v37, v36, s37
    v_accvgpr_write_b32 a132, v16
    v_perm_b32 v17, v37, v36, s38
    v_accvgpr_write_b32 a140, v17
    s_waitcnt lgkmcnt(10)
    v_perm_b32 v16, v39, v38, s37
    v_accvgpr_write_b32 a133, v16
    v_perm_b32 v17, v39, v38, s38
    v_accvgpr_write_b32 a141, v17
    s_waitcnt lgkmcnt(9)
    v_perm_b32 v16, v41, v40, s37
    v_accvgpr_write_b32 a134, v16
    v_perm_b32 v17, v41, v40, s38
    v_accvgpr_write_b32 a142, v17
    s_waitcnt lgkmcnt(8)
    v_perm_b32 v16, v43, v42, s37
    v_accvgpr_write_b32 a135, v16
    v_perm_b32 v17, v43, v42, s38
    v_accvgpr_write_b32 a143, v17
    s_waitcnt lgkmcnt(7)
    v_perm_b32 v16, v21, v20, s37
    v_accvgpr_write_b32 a160, v16
    v_perm_b32 v17, v21, v20, s38
    v_accvgpr_write_b32 a168, v17
    s_waitcnt lgkmcnt(6)
    v_perm_b32 v16, v23, v22, s37
    v_accvgpr_write_b32 a161, v16
    v_perm_b32 v17, v23, v22, s38
    v_accvgpr_write_b32 a169, v17
    s_waitcnt lgkmcnt(5)
    v_perm_b32 v16, v25, v24, s37
    v_accvgpr_write_b32 a162, v16
    v_perm_b32 v17, v25, v24, s38
    v_accvgpr_write_b32 a170, v17
    s_waitcnt lgkmcnt(4)
    v_perm_b32 v16, v27, v26, s37
    v_accvgpr_write_b32 a163, v16
    v_perm_b32 v17, v27, v26, s38
    v_accvgpr_write_b32 a171, v17
    s_waitcnt lgkmcnt(3)
    v_perm_b32 v16, v29, v28, s37
    v_accvgpr_write_b32 a164, v16
    v_perm_b32 v17, v29, v28, s38
    v_accvgpr_write_b32 a172, v17
    s_waitcnt lgkmcnt(2)
    v_perm_b32 v16, v31, v30, s37
    v_accvgpr_write_b32 a165, v16
    v_perm_b32 v17, v31, v30, s38
    v_accvgpr_write_b32 a173, v17
    s_waitcnt lgkmcnt(1)
    v_perm_b32 v16, v33, v32, s37
    v_accvgpr_write_b32 a166, v16
    v_perm_b32 v17, v33, v32, s38
    v_accvgpr_write_b32 a174, v17
    s_waitcnt lgkmcnt(0)
    v_perm_b32 v16, v35, v34, s37
    v_accvgpr_write_b32 a167, v16
    v_perm_b32 v17, v35, v34, s38
    v_accvgpr_write_b32 a175, v17
    s_barrier
    s_lshl_b32 s40, s28, 14
    s_add_u32 m0, s40, 0x0
    s_mov_b32 s36, 0x0
    buffer_load_dwordx4 v112, s[56:59], s36 offen nt lds
    s_add_u32 m0, m0, 1024
    s_add_u32 s36, s36, 32768
    buffer_load_dwordx4 v112, s[56:59], s36 offen nt lds
    s_add_u32 m0, m0, 1024
    s_add_u32 s36, s36, 32768
    buffer_load_dwordx4 v112, s[56:59], s36 offen nt lds
    s_add_u32 m0, m0, 1024
    s_add_u32 s36, s36, 32768
    buffer_load_dwordx4 v112, s[56:59], s36 offen nt lds
    s_add_u32 m0, m0, 1024
    s_add_u32 s36, s36, 32768
    buffer_load_dwordx4 v112, s[56:59], s36 offen nt lds
    s_add_u32 m0, m0, 1024
    s_add_u32 s36, s36, 32768
    buffer_load_dwordx4 v112, s[56:59], s36 offen nt lds
    s_add_u32 m0, m0, 1024
    s_add_u32 s36, s36, 32768
    buffer_load_dwordx4 v112, s[56:59], s36 offen nt lds
    s_add_u32 m0, m0, 1024
    s_add_u32 s36, s36, 32768
    buffer_load_dwordx4 v112, s[56:59], s36 offen nt lds
    s_add_u32 m0, m0, 1024
    s_add_u32 s36, s36, 32768
    buffer_load_dwordx4 v112, s[56:59], s36 offen nt lds
    s_add_u32 m0, m0, 1024
    s_add_u32 s36, s36, 32768
    buffer_load_dwordx4 v112, s[56:59], s36 offen nt lds
    s_add_u32 m0, m0, 1024
    s_add_u32 s36, s36, 32768
    buffer_load_dwordx4 v112, s[56:59], s36 offen nt lds
    s_add_u32 m0, m0, 1024
    s_add_u32 s36, s36, 32768
    buffer_load_dwordx4 v112, s[56:59], s36 offen nt lds
    s_add_u32 m0, m0, 1024
    s_add_u32 s36, s36, 32768
    buffer_load_dwordx4 v112, s[56:59], s36 offen nt lds
    s_add_u32 m0, m0, 1024
    s_add_u32 s36, s36, 32768
    buffer_load_dwordx4 v112, s[56:59], s36 offen nt lds
    s_add_u32 m0, m0, 1024
    s_add_u32 s36, s36, 32768
    buffer_load_dwordx4 v112, s[56:59], s36 offen nt lds
    s_add_u32 m0, m0, 1024
    s_add_u32 s36, s36, 32768
    buffer_load_dwordx4 v112, s[56:59], s36 offen nt lds
    s_waitcnt vmcnt(16)
    s_barrier
    ds_read2st64_b32 v[20:21], v115 offset0:0 offset1:8
    ds_read2st64_b32 v[22:23], v115 offset0:64 offset1:72
    ds_read2st64_b32 v[24:25], v115 offset0:16 offset1:24
    ds_read2st64_b32 v[26:27], v115 offset0:80 offset1:88
    ds_read2st64_b32 v[28:29], v115 offset0:128 offset1:136
    ds_read2st64_b32 v[30:31], v115 offset0:192 offset1:200
    ds_read2st64_b32 v[32:33], v115 offset0:144 offset1:152
    ds_read2st64_b32 v[34:35], v115 offset0:208 offset1:216
    ds_read2st64_b32 v[36:37], v117 offset0:0 offset1:8
    ds_read2st64_b32 v[38:39], v117 offset0:64 offset1:72
    ds_read2st64_b32 v[40:41], v117 offset0:16 offset1:24
    ds_read2st64_b32 v[42:43], v117 offset0:80 offset1:88
    s_waitcnt lgkmcnt(11)
    v_perm_b32 v16, v21, v20, s37
    v_accvgpr_write_b32 a112, v16
    v_perm_b32 v17, v21, v20, s38
    v_accvgpr_write_b32 a120, v17
    ds_read2st64_b32 v[20:21], v117 offset0:128 offset1:136
    s_waitcnt lgkmcnt(11)
    v_perm_b32 v16, v23, v22, s37
    v_accvgpr_write_b32 a113, v16
    v_perm_b32 v17, v23, v22, s38
    v_accvgpr_write_b32 a121, v17
    ds_read2st64_b32 v[22:23], v117 offset0:192 offset1:200
    s_waitcnt lgkmcnt(11)
    v_perm_b32 v16, v25, v24, s37
    v_accvgpr_write_b32 a114, v16
    v_perm_b32 v17, v25, v24, s38
    v_accvgpr_write_b32 a122, v17
    ds_read2st64_b32 v[24:25], v117 offset0:144 offset1:152
    s_waitcnt lgkmcnt(11)
    v_perm_b32 v16, v27, v26, s37
    v_accvgpr_write_b32 a115, v16
    v_perm_b32 v17, v27, v26, s38
    v_accvgpr_write_b32 a123, v17
    ds_read2st64_b32 v[26:27], v117 offset0:208 offset1:216
    s_waitcnt lgkmcnt(11)
    v_perm_b32 v16, v29, v28, s37
    v_accvgpr_write_b32 a116, v16
    v_perm_b32 v17, v29, v28, s38
    v_accvgpr_write_b32 a124, v17
    ds_read2st64_b32 v[28:29], v119 offset0:0 offset1:8
    s_waitcnt lgkmcnt(11)
    v_perm_b32 v16, v31, v30, s37
    v_accvgpr_write_b32 a117, v16
    v_perm_b32 v17, v31, v30, s38
    v_accvgpr_write_b32 a125, v17
    ds_read2st64_b32 v[30:31], v119 offset0:64 offset1:72
    s_waitcnt lgkmcnt(11)
    v_perm_b32 v16, v33, v32, s37
    v_accvgpr_write_b32 a118, v16
    v_perm_b32 v17, v33, v32, s38
    v_accvgpr_write_b32 a126, v17
    ds_read2st64_b32 v[32:33], v119 offset0:16 offset1:24
    s_waitcnt lgkmcnt(11)
    v_perm_b32 v16, v35, v34, s37
    v_accvgpr_write_b32 a119, v16
    v_perm_b32 v17, v35, v34, s38
    v_accvgpr_write_b32 a127, v17
    ds_read2st64_b32 v[34:35], v119 offset0:80 offset1:88
    s_waitcnt lgkmcnt(11)
    v_perm_b32 v96, v37, v36, s37
    v_perm_b32 v104, v37, v36, s38
    ds_read2st64_b32 v[36:37], v119 offset0:128 offset1:136
    s_waitcnt lgkmcnt(11)
    v_perm_b32 v97, v39, v38, s37
    v_perm_b32 v105, v39, v38, s38
    ds_read2st64_b32 v[38:39], v119 offset0:192 offset1:200
    s_waitcnt lgkmcnt(11)
    v_perm_b32 v98, v41, v40, s37
    v_perm_b32 v106, v41, v40, s38
    ds_read2st64_b32 v[40:41], v119 offset0:144 offset1:152
    s_waitcnt lgkmcnt(11)
    v_perm_b32 v99, v43, v42, s37
    v_perm_b32 v107, v43, v42, s38
    ds_read2st64_b32 v[42:43], v119 offset0:208 offset1:216
    s_waitcnt lgkmcnt(11)
    v_perm_b32 v100, v21, v20, s37
    v_perm_b32 v108, v21, v20, s38
    ds_read2st64_b32 v[20:21], v121 offset0:0 offset1:8
    s_waitcnt lgkmcnt(11)
    v_perm_b32 v101, v23, v22, s37
    v_perm_b32 v109, v23, v22, s38
    ds_read2st64_b32 v[22:23], v121 offset0:64 offset1:72
    s_waitcnt lgkmcnt(11)
    v_perm_b32 v102, v25, v24, s37
    v_perm_b32 v110, v25, v24, s38
    ds_read2st64_b32 v[24:25], v121 offset0:16 offset1:24
    s_waitcnt lgkmcnt(11)
    v_perm_b32 v103, v27, v26, s37
    v_perm_b32 v111, v27, v26, s38
    ds_read2st64_b32 v[26:27], v121 offset0:80 offset1:88
    s_waitcnt lgkmcnt(11)
    v_perm_b32 v16, v29, v28, s37
    v_accvgpr_write_b32 a144, v16
    v_perm_b32 v17, v29, v28, s38
    v_accvgpr_write_b32 a152, v17
    ds_read2st64_b32 v[28:29], v121 offset0:128 offset1:136
    s_waitcnt lgkmcnt(11)
    v_perm_b32 v16, v31, v30, s37
    v_accvgpr_write_b32 a145, v16
    v_perm_b32 v17, v31, v30, s38
    v_accvgpr_write_b32 a153, v17
    ds_read2st64_b32 v[30:31], v121 offset0:192 offset1:200
    s_waitcnt lgkmcnt(11)
    v_perm_b32 v16, v33, v32, s37
    v_accvgpr_write_b32 a146, v16
    v_perm_b32 v17, v33, v32, s38
    v_accvgpr_write_b32 a154, v17
    ds_read2st64_b32 v[32:33], v121 offset0:144 offset1:152
    s_waitcnt lgkmcnt(11)
    v_perm_b32 v16, v35, v34, s37
    v_accvgpr_write_b32 a147, v16
    v_perm_b32 v17, v35, v34, s38
    v_accvgpr_write_b32 a155, v17
    ds_read2st64_b32 v[34:35], v121 offset0:208 offset1:216
    s_waitcnt lgkmcnt(11)
    v_perm_b32 v16, v37, v36, s37
    v_accvgpr_write_b32 a148, v16
    v_perm_b32 v17, v37, v36, s38
    v_accvgpr_write_b32 a156, v17
    s_waitcnt lgkmcnt(10)
    v_perm_b32 v16, v39, v38, s37
    v_accvgpr_write_b32 a149, v16
    v_perm_b32 v17, v39, v38, s38
    v_accvgpr_write_b32 a157, v17
    s_waitcnt lgkmcnt(9)
    v_perm_b32 v16, v41, v40, s37
    v_accvgpr_write_b32 a150, v16
    v_perm_b32 v17, v41, v40, s38
    v_accvgpr_write_b32 a158, v17
    s_waitcnt lgkmcnt(8)
    v_perm_b32 v16, v43, v42, s37
    v_accvgpr_write_b32 a151, v16
    v_perm_b32 v17, v43, v42, s38
    v_accvgpr_write_b32 a159, v17
    s_waitcnt lgkmcnt(7)
    v_perm_b32 v16, v21, v20, s37
    v_accvgpr_write_b32 a176, v16
    v_perm_b32 v17, v21, v20, s38
    v_accvgpr_write_b32 a184, v17
    s_waitcnt lgkmcnt(6)
    v_perm_b32 v16, v23, v22, s37
    v_accvgpr_write_b32 a177, v16
    v_perm_b32 v17, v23, v22, s38
    v_accvgpr_write_b32 a185, v17
    s_waitcnt lgkmcnt(5)
    v_perm_b32 v16, v25, v24, s37
    v_accvgpr_write_b32 a178, v16
    v_perm_b32 v17, v25, v24, s38
    v_accvgpr_write_b32 a186, v17
    s_waitcnt lgkmcnt(4)
    v_perm_b32 v16, v27, v26, s37
    v_accvgpr_write_b32 a179, v16
    v_perm_b32 v17, v27, v26, s38
    v_accvgpr_write_b32 a187, v17
    s_waitcnt lgkmcnt(3)
    v_perm_b32 v16, v29, v28, s37
    v_accvgpr_write_b32 a180, v16
    v_perm_b32 v17, v29, v28, s38
    v_accvgpr_write_b32 a188, v17
    s_waitcnt lgkmcnt(2)
    v_perm_b32 v16, v31, v30, s37
    v_accvgpr_write_b32 a181, v16
    v_perm_b32 v17, v31, v30, s38
    v_accvgpr_write_b32 a189, v17
    s_waitcnt lgkmcnt(1)
    v_perm_b32 v16, v33, v32, s37
    v_accvgpr_write_b32 a182, v16
    v_perm_b32 v17, v33, v32, s38
    v_accvgpr_write_b32 a190, v17
    s_waitcnt lgkmcnt(0)
    v_perm_b32 v16, v35, v34, s37
    v_accvgpr_write_b32 a183, v16
    v_perm_b32 v17, v35, v34, s38
    v_accvgpr_write_b32 a191, v17
    s_barrier
    s_lshl_b32 s40, s28, 14
    s_add_u32 m0, s40, 0x10000
    s_mov_b32 s36, 0x200000
    buffer_load_dwordx4 v112, s[56:59], s36 offen nt lds
    s_add_u32 m0, m0, 1024
    s_add_u32 s36, s36, 32768
    buffer_load_dwordx4 v112, s[56:59], s36 offen nt lds
    s_add_u32 m0, m0, 1024
    s_add_u32 s36, s36, 32768
    buffer_load_dwordx4 v112, s[56:59], s36 offen nt lds
    s_add_u32 m0, m0, 1024
    s_add_u32 s36, s36, 32768
    buffer_load_dwordx4 v112, s[56:59], s36 offen nt lds
    s_add_u32 m0, m0, 1024
    s_add_u32 s36, s36, 32768
    buffer_load_dwordx4 v112, s[56:59], s36 offen nt lds
    s_add_u32 m0, m0, 1024
    s_add_u32 s36, s36, 32768
    buffer_load_dwordx4 v112, s[56:59], s36 offen nt lds
    s_add_u32 m0, m0, 1024
    s_add_u32 s36, s36, 32768
    buffer_load_dwordx4 v112, s[56:59], s36 offen nt lds
    s_add_u32 m0, m0, 1024
    s_add_u32 s36, s36, 32768
    buffer_load_dwordx4 v112, s[56:59], s36 offen nt lds
    s_add_u32 m0, m0, 1024
    s_add_u32 s36, s36, 32768
    buffer_load_dwordx4 v112, s[56:59], s36 offen nt lds
    s_add_u32 m0, m0, 1024
    s_add_u32 s36, s36, 32768
    buffer_load_dwordx4 v112, s[56:59], s36 offen nt lds
    s_add_u32 m0, m0, 1024
    s_add_u32 s36, s36, 32768
    buffer_load_dwordx4 v112, s[56:59], s36 offen nt lds
    s_add_u32 m0, m0, 1024
    s_add_u32 s36, s36, 32768
    buffer_load_dwordx4 v112, s[56:59], s36 offen nt lds
    s_add_u32 m0, m0, 1024
    s_add_u32 s36, s36, 32768
    buffer_load_dwordx4 v112, s[56:59], s36 offen nt lds
    s_add_u32 m0, m0, 1024
    s_add_u32 s36, s36, 32768
    buffer_load_dwordx4 v112, s[56:59], s36 offen nt lds
    s_add_u32 m0, m0, 1024
    s_add_u32 s36, s36, 32768
    buffer_load_dwordx4 v112, s[56:59], s36 offen nt lds
    s_add_u32 m0, m0, 1024
    s_add_u32 s36, s36, 32768
    buffer_load_dwordx4 v112, s[56:59], s36 offen nt lds
    v_mov_b32 v122, 176
    global_load_dword v123, v122, s[24:25] sc1
    s_waitcnt vmcnt(16)
    s_barrier
    ds_read2st64_b32 v[20:21], v114 offset0:0 offset1:8
    ds_read2st64_b32 v[22:23], v114 offset0:64 offset1:72
    ds_read2st64_b32 v[24:25], v114 offset0:16 offset1:24
    ds_read2st64_b32 v[26:27], v114 offset0:80 offset1:88
    ds_read2st64_b32 v[28:29], v114 offset0:128 offset1:136
    ds_read2st64_b32 v[30:31], v114 offset0:192 offset1:200
    ds_read2st64_b32 v[32:33], v114 offset0:144 offset1:152
    ds_read2st64_b32 v[34:35], v114 offset0:208 offset1:216
    ds_read2st64_b32 v[36:37], v116 offset0:0 offset1:8
    ds_read2st64_b32 v[38:39], v116 offset0:64 offset1:72
    ds_read2st64_b32 v[40:41], v116 offset0:16 offset1:24
    ds_read2st64_b32 v[42:43], v116 offset0:80 offset1:88
    s_waitcnt lgkmcnt(11)
    v_perm_b32 v16, v21, v20, s37
    v_accvgpr_write_b32 a192, v16
    v_perm_b32 v17, v21, v20, s38
    v_accvgpr_write_b32 a200, v17
    ds_read2st64_b32 v[20:21], v116 offset0:128 offset1:136
    s_waitcnt lgkmcnt(11)
    v_perm_b32 v16, v23, v22, s37
    v_accvgpr_write_b32 a193, v16
    v_perm_b32 v17, v23, v22, s38
    v_accvgpr_write_b32 a201, v17
    ds_read2st64_b32 v[22:23], v116 offset0:192 offset1:200
    s_waitcnt lgkmcnt(11)
    v_perm_b32 v16, v25, v24, s37
    v_accvgpr_write_b32 a194, v16
    v_perm_b32 v17, v25, v24, s38
    v_accvgpr_write_b32 a202, v17
    ds_read2st64_b32 v[24:25], v116 offset0:144 offset1:152
    s_waitcnt lgkmcnt(11)
    v_perm_b32 v16, v27, v26, s37
    v_accvgpr_write_b32 a195, v16
    v_perm_b32 v17, v27, v26, s38
    v_accvgpr_write_b32 a203, v17
    ds_read2st64_b32 v[26:27], v116 offset0:208 offset1:216
    s_waitcnt lgkmcnt(11)
    v_perm_b32 v16, v29, v28, s37
    v_accvgpr_write_b32 a196, v16
    v_perm_b32 v17, v29, v28, s38
    v_accvgpr_write_b32 a204, v17
    ds_read2st64_b32 v[28:29], v118 offset0:0 offset1:8
    s_waitcnt lgkmcnt(11)
    v_perm_b32 v16, v31, v30, s37
    v_accvgpr_write_b32 a197, v16
    v_perm_b32 v17, v31, v30, s38
    v_accvgpr_write_b32 a205, v17
    ds_read2st64_b32 v[30:31], v118 offset0:64 offset1:72
    s_waitcnt lgkmcnt(11)
    v_perm_b32 v16, v33, v32, s37
    v_accvgpr_write_b32 a198, v16
    v_perm_b32 v17, v33, v32, s38
    v_accvgpr_write_b32 a206, v17
    ds_read2st64_b32 v[32:33], v118 offset0:16 offset1:24
    s_waitcnt lgkmcnt(11)
    v_perm_b32 v16, v35, v34, s37
    v_accvgpr_write_b32 a199, v16
    v_perm_b32 v17, v35, v34, s38
    v_accvgpr_write_b32 a207, v17
    ds_read2st64_b32 v[34:35], v118 offset0:80 offset1:88
    s_waitcnt lgkmcnt(11)
    v_perm_b32 v16, v37, v36, s37
    v_accvgpr_write_b32 a224, v16
    v_perm_b32 v17, v37, v36, s38
    v_accvgpr_write_b32 a232, v17
    ds_read2st64_b32 v[36:37], v118 offset0:128 offset1:136
    s_waitcnt lgkmcnt(11)
    v_perm_b32 v16, v39, v38, s37
    v_accvgpr_write_b32 a225, v16
    v_perm_b32 v17, v39, v38, s38
    v_accvgpr_write_b32 a233, v17
    ds_read2st64_b32 v[38:39], v118 offset0:192 offset1:200
    s_waitcnt lgkmcnt(11)
    v_perm_b32 v16, v41, v40, s37
    v_accvgpr_write_b32 a226, v16
    v_perm_b32 v17, v41, v40, s38
    v_accvgpr_write_b32 a234, v17
    ds_read2st64_b32 v[40:41], v118 offset0:144 offset1:152
    s_waitcnt lgkmcnt(11)
    v_perm_b32 v16, v43, v42, s37
    v_accvgpr_write_b32 a227, v16
    v_perm_b32 v17, v43, v42, s38
    v_accvgpr_write_b32 a235, v17
    ds_read2st64_b32 v[42:43], v118 offset0:208 offset1:216
    s_waitcnt lgkmcnt(11)
    v_perm_b32 v16, v21, v20, s37
    v_accvgpr_write_b32 a228, v16
    v_perm_b32 v17, v21, v20, s38
    v_accvgpr_write_b32 a236, v17
    ds_read2st64_b32 v[20:21], v120 offset0:0 offset1:8
    s_waitcnt lgkmcnt(11)
    v_perm_b32 v16, v23, v22, s37
    v_accvgpr_write_b32 a229, v16
    v_perm_b32 v17, v23, v22, s38
    v_accvgpr_write_b32 a237, v17
    ds_read2st64_b32 v[22:23], v120 offset0:64 offset1:72
    s_waitcnt lgkmcnt(11)
    v_perm_b32 v16, v25, v24, s37
    v_accvgpr_write_b32 a230, v16
    v_perm_b32 v17, v25, v24, s38
    v_accvgpr_write_b32 a238, v17
    ds_read2st64_b32 v[24:25], v120 offset0:16 offset1:24
    s_waitcnt lgkmcnt(11)
    v_perm_b32 v16, v27, v26, s37
    v_accvgpr_write_b32 a231, v16
    v_perm_b32 v17, v27, v26, s38
    v_accvgpr_write_b32 a239, v17
    ds_read2st64_b32 v[26:27], v120 offset0:80 offset1:88
    s_waitcnt lgkmcnt(11)
    v_perm_b32 v136, v29, v28, s37
    v_perm_b32 v144, v29, v28, s38
    ds_read2st64_b32 v[28:29], v120 offset0:128 offset1:136
    s_waitcnt lgkmcnt(11)
    v_perm_b32 v137, v31, v30, s37
    v_perm_b32 v145, v31, v30, s38
    ds_read2st64_b32 v[30:31], v120 offset0:192 offset1:200
    s_waitcnt lgkmcnt(11)
    v_perm_b32 v138, v33, v32, s37
    v_perm_b32 v146, v33, v32, s38
    ds_read2st64_b32 v[32:33], v120 offset0:144 offset1:152
    s_waitcnt lgkmcnt(11)
    v_perm_b32 v139, v35, v34, s37
    v_perm_b32 v147, v35, v34, s38
    ds_read2st64_b32 v[34:35], v120 offset0:208 offset1:216
    s_waitcnt lgkmcnt(11)
    v_perm_b32 v140, v37, v36, s37
    v_perm_b32 v148, v37, v36, s38
    s_waitcnt lgkmcnt(10)
    v_perm_b32 v141, v39, v38, s37
    v_perm_b32 v149, v39, v38, s38
    s_waitcnt lgkmcnt(9)
    v_perm_b32 v142, v41, v40, s37
    v_perm_b32 v150, v41, v40, s38
    s_waitcnt lgkmcnt(8)
    v_perm_b32 v143, v43, v42, s37
    v_perm_b32 v151, v43, v42, s38
    s_waitcnt lgkmcnt(7)
    v_perm_b32 v168, v21, v20, s37
    v_perm_b32 v176, v21, v20, s38
    s_waitcnt lgkmcnt(6)
    v_perm_b32 v169, v23, v22, s37
    v_perm_b32 v177, v23, v22, s38
    s_waitcnt lgkmcnt(5)
    v_perm_b32 v170, v25, v24, s37
    v_perm_b32 v178, v25, v24, s38
    s_waitcnt lgkmcnt(4)
    v_perm_b32 v171, v27, v26, s37
    v_perm_b32 v179, v27, v26, s38
    s_waitcnt lgkmcnt(3)
    v_perm_b32 v172, v29, v28, s37
    v_perm_b32 v180, v29, v28, s38
    s_waitcnt lgkmcnt(2)
    v_perm_b32 v173, v31, v30, s37
    v_perm_b32 v181, v31, v30, s38
    s_waitcnt lgkmcnt(1)
    v_perm_b32 v174, v33, v32, s37
    v_perm_b32 v182, v33, v32, s38
    s_waitcnt lgkmcnt(0)
    v_perm_b32 v175, v35, v34, s37
    v_perm_b32 v183, v35, v34, s38
    s_waitcnt vmcnt(0)
    s_barrier
    ds_read2st64_b32 v[20:21], v115 offset0:0 offset1:8
    ds_read2st64_b32 v[22:23], v115 offset0:64 offset1:72
    ds_read2st64_b32 v[24:25], v115 offset0:16 offset1:24
    ds_read2st64_b32 v[26:27], v115 offset0:80 offset1:88
    ds_read2st64_b32 v[28:29], v115 offset0:128 offset1:136
    ds_read2st64_b32 v[30:31], v115 offset0:192 offset1:200
    ds_read2st64_b32 v[32:33], v115 offset0:144 offset1:152
    ds_read2st64_b32 v[34:35], v115 offset0:208 offset1:216
    ds_read2st64_b32 v[36:37], v117 offset0:0 offset1:8
    ds_read2st64_b32 v[38:39], v117 offset0:64 offset1:72
    ds_read2st64_b32 v[40:41], v117 offset0:16 offset1:24
    ds_read2st64_b32 v[42:43], v117 offset0:80 offset1:88
    s_waitcnt lgkmcnt(11)
    v_perm_b32 v16, v21, v20, s37
    v_accvgpr_write_b32 a208, v16
    v_perm_b32 v17, v21, v20, s38
    v_accvgpr_write_b32 a216, v17
    ds_read2st64_b32 v[20:21], v117 offset0:128 offset1:136
    s_waitcnt lgkmcnt(11)
    v_perm_b32 v16, v23, v22, s37
    v_accvgpr_write_b32 a209, v16
    v_perm_b32 v17, v23, v22, s38
    v_accvgpr_write_b32 a217, v17
    ds_read2st64_b32 v[22:23], v117 offset0:192 offset1:200
    s_waitcnt lgkmcnt(11)
    v_perm_b32 v16, v25, v24, s37
    v_accvgpr_write_b32 a210, v16
    v_perm_b32 v17, v25, v24, s38
    v_accvgpr_write_b32 a218, v17
    ds_read2st64_b32 v[24:25], v117 offset0:144 offset1:152
    s_waitcnt lgkmcnt(11)
    v_perm_b32 v16, v27, v26, s37
    v_accvgpr_write_b32 a211, v16
    v_perm_b32 v17, v27, v26, s38
    v_accvgpr_write_b32 a219, v17
    ds_read2st64_b32 v[26:27], v117 offset0:208 offset1:216
    s_waitcnt lgkmcnt(11)
    v_perm_b32 v16, v29, v28, s37
    v_accvgpr_write_b32 a212, v16
    v_perm_b32 v17, v29, v28, s38
    v_accvgpr_write_b32 a220, v17
    ds_read2st64_b32 v[28:29], v119 offset0:0 offset1:8
    s_waitcnt lgkmcnt(11)
    v_perm_b32 v16, v31, v30, s37
    v_accvgpr_write_b32 a213, v16
    v_perm_b32 v17, v31, v30, s38
    v_accvgpr_write_b32 a221, v17
    ds_read2st64_b32 v[30:31], v119 offset0:64 offset1:72
    s_waitcnt lgkmcnt(11)
    v_perm_b32 v16, v33, v32, s37
    v_accvgpr_write_b32 a214, v16
    v_perm_b32 v17, v33, v32, s38
    v_accvgpr_write_b32 a222, v17
    ds_read2st64_b32 v[32:33], v119 offset0:16 offset1:24
    s_waitcnt lgkmcnt(11)
    v_perm_b32 v16, v35, v34, s37
    v_accvgpr_write_b32 a215, v16
    v_perm_b32 v17, v35, v34, s38
    v_accvgpr_write_b32 a223, v17
    ds_read2st64_b32 v[34:35], v119 offset0:80 offset1:88
    s_waitcnt lgkmcnt(11)
    v_perm_b32 v16, v37, v36, s37
    v_accvgpr_write_b32 a240, v16
    v_perm_b32 v17, v37, v36, s38
    v_accvgpr_write_b32 a248, v17
    ds_read2st64_b32 v[36:37], v119 offset0:128 offset1:136
    s_waitcnt lgkmcnt(11)
    v_perm_b32 v16, v39, v38, s37
    v_accvgpr_write_b32 a241, v16
    v_perm_b32 v17, v39, v38, s38
    v_accvgpr_write_b32 a249, v17
    ds_read2st64_b32 v[38:39], v119 offset0:192 offset1:200
    s_waitcnt lgkmcnt(11)
    v_perm_b32 v16, v41, v40, s37
    v_accvgpr_write_b32 a242, v16
    v_perm_b32 v17, v41, v40, s38
    v_accvgpr_write_b32 a250, v17
    ds_read2st64_b32 v[40:41], v119 offset0:144 offset1:152
    s_waitcnt lgkmcnt(11)
    v_perm_b32 v16, v43, v42, s37
    v_accvgpr_write_b32 a243, v16
    v_perm_b32 v17, v43, v42, s38
    v_accvgpr_write_b32 a251, v17
    ds_read2st64_b32 v[42:43], v119 offset0:208 offset1:216
    s_waitcnt lgkmcnt(11)
    v_perm_b32 v16, v21, v20, s37
    v_accvgpr_write_b32 a244, v16
    v_perm_b32 v17, v21, v20, s38
    v_accvgpr_write_b32 a252, v17
    ds_read2st64_b32 v[20:21], v121 offset0:0 offset1:8
    s_waitcnt lgkmcnt(11)
    v_perm_b32 v16, v23, v22, s37
    v_accvgpr_write_b32 a245, v16
    v_perm_b32 v17, v23, v22, s38
    v_accvgpr_write_b32 a253, v17
    ds_read2st64_b32 v[22:23], v121 offset0:64 offset1:72
    s_waitcnt lgkmcnt(11)
    v_perm_b32 v16, v25, v24, s37
    v_accvgpr_write_b32 a246, v16
    v_perm_b32 v17, v25, v24, s38
    v_accvgpr_write_b32 a254, v17
    ds_read2st64_b32 v[24:25], v121 offset0:16 offset1:24
    s_waitcnt lgkmcnt(11)
    v_perm_b32 v16, v27, v26, s37
    v_accvgpr_write_b32 a247, v16
    v_perm_b32 v17, v27, v26, s38
    v_accvgpr_write_b32 a255, v17
    ds_read2st64_b32 v[26:27], v121 offset0:80 offset1:88
    s_waitcnt lgkmcnt(11)
    v_perm_b32 v152, v29, v28, s37
    v_perm_b32 v160, v29, v28, s38
    ds_read2st64_b32 v[28:29], v121 offset0:128 offset1:136
    s_waitcnt lgkmcnt(11)
    v_perm_b32 v153, v31, v30, s37
    v_perm_b32 v161, v31, v30, s38
    ds_read2st64_b32 v[30:31], v121 offset0:192 offset1:200
    s_waitcnt lgkmcnt(11)
    v_perm_b32 v154, v33, v32, s37
    v_perm_b32 v162, v33, v32, s38
    ds_read2st64_b32 v[32:33], v121 offset0:144 offset1:152
    s_waitcnt lgkmcnt(11)
    v_perm_b32 v155, v35, v34, s37
    v_perm_b32 v163, v35, v34, s38
    ds_read2st64_b32 v[34:35], v121 offset0:208 offset1:216
    s_waitcnt lgkmcnt(11)
    v_perm_b32 v156, v37, v36, s37
    v_perm_b32 v164, v37, v36, s38
    s_waitcnt lgkmcnt(10)
    v_perm_b32 v157, v39, v38, s37
    v_perm_b32 v165, v39, v38, s38
    s_waitcnt lgkmcnt(9)
    v_perm_b32 v158, v41, v40, s37
    v_perm_b32 v166, v41, v40, s38
    s_waitcnt lgkmcnt(8)
    v_perm_b32 v159, v43, v42, s37
    v_perm_b32 v167, v43, v42, s38
    s_waitcnt lgkmcnt(7)
    v_perm_b32 v184, v21, v20, s37
    v_perm_b32 v192, v21, v20, s38
    s_waitcnt lgkmcnt(6)
    v_perm_b32 v185, v23, v22, s37
    v_perm_b32 v193, v23, v22, s38
    s_waitcnt lgkmcnt(5)
    v_perm_b32 v186, v25, v24, s37
    v_perm_b32 v194, v25, v24, s38
    s_waitcnt lgkmcnt(4)
    v_perm_b32 v187, v27, v26, s37
    v_perm_b32 v195, v27, v26, s38
    s_waitcnt lgkmcnt(3)
    v_perm_b32 v188, v29, v28, s37
    v_perm_b32 v196, v29, v28, s38
    s_waitcnt lgkmcnt(2)
    v_perm_b32 v189, v31, v30, s37
    v_perm_b32 v197, v31, v30, s38
    s_waitcnt lgkmcnt(1)
    v_perm_b32 v190, v33, v32, s37
    v_perm_b32 v198, v33, v32, s38
    s_waitcnt lgkmcnt(0)
    v_perm_b32 v191, v35, v34, s37
    v_perm_b32 v199, v35, v34, s38
    s_barrier
    s_cmp_lg_u32 s28, 0
    s_cbranch_scc1 L_noci
    v_mov_b32 v16, 144
    s_cmp_eq_u32 s30, 0
    s_cselect_b32 s40, 1, 0x10001
    v_mov_b32 v17, s40
    s_mov_b64 exec, 1
    global_atomic_add v16, v17, s[24:25] sc1
    s_mov_b64 exec, -1
L_noci:
    ds_write_b128 v4, v[48:51] offset:0
    ds_write_b128 v4, v[52:55] offset:1024
    ds_write_b128 v4, v[56:59] offset:2048
    ds_write_b128 v4, v[60:63] offset:3072
    ds_write_b128 v4, v[64:67] offset:4096
    ds_write_b128 v4, v[68:71] offset:5120
    ds_write_b128 v4, v[72:75] offset:6144
    ds_write_b128 v4, v[76:79] offset:7168
    ds_write_b128 v4, v[80:83] offset:8192
    ds_write_b128 v4, v[84:87] offset:9216
    ds_write_b128 v4, v[88:91] offset:10240
    ds_write_b128 v4, v[92:95] offset:11264
    ds_write_b128 v4, v[96:99] offset:12288
    ds_write_b128 v4, v[100:103] offset:13312
    ds_write_b128 v4, v[104:107] offset:14336
    ds_write_b128 v4, v[108:111] offset:15360
    s_waitcnt lgkmcnt(0)
    v_cmp_ne_u32 vcc, 1, v123
    s_cbranch_vccz L_fi_ok
    v_mov_b32 v122, 176
L_wf_1:
    global_load_dword v123, v122, s[24:25] sc1
    s_add_u32 s39, s39, 1
    s_cmp_gt_u32 s39, 0x400000
    s_cbranch_scc1 L_fail
    s_sleep 1
    s_waitcnt vmcnt(0)
    v_cmp_ne_u32 vcc, 1, v123
    s_cbranch_vccnz L_wf_1
L_fi_ok:
    s_lshl_b32 s40, s29, 8
    s_add_u32 s40, s40, 0x400000
    v_mov_b32 v122, s40
    global_load_dword v123, v122, s[26:27] sc1
    s_mov_b32 s64, 0
    s_mov_b32 s36, 0x0
    buffer_load_dwordx4 v[20:23], v113, s[60:63], s36 offen
    buffer_load_dwordx4 v[24:27], v113, s[60:63], s36 offen offset:1024
    buffer_load_dwordx4 v[28:31], v113, s[60:63], s36 offen offset:2048
    buffer_load_dwordx4 v[32:35], v113, s[60:63], s36 offen offset:3072
    s_mov_b32 s36, 0x4000
    buffer_load_dwordx4 v[36:39], v113, s[60:63], s36 offen
    buffer_load_dwordx4 v[40:43], v113, s[60:63], s36 offen offset:1024
    buffer_load_dwordx4 v[44:47], v113, s[60:63], s36 offen offset:2048
    buffer_load_dwordx4 v[48:51], v113, s[60:63], s36 offen offset:3072
    s_mov_b32 s36, 0x8000
    buffer_load_dwordx4 v[52:55], v113, s[60:63], s36 offen
    buffer_load_dwordx4 v[56:59], v113, s[60:63], s36 offen offset:1024
    buffer_load_dwordx4 v[60:63], v113, s[60:63], s36 offen offset:2048
    buffer_load_dwordx4 v[64:67], v113, s[60:63], s36 offen offset:3072
    s_mov_b32 s36, 0xc000
    buffer_load_dwordx4 v[68:71], v113, s[60:63], s36 offen
    buffer_load_dwordx4 v[72:75], v113, s[60:63], s36 offen offset:1024
    buffer_load_dwordx4 v[76:79], v113, s[60:63], s36 offen offset:2048
    buffer_load_dwordx4 v[80:83], v113, s[60:63], s36 offen offset:3072
    s_waitcnt vmcnt(14)
    v_perm_b32 v200, v24, v20, s37
    v_perm_b32 v201, v24, v20, s38
    v_perm_b32 v232, v25, v21, s37
    v_perm_b32 v233, v25, v21, s38
    v_perm_b32 v96, v26, v22, s37
    v_perm_b32 v97, v26, v22, s38
    v_perm_b32 v104, v27, v23, s37
    v_perm_b32 v105, v27, v23, s38
    s_mov_b32 s36, 0x10000
    buffer_load_dwordx4 v[20:23], v113, s[60:63], s36 offen
    buffer_load_dwordx4 v[24:27], v113, s[60:63], s36 offen offset:1024
    s_waitcnt vmcnt(14)
    v_perm_b32 v202, v32, v28, s37
    v_perm_b32 v203, v32, v28, s38
    v_perm_b32 v234, v33, v29, s37
    v_perm_b32 v235, v33, v29, s38
    v_perm_b32 v98, v34, v30, s37
    v_perm_b32 v99, v34, v30, s38
    v_perm_b32 v106, v35, v31, s37
    v_perm_b32 v107, v35, v31, s38
    buffer_load_dwordx4 v[28:31], v113, s[60:63], s36 offen offset:2048
    buffer_load_dwordx4 v[32:35], v113, s[60:63], s36 offen offset:3072
    s_waitcnt vmcnt(14)
    v_perm_b32 v204, v40, v36, s37
    v_perm_b32 v205, v40, v36, s38
    v_perm_b32 v236, v41, v37, s37
    v_perm_b32 v237, v41, v37, s38
    v_perm_b32 v100, v42, v38, s37
    v_perm_b32 v101, v42, v38, s38
    v_perm_b32 v108, v43, v39, s37
    v_perm_b32 v109, v43, v39, s38
    s_mov_b32 s36, 0x14000
    buffer_load_dwordx4 v[36:39], v113, s[60:63], s36 offen
    buffer_load_dwordx4 v[40:43], v113, s[60:63], s36 offen offset:1024
    s_waitcnt vmcnt(14)
    v_perm_b32 v206, v48, v44, s37
    v_perm_b32 v207, v48, v44, s38
    v_perm_b32 v238, v49, v45, s37
    v_perm_b32 v239, v49, v45, s38
    v_perm_b32 v102, v50, v46, s37
    v_perm_b32 v103, v50, v46, s38
    v_perm_b32 v110, v51, v47, s37
    v_perm_b32 v111, v51, v47, s38
    ds_write_b128 v4, v[96:99] offset:16384
    ds_write_b128 v4, v[100:103] offset:17408
    s_waitcnt lgkmcnt(0)
    ds_write_b128 v4, v[104:107] offset:24576
    ds_write_b128 v4, v[108:111] offset:25600
    s_waitcnt lgkmcnt(0)
    buffer_load_dwordx4 v[44:47], v113, s[60:63], s36 offen offset:2048
    buffer_load_dwordx4 v[48:51], v113, s[60:63], s36 offen offset:3072
    s_waitcnt vmcnt(14)
    v_perm_b32 v208, v56, v52, s37
    v_perm_b32 v209, v56, v52, s38
    v_perm_b32 v240, v57, v53, s37
    v_perm_b32 v241, v57, v53, s38
    v_perm_b32 v96, v58, v54, s37
    v_perm_b32 v97, v58, v54, s38
    v_perm_b32 v104, v59, v55, s37
    v_perm_b32 v105, v59, v55, s38
    s_mov_b32 s36, 0x18000
    buffer_load_dwordx4 v[52:55], v113, s[60:63], s36 offen
    buffer_load_dwordx4 v[56:59], v113, s[60:63], s36 offen offset:1024
    s_waitcnt vmcnt(14)
    v_perm_b32 v210, v64, v60, s37
    v_perm_b32 v211, v64, v60, s38
    v_perm_b32 v242, v65, v61, s37
    v_perm_b32 v243, v65, v61, s38
    v_perm_b32 v98, v66, v62, s37
    v_perm_b32 v99, v66, v62, s38
    v_perm_b32 v106, v67, v63, s37
    v_perm_b32 v107, v67, v63, s38
    buffer_load_dwordx4 v[60:63], v113, s[60:63], s36 offen offset:2048
    buffer_load_dwordx4 v[64:67], v113, s[60:63], s36 offen offset:3072
    s_waitcnt vmcnt(14)
    v_perm_b32 v212, v72, v68, s37
    v_perm_b32 v213, v72, v68, s38
    v_perm_b32 v244, v73, v69, s37
    v_perm_b32 v245, v73, v69, s38
    v_perm_b32 v100, v74, v70, s37
    v_perm_b32 v101, v74, v70, s38
    v_perm_b32 v108, v75, v71, s37
    v_perm_b32 v109, v75, v71, s38
    v_add_u32 v9, v9, v10
    v_mov_b32 v124, 0x01010101
    v_cmp_ne_u32 vcc, v124, v123
    s_cbranch_vccnz L_nodma0
    global_load_dwordx4 v[128:131], v7, s[78:79] sc1
    global_load_dwordx4 v[132:135], v7, s[78:79] offset:1024 sc1
    global_load_dword v0, v9, s[26:27] sc1
    v_add_u32 v9, v9, v10
    s_mov_b32 s64, 1
L_nodma0:
    v_mov_b32 v120, 144
    global_load_dword v121, v120, s[24:25] sc1
    s_mov_b32 s36, 0x1c000
    buffer_load_dwordx4 v[68:71], v113, s[60:63], s36 offen
    buffer_load_dwordx4 v[72:75], v113, s[60:63], s36 offen offset:1024
    s_waitcnt vmcnt(14)
    v_perm_b32 v214, v80, v76, s37
    v_perm_b32 v215, v80, v76, s38
    v_perm_b32 v246, v81, v77, s37
    v_perm_b32 v247, v81, v77, s38
    v_perm_b32 v102, v82, v78, s37
    v_perm_b32 v103, v82, v78, s38
    v_perm_b32 v110, v83, v79, s37
    v_perm_b32 v111, v83, v79, s38
    ds_write_b128 v4, v[96:99] offset:18432
    ds_write_b128 v4, v[100:103] offset:19456
    s_waitcnt lgkmcnt(0)
    ds_write_b128 v4, v[104:107] offset:26624
    ds_write_b128 v4, v[108:111] offset:27648
    s_waitcnt lgkmcnt(0)
    buffer_load_dwordx4 v[76:79], v113, s[60:63], s36 offen offset:2048
    buffer_load_dwordx4 v[80:83], v113, s[60:63], s36 offen offset:3072
    s_waitcnt vmcnt(14)
    v_perm_b32 v216, v24, v20, s37
    v_perm_b32 v217, v24, v20, s38
    v_perm_b32 v248, v25, v21, s37
    v_perm_b32 v249, v25, v21, s38
    v_perm_b32 v96, v26, v22, s37
    v_perm_b32 v97, v26, v22, s38
    v_perm_b32 v104, v27, v23, s37
    v_perm_b32 v105, v27, v23, s38
    s_waitcnt vmcnt(12)
    v_perm_b32 v218, v32, v28, s37
    v_perm_b32 v219, v32, v28, s38
    v_perm_b32 v250, v33, v29, s37
    v_perm_b32 v251, v33, v29, s38
    v_perm_b32 v98, v34, v30, s37
    v_perm_b32 v99, v34, v30, s38
    v_perm_b32 v106, v35, v31, s37
    v_perm_b32 v107, v35, v31, s38
    s_waitcnt vmcnt(10)
    v_perm_b32 v220, v40, v36, s37
    v_perm_b32 v221, v40, v36, s38
    v_perm_b32 v252, v41, v37, s37
    v_perm_b32 v253, v41, v37, s38
    v_perm_b32 v100, v42, v38, s37
    v_perm_b32 v101, v42, v38, s38
    v_perm_b32 v108, v43, v39, s37
    v_perm_b32 v109, v43, v39, s38
    s_waitcnt vmcnt(8)
    v_perm_b32 v222, v48, v44, s37
    v_perm_b32 v223, v48, v44, s38
    v_perm_b32 v254, v49, v45, s37
    v_perm_b32 v255, v49, v45, s38
    v_perm_b32 v102, v50, v46, s37
    v_perm_b32 v103, v50, v46, s38
    v_perm_b32 v110, v51, v47, s37
    v_perm_b32 v111, v51, v47, s38
    ds_write_b128 v4, v[96:99] offset:20480
    ds_write_b128 v4, v[100:103] offset:21504
    s_waitcnt lgkmcnt(0)
    ds_write_b128 v4, v[104:107] offset:28672
    ds_write_b128 v4, v[108:111] offset:29696
    s_waitcnt lgkmcnt(0)
    s_waitcnt vmcnt(6)
    v_perm_b32 v224, v56, v52, s37
    v_perm_b32 v225, v56, v52, s38
    v_perm_b32 v88, v57, v53, s37
    v_perm_b32 v89, v57, v53, s38
    v_perm_b32 v96, v58, v54, s37
    v_perm_b32 v97, v58, v54, s38
    v_perm_b32 v104, v59, v55, s37
    v_perm_b32 v105, v59, v55, s38
    s_waitcnt vmcnt(4)
    v_perm_b32 v226, v64, v60, s37
    v_perm_b32 v227, v64, v60, s38
    v_perm_b32 v90, v65, v61, s37
    v_perm_b32 v91, v65, v61, s38
    v_perm_b32 v98, v66, v62, s37
    v_perm_b32 v99, v66, v62, s38
    v_perm_b32 v106, v67, v63, s37
    v_perm_b32 v107, v67, v63, s38
    s_waitcnt vmcnt(2)
    v_perm_b32 v228, v72, v68, s37
    v_perm_b32 v229, v72, v68, s38
    v_perm_b32 v92, v73, v69, s37
    v_perm_b32 v93, v73, v69, s38
    v_perm_b32 v100, v74, v70, s37
    v_perm_b32 v101, v74, v70, s38
    v_perm_b32 v108, v75, v71, s37
    v_perm_b32 v109, v75, v71, s38
    s_waitcnt vmcnt(0)
    v_perm_b32 v230, v80, v76, s37
    v_perm_b32 v231, v80, v76, s38
    v_perm_b32 v94, v81, v77, s37
    v_perm_b32 v95, v81, v77, s38
    v_perm_b32 v102, v82, v78, s37
    v_perm_b32 v103, v82, v78, s38
    v_perm_b32 v110, v83, v79, s37
    v_perm_b32 v111, v83, v79, s38
    ds_write_b128 v4, v[88:91] offset:32768
    ds_write_b128 v4, v[92:95] offset:33792
    s_waitcnt lgkmcnt(0)
    ds_write_b128 v4, v[96:99] offset:22528
    ds_write_b128 v4, v[100:103] offset:23552
    s_waitcnt lgkmcnt(0)
    ds_write_b128 v4, v[104:107] offset:30720
    ds_write_b128 v4, v[108:111] offset:31744
    s_waitcnt lgkmcnt(0)
    ds_read_b128 v[16:19], v7
    ds_read_b128 v[20:23], v7 offset:1024
    s_cmp_eq_u32 s64, 1
    s_cbranch_scc1 L_dma0_done
L_wf_2:
    global_load_dword v123, v122, s[26:27] sc1
    s_add_u32 s39, s39, 1
    s_cmp_gt_u32 s39, 0x400000
    s_cbranch_scc1 L_fail
    s_sleep 1
    s_waitcnt vmcnt(0)
    v_cmp_ne_u32 vcc, v124, v123
    s_cbranch_vccnz L_wf_2
    global_load_dwordx4 v[128:131], v7, s[78:79] sc1
    global_load_dwordx4 v[132:135], v7, s[78:79] offset:1024 sc1
    global_load_dword v0, v9, s[26:27] sc1
    v_add_u32 v9, v9, v10
L_dma0_done:
L_ci:
    v_readfirstlane_b32 s43, v121
    s_nop 0
    s_and_b32 s40, s43, 0xffff
    s_cmp_eq_u32 s40, 32
    s_cbranch_scc1 L_ci_ok
    global_load_dword v121, v120, s[24:25] sc1
    s_add_u32 s39, s39, 1
    s_cmp_gt_u32 s39, 0x400000
    s_cbranch_scc1 L_fail
    s_sleep 1
    s_waitcnt vmcnt(0)
    s_branch L_ci
L_ci_ok:
    s_add_u32 s78, s78, 0x40000
    s_addc_u32 s79, s79, 0
    s_mov_b32 s64, 0
    s_waitcnt vmcnt(0)
    ds_write_b128 v7, v[128:131] offset:12288
    ds_write_b128 v7, v[132:135] offset:13312
    s_cmp_gt_u32 s43, 0xffff
    s_cbranch_scc1 L_slowmode
    s_cmp_eq_u32 s28, 1
    s_cbranch_scc1 L_entry1
    s_cmp_eq_u32 s28, 2
    s_cbranch_scc1 L_entry2
    s_cmp_eq_u32 s28, 3
    s_cbranch_scc1 L_entry3
L_entry0:
    ds_read_b128 v[72:75], v4 offset:0
    ds_read_b128 v[76:79], v4 offset:1024
    ds_read_b128 v[80:83], v4 offset:2048
    ds_read_b128 v[84:87], v4 offset:3072
    ds_read_b128 v[88:91], v4 offset:4096
    ds_read_b128 v[92:95], v4 offset:5120
    ds_read_b128 v[96:99], v4 offset:6144
    ds_read_b128 v[100:103], v4 offset:7168
    v_mov_b64 v[48:49], 0
    v_mov_b64 v[50:51], 0
    v_mov_b64 v[52:53], 0
    v_mov_b64 v[54:55], 0
    v_mov_b64 v[56:57], 0
    v_mov_b64 v[58:59], 0
    v_mov_b64 v[60:61], 0
    v_mov_b64 v[62:63], 0
    v_mov_b64 v[64:65], 0
    v_mov_b64 v[66:67], 0
    v_mov_b64 v[68:69], 0
    v_mov_b64 v[70:71], 0
    s_mov_b64 s[70:71], s[68:69]
    s_add_u32 s100, s100, 0x40000
    s_and_b32 s100, s100, 0xc0000
    s_add_u32 s42, s100, s101
    s_add_u32 s68, s72, s42
    s_addc_u32 s69, s73, 0
    s_add_u32 s42, s100, 0x23000
    s_add_u32 s66, s72, s42
    s_addc_u32 s67, s73, 0
    s_add_u32 s36, s46, 0x4000
    s_addc_u32 s37, s47, 0
    s_lshl_b32 s40, s29, 8
    s_add_u32 s40, s40, 0x400004
    v_mov_b32 v14, s40
    v_mov_b32 v15, 0x01010101
    v_readlane_b32 s41, v0, 48
    s_nop 0
    s_cmp_eq_u32 s41, 0x01010101
    s_cbranch_scc1 L_e10
L_wf_3:
    global_load_dword v0, v14, s[26:27] sc1
    s_add_u32 s39, s39, 1
    s_cmp_gt_u32 s39, 0x400000
    s_cbranch_scc1 L_fail
    s_sleep 1
    s_waitcnt vmcnt(0)
    v_cmp_ne_u32 vcc, v15, v0
    s_cbranch_vccnz L_wf_3
L_e10:
    s_waitcnt lgkmcnt(0)
.p2align 6
L_step0:
    v_smfmac_f32_16x16x64_bf16 v[48:51], v[16:19], v[72:79], v1
    ds_write_b128 v7, v[16:19]
    v_smfmac_f32_16x16x64_bf16 v[52:55], v[16:19], v[80:87], v1
    ds_write_b128 v7, v[20:23] offset:1024
    v_smfmac_f32_16x16x64_bf16 v[48:51], v[20:23], v[88:95], v1
    ds_read_b128 v[72:75], v4 offset:8192
    v_smfmac_f32_16x16x64_bf16 v[52:55], v[20:23], v[96:103], v1
    ds_read_b128 v[76:79], v4 offset:9216
    v_mov_b64 v[112:113], -1
    v_smfmac_f32_16x16x64_bf16 v[56:59], v[16:19], a[96:103], v1
    ds_read_b128 v[80:83], v4 offset:10240
    v_mov_b64 v[114:115], -1
    v_smfmac_f32_16x16x64_bf16 v[60:63], v[16:19], a[104:111], v1
    ds_read_b128 v[84:87], v4 offset:11264
    v_smfmac_f32_16x16x64_bf16 v[56:59], v[20:23], a[112:119], v1
    v_smfmac_f32_16x16x64_bf16 v[60:63], v[20:23], a[120:127], v1
    s_waitcnt lgkmcnt(4)
    s_barrier
    ds_read_b128 v[24:27], v8 offset:2048
    ds_read_b128 v[28:31], v8 offset:3072
    v_smfmac_f32_16x16x64_bf16 v[64:67], v[16:19], a[192:199], v1
    ds_read_b128 v[32:35], v8 offset:4096
    v_smfmac_f32_16x16x64_bf16 v[68:71], v[16:19], a[200:207], v1
    ds_read_b128 v[36:39], v8 offset:5120
    v_smfmac_f32_16x16x64_bf16 v[64:67], v[20:23], a[208:215], v1
    ds_read_b128 v[40:43], v8 offset:6144
    v_smfmac_f32_16x16x64_bf16 v[68:71], v[20:23], a[216:223], v1
    s_waitcnt vmcnt(0)
    ds_read_b128 v[44:47], v8 offset:7168
    global_load_dwordx4 v[104:107], v7, s[80:81] offset:0 sc1
    s_waitcnt lgkmcnt(5)
    v_smfmac_f32_16x16x64_bf16 v[48:51], v[24:27], a[0:7], v1
    global_load_dwordx4 v[108:111], v7, s[80:81] offset:1024 sc1
    v_smfmac_f32_16x16x64_bf16 v[52:55], v[24:27], a[8:15], v1
    ds_read_b128 v[88:91], v4 offset:12288
    s_waitcnt lgkmcnt(5)
    v_smfmac_f32_16x16x64_bf16 v[48:51], v[28:31], a[16:23], v1
    ds_read_b128 v[92:95], v4 offset:13312
    v_smfmac_f32_16x16x64_bf16 v[52:55], v[28:31], a[24:31], v1
    ds_read_b128 v[96:99], v4 offset:14336
    s_waitcnt lgkmcnt(6)
    v_smfmac_f32_16x16x64_bf16 v[48:51], v[32:35], a[32:39], v1
    ds_read_b128 v[100:103], v4 offset:15360
    v_smfmac_f32_16x16x64_bf16 v[52:55], v[32:35], a[40:47], v1
    global_load_dwordx4 v[128:131], v7, s[78:79] offset:0 sc1
    s_waitcnt lgkmcnt(6)
    v_smfmac_f32_16x16x64_bf16 v[48:51], v[36:39], a[48:55], v1
    v_smfmac_f32_16x16x64_bf16 v[52:55], v[36:39], a[56:63], v1
    global_load_dwordx4 v[132:135], v7, s[78:79] offset:1024 sc1
    s_waitcnt lgkmcnt(5)
    v_smfmac_f32_16x16x64_bf16 v[48:51], v[40:43], a[64:71], v1
    v_smfmac_f32_16x16x64_bf16 v[52:55], v[40:43], a[72:79], v1
    s_waitcnt lgkmcnt(4)
    v_smfmac_f32_16x16x64_bf16 v[48:51], v[44:47], a[80:87], v1
    s_mov_b64 exec, s[44:45]
    global_store_dword v3, v112, s[36:37]
    s_mov_b64 exec, -1
    v_smfmac_f32_16x16x64_bf16 v[52:55], v[44:47], a[88:95], v1
    v_smfmac_f32_16x16x64_bf16 v[56:59], v[24:27], v[72:79], v1
    v_smfmac_f32_16x16x64_bf16 v[60:63], v[24:27], v[80:87], v1
    global_store_dwordx4 v7, v[112:115], s[70:71] offset:0
    s_waitcnt lgkmcnt(2)
    v_permlane32_swap_b32 v48, v52
    v_smfmac_f32_16x16x64_bf16 v[56:59], v[28:31], v[88:95], v1
    ds_read_b128 v[72:75], v8 offset:12288
    s_waitcnt lgkmcnt(1)
    v_permlane32_swap_b32 v49, v53
    v_smfmac_f32_16x16x64_bf16 v[60:63], v[28:31], v[96:103], v1
    ds_read_b128 v[76:79], v8 offset:16384
    v_permlane32_swap_b32 v50, v54
    v_smfmac_f32_16x16x64_bf16 v[56:59], v[32:35], a[128:135], v1
    ds_read_b128 v[80:83], v8 offset:13312
    v_permlane32_swap_b32 v51, v55
    v_smfmac_f32_16x16x64_bf16 v[60:63], v[32:35], a[136:143], v1
    ds_read_b128 v[84:87], v8 offset:17408
    v_add_f32 v48, v48, v52
    v_smfmac_f32_16x16x64_bf16 v[56:59], v[36:39], a[144:151], v1
    ds_read_b128 v[88:91], v8 offset:14336
    v_add_f32 v49, v49, v53
    v_smfmac_f32_16x16x64_bf16 v[60:63], v[36:39], a[152:159], v1
    global_store_dwordx4 v7, v[112:115], s[70:71] offset:1024
    v_add_f32 v50, v50, v54
    v_smfmac_f32_16x16x64_bf16 v[56:59], v[40:43], a[160:167], v1
    ds_read_b128 v[92:95], v8 offset:18432
    v_add_f32 v51, v51, v55
    v_smfmac_f32_16x16x64_bf16 v[60:63], v[40:43], a[168:175], v1
    ds_read_b128 v[96:99], v8 offset:15360
    v_cvt_pk_bf16_f32 v52, v48, v49
    v_smfmac_f32_16x16x64_bf16 v[56:59], v[44:47], a[176:183], v1
    ds_read_b128 v[100:103], v8 offset:19456
    v_cvt_pk_bf16_f32 v53, v50, v51
    v_smfmac_f32_16x16x64_bf16 v[60:63], v[44:47], a[184:191], v1
    ds_write_b64 v5, v[52:53]
    v_smfmac_f32_16x16x64_bf16 v[64:67], v[24:27], a[224:231], v1
    v_smfmac_f32_16x16x64_bf16 v[68:71], v[24:27], a[232:239], v1
    global_load_dword v0, v9, s[26:27] sc1
    v_permlane32_swap_b32 v56, v60
    v_smfmac_f32_16x16x64_bf16 v[64:67], v[28:31], a[240:247], v1
    v_permlane32_swap_b32 v57, v61
    v_smfmac_f32_16x16x64_bf16 v[68:71], v[28:31], a[248:255], v1
    v_permlane32_swap_b32 v58, v62
    v_smfmac_f32_16x16x64_bf16 v[64:67], v[32:35], v[136:143], v1
    v_permlane32_swap_b32 v59, v63
    v_smfmac_f32_16x16x64_bf16 v[68:71], v[32:35], v[144:151], v1
    s_waitcnt lgkmcnt(0)
    s_barrier
    ds_read_b64_tr_b16 v[112:113], v6 offset:0
    ds_read_b64_tr_b16 v[114:115], v6 offset:64
    v_add_f32 v56, v56, v60
    v_smfmac_f32_16x16x64_bf16 v[64:67], v[36:39], v[152:159], v1
    ds_read_b64_tr_b16 v[116:117], v6 offset:512
    ds_read_b64_tr_b16 v[118:119], v6 offset:576
    v_add_f32 v57, v57, v61
    v_smfmac_f32_16x16x64_bf16 v[68:71], v[36:39], v[160:167], v1
    ds_read_b64_tr_b16 v[120:121], v6 offset:1024
    ds_read_b64_tr_b16 v[122:123], v6 offset:1088
    v_add_f32 v58, v58, v62
    v_smfmac_f32_16x16x64_bf16 v[64:67], v[40:43], v[168:175], v1
    ds_read_b64_tr_b16 v[124:125], v6 offset:1536
    ds_read_b64_tr_b16 v[126:127], v6 offset:1600
    v_add_f32 v59, v59, v63
    v_smfmac_f32_16x16x64_bf16 v[68:71], v[40:43], v[176:183], v1
    v_cvt_pk_bf16_f32 v60, v56, v57
    v_cvt_pk_bf16_f32 v61, v58, v59
    v_smfmac_f32_16x16x64_bf16 v[64:67], v[44:47], v[184:191], v1
    ds_write_b64 v5, v[60:61] offset:2048
    v_smfmac_f32_16x16x64_bf16 v[68:71], v[44:47], v[192:199], v1
    s_waitcnt lgkmcnt(7)
    v_mfma_f32_16x16x32_bf16 v[48:51], v[72:75], v[112:115], 0
    v_mfma_f32_16x16x32_bf16 v[52:55], v[76:79], v[112:115], 0
    s_mov_b64 exec, 1
    global_store_dword v11, v1, s[26:27] sc1
    s_mov_b64 exec, -1
    s_waitcnt lgkmcnt(5)
    v_cvt_pk_bf16_f32 v64, v64, v65
    v_cvt_pk_bf16_f32 v65, v66, v67
    v_mfma_f32_16x16x32_bf16 v[48:51], v[80:83], v[116:119], v[48:51]
    v_cvt_pk_bf16_f32 v66, v68, v69
    v_cvt_pk_bf16_f32 v67, v70, v71
    v_mfma_f32_16x16x32_bf16 v[52:55], v[84:87], v[116:119], v[52:55]
    global_store_dwordx4 v7, v[64:67], s[82:83] offset:1024 sc1
    s_waitcnt lgkmcnt(3)
    v_mfma_f32_16x16x32_bf16 v[48:51], v[88:91], v[120:123], v[48:51]
    s_waitcnt lgkmcnt(0)
    s_barrier
    ds_read_b64_tr_b16 v[16:17], v6 offset:2048
    ds_read_b64_tr_b16 v[18:19], v6 offset:2112
    v_mfma_f32_16x16x32_bf16 v[52:55], v[92:95], v[120:123], v[52:55]
    ds_read_b64_tr_b16 v[20:21], v6 offset:2560
    ds_read_b64_tr_b16 v[22:23], v6 offset:2624
    ds_read_b64_tr_b16 v[24:25], v6 offset:3072
    ds_read_b64_tr_b16 v[26:27], v6 offset:3136
    v_mov_b64 v[68:69], s[86:87]
    v_mfma_f32_16x16x32_bf16 v[48:51], v[96:99], v[124:127], v[48:51]
    ds_read_b64_tr_b16 v[28:29], v6 offset:3584
    ds_read_b64_tr_b16 v[30:31], v6 offset:3648
    v_mov_b64 v[70:71], s[86:87]
    v_mfma_f32_16x16x32_bf16 v[52:55], v[100:103], v[124:127], v[52:55]
    ds_read_b128 v[32:35], v4 offset:24576
    s_waitcnt lgkmcnt(7)
    v_mov_b64 v[62:63], s[98:99]
    v_mfma_f32_16x16x32_bf16 v[56:59], v[16:19], v[112:115], 0
    global_store_dwordx4 v7, v[16:19], s[82:83] sc1
    s_waitcnt lgkmcnt(5)
    v_max3_f32 v13, v48, v49, v50
    v_mfma_f32_16x16x32_bf16 v[56:59], v[20:23], v[116:119], v[56:59]
    ds_read_b128 v[36:39], v4 offset:25600
    s_waitcnt lgkmcnt(4)
    v_max3_f32 v13, v13, v51, v52
    v_max3_f32 v15, v53, v54, v55
    v_mfma_f32_16x16x32_bf16 v[56:59], v[24:27], v[120:123], v[56:59]
    ds_read_b128 v[40:43], v4 offset:26624
    s_waitcnt lgkmcnt(3)
    v_max_f32 v14, v13, v15
    v_max_f32 v13, v13, v15
    v_mfma_f32_16x16x32_bf16 v[56:59], v[28:31], v[124:127], v[56:59]
    ds_read_b128 v[44:47], v4 offset:27648
    s_cmp_eq_u32 s64, 63
    s_cbranch_scc1 L_chain_fin
    v_permlane32_swap_b32 v13, v14
    v_max_f32 v13, v13, v14
    s_nop 2
    v_max3_f32 v13, v13, v56, v57
    v_max3_f32 v13, v13, v58, v59
    v_mov_b32 v14, v13
    s_nop 1
    v_permlane16_swap_b32 v13, v14
    v_max_f32 v13, v13, v14
    v_mul_f32 v14, s84, v13
    v_pk_fma_f32 v[48:49], v[48:49], s[84:85], v[14:15] op_sel_hi:[1,1,0] neg_lo:[0,0,1] neg_hi:[0,0,1]
    v_pk_fma_f32 v[50:51], v[50:51], s[84:85], v[14:15] op_sel_hi:[1,1,0] neg_lo:[0,0,1] neg_hi:[0,0,1]
    v_pk_fma_f32 v[52:53], v[52:53], s[84:85], v[14:15] op_sel_hi:[1,1,0] neg_lo:[0,0,1] neg_hi:[0,0,1]
    v_pk_fma_f32 v[54:55], v[54:55], s[84:85], v[14:15] op_sel_hi:[1,1,0] neg_lo:[0,0,1] neg_hi:[0,0,1]
    v_pk_fma_f32 v[56:57], v[56:57], s[84:85], v[14:15] op_sel_hi:[1,1,0] neg_lo:[0,0,1] neg_hi:[0,0,1]
    v_pk_fma_f32 v[58:59], v[58:59], s[84:85], v[14:15] op_sel_hi:[1,1,0] neg_lo:[0,0,1] neg_hi:[0,0,1]
    v_exp_f32 v48, v48
    v_exp_f32 v49, v49
    v_exp_f32 v50, v50
    v_exp_f32 v51, v51
    v_exp_f32 v52, v52
    v_exp_f32 v53, v53
    v_exp_f32 v54, v54
    v_exp_f32 v55, v55
    v_cvt_pk_bf16_f32 v48, v48, v49
    v_cvt_pk_bf16_f32 v49, v50, v51
    v_cvt_pk_bf16_f32 v50, v52, v53
    v_cvt_pk_bf16_f32 v51, v54, v55
    v_exp_f32 v56, v56
    v_exp_f32 v57, v57
    v_mfma_f32_16x16x32_bf16 v[120:123], v[68:71], v[48:51], 0
    s_waitcnt vmcnt(9)
    v_exp_f32 v58, v58
    v_mfma_f32_16x16x32_bf16 v[112:115], v[104:107], v[48:51], 0
    v_exp_f32 v59, v59
    v_mfma_f32_16x16x32_bf16 v[116:119], v[108:111], v[48:51], 0
    v_cvt_pk_bf16_f32 v56, v56, v57
    v_cvt_pk_bf16_f32 v57, v58, v59
    v_mov_b64 v[68:69], 0
    v_mov_b64 v[70:71], 0
    v_mfma_f32_16x16x16_bf16 v[120:123], v[62:63], v[56:57], v[120:123]
    ds_read_b128 v[72:75], v4 offset:16384
    v_mov_b64 v[58:59], 0
    v_mfma_f32_16x16x16_bf16 v[112:115], v[64:65], v[56:57], v[112:115]
    ds_read_b128 v[76:79], v4 offset:17408
    v_mov_b64 v[60:61], 0
    v_mfma_f32_16x16x16_bf16 v[116:119], v[66:67], v[56:57], v[116:119]
    ds_read_b128 v[80:83], v4 offset:18432
    v_rcp_f32 v14, v120
    v_mov_b64 v[62:63], 0
    v_mov_b64 v[56:57], 0
    v_mov_b64 v[64:65], 0
    v_mov_b64 v[66:67], 0
    v_pk_mul_f32 v[112:113], v[112:113], v[14:15] op_sel_hi:[1,0]
    v_pk_mul_f32 v[114:115], v[114:115], v[14:15] op_sel_hi:[1,0]
    v_pk_mul_f32 v[116:117], v[116:117], v[14:15] op_sel_hi:[1,0]
    v_pk_mul_f32 v[118:119], v[118:119], v[14:15] op_sel_hi:[1,0]
    v_cvt_pk_bf16_f32 v48, v112, v116
    v_cvt_pk_bf16_f32 v49, v113, v117
    v_cvt_pk_bf16_f32 v50, v114, v118
    v_cvt_pk_bf16_f32 v51, v115, v119
    ds_write_b128 v7, v[48:51]
    s_nop 0
    v_smfmac_f32_16x16x64_bf16 v[56:59], v[48:51], v[200:207], v1
    ds_read_b128 v[104:107], v4 offset:32768
    v_smfmac_f32_16x16x64_bf16 v[60:63], v[48:51], v[232:239], v1
    ds_read_b128 v[108:111], v4 offset:33792
    s_waitcnt lgkmcnt(4)
    v_smfmac_f32_16x16x64_bf16 v[64:67], v[48:51], v[72:79], v1
    s_waitcnt lgkmcnt(2)
    s_barrier
    ds_read_b128 v[116:119], v8 offset:2048
    ds_read_b128 v[120:123], v8 offset:4096
    ds_read_b128 v[124:127], v8 offset:6144
    ds_read_b128 v[84:87], v4 offset:19456
    ds_read_b128 v[88:91], v4 offset:20480
    v_smfmac_f32_16x16x64_bf16 v[68:71], v[48:51], v[32:39], v1
    s_waitcnt lgkmcnt(4)
    v_smfmac_f32_16x16x64_bf16 v[56:59], v[116:119], v[208:215], v1
    ds_read_b128 v[92:95], v4 offset:21504
    s_waitcnt lgkmcnt(4)
    v_smfmac_f32_16x16x64_bf16 v[56:59], v[120:123], v[216:223], v1
    ds_read_b128 v[96:99], v4 offset:22528
    s_waitcnt lgkmcnt(4)
    v_smfmac_f32_16x16x64_bf16 v[56:59], v[124:127], v[224:231], v1
    ds_read_b128 v[100:103], v4 offset:23552
    v_smfmac_f32_16x16x64_bf16 v[60:63], v[116:119], v[240:247], v1
    ds_read_b128 v[16:19], v4 offset:28672
    v_smfmac_f32_16x16x64_bf16 v[60:63], v[120:123], v[248:255], v1
    ds_read_b128 v[20:23], v4 offset:29696
    v_cvt_pk_bf16_f32 v56, v56, v57
    v_cvt_pk_bf16_f32 v57, v58, v59
    v_smfmac_f32_16x16x64_bf16 v[60:63], v[124:127], v[104:111], v1
    global_store_dwordx2 v2, v[56:57], s[66:67] offset:-4096
    s_waitcnt lgkmcnt(6)
    v_smfmac_f32_16x16x64_bf16 v[64:67], v[116:119], v[80:87], v1
    ds_read_b128 v[24:27], v4 offset:30720
    s_waitcnt lgkmcnt(5)
    v_smfmac_f32_16x16x64_bf16 v[64:67], v[120:123], v[88:95], v1
    ds_read_b128 v[28:31], v4 offset:31744
    s_waitcnt lgkmcnt(4)
    v_cvt_pk_bf16_f32 v60, v60, v61
    v_cvt_pk_bf16_f32 v61, v62, v63
    v_smfmac_f32_16x16x64_bf16 v[64:67], v[124:127], v[96:103], v1
    global_store_dwordx2 v2, v[60:61], s[66:67] offset:-2048
    v_smfmac_f32_16x16x64_bf16 v[68:71], v[116:119], v[40:47], v1
    ds_read_b128 v[72:75], v4 offset:0
    s_waitcnt lgkmcnt(3)
    v_smfmac_f32_16x16x64_bf16 v[68:71], v[120:123], v[16:23], v1
    ds_read_b128 v[76:79], v4 offset:1024
    s_waitcnt lgkmcnt(2)
    v_cvt_pk_bf16_f32 v64, v64, v65
    v_cvt_pk_bf16_f32 v65, v66, v67
    v_smfmac_f32_16x16x64_bf16 v[68:71], v[124:127], v[24:31], v1
    global_store_dwordx2 v2, v[64:65], s[66:67] offset:0
    s_nop 6
    v_cvt_pk_bf16_f32 v68, v68, v69
    v_cvt_pk_bf16_f32 v69, v70, v71
    global_store_dwordx2 v2, v[68:69], s[66:67] offset:2048
    ds_read_b128 v[80:83], v4 offset:2048
    ds_read_b128 v[84:87], v4 offset:3072
    ds_read_b128 v[88:91], v4 offset:4096
    ds_read_b128 v[92:95], v4 offset:5120
    ds_read_b128 v[96:99], v4 offset:6144
    ds_read_b128 v[100:103], v4 offset:7168
    ds_read_b128 v[104:107], v8 offset:20480
    v_mov_b64 v[48:49], 0
    v_mov_b64 v[50:51], 0
    v_mov_b64 v[52:53], 0
    v_mov_b64 v[54:55], 0
    v_mov_b64 v[56:57], 0
    v_mov_b64 v[58:59], 0
    v_mov_b64 v[60:61], 0
    v_mov_b64 v[62:63], 0
    v_mov_b64 v[64:65], 0
    v_mov_b64 v[66:67], 0
    v_mov_b64 v[68:69], 0
    v_mov_b64 v[70:71], 0
    s_lshr_b32 s42, s100, 5
    s_add_u32 s76, s46, s42
    s_addc_u32 s77, s47, 0
    s_sub_u32 s74, s76, 0x22000
    s_subb_u32 s75, s77, 0
    s_add_u32 s42, s42, 0x6000
    s_and_b32 s42, s42, 0x6000
    s_add_u32 s36, s46, s42
    s_addc_u32 s37, s47, 0
    s_add_u32 s64, s64, 1
    v_add_u32 v9, v9, v10
    v_add_u32 v11, 4, v11
    global_load_dwordx4 v[112:115], v12, s[68:69] sc1
    global_load_dwordx4 v[116:119], v12, s[68:69] offset:1024 sc1
    s_add_u32 s80, s80, 0x40000
    s_addc_u32 s81, s81, 0
    s_add_u32 s78, s78, 0x40000
    s_addc_u32 s79, s79, 0
    s_add_u32 s82, s82, 0x40000
    s_addc_u32 s83, s83, 0
    s_nop 0
    s_nop 0
    v_mov_b32 v14, 0
    s_nop 2
    v_mov_b32 v14, 0
    s_nop 2
    v_mov_b32 v14, 0
    s_nop 2
    v_mov_b32 v14, 0
    s_nop 2
    v_mov_b32 v14, 0
    s_nop 2
    v_mov_b32 v14, 0
    s_nop 2
    v_mov_b32 v14, 0
    s_nop 2
    global_load_dwordx4 v[112:115], v12, s[68:69] sc1
    global_load_dwordx4 v[116:119], v12, s[68:69] offset:1024 sc1
    s_waitcnt lgkmcnt(0)
    s_waitcnt vmcnt(11)
    ds_write_b128 v7, v[128:131] offset:12288
    ds_write_b128 v7, v[132:135] offset:13312
    v_mov_b32 v14, 0
    s_nop 2
    s_waitcnt vmcnt(2)
    v_max3_u32 v14, v112, v113, v114
    v_max3_u32 v15, v115, v116, v117
    v_max3_u32 v14, v14, v118, v119
    v_max_u32 v14, v14, v15
    v_cmp_eq_u32 vcc, -1, v14
    s_cbranch_vccnz L_hop1_0
L_hop1_ok0:
    v_mfma_f32_16x16x32_bf16 v[108:111], v[112:115], v[104:107], 0
    v_mfma_f32_16x16x32_bf16 v[108:111], v[116:119], v[104:107], v[108:111]
    s_nop 7
    v_add_f32 v108, v108, v109
    v_add_f32 v110, v110, v111
    s_nop 1
    v_permlane32_swap_b32 v108, v110
    v_add_f32 v108, v108, v110
    s_nop 1
    v_mov_b32_dpp v109, v108 row_shl:4 row_mask:0xf bank_mask:0xf
    v_cvt_pk_bf16_f32 v108, v108, v109
    s_mov_b64 exec, s[44:45]
    global_store_dword v3, v108, s[76:77]
    s_mov_b64 exec, -1
    s_mov_b64 s[70:71], s[68:69]
    s_add_u32 s100, s100, 0x40000
    s_and_b32 s100, s100, 0xc0000
    s_add_u32 s42, s100, s101
    s_add_u32 s68, s72, s42
    s_addc_u32 s69, s73, 0
    s_add_u32 s42, s100, 0x23000
    s_add_u32 s66, s72, s42
    s_addc_u32 s67, s73, 0
    v_readlane_b32 s41, v0, 48
    s_nop 0
    s_cmp_eq_u32 s41, 0x01010101
    s_cbranch_scc0 L_flag_slow0
L_flag_ok0:
    v_mov_b32 v14, 0
    s_nop 2
    v_mov_b32 v14, 0
    s_nop 2
    v_mov_b32 v14, 0
    s_nop 2
    v_mov_b32 v14, 0
    s_nop 2
    v_mov_b32 v14, 0
    s_nop 2
    v_mov_b32 v14, 0
    s_nop 2
    v_mov_b32 v14, 0
    s_nop 2
    global_load_dwordx4 v[16:19], v7, s[74:75] sc1
    global_load_dwordx4 v[20:23], v7, s[74:75] offset:1024 sc1
    v_mov_b32 v14, 0
    s_nop 2
    v_mov_b32 v14, 0
    s_nop 2
    v_mov_b32 v14, 0
    s_nop 2
    v_mov_b32 v14, 0
    s_nop 2
    v_mov_b32 v14, 0
    s_nop 2
    v_mov_b32 v14, 0
    s_nop 2
    v_mov_b32 v14, 0
    s_nop 2
    v_mov_b32 v14, 0
    s_nop 2
    v_mov_b32 v14, 0
    s_nop 2
    global_load_dwordx4 v[16:19], v7, s[74:75] sc1
    global_load_dwordx4 v[20:23], v7, s[74:75] offset:1024 sc1
    v_mov_b32 v14, 0
    s_nop 2
    v_mov_b32 v14, 0
    s_nop 2
    v_mov_b32 v14, 0
    s_nop 2
    s_waitcnt lgkmcnt(0)
    s_waitcnt vmcnt(2)
    v_max3_u32 v14, v16, v17, v18
    v_max3_u32 v15, v19, v20, v21
    v_max3_u32 v14, v14, v22, v23
    v_max_u32 v14, v14, v15
    v_cmp_eq_u32 vcc, -1, v14
    s_cbranch_vccz L_step0
L_hop2_0:
    s_mov_b64 exec, vcc
    global_load_dwordx4 v[16:19], v7, s[74:75] sc1
    global_load_dwordx4 v[20:23], v7, s[74:75] offset:1024 sc1
    s_mov_b64 exec, -1
    v_max3_u32 v14, v16, v17, v18
    v_max3_u32 v15, v19, v20, v21
    v_max3_u32 v14, v14, v22, v23
    v_max_u32 v14, v14, v15
    v_cmp_eq_u32 vcc, -1, v14
    s_cbranch_vccz L_step0
    v_max3_u32 v14, v16, v17, v18
    v_max3_u32 v15, v19, v20, v21
    v_max3_u32 v14, v14, v22, v23
    v_max_u32 v14, v14, v15
    v_cmp_eq_u32 vcc, -1, v14
    s_cbranch_vccz L_step0
    s_mov_b64 exec, vcc
    global_load_dwordx4 v[16:19], v7, s[74:75] sc1
    global_load_dwordx4 v[20:23], v7, s[74:75] offset:1024 sc1
    s_mov_b64 exec, -1
    v_max3_u32 v14, v16, v17, v18
    v_max3_u32 v15, v19, v20, v21
    v_max3_u32 v14, v14, v22, v23
    v_max_u32 v14, v14, v15
    v_cmp_eq_u32 vcc, -1, v14
    s_cbranch_vccz L_step0
    v_max3_u32 v14, v16, v17, v18
    v_max3_u32 v15, v19, v20, v21
    v_max3_u32 v14, v14, v22, v23
    v_max_u32 v14, v14, v15
    v_cmp_eq_u32 vcc, -1, v14
    s_cbranch_vccz L_step0
    s_waitcnt vmcnt(32)
    s_add_u32 s39, s39, 1
    s_cmp_gt_u32 s39, 0x400000
    s_cbranch_scc1 L_fail
    s_branch L_hop2_0
L_hop1_0:
    s_mov_b64 exec, vcc
    global_load_dwordx4 v[112:115], v12, s[68:69] sc1
    global_load_dwordx4 v[116:119], v12, s[68:69] offset:1024 sc1
    s_mov_b64 exec, -1
    v_max3_u32 v14, v112, v113, v114
    v_max3_u32 v15, v115, v116, v117
    v_max3_u32 v14, v14, v118, v119
    v_max_u32 v14, v14, v15
    v_cmp_eq_u32 vcc, -1, v14
    s_cbranch_vccz L_hop1_ok0
    v_max3_u32 v14, v112, v113, v114
    v_max3_u32 v15, v115, v116, v117
    v_max3_u32 v14, v14, v118, v119
    v_max_u32 v14, v14, v15
    v_cmp_eq_u32 vcc, -1, v14
    s_cbranch_vccz L_hop1_ok0
    s_mov_b64 exec, vcc
    global_load_dwordx4 v[112:115], v12, s[68:69] sc1
    global_load_dwordx4 v[116:119], v12, s[68:69] offset:1024 sc1
    s_mov_b64 exec, -1
    v_max3_u32 v14, v112, v113, v114
    v_max3_u32 v15, v115, v116, v117
    v_max3_u32 v14, v14, v118, v119
    v_max_u32 v14, v14, v15
    v_cmp_eq_u32 vcc, -1, v14
    s_cbranch_vccz L_hop1_ok0
    v_max3_u32 v14, v112, v113, v114
    v_max3_u32 v15, v115, v116, v117
    v_max3_u32 v14, v14, v118, v119
    v_max_u32 v14, v14, v15
    v_cmp_eq_u32 vcc, -1, v14
    s_cbranch_vccz L_hop1_ok0
    s_waitcnt vmcnt(32)
    s_add_u32 s39, s39, 1
    s_cmp_gt_u32 s39, 0x400000
    s_cbranch_scc1 L_fail
    s_branch L_hop1_0
L_flag_slow0:
    s_cmp_ge_u32 s64, 63
    s_cbranch_scc1 L_flag_ok0
    s_lshl_b32 s40, s29, 6
    s_add_u32 s40, s40, s64
    s_lshl_b32 s40, s40, 2
    s_add_u32 s40, s40, 0x400004
    v_mov_b32 v14, s40
    v_mov_b32 v15, 0x01010101
L_wf_4:
    global_load_dword v0, v14, s[26:27] sc1
    s_add_u32 s39, s39, 1
    s_cmp_gt_u32 s39, 0x400000
    s_cbranch_scc1 L_fail
    s_sleep 1
    s_waitcnt vmcnt(0)
    v_cmp_ne_u32 vcc, v15, v0
    s_cbranch_vccnz L_wf_4
    s_branch L_flag_ok0
L_entry1:
    ds_read_b128 v[72:75], v4 offset:0
    ds_read_b128 v[76:79], v4 offset:1024
    ds_read_b128 v[80:83], v4 offset:2048
    ds_read_b128 v[84:87], v4 offset:3072
    ds_read_b128 v[88:91], v4 offset:4096
    ds_read_b128 v[92:95], v4 offset:5120
    ds_read_b128 v[96:99], v4 offset:6144
    ds_read_b128 v[100:103], v4 offset:7168
    v_mov_b64 v[48:49], 0
    v_mov_b64 v[50:51], 0
    v_mov_b64 v[52:53], 0
    v_mov_b64 v[54:55], 0
    v_mov_b64 v[56:57], 0
    v_mov_b64 v[58:59], 0
    v_mov_b64 v[60:61], 0
    v_mov_b64 v[62:63], 0
    v_mov_b64 v[64:65], 0
    v_mov_b64 v[66:67], 0
    v_mov_b64 v[68:69], 0
    v_mov_b64 v[70:71], 0
    s_mov_b64 s[70:71], s[68:69]
    s_add_u32 s100, s100, 0x40000
    s_and_b32 s100, s100, 0xc0000
    s_add_u32 s42, s100, s101
    s_add_u32 s68, s72, s42
    s_addc_u32 s69, s73, 0
    s_add_u32 s42, s100, 0x23000
    s_add_u32 s66, s72, s42
    s_addc_u32 s67, s73, 0
    s_add_u32 s36, s46, 0x4000
    s_addc_u32 s37, s47, 0
    s_lshl_b32 s40, s29, 8
    s_add_u32 s40, s40, 0x400004
    v_mov_b32 v14, s40
    v_mov_b32 v15, 0x01010101
    v_readlane_b32 s41, v0, 48
    s_nop 0
    s_cmp_eq_u32 s41, 0x01010101
    s_cbranch_scc1 L_e11
L_wf_5:
    global_load_dword v0, v14, s[26:27] sc1
    s_add_u32 s39, s39, 1
    s_cmp_gt_u32 s39, 0x400000
    s_cbranch_scc1 L_fail
    s_sleep 1
    s_waitcnt vmcnt(0)
    v_cmp_ne_u32 vcc, v15, v0
    s_cbranch_vccnz L_wf_5
L_e11:
    s_waitcnt lgkmcnt(0)
.p2align 6
L_step1:
    v_smfmac_f32_16x16x64_bf16 v[48:51], v[16:19], v[72:79], v1
    ds_write_b128 v7, v[16:19]
    v_smfmac_f32_16x16x64_bf16 v[52:55], v[16:19], v[80:87], v1
    ds_write_b128 v7, v[20:23] offset:1024
    v_smfmac_f32_16x16x64_bf16 v[48:51], v[20:23], v[88:95], v1
    ds_read_b128 v[72:75], v4 offset:8192
    v_smfmac_f32_16x16x64_bf16 v[52:55], v[20:23], v[96:103], v1
    ds_read_b128 v[76:79], v4 offset:9216
    v_mov_b64 v[112:113], -1
    v_smfmac_f32_16x16x64_bf16 v[56:59], v[16:19], a[96:103], v1
    ds_read_b128 v[80:83], v4 offset:10240
    v_mov_b64 v[114:115], -1
    v_smfmac_f32_16x16x64_bf16 v[60:63], v[16:19], a[104:111], v1
    ds_read_b128 v[84:87], v4 offset:11264
    v_smfmac_f32_16x16x64_bf16 v[56:59], v[20:23], a[112:119], v1
    v_smfmac_f32_16x16x64_bf16 v[60:63], v[20:23], a[120:127], v1
    s_waitcnt lgkmcnt(4)
    s_barrier
    ds_read_b128 v[24:27], v8 offset:0
    ds_read_b128 v[28:31], v8 offset:1024
    v_smfmac_f32_16x16x64_bf16 v[64:67], v[16:19], a[192:199], v1
    ds_read_b128 v[32:35], v8 offset:6144
    v_smfmac_f32_16x16x64_bf16 v[68:71], v[16:19], a[200:207], v1
    ds_read_b128 v[36:39], v8 offset:7168
    v_smfmac_f32_16x16x64_bf16 v[64:67], v[20:23], a[208:215], v1
    ds_read_b128 v[40:43], v8 offset:4096
    v_smfmac_f32_16x16x64_bf16 v[68:71], v[20:23], a[216:223], v1
    s_waitcnt vmcnt(0)
    ds_read_b128 v[44:47], v8 offset:5120
    global_load_dwordx4 v[104:107], v7, s[80:81] offset:0 sc1
    s_waitcnt lgkmcnt(5)
    v_smfmac_f32_16x16x64_bf16 v[48:51], v[24:27], a[0:7], v1
    global_load_dwordx4 v[108:111], v7, s[80:81] offset:1024 sc1
    v_smfmac_f32_16x16x64_bf16 v[52:55], v[24:27], a[8:15], v1
    ds_read_b128 v[88:91], v4 offset:12288
    s_waitcnt lgkmcnt(5)
    v_smfmac_f32_16x16x64_bf16 v[48:51], v[28:31], a[16:23], v1
    ds_read_b128 v[92:95], v4 offset:13312
    v_smfmac_f32_16x16x64_bf16 v[52:55], v[28:31], a[24:31], v1
    ds_read_b128 v[96:99], v4 offset:14336
    s_waitcnt lgkmcnt(6)
    v_smfmac_f32_16x16x64_bf16 v[48:51], v[32:35], a[32:39], v1
    ds_read_b128 v[100:103], v4 offset:15360
    v_smfmac_f32_16x16x64_bf16 v[52:55], v[32:35], a[40:47], v1
    s_waitcnt lgkmcnt(6)
    v_smfmac_f32_16x16x64_bf16 v[48:51], v[36:39], a[48:55], v1
    global_load_dwordx4 v[128:131], v7, s[78:79] offset:0 sc1
    v_smfmac_f32_16x16x64_bf16 v[52:55], v[36:39], a[56:63], v1
    s_waitcnt lgkmcnt(5)
    v_smfmac_f32_16x16x64_bf16 v[48:51], v[40:43], a[64:71], v1
    global_load_dwordx4 v[132:135], v7, s[78:79] offset:1024 sc1
    v_smfmac_f32_16x16x64_bf16 v[52:55], v[40:43], a[72:79], v1
    s_waitcnt lgkmcnt(4)
    v_smfmac_f32_16x16x64_bf16 v[48:51], v[44:47], a[80:87], v1
    s_mov_b64 exec, s[44:45]
    global_store_dword v3, v112, s[36:37]
    s_mov_b64 exec, -1
    v_smfmac_f32_16x16x64_bf16 v[52:55], v[44:47], a[88:95], v1
    v_smfmac_f32_16x16x64_bf16 v[56:59], v[24:27], v[72:79], v1
    v_smfmac_f32_16x16x64_bf16 v[60:63], v[24:27], v[80:87], v1
    ds_read_b128 v[72:75], v8 offset:12288
    s_waitcnt lgkmcnt(3)
    v_permlane32_swap_b32 v48, v52
    v_smfmac_f32_16x16x64_bf16 v[56:59], v[28:31], v[88:95], v1
    global_store_dwordx4 v7, v[112:115], s[70:71] offset:0
    s_waitcnt lgkmcnt(1)
    v_permlane32_swap_b32 v49, v53
    v_smfmac_f32_16x16x64_bf16 v[60:63], v[28:31], v[96:103], v1
    ds_read_b128 v[76:79], v8 offset:16384
    v_permlane32_swap_b32 v50, v54
    v_smfmac_f32_16x16x64_bf16 v[56:59], v[32:35], a[128:135], v1
    ds_read_b128 v[80:83], v8 offset:13312
    v_permlane32_swap_b32 v51, v55
    v_smfmac_f32_16x16x64_bf16 v[60:63], v[32:35], a[136:143], v1
    ds_read_b128 v[84:87], v8 offset:17408
    v_add_f32 v48, v48, v52
    v_smfmac_f32_16x16x64_bf16 v[56:59], v[36:39], a[144:151], v1
    ds_read_b128 v[88:91], v8 offset:14336
    v_add_f32 v49, v49, v53
    v_smfmac_f32_16x16x64_bf16 v[60:63], v[36:39], a[152:159], v1
    ds_read_b128 v[92:95], v8 offset:18432
    v_add_f32 v50, v50, v54
    v_smfmac_f32_16x16x64_bf16 v[56:59], v[40:43], a[160:167], v1
    global_store_dwordx4 v7, v[112:115], s[70:71] offset:1024
    v_add_f32 v51, v51, v55
    v_smfmac_f32_16x16x64_bf16 v[60:63], v[40:43], a[168:175], v1
    ds_read_b128 v[96:99], v8 offset:15360
    v_cvt_pk_bf16_f32 v52, v48, v49
    v_smfmac_f32_16x16x64_bf16 v[56:59], v[44:47], a[176:183], v1
    ds_read_b128 v[100:103], v8 offset:19456
    v_cvt_pk_bf16_f32 v53, v50, v51
    v_smfmac_f32_16x16x64_bf16 v[60:63], v[44:47], a[184:191], v1
    ds_write_b64 v5, v[52:53]
    v_smfmac_f32_16x16x64_bf16 v[64:67], v[24:27], a[224:231], v1
    v_smfmac_f32_16x16x64_bf16 v[68:71], v[24:27], a[232:239], v1
    global_load_dword v0, v9, s[26:27] sc1
    v_permlane32_swap_b32 v56, v60
    v_smfmac_f32_16x16x64_bf16 v[64:67], v[28:31], a[240:247], v1
    v_permlane32_swap_b32 v57, v61
    v_smfmac_f32_16x16x64_bf16 v[68:71], v[28:31], a[248:255], v1
    v_permlane32_swap_b32 v58, v62
    v_smfmac_f32_16x16x64_bf16 v[64:67], v[32:35], v[136:143], v1
    v_permlane32_swap_b32 v59, v63
    v_smfmac_f32_16x16x64_bf16 v[68:71], v[32:35], v[144:151], v1
    s_waitcnt lgkmcnt(0)
    s_barrier
    ds_read_b64_tr_b16 v[112:113], v6 offset:0
    ds_read_b64_tr_b16 v[114:115], v6 offset:64
    v_add_f32 v56, v56, v60
    v_smfmac_f32_16x16x64_bf16 v[64:67], v[36:39], v[152:159], v1
    ds_read_b64_tr_b16 v[116:117], v6 offset:512
    ds_read_b64_tr_b16 v[118:119], v6 offset:576
    v_add_f32 v57, v57, v61
    v_smfmac_f32_16x16x64_bf16 v[68:71], v[36:39], v[160:167], v1
    ds_read_b64_tr_b16 v[120:121], v6 offset:1024
    ds_read_b64_tr_b16 v[122:123], v6 offset:1088
    v_add_f32 v58, v58, v62
    v_smfmac_f32_16x16x64_bf16 v[64:67], v[40:43], v[168:175], v1
    ds_read_b64_tr_b16 v[124:125], v6 offset:1536
    ds_read_b64_tr_b16 v[126:127], v6 offset:1600
    v_add_f32 v59, v59, v63
    v_smfmac_f32_16x16x64_bf16 v[68:71], v[40:43], v[176:183], v1
    v_cvt_pk_bf16_f32 v60, v56, v57
    v_cvt_pk_bf16_f32 v61, v58, v59
    v_smfmac_f32_16x16x64_bf16 v[64:67], v[44:47], v[184:191], v1
    ds_write_b64 v5, v[60:61] offset:2048
    v_smfmac_f32_16x16x64_bf16 v[68:71], v[44:47], v[192:199], v1
    s_waitcnt lgkmcnt(7)
    v_mfma_f32_16x16x32_bf16 v[48:51], v[72:75], v[112:115], 0
    v_mfma_f32_16x16x32_bf16 v[52:55], v[76:79], v[112:115], 0
    s_waitcnt lgkmcnt(5)
    v_cvt_pk_bf16_f32 v64, v64, v65
    v_cvt_pk_bf16_f32 v65, v66, v67
    v_mfma_f32_16x16x32_bf16 v[48:51], v[80:83], v[116:119], v[48:51]
    v_cvt_pk_bf16_f32 v66, v68, v69
    v_cvt_pk_bf16_f32 v67, v70, v71
    v_mfma_f32_16x16x32_bf16 v[52:55], v[84:87], v[116:119], v[52:55]
    global_store_dwordx4 v7, v[64:67], s[82:83] offset:1024 sc1
    s_waitcnt lgkmcnt(3)
    v_mfma_f32_16x16x32_bf16 v[48:51], v[88:91], v[120:123], v[48:51]
    s_waitcnt lgkmcnt(0)
    s_barrier
    ds_read_b64_tr_b16 v[16:17], v6 offset:2048
    ds_read_b64_tr_b16 v[18:19], v6 offset:2112
    v_mfma_f32_16x16x32_bf16 v[52:55], v[92:95], v[120:123], v[52:55]
    ds_read_b64_tr_b16 v[20:21], v6 offset:2560
    ds_read_b64_tr_b16 v[22:23], v6 offset:2624
    ds_read_b64_tr_b16 v[24:25], v6 offset:3072
    ds_read_b64_tr_b16 v[26:27], v6 offset:3136
    v_mov_b64 v[68:69], s[86:87]
    v_mfma_f32_16x16x32_bf16 v[48:51], v[96:99], v[124:127], v[48:51]
    ds_read_b64_tr_b16 v[28:29], v6 offset:3584
    ds_read_b64_tr_b16 v[30:31], v6 offset:3648
    v_mov_b64 v[70:71], s[86:87]
    v_mfma_f32_16x16x32_bf16 v[52:55], v[100:103], v[124:127], v[52:55]
    ds_read_b128 v[32:35], v4 offset:26624
    s_waitcnt lgkmcnt(7)
    v_mov_b64 v[62:63], s[98:99]
    v_mfma_f32_16x16x32_bf16 v[56:59], v[16:19], v[112:115], 0
    ds_read_b128 v[36:39], v4 offset:27648
    s_waitcnt lgkmcnt(6)
    v_max3_f32 v13, v48, v49, v50
    v_mfma_f32_16x16x32_bf16 v[56:59], v[20:23], v[116:119], v[56:59]
    global_store_dwordx4 v7, v[20:23], s[82:83] sc1
    s_waitcnt lgkmcnt(4)
    v_max3_f32 v13, v13, v51, v52
    v_max3_f32 v15, v53, v54, v55
    v_mfma_f32_16x16x32_bf16 v[56:59], v[24:27], v[120:123], v[56:59]
    ds_read_b128 v[40:43], v4 offset:24576
    s_waitcnt lgkmcnt(3)
    v_max_f32 v14, v13, v15
    v_max_f32 v13, v13, v15
    v_mfma_f32_16x16x32_bf16 v[56:59], v[28:31], v[124:127], v[56:59]
    ds_read_b128 v[44:47], v4 offset:25600
    s_cmp_eq_u32 s64, 63
    s_cbranch_scc1 L_chain_fin
    v_permlane32_swap_b32 v13, v14
    v_max_f32 v13, v13, v14
    s_nop 2
    v_max3_f32 v13, v13, v56, v57
    v_max3_f32 v13, v13, v58, v59
    v_mov_b32 v14, v13
    s_nop 1
    v_permlane16_swap_b32 v13, v14
    v_max_f32 v13, v13, v14
    v_mul_f32 v14, s84, v13
    v_pk_fma_f32 v[48:49], v[48:49], s[84:85], v[14:15] op_sel_hi:[1,1,0] neg_lo:[0,0,1] neg_hi:[0,0,1]
    v_pk_fma_f32 v[50:51], v[50:51], s[84:85], v[14:15] op_sel_hi:[1,1,0] neg_lo:[0,0,1] neg_hi:[0,0,1]
    v_pk_fma_f32 v[52:53], v[52:53], s[84:85], v[14:15] op_sel_hi:[1,1,0] neg_lo:[0,0,1] neg_hi:[0,0,1]
    v_pk_fma_f32 v[54:55], v[54:55], s[84:85], v[14:15] op_sel_hi:[1,1,0] neg_lo:[0,0,1] neg_hi:[0,0,1]
    v_pk_fma_f32 v[56:57], v[56:57], s[84:85], v[14:15] op_sel_hi:[1,1,0] neg_lo:[0,0,1] neg_hi:[0,0,1]
    v_pk_fma_f32 v[58:59], v[58:59], s[84:85], v[14:15] op_sel_hi:[1,1,0] neg_lo:[0,0,1] neg_hi:[0,0,1]
    v_exp_f32 v48, v48
    v_exp_f32 v49, v49
    v_exp_f32 v50, v50
    v_exp_f32 v51, v51
    v_exp_f32 v52, v52
    v_exp_f32 v53, v53
    v_exp_f32 v54, v54
    v_exp_f32 v55, v55
    v_cvt_pk_bf16_f32 v48, v48, v49
    v_cvt_pk_bf16_f32 v49, v50, v51
    v_cvt_pk_bf16_f32 v50, v52, v53
    v_cvt_pk_bf16_f32 v51, v54, v55
    v_exp_f32 v56, v56
    v_exp_f32 v57, v57
    v_mfma_f32_16x16x32_bf16 v[120:123], v[68:71], v[48:51], 0
    s_waitcnt vmcnt(8)
    v_exp_f32 v58, v58
    v_mfma_f32_16x16x32_bf16 v[112:115], v[104:107], v[48:51], 0
    v_exp_f32 v59, v59
    v_mfma_f32_16x16x32_bf16 v[116:119], v[108:111], v[48:51], 0
    v_cvt_pk_bf16_f32 v56, v56, v57
    v_cvt_pk_bf16_f32 v57, v58, v59
    v_mov_b64 v[68:69], 0
    v_mov_b64 v[70:71], 0
    v_mfma_f32_16x16x16_bf16 v[120:123], v[62:63], v[56:57], v[120:123]
    ds_read_b128 v[80:83], v4 offset:18432
    v_mov_b64 v[58:59], 0
    v_mfma_f32_16x16x16_bf16 v[112:115], v[64:65], v[56:57], v[112:115]
    ds_read_b128 v[84:87], v4 offset:19456
    v_mov_b64 v[60:61], 0
    v_mfma_f32_16x16x16_bf16 v[116:119], v[66:67], v[56:57], v[116:119]
    ds_read_b128 v[72:75], v4 offset:16384
    v_rcp_f32 v14, v120
    v_mov_b64 v[62:63], 0
    v_mov_b64 v[56:57], 0
    v_mov_b64 v[64:65], 0
    v_mov_b64 v[66:67], 0
    v_pk_mul_f32 v[112:113], v[112:113], v[14:15] op_sel_hi:[1,0]
    v_pk_mul_f32 v[114:115], v[114:115], v[14:15] op_sel_hi:[1,0]
    v_pk_mul_f32 v[116:117], v[116:117], v[14:15] op_sel_hi:[1,0]
    v_pk_mul_f32 v[118:119], v[118:119], v[14:15] op_sel_hi:[1,0]
    v_cvt_pk_bf16_f32 v48, v112, v116
    v_cvt_pk_bf16_f32 v49, v113, v117
    v_cvt_pk_bf16_f32 v50, v114, v118
    v_cvt_pk_bf16_f32 v51, v115, v119
    ds_write_b128 v7, v[48:51]
    s_nop 0
    v_smfmac_f32_16x16x64_bf16 v[56:59], v[48:51], v[208:215], v1
    ds_read_b128 v[104:107], v4 offset:32768
    v_smfmac_f32_16x16x64_bf16 v[60:63], v[48:51], v[240:247], v1
    ds_read_b128 v[108:111], v4 offset:33792
    s_waitcnt lgkmcnt(4)
    v_smfmac_f32_16x16x64_bf16 v[64:67], v[48:51], v[80:87], v1
    s_waitcnt lgkmcnt(2)
    s_barrier
    ds_read_b128 v[112:115], v8 offset:0
    ds_read_b128 v[120:123], v8 offset:4096
    ds_read_b128 v[124:127], v8 offset:6144
    ds_read_b128 v[76:79], v4 offset:17408
    ds_read_b128 v[88:91], v4 offset:20480
    v_smfmac_f32_16x16x64_bf16 v[68:71], v[48:51], v[32:39], v1
    s_waitcnt lgkmcnt(4)
    v_smfmac_f32_16x16x64_bf16 v[56:59], v[112:115], v[200:207], v1
    ds_read_b128 v[92:95], v4 offset:21504
    s_waitcnt lgkmcnt(4)
    v_smfmac_f32_16x16x64_bf16 v[56:59], v[120:123], v[216:223], v1
    ds_read_b128 v[96:99], v4 offset:22528
    s_waitcnt lgkmcnt(4)
    v_smfmac_f32_16x16x64_bf16 v[56:59], v[124:127], v[224:231], v1
    ds_read_b128 v[100:103], v4 offset:23552
    v_smfmac_f32_16x16x64_bf16 v[60:63], v[112:115], v[232:239], v1
    ds_read_b128 v[16:19], v4 offset:28672
    v_smfmac_f32_16x16x64_bf16 v[60:63], v[120:123], v[248:255], v1
    ds_read_b128 v[20:23], v4 offset:29696
    v_cvt_pk_bf16_f32 v56, v56, v57
    v_cvt_pk_bf16_f32 v57, v58, v59
    v_smfmac_f32_16x16x64_bf16 v[60:63], v[124:127], v[104:111], v1
    global_store_dwordx2 v2, v[56:57], s[66:67] offset:-4096
    s_waitcnt lgkmcnt(6)
    v_smfmac_f32_16x16x64_bf16 v[64:67], v[112:115], v[72:79], v1
    ds_read_b128 v[24:27], v4 offset:30720
    s_waitcnt lgkmcnt(5)
    v_smfmac_f32_16x16x64_bf16 v[64:67], v[120:123], v[88:95], v1
    ds_read_b128 v[28:31], v4 offset:31744
    s_waitcnt lgkmcnt(4)
    v_cvt_pk_bf16_f32 v60, v60, v61
    v_cvt_pk_bf16_f32 v61, v62, v63
    v_smfmac_f32_16x16x64_bf16 v[64:67], v[124:127], v[96:103], v1
    global_store_dwordx2 v2, v[60:61], s[66:67] offset:-2048
    v_smfmac_f32_16x16x64_bf16 v[68:71], v[112:115], v[40:47], v1
    ds_read_b128 v[72:75], v4 offset:0
    s_waitcnt lgkmcnt(3)
    v_smfmac_f32_16x16x64_bf16 v[68:71], v[120:123], v[16:23], v1
    ds_read_b128 v[76:79], v4 offset:1024
    s_waitcnt lgkmcnt(2)
    v_cvt_pk_bf16_f32 v64, v64, v65
    v_cvt_pk_bf16_f32 v65, v66, v67
    v_smfmac_f32_16x16x64_bf16 v[68:71], v[124:127], v[24:31], v1
    global_store_dwordx2 v2, v[64:65], s[66:67] offset:0
    s_nop 6
    v_cvt_pk_bf16_f32 v68, v68, v69
    v_cvt_pk_bf16_f32 v69, v70, v71
    global_store_dwordx2 v2, v[68:69], s[66:67] offset:2048
    ds_read_b128 v[80:83], v4 offset:2048
    ds_read_b128 v[84:87], v4 offset:3072
    ds_read_b128 v[88:91], v4 offset:4096
    ds_read_b128 v[92:95], v4 offset:5120
    ds_read_b128 v[96:99], v4 offset:6144
    ds_read_b128 v[100:103], v4 offset:7168
    ds_read_b128 v[104:107], v8 offset:20480
    v_mov_b64 v[48:49], 0
    v_mov_b64 v[50:51], 0
    v_mov_b64 v[52:53], 0
    v_mov_b64 v[54:55], 0
    v_mov_b64 v[56:57], 0
    v_mov_b64 v[58:59], 0
    v_mov_b64 v[60:61], 0
    v_mov_b64 v[62:63], 0
    v_mov_b64 v[64:65], 0
    v_mov_b64 v[66:67], 0
    v_mov_b64 v[68:69], 0
    v_mov_b64 v[70:71], 0
    s_lshr_b32 s42, s100, 5
    s_add_u32 s76, s46, s42
    s_addc_u32 s77, s47, 0
    s_sub_u32 s74, s76, 0x22000
    s_subb_u32 s75, s77, 0
    s_add_u32 s42, s42, 0x6000
    s_and_b32 s42, s42, 0x6000
    s_add_u32 s36, s46, s42
    s_addc_u32 s37, s47, 0
    s_add_u32 s64, s64, 1
    v_add_u32 v9, v9, v10
    v_add_u32 v11, 4, v11
    s_add_u32 s80, s80, 0x40000
    s_addc_u32 s81, s81, 0
    s_add_u32 s78, s78, 0x40000
    s_addc_u32 s79, s79, 0
    s_add_u32 s82, s82, 0x40000
    s_addc_u32 s83, s83, 0
    s_nop 0
    s_nop 0
    global_load_dwordx4 v[112:115], v12, s[68:69] sc1
    global_load_dwordx4 v[116:119], v12, s[68:69] offset:1024 sc1
    v_mov_b32 v14, 0
    s_nop 2
    v_mov_b32 v14, 0
    s_nop 2
    v_mov_b32 v14, 0
    s_nop 2
    v_mov_b32 v14, 0
    s_nop 2
    v_mov_b32 v14, 0
    s_nop 2
    v_mov_b32 v14, 0
    s_nop 2
    v_mov_b32 v14, 0
    s_nop 2
    v_mov_b32 v14, 0
    s_nop 2
    v_mov_b32 v14, 0
    s_nop 2
    global_load_dwordx4 v[112:115], v12, s[68:69] sc1
    global_load_dwordx4 v[116:119], v12, s[68:69] offset:1024 sc1
    s_waitcnt lgkmcnt(0)
    s_waitcnt vmcnt(10)
    ds_write_b128 v7, v[128:131] offset:12288
    ds_write_b128 v7, v[132:135] offset:13312
    v_mov_b32 v14, 0
    s_nop 2
    s_waitcnt vmcnt(2)
    v_max3_u32 v14, v112, v113, v114
    v_max3_u32 v15, v115, v116, v117
    v_max3_u32 v14, v14, v118, v119
    v_max_u32 v14, v14, v15
    v_cmp_eq_u32 vcc, -1, v14
    s_cbranch_vccnz L_hop1_1
L_hop1_ok1:
    v_mfma_f32_16x16x32_bf16 v[108:111], v[112:115], v[104:107], 0
    v_mfma_f32_16x16x32_bf16 v[108:111], v[116:119], v[104:107], v[108:111]
    s_nop 7
    v_add_f32 v108, v108, v109
    v_add_f32 v110, v110, v111
    s_nop 1
    v_permlane32_swap_b32 v108, v110
    v_add_f32 v108, v108, v110
    s_nop 1
    v_mov_b32_dpp v109, v108 row_shl:4 row_mask:0xf bank_mask:0xf
    v_cvt_pk_bf16_f32 v108, v108, v109
    s_mov_b64 exec, s[44:45]
    global_store_dword v3, v108, s[76:77]
    s_mov_b64 exec, -1
    s_mov_b64 s[70:71], s[68:69]
    s_add_u32 s100, s100, 0x40000
    s_and_b32 s100, s100, 0xc0000
    s_add_u32 s42, s100, s101
    s_add_u32 s68, s72, s42
    s_addc_u32 s69, s73, 0
    s_add_u32 s42, s100, 0x23000
    s_add_u32 s66, s72, s42
    s_addc_u32 s67, s73, 0
    v_readlane_b32 s41, v0, 48
    s_nop 0
    s_cmp_eq_u32 s41, 0x01010101
    s_cbranch_scc0 L_flag_slow1
L_flag_ok1:
    v_mov_b32 v14, 0
    s_nop 2
    v_mov_b32 v14, 0
    s_nop 2
    v_mov_b32 v14, 0
    s_nop 2
    v_mov_b32 v14, 0
    s_nop 2
    v_mov_b32 v14, 0
    s_nop 2
    v_mov_b32 v14, 0
    s_nop 2
    v_mov_b32 v14, 0
    s_nop 2
    global_load_dwordx4 v[16:19], v7, s[74:75] sc1
    global_load_dwordx4 v[20:23], v7, s[74:75] offset:1024 sc1
    v_mov_b32 v14, 0
    s_nop 2
    v_mov_b32 v14, 0
    s_nop 2
    v_mov_b32 v14, 0
    s_nop 2
    v_mov_b32 v14, 0
    s_nop 2
    v_mov_b32 v14, 0
    s_nop 2
    v_mov_b32 v14, 0
    s_nop 2
    v_mov_b32 v14, 0
    s_nop 2
    v_mov_b32 v14, 0
    s_nop 2
    v_mov_b32 v14, 0
    s_nop 2
    global_load_dwordx4 v[16:19], v7, s[74:75] sc1
    global_load_dwordx4 v[20:23], v7, s[74:75] offset:1024 sc1
    v_mov_b32 v14, 0
    s_nop 2
    v_mov_b32 v14, 0
    s_nop 2
    v_mov_b32 v14, 0
    s_nop 2
    s_waitcnt lgkmcnt(0)
    s_waitcnt vmcnt(2)
    v_max3_u32 v14, v16, v17, v18
    v_max3_u32 v15, v19, v20, v21
    v_max3_u32 v14, v14, v22, v23
    v_max_u32 v14, v14, v15
    v_cmp_eq_u32 vcc, -1, v14
    s_cbranch_vccz L_step1
L_hop2_1:
    s_mov_b64 exec, vcc
    global_load_dwordx4 v[16:19], v7, s[74:75] sc1
    global_load_dwordx4 v[20:23], v7, s[74:75] offset:1024 sc1
    s_mov_b64 exec, -1
    v_max3_u32 v14, v16, v17, v18
    v_max3_u32 v15, v19, v20, v21
    v_max3_u32 v14, v14, v22, v23
    v_max_u32 v14, v14, v15
    v_cmp_eq_u32 vcc, -1, v14
    s_cbranch_vccz L_step1
    v_max3_u32 v14, v16, v17, v18
    v_max3_u32 v15, v19, v20, v21
    v_max3_u32 v14, v14, v22, v23
    v_max_u32 v14, v14, v15
    v_cmp_eq_u32 vcc, -1, v14
    s_cbranch_vccz L_step1
    s_mov_b64 exec, vcc
    global_load_dwordx4 v[16:19], v7, s[74:75] sc1
    global_load_dwordx4 v[20:23], v7, s[74:75] offset:1024 sc1
    s_mov_b64 exec, -1
    v_max3_u32 v14, v16, v17, v18
    v_max3_u32 v15, v19, v20, v21
    v_max3_u32 v14, v14, v22, v23
    v_max_u32 v14, v14, v15
    v_cmp_eq_u32 vcc, -1, v14
    s_cbranch_vccz L_step1
    v_max3_u32 v14, v16, v17, v18
    v_max3_u32 v15, v19, v20, v21
    v_max3_u32 v14, v14, v22, v23
    v_max_u32 v14, v14, v15
    v_cmp_eq_u32 vcc, -1, v14
    s_cbranch_vccz L_step1
    s_waitcnt vmcnt(32)
    s_add_u32 s39, s39, 1
    s_cmp_gt_u32 s39, 0x400000
    s_cbranch_scc1 L_fail
    s_branch L_hop2_1
L_hop1_1:
    s_mov_b64 exec, vcc
    global_load_dwordx4 v[112:115], v12, s[68:69] sc1
    global_load_dwordx4 v[116:119], v12, s[68:69] offset:1024 sc1
    s_mov_b64 exec, -1
    v_max3_u32 v14, v112, v113, v114
    v_max3_u32 v15, v115, v116, v117
    v_max3_u32 v14, v14, v118, v119
    v_max_u32 v14, v14, v15
    v_cmp_eq_u32 vcc, -1, v14
    s_cbranch_vccz L_hop1_ok1
    v_max3_u32 v14, v112, v113, v114
    v_max3_u32 v15, v115, v116, v117
    v_max3_u32 v14, v14, v118, v119
    v_max_u32 v14, v14, v15
    v_cmp_eq_u32 vcc, -1, v14
    s_cbranch_vccz L_hop1_ok1
    s_mov_b64 exec, vcc
    global_load_dwordx4 v[112:115], v12, s[68:69] sc1
    global_load_dwordx4 v[116:119], v12, s[68:69] offset:1024 sc1
    s_mov_b64 exec, -1
    v_max3_u32 v14, v112, v113, v114
    v_max3_u32 v15, v115, v116, v117
    v_max3_u32 v14, v14, v118, v119
    v_max_u32 v14, v14, v15
    v_cmp_eq_u32 vcc, -1, v14
    s_cbranch_vccz L_hop1_ok1
    v_max3_u32 v14, v112, v113, v114
    v_max3_u32 v15, v115, v116, v117
    v_max3_u32 v14, v14, v118, v119
    v_max_u32 v14, v14, v15
    v_cmp_eq_u32 vcc, -1, v14
    s_cbranch_vccz L_hop1_ok1
    s_waitcnt vmcnt(32)
    s_add_u32 s39, s39, 1
    s_cmp_gt_u32 s39, 0x400000
    s_cbranch_scc1 L_fail
    s_branch L_hop1_1
L_flag_slow1:
    s_cmp_ge_u32 s64, 63
    s_cbranch_scc1 L_flag_ok1
    s_lshl_b32 s40, s29, 6
    s_add_u32 s40, s40, s64
    s_lshl_b32 s40, s40, 2
    s_add_u32 s40, s40, 0x400004
    v_mov_b32 v14, s40
    v_mov_b32 v15, 0x01010101
L_wf_6:
    global_load_dword v0, v14, s[26:27] sc1
    s_add_u32 s39, s39, 1
    s_cmp_gt_u32 s39, 0x400000
    s_cbranch_scc1 L_fail
    s_sleep 1
    s_waitcnt vmcnt(0)
    v_cmp_ne_u32 vcc, v15, v0
    s_cbranch_vccnz L_wf_6
    s_branch L_flag_ok1
L_entry2:
    ds_read_b128 v[72:75], v4 offset:0
    ds_read_b128 v[76:79], v4 offset:1024
    ds_read_b128 v[80:83], v4 offset:2048
    ds_read_b128 v[84:87], v4 offset:3072
    ds_read_b128 v[88:91], v4 offset:4096
    ds_read_b128 v[92:95], v4 offset:5120
    ds_read_b128 v[96:99], v4 offset:6144
    ds_read_b128 v[100:103], v4 offset:7168
    v_mov_b64 v[48:49], 0
    v_mov_b64 v[50:51], 0
    v_mov_b64 v[52:53], 0
    v_mov_b64 v[54:55], 0
    v_mov_b64 v[56:57], 0
    v_mov_b64 v[58:59], 0
    v_mov_b64 v[60:61], 0
    v_mov_b64 v[62:63], 0
    v_mov_b64 v[64:65], 0
    v_mov_b64 v[66:67], 0
    v_mov_b64 v[68:69], 0
    v_mov_b64 v[70:71], 0
    s_mov_b64 s[70:71], s[68:69]
    s_add_u32 s100, s100, 0x40000
    s_and_b32 s100, s100, 0xc0000
    s_add_u32 s42, s100, s101
    s_add_u32 s68, s72, s42
    s_addc_u32 s69, s73, 0
    s_add_u32 s42, s100, 0x23000
    s_add_u32 s66, s72, s42
    s_addc_u32 s67, s73, 0
    s_add_u32 s36, s46, 0x4000
    s_addc_u32 s37, s47, 0
    s_lshl_b32 s40, s29, 8
    s_add_u32 s40, s40, 0x400004
    v_mov_b32 v14, s40
    v_mov_b32 v15, 0x01010101
    v_readlane_b32 s41, v0, 48
    s_nop 0
    s_cmp_eq_u32 s41, 0x01010101
    s_cbranch_scc1 L_e12
L_wf_7:
    global_load_dword v0, v14, s[26:27] sc1
    s_add_u32 s39, s39, 1
    s_cmp_gt_u32 s39, 0x400000
    s_cbranch_scc1 L_fail
    s_sleep 1
    s_waitcnt vmcnt(0)
    v_cmp_ne_u32 vcc, v15, v0
    s_cbranch_vccnz L_wf_7
L_e12:
    s_waitcnt lgkmcnt(0)
.p2align 6
L_step2:
    v_smfmac_f32_16x16x64_bf16 v[48:51], v[16:19], v[72:79], v1
    ds_write_b128 v7, v[16:19]
    v_smfmac_f32_16x16x64_bf16 v[52:55], v[16:19], v[80:87], v1
    ds_write_b128 v7, v[20:23] offset:1024
    v_smfmac_f32_16x16x64_bf16 v[48:51], v[20:23], v[88:95], v1
    ds_read_b128 v[72:75], v4 offset:8192
    v_smfmac_f32_16x16x64_bf16 v[52:55], v[20:23], v[96:103], v1
    ds_read_b128 v[76:79], v4 offset:9216
    v_mov_b64 v[112:113], -1
    v_smfmac_f32_16x16x64_bf16 v[56:59], v[16:19], a[96:103], v1
    ds_read_b128 v[80:83], v4 offset:10240
    v_mov_b64 v[114:115], -1
    v_smfmac_f32_16x16x64_bf16 v[60:63], v[16:19], a[104:111], v1
    ds_read_b128 v[84:87], v4 offset:11264
    v_smfmac_f32_16x16x64_bf16 v[56:59], v[20:23], a[112:119], v1
    v_smfmac_f32_16x16x64_bf16 v[60:63], v[20:23], a[120:127], v1
    s_waitcnt lgkmcnt(4)
    s_barrier
    ds_read_b128 v[24:27], v8 offset:6144
    ds_read_b128 v[28:31], v8 offset:7168
    v_smfmac_f32_16x16x64_bf16 v[64:67], v[16:19], a[192:199], v1
    ds_read_b128 v[32:35], v8 offset:0
    v_smfmac_f32_16x16x64_bf16 v[68:71], v[16:19], a[200:207], v1
    ds_read_b128 v[36:39], v8 offset:1024
    v_smfmac_f32_16x16x64_bf16 v[64:67], v[20:23], a[208:215], v1
    ds_read_b128 v[40:43], v8 offset:2048
    v_smfmac_f32_16x16x64_bf16 v[68:71], v[20:23], a[216:223], v1
    s_waitcnt vmcnt(0)
    ds_read_b128 v[44:47], v8 offset:3072
    global_load_dwordx4 v[104:107], v7, s[80:81] offset:0 sc1
    s_waitcnt lgkmcnt(5)
    v_smfmac_f32_16x16x64_bf16 v[48:51], v[24:27], a[0:7], v1
    global_load_dwordx4 v[108:111], v7, s[80:81] offset:1024 sc1
    v_smfmac_f32_16x16x64_bf16 v[52:55], v[24:27], a[8:15], v1
    ds_read_b128 v[88:91], v4 offset:12288
    s_waitcnt lgkmcnt(5)
    v_smfmac_f32_16x16x64_bf16 v[48:51], v[28:31], a[16:23], v1
    ds_read_b128 v[92:95], v4 offset:13312
    v_smfmac_f32_16x16x64_bf16 v[52:55], v[28:31], a[24:31], v1
    ds_read_b128 v[96:99], v4 offset:14336
    s_waitcnt lgkmcnt(6)
    v_smfmac_f32_16x16x64_bf16 v[48:51], v[32:35], a[32:39], v1
    ds_read_b128 v[100:103], v4 offset:15360
    v_smfmac_f32_16x16x64_bf16 v[52:55], v[32:35], a[40:47], v1
    global_load_dwordx4 v[128:131], v7, s[78:79] offset:0 sc1
    s_waitcnt lgkmcnt(6)
    v_smfmac_f32_16x16x64_bf16 v[48:51], v[36:39], a[48:55], v1
    v_smfmac_f32_16x16x64_bf16 v[52:55], v[36:39], a[56:63], v1
    global_load_dwordx4 v[132:135], v7, s[78:79] offset:1024 sc1
    s_waitcnt lgkmcnt(5)
    v_smfmac_f32_16x16x64_bf16 v[48:51], v[40:43], a[64:71], v1
    v_smfmac_f32_16x16x64_bf16 v[52:55], v[40:43], a[72:79], v1
    s_waitcnt lgkmcnt(4)
    v_smfmac_f32_16x16x64_bf16 v[48:51], v[44:47], a[80:87], v1
    s_mov_b64 exec, s[44:45]
    global_store_dword v3, v112, s[36:37]
    s_mov_b64 exec, -1
    v_smfmac_f32_16x16x64_bf16 v[52:55], v[44:47], a[88:95], v1
    v_smfmac_f32_16x16x64_bf16 v[56:59], v[24:27], v[72:79], v1
    v_smfmac_f32_16x16x64_bf16 v[60:63], v[24:27], v[80:87], v1
    ds_read_b128 v[72:75], v8 offset:12288
    s_waitcnt lgkmcnt(3)
    v_permlane32_swap_b32 v48, v52
    v_smfmac_f32_16x16x64_bf16 v[56:59], v[28:31], v[88:95], v1
    ds_read_b128 v[76:79], v8 offset:16384
    s_waitcnt lgkmcnt(2)
    v_permlane32_swap_b32 v49, v53
    v_smfmac_f32_16x16x64_bf16 v[60:63], v[28:31], v[96:103], v1
    global_store_dwordx4 v7, v[112:115], s[70:71] offset:0
    v_permlane32_swap_b32 v50, v54
    v_smfmac_f32_16x16x64_bf16 v[56:59], v[32:35], a[128:135], v1
    ds_read_b128 v[80:83], v8 offset:13312
    v_permlane32_swap_b32 v51, v55
    v_smfmac_f32_16x16x64_bf16 v[60:63], v[32:35], a[136:143], v1
    ds_read_b128 v[84:87], v8 offset:17408
    v_add_f32 v48, v48, v52
    v_smfmac_f32_16x16x64_bf16 v[56:59], v[36:39], a[144:151], v1
    ds_read_b128 v[88:91], v8 offset:14336
    v_add_f32 v49, v49, v53
    v_smfmac_f32_16x16x64_bf16 v[60:63], v[36:39], a[152:159], v1
    ds_read_b128 v[92:95], v8 offset:18432
    v_add_f32 v50, v50, v54
    v_smfmac_f32_16x16x64_bf16 v[56:59], v[40:43], a[160:167], v1
    ds_read_b128 v[96:99], v8 offset:15360
    v_add_f32 v51, v51, v55
    v_smfmac_f32_16x16x64_bf16 v[60:63], v[40:43], a[168:175], v1
    global_store_dwordx4 v7, v[112:115], s[70:71] offset:1024
    v_cvt_pk_bf16_f32 v52, v48, v49
    v_smfmac_f32_16x16x64_bf16 v[56:59], v[44:47], a[176:183], v1
    ds_read_b128 v[100:103], v8 offset:19456
    v_cvt_pk_bf16_f32 v53, v50, v51
    v_smfmac_f32_16x16x64_bf16 v[60:63], v[44:47], a[184:191], v1
    ds_write_b64 v5, v[52:53]
    v_smfmac_f32_16x16x64_bf16 v[64:67], v[24:27], a[224:231], v1
    v_smfmac_f32_16x16x64_bf16 v[68:71], v[24:27], a[232:239], v1
    global_load_dword v0, v9, s[26:27] sc1
    v_permlane32_swap_b32 v56, v60
    v_smfmac_f32_16x16x64_bf16 v[64:67], v[28:31], a[240:247], v1
    v_permlane32_swap_b32 v57, v61
    v_smfmac_f32_16x16x64_bf16 v[68:71], v[28:31], a[248:255], v1
    v_permlane32_swap_b32 v58, v62
    v_smfmac_f32_16x16x64_bf16 v[64:67], v[32:35], v[136:143], v1
    v_permlane32_swap_b32 v59, v63
    v_smfmac_f32_16x16x64_bf16 v[68:71], v[32:35], v[144:151], v1
    s_waitcnt lgkmcnt(0)
    s_barrier
    ds_read_b64_tr_b16 v[112:113], v6 offset:0
    ds_read_b64_tr_b16 v[114:115], v6 offset:64
    v_add_f32 v56, v56, v60
    v_smfmac_f32_16x16x64_bf16 v[64:67], v[36:39], v[152:159], v1
    ds_read_b64_tr_b16 v[116:117], v6 offset:512
    ds_read_b64_tr_b16 v[118:119], v6 offset:576
    v_add_f32 v57, v57, v61
    v_smfmac_f32_16x16x64_bf16 v[68:71], v[36:39], v[160:167], v1
    ds_read_b64_tr_b16 v[120:121], v6 offset:1024
    ds_read_b64_tr_b16 v[122:123], v6 offset:1088
    v_add_f32 v58, v58, v62
    v_smfmac_f32_16x16x64_bf16 v[64:67], v[40:43], v[168:175], v1
    ds_read_b64_tr_b16 v[124:125], v6 offset:1536
    ds_read_b64_tr_b16 v[126:127], v6 offset:1600
    v_add_f32 v59, v59, v63
    v_smfmac_f32_16x16x64_bf16 v[68:71], v[40:43], v[176:183], v1
    v_cvt_pk_bf16_f32 v60, v56, v57
    v_cvt_pk_bf16_f32 v61, v58, v59
    v_smfmac_f32_16x16x64_bf16 v[64:67], v[44:47], v[184:191], v1
    ds_write_b64 v5, v[60:61] offset:2048
    v_smfmac_f32_16x16x64_bf16 v[68:71], v[44:47], v[192:199], v1
    s_waitcnt lgkmcnt(7)
    v_mfma_f32_16x16x32_bf16 v[48:51], v[72:75], v[112:115], 0
    v_mfma_f32_16x16x32_bf16 v[52:55], v[76:79], v[112:115], 0
    s_waitcnt lgkmcnt(5)
    v_cvt_pk_bf16_f32 v64, v64, v65
    v_cvt_pk_bf16_f32 v65, v66, v67
    v_mfma_f32_16x16x32_bf16 v[48:51], v[80:83], v[116:119], v[48:51]
    v_cvt_pk_bf16_f32 v66, v68, v69
    v_cvt_pk_bf16_f32 v67, v70, v71
    v_mfma_f32_16x16x32_bf16 v[52:55], v[84:87], v[116:119], v[52:55]
    global_store_dwordx4 v7, v[64:67], s[82:83] offset:1024 sc1
    s_waitcnt lgkmcnt(3)
    v_mfma_f32_16x16x32_bf16 v[48:51], v[88:91], v[120:123], v[48:51]
    s_waitcnt lgkmcnt(0)
    s_barrier
    ds_read_b64_tr_b16 v[16:17], v6 offset:2048
    ds_read_b64_tr_b16 v[18:19], v6 offset:2112
    v_mfma_f32_16x16x32_bf16 v[52:55], v[92:95], v[120:123], v[52:55]
    ds_read_b64_tr_b16 v[20:21], v6 offset:2560
    ds_read_b64_tr_b16 v[22:23], v6 offset:2624
    ds_read_b64_tr_b16 v[24:25], v6 offset:3072
    ds_read_b64_tr_b16 v[26:27], v6 offset:3136
    v_mov_b64 v[68:69], s[86:87]
    v_mfma_f32_16x16x32_bf16 v[48:51], v[96:99], v[124:127], v[48:51]
    ds_read_b64_tr_b16 v[28:29], v6 offset:3584
    ds_read_b64_tr_b16 v[30:31], v6 offset:3648
    v_mov_b64 v[70:71], s[86:87]
    v_mfma_f32_16x16x32_bf16 v[52:55], v[100:103], v[124:127], v[52:55]
    ds_read_b128 v[32:35], v4 offset:28672
    s_waitcnt lgkmcnt(7)
    v_mov_b64 v[62:63], s[98:99]
    v_mfma_f32_16x16x32_bf16 v[56:59], v[16:19], v[112:115], 0
    ds_read_b128 v[36:39], v4 offset:29696
    s_waitcnt lgkmcnt(6)
    v_max3_f32 v13, v48, v49, v50
    v_mfma_f32_16x16x32_bf16 v[56:59], v[20:23], v[116:119], v[56:59]
    ds_read_b128 v[40:43], v4 offset:24576
    s_waitcnt lgkmcnt(5)
    v_max3_f32 v13, v13, v51, v52
    v_max3_f32 v15, v53, v54, v55
    v_mfma_f32_16x16x32_bf16 v[56:59], v[24:27], v[120:123], v[56:59]
    global_store_dwordx4 v7, v[24:27], s[82:83] sc1
    s_waitcnt lgkmcnt(3)
    v_max_f32 v14, v13, v15
    v_max_f32 v13, v13, v15
    v_mfma_f32_16x16x32_bf16 v[56:59], v[28:31], v[124:127], v[56:59]
    ds_read_b128 v[44:47], v4 offset:25600
    s_cmp_eq_u32 s64, 63
    s_cbranch_scc1 L_chain_fin
    v_permlane32_swap_b32 v13, v14
    v_max_f32 v13, v13, v14
    s_nop 2
    v_max3_f32 v13, v13, v56, v57
    v_max3_f32 v13, v13, v58, v59
    v_mov_b32 v14, v13
    s_nop 1
    v_permlane16_swap_b32 v13, v14
    v_max_f32 v13, v13, v14
    v_mul_f32 v14, s84, v13
    v_pk_fma_f32 v[48:49], v[48:49], s[84:85], v[14:15] op_sel_hi:[1,1,0] neg_lo:[0,0,1] neg_hi:[0,0,1]
    v_pk_fma_f32 v[50:51], v[50:51], s[84:85], v[14:15] op_sel_hi:[1,1,0] neg_lo:[0,0,1] neg_hi:[0,0,1]
    v_pk_fma_f32 v[52:53], v[52:53], s[84:85], v[14:15] op_sel_hi:[1,1,0] neg_lo:[0,0,1] neg_hi:[0,0,1]
    v_pk_fma_f32 v[54:55], v[54:55], s[84:85], v[14:15] op_sel_hi:[1,1,0] neg_lo:[0,0,1] neg_hi:[0,0,1]
    v_pk_fma_f32 v[56:57], v[56:57], s[84:85], v[14:15] op_sel_hi:[1,1,0] neg_lo:[0,0,1] neg_hi:[0,0,1]
    v_pk_fma_f32 v[58:59], v[58:59], s[84:85], v[14:15] op_sel_hi:[1,1,0] neg_lo:[0,0,1] neg_hi:[0,0,1]
    v_exp_f32 v48, v48
    v_exp_f32 v49, v49
    v_exp_f32 v50, v50
    v_exp_f32 v51, v51
    v_exp_f32 v52, v52
    v_exp_f32 v53, v53
    v_exp_f32 v54, v54
    v_exp_f32 v55, v55
    v_cvt_pk_bf16_f32 v48, v48, v49
    v_cvt_pk_bf16_f32 v49, v50, v51
    v_cvt_pk_bf16_f32 v50, v52, v53
    v_cvt_pk_bf16_f32 v51, v54, v55
    v_exp_f32 v56, v56
    v_exp_f32 v57, v57
    v_mfma_f32_16x16x32_bf16 v[120:123], v[68:71], v[48:51], 0
    s_waitcnt vmcnt(8)
    v_exp_f32 v58, v58
    v_mfma_f32_16x16x32_bf16 v[112:115], v[104:107], v[48:51], 0
    v_exp_f32 v59, v59
    v_mfma_f32_16x16x32_bf16 v[116:119], v[108:111], v[48:51], 0
    v_cvt_pk_bf16_f32 v56, v56, v57
    v_cvt_pk_bf16_f32 v57, v58, v59
    v_mov_b64 v[68:69], 0
    v_mov_b64 v[70:71], 0
    v_mfma_f32_16x16x16_bf16 v[120:123], v[62:63], v[56:57], v[120:123]
    ds_read_b128 v[88:91], v4 offset:20480
    v_mov_b64 v[58:59], 0
    v_mfma_f32_16x16x16_bf16 v[112:115], v[64:65], v[56:57], v[112:115]
    ds_read_b128 v[92:95], v4 offset:21504
    v_mov_b64 v[60:61], 0
    v_mfma_f32_16x16x16_bf16 v[116:119], v[66:67], v[56:57], v[116:119]
    ds_read_b128 v[72:75], v4 offset:16384
    v_rcp_f32 v14, v120
    v_mov_b64 v[62:63], 0
    v_mov_b64 v[56:57], 0
    v_mov_b64 v[64:65], 0
    v_mov_b64 v[66:67], 0
    v_pk_mul_f32 v[112:113], v[112:113], v[14:15] op_sel_hi:[1,0]
    v_pk_mul_f32 v[114:115], v[114:115], v[14:15] op_sel_hi:[1,0]
    v_pk_mul_f32 v[116:117], v[116:117], v[14:15] op_sel_hi:[1,0]
    v_pk_mul_f32 v[118:119], v[118:119], v[14:15] op_sel_hi:[1,0]
    v_cvt_pk_bf16_f32 v48, v112, v116
    v_cvt_pk_bf16_f32 v49, v113, v117
    v_cvt_pk_bf16_f32 v50, v114, v118
    v_cvt_pk_bf16_f32 v51, v115, v119
    ds_write_b128 v7, v[48:51]
    s_nop 0
    v_smfmac_f32_16x16x64_bf16 v[56:59], v[48:51], v[216:223], v1
    ds_read_b128 v[104:107], v4 offset:32768
    v_smfmac_f32_16x16x64_bf16 v[60:63], v[48:51], v[248:255], v1
    ds_read_b128 v[108:111], v4 offset:33792
    s_waitcnt lgkmcnt(4)
    v_smfmac_f32_16x16x64_bf16 v[64:67], v[48:51], v[88:95], v1
    s_waitcnt lgkmcnt(2)
    s_barrier
    ds_read_b128 v[112:115], v8 offset:0
    ds_read_b128 v[116:119], v8 offset:2048
    ds_read_b128 v[124:127], v8 offset:6144
    ds_read_b128 v[76:79], v4 offset:17408
    ds_read_b128 v[80:83], v4 offset:18432
    v_smfmac_f32_16x16x64_bf16 v[68:71], v[48:51], v[32:39], v1
    s_waitcnt lgkmcnt(4)
    v_smfmac_f32_16x16x64_bf16 v[56:59], v[112:115], v[200:207], v1
    ds_read_b128 v[84:87], v4 offset:19456
    s_waitcnt lgkmcnt(4)
    v_smfmac_f32_16x16x64_bf16 v[56:59], v[116:119], v[208:215], v1
    ds_read_b128 v[96:99], v4 offset:22528
    s_waitcnt lgkmcnt(4)
    v_smfmac_f32_16x16x64_bf16 v[56:59], v[124:127], v[224:231], v1
    ds_read_b128 v[100:103], v4 offset:23552
    v_smfmac_f32_16x16x64_bf16 v[60:63], v[112:115], v[232:239], v1
    ds_read_b128 v[16:19], v4 offset:26624
    v_smfmac_f32_16x16x64_bf16 v[60:63], v[116:119], v[240:247], v1
    ds_read_b128 v[20:23], v4 offset:27648
    v_cvt_pk_bf16_f32 v56, v56, v57
    v_cvt_pk_bf16_f32 v57, v58, v59
    v_smfmac_f32_16x16x64_bf16 v[60:63], v[124:127], v[104:111], v1
    global_store_dwordx2 v2, v[56:57], s[66:67] offset:-4096
    s_waitcnt lgkmcnt(6)
    v_smfmac_f32_16x16x64_bf16 v[64:67], v[112:115], v[72:79], v1
    ds_read_b128 v[24:27], v4 offset:30720
    s_waitcnt lgkmcnt(5)
    v_smfmac_f32_16x16x64_bf16 v[64:67], v[116:119], v[80:87], v1
    ds_read_b128 v[28:31], v4 offset:31744
    s_waitcnt lgkmcnt(4)
    v_cvt_pk_bf16_f32 v60, v60, v61
    v_cvt_pk_bf16_f32 v61, v62, v63
    v_smfmac_f32_16x16x64_bf16 v[64:67], v[124:127], v[96:103], v1
    global_store_dwordx2 v2, v[60:61], s[66:67] offset:-2048
    v_smfmac_f32_16x16x64_bf16 v[68:71], v[112:115], v[40:47], v1
    ds_read_b128 v[72:75], v4 offset:0
    s_waitcnt lgkmcnt(3)
    v_smfmac_f32_16x16x64_bf16 v[68:71], v[116:119], v[16:23], v1
    ds_read_b128 v[76:79], v4 offset:1024
    s_waitcnt lgkmcnt(2)
    v_cvt_pk_bf16_f32 v64, v64, v65
    v_cvt_pk_bf16_f32 v65, v66, v67
    v_smfmac_f32_16x16x64_bf16 v[68:71], v[124:127], v[24:31], v1
    global_store_dwordx2 v2, v[64:65], s[66:67] offset:0
    s_nop 6
    v_cvt_pk_bf16_f32 v68, v68, v69
    v_cvt_pk_bf16_f32 v69, v70, v71
    global_store_dwordx2 v2, v[68:69], s[66:67] offset:2048
    ds_read_b128 v[80:83], v4 offset:2048
    ds_read_b128 v[84:87], v4 offset:3072
    ds_read_b128 v[88:91], v4 offset:4096
    ds_read_b128 v[92:95], v4 offset:5120
    ds_read_b128 v[96:99], v4 offset:6144
    ds_read_b128 v[100:103], v4 offset:7168
    ds_read_b128 v[104:107], v8 offset:20480
    v_mov_b64 v[48:49], 0
    v_mov_b64 v[50:51], 0
    v_mov_b64 v[52:53], 0
    v_mov_b64 v[54:55], 0
    v_mov_b64 v[56:57], 0
    v_mov_b64 v[58:59], 0
    v_mov_b64 v[60:61], 0
    v_mov_b64 v[62:63], 0
    v_mov_b64 v[64:65], 0
    v_mov_b64 v[66:67], 0
    v_mov_b64 v[68:69], 0
    v_mov_b64 v[70:71], 0
    s_lshr_b32 s42, s100, 5
    s_add_u32 s76, s46, s42
    s_addc_u32 s77, s47, 0
    s_sub_u32 s74, s76, 0x22000
    s_subb_u32 s75, s77, 0
    s_add_u32 s42, s42, 0x6000
    s_and_b32 s42, s42, 0x6000
    s_add_u32 s36, s46, s42
    s_addc_u32 s37, s47, 0
    s_add_u32 s64, s64, 1
    v_add_u32 v9, v9, v10
    v_add_u32 v11, 4, v11
    s_add_u32 s80, s80, 0x40000
    s_addc_u32 s81, s81, 0
    s_add_u32 s78, s78, 0x40000
    s_addc_u32 s79, s79, 0
    s_add_u32 s82, s82, 0x40000
    s_addc_u32 s83, s83, 0
    s_nop 0
    s_nop 0
    v_mov_b32 v14, 0
    s_nop 2
    v_mov_b32 v14, 0
    s_nop 2
    v_mov_b32 v14, 0
    s_nop 2
    global_load_dwordx4 v[112:115], v12, s[68:69] sc1
    global_load_dwordx4 v[116:119], v12, s[68:69] offset:1024 sc1
    v_mov_b32 v14, 0
    s_nop 2
    v_mov_b32 v14, 0
    s_nop 2
    v_mov_b32 v14, 0
    s_nop 2
    v_mov_b32 v14, 0
    s_nop 2
    v_mov_b32 v14, 0
    s_nop 2
    v_mov_b32 v14, 0
    s_nop 2
    v_mov_b32 v14, 0
    s_nop 2
    v_mov_b32 v14, 0
    s_nop 2
    v_mov_b32 v14, 0
    s_nop 2
    global_load_dwordx4 v[112:115], v12, s[68:69] sc1
    global_load_dwordx4 v[116:119], v12, s[68:69] offset:1024 sc1
    s_waitcnt lgkmcnt(0)
    s_waitcnt vmcnt(10)
    ds_write_b128 v7, v[128:131] offset:12288
    ds_write_b128 v7, v[132:135] offset:13312
    v_mov_b32 v14, 0
    s_nop 2
    s_waitcnt vmcnt(2)
    v_max3_u32 v14, v112, v113, v114
    v_max3_u32 v15, v115, v116, v117
    v_max3_u32 v14, v14, v118, v119
    v_max_u32 v14, v14, v15
    v_cmp_eq_u32 vcc, -1, v14
    s_cbranch_vccnz L_hop1_2
L_hop1_ok2:
    v_mfma_f32_16x16x32_bf16 v[108:111], v[112:115], v[104:107], 0
    v_mfma_f32_16x16x32_bf16 v[108:111], v[116:119], v[104:107], v[108:111]
    s_nop 7
    v_add_f32 v108, v108, v109
    v_add_f32 v110, v110, v111
    s_nop 1
    v_permlane32_swap_b32 v108, v110
    v_add_f32 v108, v108, v110
    s_nop 1
    v_mov_b32_dpp v109, v108 row_shl:4 row_mask:0xf bank_mask:0xf
    v_cvt_pk_bf16_f32 v108, v108, v109
    s_mov_b64 exec, s[44:45]
    global_store_dword v3, v108, s[76:77]
    s_mov_b64 exec, -1
    s_mov_b64 s[70:71], s[68:69]
    s_add_u32 s100, s100, 0x40000
    s_and_b32 s100, s100, 0xc0000
    s_add_u32 s42, s100, s101
    s_add_u32 s68, s72, s42
    s_addc_u32 s69, s73, 0
    s_add_u32 s42, s100, 0x23000
    s_add_u32 s66, s72, s42
    s_addc_u32 s67, s73, 0
    v_readlane_b32 s41, v0, 48
    s_nop 0
    s_cmp_eq_u32 s41, 0x01010101
    s_cbranch_scc0 L_flag_slow2
L_flag_ok2:
    v_mov_b32 v14, 0
    s_nop 2
    v_mov_b32 v14, 0
    s_nop 2
    v_mov_b32 v14, 0
    s_nop 2
    v_mov_b32 v14, 0
    s_nop 2
    v_mov_b32 v14, 0
    s_nop 2
    v_mov_b32 v14, 0
    s_nop 2
    v_mov_b32 v14, 0
    s_nop 2
    global_load_dwordx4 v[16:19], v7, s[74:75] sc1
    global_load_dwordx4 v[20:23], v7, s[74:75] offset:1024 sc1
    v_mov_b32 v14, 0
    s_nop 2
    v_mov_b32 v14, 0
    s_nop 2
    v_mov_b32 v14, 0
    s_nop 2
    v_mov_b32 v14, 0
    s_nop 2
    v_mov_b32 v14, 0
    s_nop 2
    v_mov_b32 v14, 0
    s_nop 2
    v_mov_b32 v14, 0
    s_nop 2
    v_mov_b32 v14, 0
    s_nop 2
    v_mov_b32 v14, 0
    s_nop 2
    global_load_dwordx4 v[16:19], v7, s[74:75] sc1
    global_load_dwordx4 v[20:23], v7, s[74:75] offset:1024 sc1
    v_mov_b32 v14, 0
    s_nop 2
    v_mov_b32 v14, 0
    s_nop 2
    v_mov_b32 v14, 0
    s_nop 2
    s_waitcnt lgkmcnt(0)
    s_waitcnt vmcnt(2)
    v_max3_u32 v14, v16, v17, v18
    v_max3_u32 v15, v19, v20, v21
    v_max3_u32 v14, v14, v22, v23
    v_max_u32 v14, v14, v15
    v_cmp_eq_u32 vcc, -1, v14
    s_cbranch_vccz L_step2
L_hop2_2:
    s_mov_b64 exec, vcc
    global_load_dwordx4 v[16:19], v7, s[74:75] sc1
    global_load_dwordx4 v[20:23], v7, s[74:75] offset:1024 sc1
    s_mov_b64 exec, -1
    v_max3_u32 v14, v16, v17, v18
    v_max3_u32 v15, v19, v20, v21
    v_max3_u32 v14, v14, v22, v23
    v_max_u32 v14, v14, v15
    v_cmp_eq_u32 vcc, -1, v14
    s_cbranch_vccz L_step2
    v_max3_u32 v14, v16, v17, v18
    v_max3_u32 v15, v19, v20, v21
    v_max3_u32 v14, v14, v22, v23
    v_max_u32 v14, v14, v15
    v_cmp_eq_u32 vcc, -1, v14
    s_cbranch_vccz L_step2
    s_mov_b64 exec, vcc
    global_load_dwordx4 v[16:19], v7, s[74:75] sc1
    global_load_dwordx4 v[20:23], v7, s[74:75] offset:1024 sc1
    s_mov_b64 exec, -1
    v_max3_u32 v14, v16, v17, v18
    v_max3_u32 v15, v19, v20, v21
    v_max3_u32 v14, v14, v22, v23
    v_max_u32 v14, v14, v15
    v_cmp_eq_u32 vcc, -1, v14
    s_cbranch_vccz L_step2
    v_max3_u32 v14, v16, v17, v18
    v_max3_u32 v15, v19, v20, v21
    v_max3_u32 v14, v14, v22, v23
    v_max_u32 v14, v14, v15
    v_cmp_eq_u32 vcc, -1, v14
    s_cbranch_vccz L_step2
    s_waitcnt vmcnt(32)
    s_add_u32 s39, s39, 1
    s_cmp_gt_u32 s39, 0x400000
    s_cbranch_scc1 L_fail
    s_branch L_hop2_2
L_hop1_2:
    s_mov_b64 exec, vcc
    global_load_dwordx4 v[112:115], v12, s[68:69] sc1
    global_load_dwordx4 v[116:119], v12, s[68:69] offset:1024 sc1
    s_mov_b64 exec, -1
    v_max3_u32 v14, v112, v113, v114
    v_max3_u32 v15, v115, v116, v117
    v_max3_u32 v14, v14, v118, v119
    v_max_u32 v14, v14, v15
    v_cmp_eq_u32 vcc, -1, v14
    s_cbranch_vccz L_hop1_ok2
    v_max3_u32 v14, v112, v113, v114
    v_max3_u32 v15, v115, v116, v117
    v_max3_u32 v14, v14, v118, v119
    v_max_u32 v14, v14, v15
    v_cmp_eq_u32 vcc, -1, v14
    s_cbranch_vccz L_hop1_ok2
    s_mov_b64 exec, vcc
    global_load_dwordx4 v[112:115], v12, s[68:69] sc1
    global_load_dwordx4 v[116:119], v12, s[68:69] offset:1024 sc1
    s_mov_b64 exec, -1
    v_max3_u32 v14, v112, v113, v114
    v_max3_u32 v15, v115, v116, v117
    v_max3_u32 v14, v14, v118, v119
    v_max_u32 v14, v14, v15
    v_cmp_eq_u32 vcc, -1, v14
    s_cbranch_vccz L_hop1_ok2
    v_max3_u32 v14, v112, v113, v114
    v_max3_u32 v15, v115, v116, v117
    v_max3_u32 v14, v14, v118, v119
    v_max_u32 v14, v14, v15
    v_cmp_eq_u32 vcc, -1, v14
    s_cbranch_vccz L_hop1_ok2
    s_waitcnt vmcnt(32)
    s_add_u32 s39, s39, 1
    s_cmp_gt_u32 s39, 0x400000
    s_cbranch_scc1 L_fail
    s_branch L_hop1_2
L_flag_slow2:
    s_cmp_ge_u32 s64, 63
    s_cbranch_scc1 L_flag_ok2
    s_lshl_b32 s40, s29, 6
    s_add_u32 s40, s40, s64
    s_lshl_b32 s40, s40, 2
    s_add_u32 s40, s40, 0x400004
    v_mov_b32 v14, s40
    v_mov_b32 v15, 0x01010101
L_wf_8:
    global_load_dword v0, v14, s[26:27] sc1
    s_add_u32 s39, s39, 1
    s_cmp_gt_u32 s39, 0x400000
    s_cbranch_scc1 L_fail
    s_sleep 1
    s_waitcnt vmcnt(0)
    v_cmp_ne_u32 vcc, v15, v0
    s_cbranch_vccnz L_wf_8
    s_branch L_flag_ok2
L_entry3:
    ds_read_b128 v[72:75], v4 offset:0
    ds_read_b128 v[76:79], v4 offset:1024
    ds_read_b128 v[80:83], v4 offset:2048
    ds_read_b128 v[84:87], v4 offset:3072
    ds_read_b128 v[88:91], v4 offset:4096
    ds_read_b128 v[92:95], v4 offset:5120
    ds_read_b128 v[96:99], v4 offset:6144
    ds_read_b128 v[100:103], v4 offset:7168
    v_mov_b64 v[48:49], 0
    v_mov_b64 v[50:51], 0
    v_mov_b64 v[52:53], 0
    v_mov_b64 v[54:55], 0
    v_mov_b64 v[56:57], 0
    v_mov_b64 v[58:59], 0
    v_mov_b64 v[60:61], 0
    v_mov_b64 v[62:63], 0
    v_mov_b64 v[64:65], 0
    v_mov_b64 v[66:67], 0
    v_mov_b64 v[68:69], 0
    v_mov_b64 v[70:71], 0
    s_mov_b64 s[70:71], s[68:69]
    s_add_u32 s100, s100, 0x40000
    s_and_b32 s100, s100, 0xc0000
    s_add_u32 s42, s100, s101
    s_add_u32 s68, s72, s42
    s_addc_u32 s69, s73, 0
    s_add_u32 s42, s100, 0x23000
    s_add_u32 s66, s72, s42
    s_addc_u32 s67, s73, 0
    s_add_u32 s36, s46, 0x4000
    s_addc_u32 s37, s47, 0
    s_lshl_b32 s40, s29, 8
    s_add_u32 s40, s40, 0x400004
    v_mov_b32 v14, s40
    v_mov_b32 v15, 0x01010101
    v_readlane_b32 s41, v0, 48
    s_nop 0
    s_cmp_eq_u32 s41, 0x01010101
    s_cbranch_scc1 L_e13
L_wf_9:
    global_load_dword v0, v14, s[26:27] sc1
    s_add_u32 s39, s39, 1
    s_cmp_gt_u32 s39, 0x400000
    s_cbranch_scc1 L_fail
    s_sleep 1
    s_waitcnt vmcnt(0)
    v_cmp_ne_u32 vcc, v15, v0
    s_cbranch_vccnz L_wf_9
L_e13:
    s_waitcnt lgkmcnt(0)
.p2align 6
L_step3:
    v_smfmac_f32_16x16x64_bf16 v[48:51], v[16:19], v[72:79], v1
    ds_write_b128 v7, v[16:19]
    v_smfmac_f32_16x16x64_bf16 v[52:55], v[16:19], v[80:87], v1
    ds_write_b128 v7, v[20:23] offset:1024
    v_smfmac_f32_16x16x64_bf16 v[48:51], v[20:23], v[88:95], v1
    ds_read_b128 v[72:75], v4 offset:8192
    v_smfmac_f32_16x16x64_bf16 v[52:55], v[20:23], v[96:103], v1
    ds_read_b128 v[76:79], v4 offset:9216
    v_mov_b64 v[112:113], -1
    v_smfmac_f32_16x16x64_bf16 v[56:59], v[16:19], a[96:103], v1
    ds_read_b128 v[80:83], v4 offset:10240
    v_mov_b64 v[114:115], -1
    v_smfmac_f32_16x16x64_bf16 v[60:63], v[16:19], a[104:111], v1
    ds_read_b128 v[84:87], v4 offset:11264
    v_smfmac_f32_16x16x64_bf16 v[56:59], v[20:23], a[112:119], v1
    v_smfmac_f32_16x16x64_bf16 v[60:63], v[20:23], a[120:127], v1
    s_waitcnt lgkmcnt(4)
    s_barrier
    ds_read_b128 v[24:27], v8 offset:4096
    ds_read_b128 v[28:31], v8 offset:5120
    v_smfmac_f32_16x16x64_bf16 v[64:67], v[16:19], a[192:199], v1
    ds_read_b128 v[32:35], v8 offset:2048
    v_smfmac_f32_16x16x64_bf16 v[68:71], v[16:19], a[200:207], v1
    ds_read_b128 v[36:39], v8 offset:3072
    v_smfmac_f32_16x16x64_bf16 v[64:67], v[20:23], a[208:215], v1
    ds_read_b128 v[40:43], v8 offset:0
    v_smfmac_f32_16x16x64_bf16 v[68:71], v[20:23], a[216:223], v1
    s_waitcnt vmcnt(0)
    ds_read_b128 v[44:47], v8 offset:1024
    global_load_dwordx4 v[104:107], v7, s[80:81] offset:0 sc1
    s_waitcnt lgkmcnt(5)
    v_smfmac_f32_16x16x64_bf16 v[48:51], v[24:27], a[0:7], v1
    global_load_dwordx4 v[108:111], v7, s[80:81] offset:1024 sc1
    v_smfmac_f32_16x16x64_bf16 v[52:55], v[24:27], a[8:15], v1
    ds_read_b128 v[88:91], v4 offset:12288
    s_waitcnt lgkmcnt(5)
    v_smfmac_f32_16x16x64_bf16 v[48:51], v[28:31], a[16:23], v1
    ds_read_b128 v[92:95], v4 offset:13312
    v_smfmac_f32_16x16x64_bf16 v[52:55], v[28:31], a[24:31], v1
    ds_read_b128 v[96:99], v4 offset:14336
    s_waitcnt lgkmcnt(6)
    v_smfmac_f32_16x16x64_bf16 v[48:51], v[32:35], a[32:39], v1
    ds_read_b128 v[100:103], v4 offset:15360
    v_smfmac_f32_16x16x64_bf16 v[52:55], v[32:35], a[40:47], v1
    s_waitcnt lgkmcnt(6)
    v_smfmac_f32_16x16x64_bf16 v[48:51], v[36:39], a[48:55], v1
    global_load_dwordx4 v[128:131], v7, s[78:79] offset:0 sc1
    v_smfmac_f32_16x16x64_bf16 v[52:55], v[36:39], a[56:63], v1
    s_waitcnt lgkmcnt(5)
    v_smfmac_f32_16x16x64_bf16 v[48:51], v[40:43], a[64:71], v1
    global_load_dwordx4 v[132:135], v7, s[78:79] offset:1024 sc1
    v_smfmac_f32_16x16x64_bf16 v[52:55], v[40:43], a[72:79], v1
    s_waitcnt lgkmcnt(4)
    v_smfmac_f32_16x16x64_bf16 v[48:51], v[44:47], a[80:87], v1
    s_mov_b64 exec, s[44:45]
    global_store_dword v3, v112, s[36:37]
    s_mov_b64 exec, -1
    v_smfmac_f32_16x16x64_bf16 v[52:55], v[44:47], a[88:95], v1
    v_smfmac_f32_16x16x64_bf16 v[56:59], v[24:27], v[72:79], v1
    v_smfmac_f32_16x16x64_bf16 v[60:63], v[24:27], v[80:87], v1
    ds_read_b128 v[72:75], v8 offset:12288
    s_waitcnt lgkmcnt(3)
    v_permlane32_swap_b32 v48, v52
    v_smfmac_f32_16x16x64_bf16 v[56:59], v[28:31], v[88:95], v1
    ds_read_b128 v[76:79], v8 offset:16384
    s_waitcnt lgkmcnt(2)
    v_permlane32_swap_b32 v49, v53
    v_smfmac_f32_16x16x64_bf16 v[60:63], v[28:31], v[96:103], v1
    ds_read_b128 v[80:83], v8 offset:13312
    v_permlane32_swap_b32 v50, v54
    v_smfmac_f32_16x16x64_bf16 v[56:59], v[32:35], a[128:135], v1
    global_store_dwordx4 v7, v[112:115], s[70:71] offset:0
    v_permlane32_swap_b32 v51, v55
    v_smfmac_f32_16x16x64_bf16 v[60:63], v[32:35], a[136:143], v1
    ds_read_b128 v[84:87], v8 offset:17408
    v_add_f32 v48, v48, v52
    v_smfmac_f32_16x16x64_bf16 v[56:59], v[36:39], a[144:151], v1
    ds_read_b128 v[88:91], v8 offset:14336
    v_add_f32 v49, v49, v53
    v_smfmac_f32_16x16x64_bf16 v[60:63], v[36:39], a[152:159], v1
    ds_read_b128 v[92:95], v8 offset:18432
    v_add_f32 v50, v50, v54
    v_smfmac_f32_16x16x64_bf16 v[56:59], v[40:43], a[160:167], v1
    ds_read_b128 v[96:99], v8 offset:15360
    v_add_f32 v51, v51, v55
    v_smfmac_f32_16x16x64_bf16 v[60:63], v[40:43], a[168:175], v1
    ds_read_b128 v[100:103], v8 offset:19456
    v_cvt_pk_bf16_f32 v52, v48, v49
    v_smfmac_f32_16x16x64_bf16 v[56:59], v[44:47], a[176:183], v1
    global_store_dwordx4 v7, v[112:115], s[70:71] offset:1024
    v_cvt_pk_bf16_f32 v53, v50, v51
    v_smfmac_f32_16x16x64_bf16 v[60:63], v[44:47], a[184:191], v1
    ds_write_b64 v5, v[52:53]
    v_smfmac_f32_16x16x64_bf16 v[64:67], v[24:27], a[224:231], v1
    v_smfmac_f32_16x16x64_bf16 v[68:71], v[24:27], a[232:239], v1
    global_load_dword v0, v9, s[26:27] sc1
    v_permlane32_swap_b32 v56, v60
    v_smfmac_f32_16x16x64_bf16 v[64:67], v[28:31], a[240:247], v1
    v_permlane32_swap_b32 v57, v61
    v_smfmac_f32_16x16x64_bf16 v[68:71], v[28:31], a[248:255], v1
    v_permlane32_swap_b32 v58, v62
    v_smfmac_f32_16x16x64_bf16 v[64:67], v[32:35], v[136:143], v1
    v_permlane32_swap_b32 v59, v63
    v_smfmac_f32_16x16x64_bf16 v[68:71], v[32:35], v[144:151], v1
    s_waitcnt lgkmcnt(0)
    s_barrier
    ds_read_b64_tr_b16 v[112:113], v6 offset:0
    ds_read_b64_tr_b16 v[114:115], v6 offset:64
    v_add_f32 v56, v56, v60
    v_smfmac_f32_16x16x64_bf16 v[64:67], v[36:39], v[152:159], v1
    ds_read_b64_tr_b16 v[116:117], v6 offset:512
    ds_read_b64_tr_b16 v[118:119], v6 offset:576
    v_add_f32 v57, v57, v61
    v_smfmac_f32_16x16x64_bf16 v[68:71], v[36:39], v[160:167], v1
    ds_read_b64_tr_b16 v[120:121], v6 offset:1024
    ds_read_b64_tr_b16 v[122:123], v6 offset:1088
    v_add_f32 v58, v58, v62
    v_smfmac_f32_16x16x64_bf16 v[64:67], v[40:43], v[168:175], v1
    ds_read_b64_tr_b16 v[124:125], v6 offset:1536
    ds_read_b64_tr_b16 v[126:127], v6 offset:1600
    v_add_f32 v59, v59, v63
    v_smfmac_f32_16x16x64_bf16 v[68:71], v[40:43], v[176:183], v1
    v_cvt_pk_bf16_f32 v60, v56, v57
    v_cvt_pk_bf16_f32 v61, v58, v59
    v_smfmac_f32_16x16x64_bf16 v[64:67], v[44:47], v[184:191], v1
    ds_write_b64 v5, v[60:61] offset:2048
    v_smfmac_f32_16x16x64_bf16 v[68:71], v[44:47], v[192:199], v1
    s_waitcnt lgkmcnt(7)
    v_mfma_f32_16x16x32_bf16 v[48:51], v[72:75], v[112:115], 0
    v_mfma_f32_16x16x32_bf16 v[52:55], v[76:79], v[112:115], 0
    s_waitcnt lgkmcnt(5)
    v_cvt_pk_bf16_f32 v64, v64, v65
    v_cvt_pk_bf16_f32 v65, v66, v67
    v_mfma_f32_16x16x32_bf16 v[48:51], v[80:83], v[116:119], v[48:51]
    v_cvt_pk_bf16_f32 v66, v68, v69
    v_cvt_pk_bf16_f32 v67, v70, v71
    v_mfma_f32_16x16x32_bf16 v[52:55], v[84:87], v[116:119], v[52:55]
    global_store_dwordx4 v7, v[64:67], s[82:83] offset:1024 sc1
    s_waitcnt lgkmcnt(3)
    v_mfma_f32_16x16x32_bf16 v[48:51], v[88:91], v[120:123], v[48:51]
    s_waitcnt lgkmcnt(0)
    s_barrier
    ds_read_b64_tr_b16 v[16:17], v6 offset:2048
    ds_read_b64_tr_b16 v[18:19], v6 offset:2112
    v_mfma_f32_16x16x32_bf16 v[52:55], v[92:95], v[120:123], v[52:55]
    ds_read_b64_tr_b16 v[20:21], v6 offset:2560
    ds_read_b64_tr_b16 v[22:23], v6 offset:2624
    ds_read_b64_tr_b16 v[24:25], v6 offset:3072
    ds_read_b64_tr_b16 v[26:27], v6 offset:3136
    v_mov_b64 v[68:69], s[86:87]
    v_mfma_f32_16x16x32_bf16 v[48:51], v[96:99], v[124:127], v[48:51]
    ds_read_b64_tr_b16 v[28:29], v6 offset:3584
    ds_read_b64_tr_b16 v[30:31], v6 offset:3648
    v_mov_b64 v[70:71], s[86:87]
    v_mfma_f32_16x16x32_bf16 v[52:55], v[100:103], v[124:127], v[52:55]
    ds_read_b128 v[32:35], v4 offset:30720
    s_waitcnt lgkmcnt(7)
    v_mov_b64 v[62:63], s[98:99]
    v_mfma_f32_16x16x32_bf16 v[56:59], v[16:19], v[112:115], 0
    ds_read_b128 v[36:39], v4 offset:31744
    s_waitcnt lgkmcnt(6)
    v_max3_f32 v13, v48, v49, v50
    v_mfma_f32_16x16x32_bf16 v[56:59], v[20:23], v[116:119], v[56:59]
    ds_read_b128 v[40:43], v4 offset:24576
    s_waitcnt lgkmcnt(5)
    v_max3_f32 v13, v13, v51, v52
    v_max3_f32 v15, v53, v54, v55
    v_mfma_f32_16x16x32_bf16 v[56:59], v[24:27], v[120:123], v[56:59]
    ds_read_b128 v[44:47], v4 offset:25600
    s_waitcnt lgkmcnt(4)
    v_max_f32 v14, v13, v15
    v_max_f32 v13, v13, v15
    v_mfma_f32_16x16x32_bf16 v[56:59], v[28:31], v[124:127], v[56:59]
    global_store_dwordx4 v7, v[28:31], s[82:83] sc1
    s_cmp_eq_u32 s64, 63
    s_cbranch_scc1 L_chain_fin
    v_permlane32_swap_b32 v13, v14
    v_max_f32 v13, v13, v14
    s_nop 2
    v_max3_f32 v13, v13, v56, v57
    v_max3_f32 v13, v13, v58, v59
    v_mov_b32 v14, v13
    s_nop 1
    v_permlane16_swap_b32 v13, v14
    v_max_f32 v13, v13, v14
    v_mul_f32 v14, s84, v13
    v_pk_fma_f32 v[48:49], v[48:49], s[84:85], v[14:15] op_sel_hi:[1,1,0] neg_lo:[0,0,1] neg_hi:[0,0,1]
    v_pk_fma_f32 v[50:51], v[50:51], s[84:85], v[14:15] op_sel_hi:[1,1,0] neg_lo:[0,0,1] neg_hi:[0,0,1]
    v_pk_fma_f32 v[52:53], v[52:53], s[84:85], v[14:15] op_sel_hi:[1,1,0] neg_lo:[0,0,1] neg_hi:[0,0,1]
    v_pk_fma_f32 v[54:55], v[54:55], s[84:85], v[14:15] op_sel_hi:[1,1,0] neg_lo:[0,0,1] neg_hi:[0,0,1]
    v_pk_fma_f32 v[56:57], v[56:57], s[84:85], v[14:15] op_sel_hi:[1,1,0] neg_lo:[0,0,1] neg_hi:[0,0,1]
    v_pk_fma_f32 v[58:59], v[58:59], s[84:85], v[14:15] op_sel_hi:[1,1,0] neg_lo:[0,0,1] neg_hi:[0,0,1]
    v_exp_f32 v48, v48
    v_exp_f32 v49, v49
    v_exp_f32 v50, v50
    v_exp_f32 v51, v51
    v_exp_f32 v52, v52
    v_exp_f32 v53, v53
    v_exp_f32 v54, v54
    v_exp_f32 v55, v55
    v_cvt_pk_bf16_f32 v48, v48, v49
    v_cvt_pk_bf16_f32 v49, v50, v51
    v_cvt_pk_bf16_f32 v50, v52, v53
    v_cvt_pk_bf16_f32 v51, v54, v55
    v_exp_f32 v56, v56
    v_exp_f32 v57, v57
    v_mfma_f32_16x16x32_bf16 v[120:123], v[68:71], v[48:51], 0
    s_waitcnt vmcnt(8)
    v_exp_f32 v58, v58
    v_mfma_f32_16x16x32_bf16 v[112:115], v[104:107], v[48:51], 0
    v_exp_f32 v59, v59
    v_mfma_f32_16x16x32_bf16 v[116:119], v[108:111], v[48:51], 0
    v_cvt_pk_bf16_f32 v56, v56, v57
    v_cvt_pk_bf16_f32 v57, v58, v59
    v_mov_b64 v[68:69], 0
    v_mov_b64 v[70:71], 0
    v_mfma_f32_16x16x16_bf16 v[120:123], v[62:63], v[56:57], v[120:123]
    ds_read_b128 v[96:99], v4 offset:22528
    v_mov_b64 v[58:59], 0
    v_mfma_f32_16x16x16_bf16 v[112:115], v[64:65], v[56:57], v[112:115]
    ds_read_b128 v[100:103], v4 offset:23552
    v_mov_b64 v[60:61], 0
    v_mfma_f32_16x16x16_bf16 v[116:119], v[66:67], v[56:57], v[116:119]
    ds_read_b128 v[72:75], v4 offset:16384
    v_rcp_f32 v14, v120
    v_mov_b64 v[62:63], 0
    v_mov_b64 v[56:57], 0
    v_mov_b64 v[64:65], 0
    v_mov_b64 v[66:67], 0
    v_pk_mul_f32 v[112:113], v[112:113], v[14:15] op_sel_hi:[1,0]
    v_pk_mul_f32 v[114:115], v[114:115], v[14:15] op_sel_hi:[1,0]
    v_pk_mul_f32 v[116:117], v[116:117], v[14:15] op_sel_hi:[1,0]
    v_pk_mul_f32 v[118:119], v[118:119], v[14:15] op_sel_hi:[1,0]
    v_cvt_pk_bf16_f32 v48, v112, v116
    v_cvt_pk_bf16_f32 v49, v113, v117
    v_cvt_pk_bf16_f32 v50, v114, v118
    v_cvt_pk_bf16_f32 v51, v115, v119
    ds_write_b128 v7, v[48:51]
    ds_read_b128 v[104:107], v4 offset:32768
    ds_read_b128 v[108:111], v4 offset:33792
    v_smfmac_f32_16x16x64_bf16 v[56:59], v[48:51], v[224:231], v1
    s_waitcnt lgkmcnt(4)
    v_smfmac_f32_16x16x64_bf16 v[64:67], v[48:51], v[96:103], v1
    v_smfmac_f32_16x16x64_bf16 v[68:71], v[48:51], v[32:39], v1
    s_waitcnt lgkmcnt(2)
    s_barrier
    ds_read_b128 v[112:115], v8 offset:0
    ds_read_b128 v[116:119], v8 offset:2048
    ds_read_b128 v[120:123], v8 offset:4096
    ds_read_b128 v[76:79], v4 offset:17408
    ds_read_b128 v[80:83], v4 offset:18432
    s_waitcnt lgkmcnt(5)
    v_smfmac_f32_16x16x64_bf16 v[60:63], v[48:51], v[104:111], v1
    s_waitcnt lgkmcnt(4)
    v_smfmac_f32_16x16x64_bf16 v[56:59], v[112:115], v[200:207], v1
    ds_read_b128 v[84:87], v4 offset:19456
    s_waitcnt lgkmcnt(4)
    v_smfmac_f32_16x16x64_bf16 v[56:59], v[116:119], v[208:215], v1
    ds_read_b128 v[88:91], v4 offset:20480
    s_waitcnt lgkmcnt(4)
    v_smfmac_f32_16x16x64_bf16 v[56:59], v[120:123], v[216:223], v1
    ds_read_b128 v[92:95], v4 offset:21504
    v_smfmac_f32_16x16x64_bf16 v[60:63], v[112:115], v[232:239], v1
    ds_read_b128 v[16:19], v4 offset:26624
    v_smfmac_f32_16x16x64_bf16 v[60:63], v[116:119], v[240:247], v1
    ds_read_b128 v[20:23], v4 offset:27648
    v_cvt_pk_bf16_f32 v56, v56, v57
    v_cvt_pk_bf16_f32 v57, v58, v59
    v_smfmac_f32_16x16x64_bf16 v[60:63], v[120:123], v[248:255], v1
    global_store_dwordx2 v2, v[56:57], s[66:67] offset:-4096
    s_waitcnt lgkmcnt(6)
    v_smfmac_f32_16x16x64_bf16 v[64:67], v[112:115], v[72:79], v1
    ds_read_b128 v[24:27], v4 offset:28672
    s_waitcnt lgkmcnt(5)
    v_smfmac_f32_16x16x64_bf16 v[64:67], v[116:119], v[80:87], v1
    ds_read_b128 v[28:31], v4 offset:29696
    s_waitcnt lgkmcnt(4)
    v_cvt_pk_bf16_f32 v60, v60, v61
    v_cvt_pk_bf16_f32 v61, v62, v63
    v_smfmac_f32_16x16x64_bf16 v[64:67], v[120:123], v[88:95], v1
    global_store_dwordx2 v2, v[60:61], s[66:67] offset:-2048
    v_smfmac_f32_16x16x64_bf16 v[68:71], v[112:115], v[40:47], v1
    ds_read_b128 v[72:75], v4 offset:0
    s_waitcnt lgkmcnt(3)
    v_smfmac_f32_16x16x64_bf16 v[68:71], v[116:119], v[16:23], v1
    ds_read_b128 v[76:79], v4 offset:1024
    s_waitcnt lgkmcnt(2)
    v_cvt_pk_bf16_f32 v64, v64, v65
    v_cvt_pk_bf16_f32 v65, v66, v67
    v_smfmac_f32_16x16x64_bf16 v[68:71], v[120:123], v[24:31], v1
    global_store_dwordx2 v2, v[64:65], s[66:67] offset:0
    s_nop 6
    v_cvt_pk_bf16_f32 v68, v68, v69
    v_cvt_pk_bf16_f32 v69, v70, v71
    global_store_dwordx2 v2, v[68:69], s[66:67] offset:2048
    ds_read_b128 v[80:83], v4 offset:2048
    ds_read_b128 v[84:87], v4 offset:3072
    ds_read_b128 v[88:91], v4 offset:4096
    ds_read_b128 v[92:95], v4 offset:5120
    ds_read_b128 v[96:99], v4 offset:6144
    ds_read_b128 v[100:103], v4 offset:7168
    ds_read_b128 v[104:107], v8 offset:20480
    v_mov_b64 v[48:49], 0
    v_mov_b64 v[50:51], 0
    v_mov_b64 v[52:53], 0
    v_mov_b64 v[54:55], 0
    v_mov_b64 v[56:57], 0
    v_mov_b64 v[58:59], 0
    v_mov_b64 v[60:61], 0
    v_mov_b64 v[62:63], 0
    v_mov_b64 v[64:65], 0
    v_mov_b64 v[66:67], 0
    v_mov_b64 v[68:69], 0
    v_mov_b64 v[70:71], 0
    s_lshr_b32 s42, s100, 5
    s_add_u32 s76, s46, s42
    s_addc_u32 s77, s47, 0
    s_sub_u32 s74, s76, 0x22000
    s_subb_u32 s75, s77, 0
    s_add_u32 s42, s42, 0x6000
    s_and_b32 s42, s42, 0x6000
    s_add_u32 s36, s46, s42
    s_addc_u32 s37, s47, 0
    s_add_u32 s64, s64, 1
    v_add_u32 v9, v9, v10
    v_add_u32 v11, 4, v11
    s_add_u32 s80, s80, 0x40000
    s_addc_u32 s81, s81, 0
    s_add_u32 s78, s78, 0x40000
    s_addc_u32 s79, s79, 0
    s_add_u32 s82, s82, 0x40000
    s_addc_u32 s83, s83, 0
    s_nop 0
    s_nop 0
    v_mov_b32 v14, 0
    s_nop 2
    v_mov_b32 v14, 0
    s_nop 2
    v_mov_b32 v14, 0
    s_nop 2
    v_mov_b32 v14, 0
    s_nop 2
    v_mov_b32 v14, 0
    s_nop 2
    v_mov_b32 v14, 0
    s_nop 2
    global_load_dwordx4 v[112:115], v12, s[68:69] sc1
    global_load_dwordx4 v[116:119], v12, s[68:69] offset:1024 sc1
    v_mov_b32 v14, 0
    s_nop 2
    v_mov_b32 v14, 0
    s_nop 2
    v_mov_b32 v14, 0
    s_nop 2
    v_mov_b32 v14, 0
    s_nop 2
    v_mov_b32 v14, 0
    s_nop 2
    v_mov_b32 v14, 0
    s_nop 2
    v_mov_b32 v14, 0
    s_nop 2
    v_mov_b32 v14, 0
    s_nop 2
    v_mov_b32 v14, 0
    s_nop 2
    global_load_dwordx4 v[112:115], v12, s[68:69] sc1
    global_load_dwordx4 v[116:119], v12, s[68:69] offset:1024 sc1
    s_waitcnt lgkmcnt(0)
    s_waitcnt vmcnt(10)
    ds_write_b128 v7, v[128:131] offset:12288
    ds_write_b128 v7, v[132:135] offset:13312
    v_mov_b32 v14, 0
    s_nop 2
    s_waitcnt vmcnt(2)
    v_max3_u32 v14, v112, v113, v114
    v_max3_u32 v15, v115, v116, v117
    v_max3_u32 v14, v14, v118, v119
    v_max_u32 v14, v14, v15
    v_cmp_eq_u32 vcc, -1, v14
    s_cbranch_vccnz L_hop1_3
L_hop1_ok3:
    v_mfma_f32_16x16x32_bf16 v[108:111], v[112:115], v[104:107], 0
    v_mfma_f32_16x16x32_bf16 v[108:111], v[116:119], v[104:107], v[108:111]
    s_nop 7
    v_add_f32 v108, v108, v109
    v_add_f32 v110, v110, v111
    s_nop 1
    v_permlane32_swap_b32 v108, v110
    v_add_f32 v108, v108, v110
    s_nop 1
    v_mov_b32_dpp v109, v108 row_shl:4 row_mask:0xf bank_mask:0xf
    v_cvt_pk_bf16_f32 v108, v108, v109
    s_mov_b64 exec, s[44:45]
    global_store_dword v3, v108, s[76:77]
    s_mov_b64 exec, -1
    s_mov_b64 s[70:71], s[68:69]
    s_add_u32 s100, s100, 0x40000
    s_and_b32 s100, s100, 0xc0000
    s_add_u32 s42, s100, s101
    s_add_u32 s68, s72, s42
    s_addc_u32 s69, s73, 0
    s_add_u32 s42, s100, 0x23000
    s_add_u32 s66, s72, s42
    s_addc_u32 s67, s73, 0
    v_readlane_b32 s41, v0, 48
    s_nop 0
    s_cmp_eq_u32 s41, 0x01010101
    s_cbranch_scc0 L_flag_slow3
L_flag_ok3:
    v_mov_b32 v14, 0
    s_nop 2
    v_mov_b32 v14, 0
    s_nop 2
    v_mov_b32 v14, 0
    s_nop 2
    v_mov_b32 v14, 0
    s_nop 2
    v_mov_b32 v14, 0
    s_nop 2
    v_mov_b32 v14, 0
    s_nop 2
    v_mov_b32 v14, 0
    s_nop 2
    global_load_dwordx4 v[16:19], v7, s[74:75] sc1
    global_load_dwordx4 v[20:23], v7, s[74:75] offset:1024 sc1
    v_mov_b32 v14, 0
    s_nop 2
    v_mov_b32 v14, 0
    s_nop 2
    v_mov_b32 v14, 0
    s_nop 2
    v_mov_b32 v14, 0
    s_nop 2
    v_mov_b32 v14, 0
    s_nop 2
    v_mov_b32 v14, 0
    s_nop 2
    v_mov_b32 v14, 0
    s_nop 2
    v_mov_b32 v14, 0
    s_nop 2
    v_mov_b32 v14, 0
    s_nop 2
    global_load_dwordx4 v[16:19], v7, s[74:75] sc1
    global_load_dwordx4 v[20:23], v7, s[74:75] offset:1024 sc1
    v_mov_b32 v14, 0
    s_nop 2
    v_mov_b32 v14, 0
    s_nop 2
    v_mov_b32 v14, 0
    s_nop 2
    s_waitcnt lgkmcnt(0)
    s_waitcnt vmcnt(2)
    v_max3_u32 v14, v16, v17, v18
    v_max3_u32 v15, v19, v20, v21
    v_max3_u32 v14, v14, v22, v23
    v_max_u32 v14, v14, v15
    v_cmp_eq_u32 vcc, -1, v14
    s_cbranch_vccz L_step3
L_hop2_3:
    s_mov_b64 exec, vcc
    global_load_dwordx4 v[16:19], v7, s[74:75] sc1
    global_load_dwordx4 v[20:23], v7, s[74:75] offset:1024 sc1
    s_mov_b64 exec, -1
    v_max3_u32 v14, v16, v17, v18
    v_max3_u32 v15, v19, v20, v21
    v_max3_u32 v14, v14, v22, v23
    v_max_u32 v14, v14, v15
    v_cmp_eq_u32 vcc, -1, v14
    s_cbranch_vccz L_step3
    v_max3_u32 v14, v16, v17, v18
    v_max3_u32 v15, v19, v20, v21
    v_max3_u32 v14, v14, v22, v23
    v_max_u32 v14, v14, v15
    v_cmp_eq_u32 vcc, -1, v14
    s_cbranch_vccz L_step3
    s_mov_b64 exec, vcc
    global_load_dwordx4 v[16:19], v7, s[74:75] sc1
    global_load_dwordx4 v[20:23], v7, s[74:75] offset:1024 sc1
    s_mov_b64 exec, -1
    v_max3_u32 v14, v16, v17, v18
    v_max3_u32 v15, v19, v20, v21
    v_max3_u32 v14, v14, v22, v23
    v_max_u32 v14, v14, v15
    v_cmp_eq_u32 vcc, -1, v14
    s_cbranch_vccz L_step3
    v_max3_u32 v14, v16, v17, v18
    v_max3_u32 v15, v19, v20, v21
    v_max3_u32 v14, v14, v22, v23
    v_max_u32 v14, v14, v15
    v_cmp_eq_u32 vcc, -1, v14
    s_cbranch_vccz L_step3
    s_waitcnt vmcnt(32)
    s_add_u32 s39, s39, 1
    s_cmp_gt_u32 s39, 0x400000
    s_cbranch_scc1 L_fail
    s_branch L_hop2_3
L_hop1_3:
    s_mov_b64 exec, vcc
    global_load_dwordx4 v[112:115], v12, s[68:69] sc1
    global_load_dwordx4 v[116:119], v12, s[68:69] offset:1024 sc1
    s_mov_b64 exec, -1
    v_max3_u32 v14, v112, v113, v114
    v_max3_u32 v15, v115, v116, v117
    v_max3_u32 v14, v14, v118, v119
    v_max_u32 v14, v14, v15
    v_cmp_eq_u32 vcc, -1, v14
    s_cbranch_vccz L_hop1_ok3
    v_max3_u32 v14, v112, v113, v114
    v_max3_u32 v15, v115, v116, v117
    v_max3_u32 v14, v14, v118, v119
    v_max_u32 v14, v14, v15
    v_cmp_eq_u32 vcc, -1, v14
    s_cbranch_vccz L_hop1_ok3
    s_mov_b64 exec, vcc
    global_load_dwordx4 v[112:115], v12, s[68:69] sc1
    global_load_dwordx4 v[116:119], v12, s[68:69] offset:1024 sc1
    s_mov_b64 exec, -1
    v_max3_u32 v14, v112, v113, v114
    v_max3_u32 v15, v115, v116, v117
    v_max3_u32 v14, v14, v118, v119
    v_max_u32 v14, v14, v15
    v_cmp_eq_u32 vcc, -1, v14
    s_cbranch_vccz L_hop1_ok3
    v_max3_u32 v14, v112, v113, v114
    v_max3_u32 v15, v115, v116, v117
    v_max3_u32 v14, v14, v118, v119
    v_max_u32 v14, v14, v15
    v_cmp_eq_u32 vcc, -1, v14
    s_cbranch_vccz L_hop1_ok3
    s_waitcnt vmcnt(32)
    s_add_u32 s39, s39, 1
    s_cmp_gt_u32 s39, 0x400000
    s_cbranch_scc1 L_fail
    s_branch L_hop1_3
L_flag_slow3:
    s_cmp_ge_u32 s64, 63
    s_cbranch_scc1 L_flag_ok3
    s_lshl_b32 s40, s29, 6
    s_add_u32 s40, s40, s64
    s_lshl_b32 s40, s40, 2
    s_add_u32 s40, s40, 0x400004
    v_mov_b32 v14, s40
    v_mov_b32 v15, 0x01010101
L_wf_10:
    global_load_dword v0, v14, s[26:27] sc1
    s_add_u32 s39, s39, 1
    s_cmp_gt_u32 s39, 0x400000
    s_cbranch_scc1 L_fail
    s_sleep 1
    s_waitcnt vmcnt(0)
    v_cmp_ne_u32 vcc, v15, v0
    s_cbranch_vccnz L_wf_10
    s_branch L_flag_ok3
L_slowmode:
    s_cmp_eq_u32 s28, 1
    s_cbranch_scc1 L_entrys1
    s_cmp_eq_u32 s28, 2
    s_cbranch_scc1 L_entrys2
    s_cmp_eq_u32 s28, 3
    s_cbranch_scc1 L_entrys3
L_entrys0:
    ds_read_b128 v[72:75], v4 offset:0
    ds_read_b128 v[76:79], v4 offset:1024
    ds_read_b128 v[80:83], v4 offset:2048
    ds_read_b128 v[84:87], v4 offset:3072
    ds_read_b128 v[88:91], v4 offset:4096
    ds_read_b128 v[92:95], v4 offset:5120
    ds_read_b128 v[96:99], v4 offset:6144
    ds_read_b128 v[100:103], v4 offset:7168
    v_mov_b64 v[48:49], 0
    v_mov_b64 v[50:51], 0
    v_mov_b64 v[52:53], 0
    v_mov_b64 v[54:55], 0
    v_mov_b64 v[56:57], 0
    v_mov_b64 v[58:59], 0
    v_mov_b64 v[60:61], 0
    v_mov_b64 v[62:63], 0
    v_mov_b64 v[64:65], 0
    v_mov_b64 v[66:67], 0
    v_mov_b64 v[68:69], 0
    v_mov_b64 v[70:71], 0
    s_mov_b64 s[70:71], s[68:69]
    s_add_u32 s100, s100, 0x40000
    s_and_b32 s100, s100, 0xc0000
    s_add_u32 s42, s100, s101
    s_add_u32 s68, s72, s42
    s_addc_u32 s69, s73, 0
    s_add_u32 s42, s100, 0x23000
    s_add_u32 s66, s72, s42
    s_addc_u32 s67, s73, 0
    s_add_u32 s36, s46, 0x4000
    s_addc_u32 s37, s47, 0
    s_lshl_b32 s40, s29, 8
    s_add_u32 s40, s40, 0x400004
    v_mov_b32 v14, s40
    v_mov_b32 v15, 0x01010101
    v_readlane_b32 s41, v0, 48
    s_nop 0
    s_cmp_eq_u32 s41, 0x01010101
    s_cbranch_scc1 L_e1s0
L_wf_11:
    global_load_dword v0, v14, s[26:27] sc1
    s_add_u32 s39, s39, 1
    s_cmp_gt_u32 s39, 0x400000
    s_cbranch_scc1 L_fail
    s_sleep 1
    s_waitcnt vmcnt(0)
    v_cmp_ne_u32 vcc, v15, v0
    s_cbranch_vccnz L_wf_11
L_e1s0:
    s_waitcnt lgkmcnt(0)
.p2align 6
L_steps0:
    v_smfmac_f32_16x16x64_bf16 v[48:51], v[16:19], v[72:79], v1
    ds_write_b128 v7, v[16:19]
    v_smfmac_f32_16x16x64_bf16 v[52:55], v[16:19], v[80:87], v1
    ds_write_b128 v7, v[20:23] offset:1024
    v_smfmac_f32_16x16x64_bf16 v[48:51], v[20:23], v[88:95], v1
    ds_read_b128 v[72:75], v4 offset:8192
    v_smfmac_f32_16x16x64_bf16 v[52:55], v[20:23], v[96:103], v1
    ds_read_b128 v[76:79], v4 offset:9216
    v_mov_b64 v[112:113], -1
    v_smfmac_f32_16x16x64_bf16 v[56:59], v[16:19], a[96:103], v1
    ds_read_b128 v[80:83], v4 offset:10240
    v_mov_b64 v[114:115], -1
    v_smfmac_f32_16x16x64_bf16 v[60:63], v[16:19], a[104:111], v1
    ds_read_b128 v[84:87], v4 offset:11264
    v_smfmac_f32_16x16x64_bf16 v[56:59], v[20:23], a[112:119], v1
    v_smfmac_f32_16x16x64_bf16 v[60:63], v[20:23], a[120:127], v1
    s_waitcnt lgkmcnt(4)
    s_barrier
    ds_read_b128 v[24:27], v8 offset:2048
    ds_read_b128 v[28:31], v8 offset:3072
    v_smfmac_f32_16x16x64_bf16 v[64:67], v[16:19], a[192:199], v1
    ds_read_b128 v[32:35], v8 offset:4096
    v_smfmac_f32_16x16x64_bf16 v[68:71], v[16:19], a[200:207], v1
    ds_read_b128 v[36:39], v8 offset:5120
    v_smfmac_f32_16x16x64_bf16 v[64:67], v[20:23], a[208:215], v1
    ds_read_b128 v[40:43], v8 offset:6144
    v_smfmac_f32_16x16x64_bf16 v[68:71], v[20:23], a[216:223], v1
    s_waitcnt vmcnt(0)
    ds_read_b128 v[44:47], v8 offset:7168
    global_load_dwordx4 v[104:107], v7, s[80:81] offset:0 sc1
    s_waitcnt lgkmcnt(5)
    v_smfmac_f32_16x16x64_bf16 v[48:51], v[24:27], a[0:7], v1
    global_load_dwordx4 v[108:111], v7, s[80:81] offset:1024 sc1
    v_smfmac_f32_16x16x64_bf16 v[52:55], v[24:27], a[8:15], v1
    ds_read_b128 v[88:91], v4 offset:12288
    s_waitcnt lgkmcnt(5)
    v_smfmac_f32_16x16x64_bf16 v[48:51], v[28:31], a[16:23], v1
    ds_read_b128 v[92:95], v4 offset:13312
    v_smfmac_f32_16x16x64_bf16 v[52:55], v[28:31], a[24:31], v1
    ds_read_b128 v[96:99], v4 offset:14336
    s_waitcnt lgkmcnt(6)
    v_smfmac_f32_16x16x64_bf16 v[48:51], v[32:35], a[32:39], v1
    ds_read_b128 v[100:103], v4 offset:15360
    v_smfmac_f32_16x16x64_bf16 v[52:55], v[32:35], a[40:47], v1
    global_load_dwordx4 v[128:131], v7, s[78:79] offset:0 sc1
    s_waitcnt lgkmcnt(6)
    v_smfmac_f32_16x16x64_bf16 v[48:51], v[36:39], a[48:55], v1
    v_smfmac_f32_16x16x64_bf16 v[52:55], v[36:39], a[56:63], v1
    global_load_dwordx4 v[132:135], v7, s[78:79] offset:1024 sc1
    s_waitcnt lgkmcnt(5)
    v_smfmac_f32_16x16x64_bf16 v[48:51], v[40:43], a[64:71], v1
    v_smfmac_f32_16x16x64_bf16 v[52:55], v[40:43], a[72:79], v1
    s_waitcnt lgkmcnt(4)
    v_smfmac_f32_16x16x64_bf16 v[48:51], v[44:47], a[80:87], v1
    s_mov_b64 exec, s[44:45]
    global_store_dword v3, v112, s[36:37] sc1
    s_mov_b64 exec, -1
    v_smfmac_f32_16x16x64_bf16 v[52:55], v[44:47], a[88:95], v1
    v_smfmac_f32_16x16x64_bf16 v[56:59], v[24:27], v[72:79], v1
    v_smfmac_f32_16x16x64_bf16 v[60:63], v[24:27], v[80:87], v1
    global_store_dwordx4 v7, v[112:115], s[70:71] offset:0 sc1
    s_waitcnt lgkmcnt(2)
    v_permlane32_swap_b32 v48, v52
    v_smfmac_f32_16x16x64_bf16 v[56:59], v[28:31], v[88:95], v1
    ds_read_b128 v[72:75], v8 offset:12288
    s_waitcnt lgkmcnt(1)
    v_permlane32_swap_b32 v49, v53
    v_smfmac_f32_16x16x64_bf16 v[60:63], v[28:31], v[96:103], v1
    ds_read_b128 v[76:79], v8 offset:16384
    v_permlane32_swap_b32 v50, v54
    v_smfmac_f32_16x16x64_bf16 v[56:59], v[32:35], a[128:135], v1
    ds_read_b128 v[80:83], v8 offset:13312
    v_permlane32_swap_b32 v51, v55
    v_smfmac_f32_16x16x64_bf16 v[60:63], v[32:35], a[136:143], v1
    ds_read_b128 v[84:87], v8 offset:17408
    v_add_f32 v48, v48, v52
    v_smfmac_f32_16x16x64_bf16 v[56:59], v[36:39], a[144:151], v1
    ds_read_b128 v[88:91], v8 offset:14336
    v_add_f32 v49, v49, v53
    v_smfmac_f32_16x16x64_bf16 v[60:63], v[36:39], a[152:159], v1
    global_store_dwordx4 v7, v[112:115], s[70:71] offset:1024 sc1
    v_add_f32 v50, v50, v54
    v_smfmac_f32_16x16x64_bf16 v[56:59], v[40:43], a[160:167], v1
    ds_read_b128 v[92:95], v8 offset:18432
    v_add_f32 v51, v51, v55
    v_smfmac_f32_16x16x64_bf16 v[60:63], v[40:43], a[168:175], v1
    ds_read_b128 v[96:99], v8 offset:15360
    v_cvt_pk_bf16_f32 v52, v48, v49
    v_smfmac_f32_16x16x64_bf16 v[56:59], v[44:47], a[176:183], v1
    ds_read_b128 v[100:103], v8 offset:19456
    v_cvt_pk_bf16_f32 v53, v50, v51
    v_smfmac_f32_16x16x64_bf16 v[60:63], v[44:47], a[184:191], v1
    ds_write_b64 v5, v[52:53]
    v_smfmac_f32_16x16x64_bf16 v[64:67], v[24:27], a[224:231], v1
    v_smfmac_f32_16x16x64_bf16 v[68:71], v[24:27], a[232:239], v1
    global_load_dword v0, v9, s[26:27] sc1
    v_permlane32_swap_b32 v56, v60
    v_smfmac_f32_16x16x64_bf16 v[64:67], v[28:31], a[240:247], v1
    v_permlane32_swap_b32 v57, v61
    v_smfmac_f32_16x16x64_bf16 v[68:71], v[28:31], a[248:255], v1
    v_permlane32_swap_b32 v58, v62
    v_smfmac_f32_16x16x64_bf16 v[64:67], v[32:35], v[136:143], v1
    v_permlane32_swap_b32 v59, v63
    v_smfmac_f32_16x16x64_bf16 v[68:71], v[32:35], v[144:151], v1
    s_waitcnt lgkmcnt(0)
    s_barrier
    ds_read_b64_tr_b16 v[112:113], v6 offset:0
    ds_read_b64_tr_b16 v[114:115], v6 offset:64
    v_add_f32 v56, v56, v60
    v_smfmac_f32_16x16x64_bf16 v[64:67], v[36:39], v[152:159], v1
    ds_read_b64_tr_b16 v[116:117], v6 offset:512
    ds_read_b64_tr_b16 v[118:119], v6 offset:576
    v_add_f32 v57, v57, v61
    v_smfmac_f32_16x16x64_bf16 v[68:71], v[36:39], v[160:167], v1
    ds_read_b64_tr_b16 v[120:121], v6 offset:1024
    ds_read_b64_tr_b16 v[122:123], v6 offset:1088
    v_add_f32 v58, v58, v62
    v_smfmac_f32_16x16x64_bf16 v[64:67], v[40:43], v[168:175], v1
    ds_read_b64_tr_b16 v[124:125], v6 offset:1536
    ds_read_b64_tr_b16 v[126:127], v6 offset:1600
    v_add_f32 v59, v59, v63
    v_smfmac_f32_16x16x64_bf16 v[68:71], v[40:43], v[176:183], v1
    v_cvt_pk_bf16_f32 v60, v56, v57
    v_cvt_pk_bf16_f32 v61, v58, v59
    v_smfmac_f32_16x16x64_bf16 v[64:67], v[44:47], v[184:191], v1
    ds_write_b64 v5, v[60:61] offset:2048
    v_smfmac_f32_16x16x64_bf16 v[68:71], v[44:47], v[192:199], v1
    s_waitcnt lgkmcnt(7)
    v_mfma_f32_16x16x32_bf16 v[48:51], v[72:75], v[112:115], 0
    v_mfma_f32_16x16x32_bf16 v[52:55], v[76:79], v[112:115], 0
    s_mov_b64 exec, 1
    global_store_dword v11, v1, s[26:27] sc1
    s_mov_b64 exec, -1
    s_waitcnt lgkmcnt(5)
    v_cvt_pk_bf16_f32 v64, v64, v65
    v_cvt_pk_bf16_f32 v65, v66, v67
    v_mfma_f32_16x16x32_bf16 v[48:51], v[80:83], v[116:119], v[48:51]
    v_cvt_pk_bf16_f32 v66, v68, v69
    v_cvt_pk_bf16_f32 v67, v70, v71
    v_mfma_f32_16x16x32_bf16 v[52:55], v[84:87], v[116:119], v[52:55]
    global_store_dwordx4 v7, v[64:67], s[82:83] offset:1024 sc1
    s_waitcnt lgkmcnt(3)
    v_mfma_f32_16x16x32_bf16 v[48:51], v[88:91], v[120:123], v[48:51]
    s_waitcnt lgkmcnt(0)
    s_barrier
    ds_read_b64_tr_b16 v[16:17], v6 offset:2048
    ds_read_b64_tr_b16 v[18:19], v6 offset:2112
    v_mfma_f32_16x16x32_bf16 v[52:55], v[92:95], v[120:123], v[52:55]
    ds_read_b64_tr_b16 v[20:21], v6 offset:2560
    ds_read_b64_tr_b16 v[22:23], v6 offset:2624
    ds_read_b64_tr_b16 v[24:25], v6 offset:3072
    ds_read_b64_tr_b16 v[26:27], v6 offset:3136
    v_mov_b64 v[68:69], s[86:87]
    v_mfma_f32_16x16x32_bf16 v[48:51], v[96:99], v[124:127], v[48:51]
    ds_read_b64_tr_b16 v[28:29], v6 offset:3584
    ds_read_b64_tr_b16 v[30:31], v6 offset:3648
    v_mov_b64 v[70:71], s[86:87]
    v_mfma_f32_16x16x32_bf16 v[52:55], v[100:103], v[124:127], v[52:55]
    ds_read_b128 v[32:35], v4 offset:24576
    s_waitcnt lgkmcnt(7)
    v_mov_b64 v[62:63], s[98:99]
    v_mfma_f32_16x16x32_bf16 v[56:59], v[16:19], v[112:115], 0
    global_store_dwordx4 v7, v[16:19], s[82:83] sc1
    s_waitcnt lgkmcnt(5)
    v_max3_f32 v13, v48, v49, v50
    v_mfma_f32_16x16x32_bf16 v[56:59], v[20:23], v[116:119], v[56:59]
    ds_read_b128 v[36:39], v4 offset:25600
    s_waitcnt lgkmcnt(4)
    v_max3_f32 v13, v13, v51, v52
    v_max3_f32 v15, v53, v54, v55
    v_mfma_f32_16x16x32_bf16 v[56:59], v[24:27], v[120:123], v[56:59]
    ds_read_b128 v[40:43], v4 offset:26624
    s_waitcnt lgkmcnt(3)
    v_max_f32 v14, v13, v15
    v_max_f32 v13, v13, v15
    v_mfma_f32_16x16x32_bf16 v[56:59], v[28:31], v[124:127], v[56:59]
    ds_read_b128 v[44:47], v4 offset:27648
    s_cmp_eq_u32 s64, 63
    s_cbranch_scc1 L_chain_fin
    v_permlane32_swap_b32 v13, v14
    v_max_f32 v13, v13, v14
    s_nop 2
    v_max3_f32 v13, v13, v56, v57
    v_max3_f32 v13, v13, v58, v59
    v_mov_b32 v14, v13
    s_nop 1
    v_permlane16_swap_b32 v13, v14
    v_max_f32 v13, v13, v14
    v_mul_f32 v14, s84, v13
    v_pk_fma_f32 v[48:49], v[48:49], s[84:85], v[14:15] op_sel_hi:[1,1,0] neg_lo:[0,0,1] neg_hi:[0,0,1]
    v_pk_fma_f32 v[50:51], v[50:51], s[84:85], v[14:15] op_sel_hi:[1,1,0] neg_lo:[0,0,1] neg_hi:[0,0,1]
    v_pk_fma_f32 v[52:53], v[52:53], s[84:85], v[14:15] op_sel_hi:[1,1,0] neg_lo:[0,0,1] neg_hi:[0,0,1]
    v_pk_fma_f32 v[54:55], v[54:55], s[84:85], v[14:15] op_sel_hi:[1,1,0] neg_lo:[0,0,1] neg_hi:[0,0,1]
    v_pk_fma_f32 v[56:57], v[56:57], s[84:85], v[14:15] op_sel_hi:[1,1,0] neg_lo:[0,0,1] neg_hi:[0,0,1]
    v_pk_fma_f32 v[58:59], v[58:59], s[84:85], v[14:15] op_sel_hi:[1,1,0] neg_lo:[0,0,1] neg_hi:[0,0,1]
    v_exp_f32 v48, v48
    v_exp_f32 v49, v49
    v_exp_f32 v50, v50
    v_exp_f32 v51, v51
    v_exp_f32 v52, v52
    v_exp_f32 v53, v53
    v_exp_f32 v54, v54
    v_exp_f32 v55, v55
    v_cvt_pk_bf16_f32 v48, v48, v49
    v_cvt_pk_bf16_f32 v49, v50, v51
    v_cvt_pk_bf16_f32 v50, v52, v53
    v_cvt_pk_bf16_f32 v51, v54, v55
    v_exp_f32 v56, v56
    v_exp_f32 v57, v57
    v_mfma_f32_16x16x32_bf16 v[120:123], v[68:71], v[48:51], 0
    s_waitcnt vmcnt(9)
    v_exp_f32 v58, v58
    v_mfma_f32_16x16x32_bf16 v[112:115], v[104:107], v[48:51], 0
    v_exp_f32 v59, v59
    v_mfma_f32_16x16x32_bf16 v[116:119], v[108:111], v[48:51], 0
    v_cvt_pk_bf16_f32 v56, v56, v57
    v_cvt_pk_bf16_f32 v57, v58, v59
    v_mov_b64 v[68:69], 0
    v_mov_b64 v[70:71], 0
    v_mfma_f32_16x16x16_bf16 v[120:123], v[62:63], v[56:57], v[120:123]
    ds_read_b128 v[72:75], v4 offset:16384
    v_mov_b64 v[58:59], 0
    v_mfma_f32_16x16x16_bf16 v[112:115], v[64:65], v[56:57], v[112:115]
    ds_read_b128 v[76:79], v4 offset:17408
    v_mov_b64 v[60:61], 0
    v_mfma_f32_16x16x16_bf16 v[116:119], v[66:67], v[56:57], v[116:119]
    ds_read_b128 v[80:83], v4 offset:18432
    v_rcp_f32 v14, v120
    v_mov_b64 v[62:63], 0
    v_mov_b64 v[56:57], 0
    v_mov_b64 v[64:65], 0
    v_mov_b64 v[66:67], 0
    v_pk_mul_f32 v[112:113], v[112:113], v[14:15] op_sel_hi:[1,0]
    v_pk_mul_f32 v[114:115], v[114:115], v[14:15] op_sel_hi:[1,0]
    v_pk_mul_f32 v[116:117], v[116:117], v[14:15] op_sel_hi:[1,0]
    v_pk_mul_f32 v[118:119], v[118:119], v[14:15] op_sel_hi:[1,0]
    v_cvt_pk_bf16_f32 v48, v112, v116
    v_cvt_pk_bf16_f32 v49, v113, v117
    v_cvt_pk_bf16_f32 v50, v114, v118
    v_cvt_pk_bf16_f32 v51, v115, v119
    ds_write_b128 v7, v[48:51]
    s_nop 0
    v_smfmac_f32_16x16x64_bf16 v[56:59], v[48:51], v[200:207], v1
    ds_read_b128 v[104:107], v4 offset:32768
    v_smfmac_f32_16x16x64_bf16 v[60:63], v[48:51], v[232:239], v1
    ds_read_b128 v[108:111], v4 offset:33792
    s_waitcnt lgkmcnt(4)
    v_smfmac_f32_16x16x64_bf16 v[64:67], v[48:51], v[72:79], v1
    s_waitcnt lgkmcnt(2)
    s_barrier
    ds_read_b128 v[116:119], v8 offset:2048
    ds_read_b128 v[120:123], v8 offset:4096
    ds_read_b128 v[124:127], v8 offset:6144
    ds_read_b128 v[84:87], v4 offset:19456
    ds_read_b128 v[88:91], v4 offset:20480
    v_smfmac_f32_16x16x64_bf16 v[68:71], v[48:51], v[32:39], v1
    s_waitcnt lgkmcnt(4)
    v_smfmac_f32_16x16x64_bf16 v[56:59], v[116:119], v[208:215], v1
    ds_read_b128 v[92:95], v4 offset:21504
    s_waitcnt lgkmcnt(4)
    v_smfmac_f32_16x16x64_bf16 v[56:59], v[120:123], v[216:223], v1
    ds_read_b128 v[96:99], v4 offset:22528
    s_waitcnt lgkmcnt(4)
    v_smfmac_f32_16x16x64_bf16 v[56:59], v[124:127], v[224:231], v1
    ds_read_b128 v[100:103], v4 offset:23552
    v_smfmac_f32_16x16x64_bf16 v[60:63], v[116:119], v[240:247], v1
    ds_read_b128 v[16:19], v4 offset:28672
    v_smfmac_f32_16x16x64_bf16 v[60:63], v[120:123], v[248:255], v1
    ds_read_b128 v[20:23], v4 offset:29696
    v_cvt_pk_bf16_f32 v56, v56, v57
    v_cvt_pk_bf16_f32 v57, v58, v59
    v_smfmac_f32_16x16x64_bf16 v[60:63], v[124:127], v[104:111], v1
    global_store_dwordx2 v2, v[56:57], s[66:67] offset:-4096 sc1
    s_waitcnt lgkmcnt(6)
    v_smfmac_f32_16x16x64_bf16 v[64:67], v[116:119], v[80:87], v1
    ds_read_b128 v[24:27], v4 offset:30720
    s_waitcnt lgkmcnt(5)
    v_smfmac_f32_16x16x64_bf16 v[64:67], v[120:123], v[88:95], v1
    ds_read_b128 v[28:31], v4 offset:31744
    s_waitcnt lgkmcnt(4)
    v_cvt_pk_bf16_f32 v60, v60, v61
    v_cvt_pk_bf16_f32 v61, v62, v63
    v_smfmac_f32_16x16x64_bf16 v[64:67], v[124:127], v[96:103], v1
    global_store_dwordx2 v2, v[60:61], s[66:67] offset:-2048 sc1
    v_smfmac_f32_16x16x64_bf16 v[68:71], v[116:119], v[40:47], v1
    ds_read_b128 v[72:75], v4 offset:0
    s_waitcnt lgkmcnt(3)
    v_smfmac_f32_16x16x64_bf16 v[68:71], v[120:123], v[16:23], v1
    ds_read_b128 v[76:79], v4 offset:1024
    s_waitcnt lgkmcnt(2)
    v_cvt_pk_bf16_f32 v64, v64, v65
    v_cvt_pk_bf16_f32 v65, v66, v67
    v_smfmac_f32_16x16x64_bf16 v[68:71], v[124:127], v[24:31], v1
    global_store_dwordx2 v2, v[64:65], s[66:67] offset:0 sc1
    s_nop 6
    v_cvt_pk_bf16_f32 v68, v68, v69
    v_cvt_pk_bf16_f32 v69, v70, v71
    global_store_dwordx2 v2, v[68:69], s[66:67] offset:2048 sc1
    ds_read_b128 v[80:83], v4 offset:2048
    ds_read_b128 v[84:87], v4 offset:3072
    ds_read_b128 v[88:91], v4 offset:4096
    ds_read_b128 v[92:95], v4 offset:5120
    ds_read_b128 v[96:99], v4 offset:6144
    ds_read_b128 v[100:103], v4 offset:7168
    ds_read_b128 v[104:107], v8 offset:20480
    v_mov_b64 v[48:49], 0
    v_mov_b64 v[50:51], 0
    v_mov_b64 v[52:53], 0
    v_mov_b64 v[54:55], 0
    v_mov_b64 v[56:57], 0
    v_mov_b64 v[58:59], 0
    v_mov_b64 v[60:61], 0
    v_mov_b64 v[62:63], 0
    v_mov_b64 v[64:65], 0
    v_mov_b64 v[66:67], 0
    v_mov_b64 v[68:69], 0
    v_mov_b64 v[70:71], 0
    s_lshr_b32 s42, s100, 5
    s_add_u32 s76, s46, s42
    s_addc_u32 s77, s47, 0
    s_sub_u32 s74, s76, 0x22000
    s_subb_u32 s75, s77, 0
    s_add_u32 s42, s42, 0x6000
    s_and_b32 s42, s42, 0x6000
    s_add_u32 s36, s46, s42
    s_addc_u32 s37, s47, 0
    s_add_u32 s64, s64, 1
    v_add_u32 v9, v9, v10
    v_add_u32 v11, 4, v11
    global_load_dwordx4 v[112:115], v12, s[68:69] sc1
    global_load_dwordx4 v[116:119], v12, s[68:69] offset:1024 sc1
    s_add_u32 s80, s80, 0x40000
    s_addc_u32 s81, s81, 0
    s_add_u32 s78, s78, 0x40000
    s_addc_u32 s79, s79, 0
    s_add_u32 s82, s82, 0x40000
    s_addc_u32 s83, s83, 0
    s_nop 0
    s_nop 0
    v_mov_b32 v14, 0
    s_nop 2
    v_mov_b32 v14, 0
    s_nop 2
    v_mov_b32 v14, 0
    s_nop 2
    v_mov_b32 v14, 0
    s_nop 2
    v_mov_b32 v14, 0
    s_nop 2
    v_mov_b32 v14, 0
    s_nop 2
    v_mov_b32 v14, 0
    s_nop 2
    global_load_dwordx4 v[112:115], v12, s[68:69] sc1
    global_load_dwordx4 v[116:119], v12, s[68:69] offset:1024 sc1
    s_waitcnt lgkmcnt(0)
    s_waitcnt vmcnt(11)
    ds_write_b128 v7, v[128:131] offset:12288
    ds_write_b128 v7, v[132:135] offset:13312
    v_mov_b32 v14, 0
    s_nop 2
    s_waitcnt vmcnt(2)
    v_max3_u32 v14, v112, v113, v114
    v_max3_u32 v15, v115, v116, v117
    v_max3_u32 v14, v14, v118, v119
    v_max_u32 v14, v14, v15
    v_cmp_eq_u32 vcc, -1, v14
    s_cbranch_vccnz L_hop1_s0
L_hop1_oks0:
    v_mfma_f32_16x16x32_bf16 v[108:111], v[112:115], v[104:107], 0
    v_mfma_f32_16x16x32_bf16 v[108:111], v[116:119], v[104:107], v[108:111]
    s_nop 7
    v_add_f32 v108, v108, v109
    v_add_f32 v110, v110, v111
    s_nop 1
    v_permlane32_swap_b32 v108, v110
    v_add_f32 v108, v108, v110
    s_nop 1
    v_mov_b32_dpp v109, v108 row_shl:4 row_mask:0xf bank_mask:0xf
    v_cvt_pk_bf16_f32 v108, v108, v109
    s_mov_b64 exec, s[44:45]
    global_store_dword v3, v108, s[76:77] sc1
    s_mov_b64 exec, -1
    s_mov_b64 s[70:71], s[68:69]
    s_add_u32 s100, s100, 0x40000
    s_and_b32 s100, s100, 0xc0000
    s_add_u32 s42, s100, s101
    s_add_u32 s68, s72, s42
    s_addc_u32 s69, s73, 0
    s_add_u32 s42, s100, 0x23000
    s_add_u32 s66, s72, s42
    s_addc_u32 s67, s73, 0
    v_readlane_b32 s41, v0, 48
    s_nop 0
    s_cmp_eq_u32 s41, 0x01010101
    s_cbranch_scc0 L_flag_slows0
L_flag_oks0:
    v_mov_b32 v14, 0
    s_nop 2
    v_mov_b32 v14, 0
    s_nop 2
    v_mov_b32 v14, 0
    s_nop 2
    v_mov_b32 v14, 0
    s_nop 2
    v_mov_b32 v14, 0
    s_nop 2
    v_mov_b32 v14, 0
    s_nop 2
    v_mov_b32 v14, 0
    s_nop 2
    global_load_dwordx4 v[16:19], v7, s[74:75] sc1
    global_load_dwordx4 v[20:23], v7, s[74:75] offset:1024 sc1
    v_mov_b32 v14, 0
    s_nop 2
    v_mov_b32 v14, 0
    s_nop 2
    v_mov_b32 v14, 0
    s_nop 2
    v_mov_b32 v14, 0
    s_nop 2
    v_mov_b32 v14, 0
    s_nop 2
    v_mov_b32 v14, 0
    s_nop 2
    v_mov_b32 v14, 0
    s_nop 2
    v_mov_b32 v14, 0
    s_nop 2
    v_mov_b32 v14, 0
    s_nop 2
    global_load_dwordx4 v[16:19], v7, s[74:75] sc1
    global_load_dwordx4 v[20:23], v7, s[74:75] offset:1024 sc1
    v_mov_b32 v14, 0
    s_nop 2
    v_mov_b32 v14, 0
    s_nop 2
    v_mov_b32 v14, 0
    s_nop 2
    s_waitcnt lgkmcnt(0)
    s_waitcnt vmcnt(2)
    v_max3_u32 v14, v16, v17, v18
    v_max3_u32 v15, v19, v20, v21
    v_max3_u32 v14, v14, v22, v23
    v_max_u32 v14, v14, v15
    v_cmp_eq_u32 vcc, -1, v14
    s_cbranch_vccz L_steps0
L_hop2_s0:
    s_mov_b64 exec, vcc
    global_load_dwordx4 v[16:19], v7, s[74:75] sc1
    global_load_dwordx4 v[20:23], v7, s[74:75] offset:1024 sc1
    s_mov_b64 exec, -1
    v_max3_u32 v14, v16, v17, v18
    v_max3_u32 v15, v19, v20, v21
    v_max3_u32 v14, v14, v22, v23
    v_max_u32 v14, v14, v15
    v_cmp_eq_u32 vcc, -1, v14
    s_cbranch_vccz L_steps0
    v_max3_u32 v14, v16, v17, v18
    v_max3_u32 v15, v19, v20, v21
    v_max3_u32 v14, v14, v22, v23
    v_max_u32 v14, v14, v15
    v_cmp_eq_u32 vcc, -1, v14
    s_cbranch_vccz L_steps0
    s_mov_b64 exec, vcc
    global_load_dwordx4 v[16:19], v7, s[74:75] sc1
    global_load_dwordx4 v[20:23], v7, s[74:75] offset:1024 sc1
    s_mov_b64 exec, -1
    v_max3_u32 v14, v16, v17, v18
    v_max3_u32 v15, v19, v20, v21
    v_max3_u32 v14, v14, v22, v23
    v_max_u32 v14, v14, v15
    v_cmp_eq_u32 vcc, -1, v14
    s_cbranch_vccz L_steps0
    v_max3_u32 v14, v16, v17, v18
    v_max3_u32 v15, v19, v20, v21
    v_max3_u32 v14, v14, v22, v23
    v_max_u32 v14, v14, v15
    v_cmp_eq_u32 vcc, -1, v14
    s_cbranch_vccz L_steps0
    s_waitcnt vmcnt(32)
    s_add_u32 s39, s39, 1
    s_cmp_gt_u32 s39, 0x400000
    s_cbranch_scc1 L_fail
    s_branch L_hop2_s0
L_hop1_s0:
    s_mov_b64 exec, vcc
    global_load_dwordx4 v[112:115], v12, s[68:69] sc1
    global_load_dwordx4 v[116:119], v12, s[68:69] offset:1024 sc1
    s_mov_b64 exec, -1
    v_max3_u32 v14, v112, v113, v114
    v_max3_u32 v15, v115, v116, v117
    v_max3_u32 v14, v14, v118, v119
    v_max_u32 v14, v14, v15
    v_cmp_eq_u32 vcc, -1, v14
    s_cbranch_vccz L_hop1_oks0
    v_max3_u32 v14, v112, v113, v114
    v_max3_u32 v15, v115, v116, v117
    v_max3_u32 v14, v14, v118, v119
    v_max_u32 v14, v14, v15
    v_cmp_eq_u32 vcc, -1, v14
    s_cbranch_vccz L_hop1_oks0
    s_mov_b64 exec, vcc
    global_load_dwordx4 v[112:115], v12, s[68:69] sc1
    global_load_dwordx4 v[116:119], v12, s[68:69] offset:1024 sc1
    s_mov_b64 exec, -1
    v_max3_u32 v14, v112, v113, v114
    v_max3_u32 v15, v115, v116, v117
    v_max3_u32 v14, v14, v118, v119
    v_max_u32 v14, v14, v15
    v_cmp_eq_u32 vcc, -1, v14
    s_cbranch_vccz L_hop1_oks0
    v_max3_u32 v14, v112, v113, v114
    v_max3_u32 v15, v115, v116, v117
    v_max3_u32 v14, v14, v118, v119
    v_max_u32 v14, v14, v15
    v_cmp_eq_u32 vcc, -1, v14
    s_cbranch_vccz L_hop1_oks0
    s_waitcnt vmcnt(32)
    s_add_u32 s39, s39, 1
    s_cmp_gt_u32 s39, 0x400000
    s_cbranch_scc1 L_fail
    s_branch L_hop1_s0
L_flag_slows0:
    s_cmp_ge_u32 s64, 63
    s_cbranch_scc1 L_flag_oks0
    s_lshl_b32 s40, s29, 6
    s_add_u32 s40, s40, s64
    s_lshl_b32 s40, s40, 2
    s_add_u32 s40, s40, 0x400004
    v_mov_b32 v14, s40
    v_mov_b32 v15, 0x01010101
L_wf_12:
    global_load_dword v0, v14, s[26:27] sc1
    s_add_u32 s39, s39, 1
    s_cmp_gt_u32 s39, 0x400000
    s_cbranch_scc1 L_fail
    s_sleep 1
    s_waitcnt vmcnt(0)
    v_cmp_ne_u32 vcc, v15, v0
    s_cbranch_vccnz L_wf_12
    s_branch L_flag_oks0
L_entrys1:
    ds_read_b128 v[72:75], v4 offset:0
    ds_read_b128 v[76:79], v4 offset:1024
    ds_read_b128 v[80:83], v4 offset:2048
    ds_read_b128 v[84:87], v4 offset:3072
    ds_read_b128 v[88:91], v4 offset:4096
    ds_read_b128 v[92:95], v4 offset:5120
    ds_read_b128 v[96:99], v4 offset:6144
    ds_read_b128 v[100:103], v4 offset:7168
    v_mov_b64 v[48:49], 0
    v_mov_b64 v[50:51], 0
    v_mov_b64 v[52:53], 0
    v_mov_b64 v[54:55], 0
    v_mov_b64 v[56:57], 0
    v_mov_b64 v[58:59], 0
    v_mov_b64 v[60:61], 0
    v_mov_b64 v[62:63], 0
    v_mov_b64 v[64:65], 0
    v_mov_b64 v[66:67], 0
    v_mov_b64 v[68:69], 0
    v_mov_b64 v[70:71], 0
    s_mov_b64 s[70:71], s[68:69]
    s_add_u32 s100, s100, 0x40000
    s_and_b32 s100, s100, 0xc0000
    s_add_u32 s42, s100, s101
    s_add_u32 s68, s72, s42
    s_addc_u32 s69, s73, 0
    s_add_u32 s42, s100, 0x23000
    s_add_u32 s66, s72, s42
    s_addc_u32 s67, s73, 0
    s_add_u32 s36, s46, 0x4000
    s_addc_u32 s37, s47, 0
    s_lshl_b32 s40, s29, 8
    s_add_u32 s40, s40, 0x400004
    v_mov_b32 v14, s40
    v_mov_b32 v15, 0x01010101
    v_readlane_b32 s41, v0, 48
    s_nop 0
    s_cmp_eq_u32 s41, 0x01010101
    s_cbranch_scc1 L_e1s1
L_wf_13:
    global_load_dword v0, v14, s[26:27] sc1
    s_add_u32 s39, s39, 1
    s_cmp_gt_u32 s39, 0x400000
    s_cbranch_scc1 L_fail
    s_sleep 1
    s_waitcnt vmcnt(0)
    v_cmp_ne_u32 vcc, v15, v0
    s_cbranch_vccnz L_wf_13
L_e1s1:
    s_waitcnt lgkmcnt(0)
.p2align 6
L_steps1:
    v_smfmac_f32_16x16x64_bf16 v[48:51], v[16:19], v[72:79], v1
    ds_write_b128 v7, v[16:19]
    v_smfmac_f32_16x16x64_bf16 v[52:55], v[16:19], v[80:87], v1
    ds_write_b128 v7, v[20:23] offset:1024
    v_smfmac_f32_16x16x64_bf16 v[48:51], v[20:23], v[88:95], v1
    ds_read_b128 v[72:75], v4 offset:8192
    v_smfmac_f32_16x16x64_bf16 v[52:55], v[20:23], v[96:103], v1
    ds_read_b128 v[76:79], v4 offset:9216
    v_mov_b64 v[112:113], -1
    v_smfmac_f32_16x16x64_bf16 v[56:59], v[16:19], a[96:103], v1
    ds_read_b128 v[80:83], v4 offset:10240
    v_mov_b64 v[114:115], -1
    v_smfmac_f32_16x16x64_bf16 v[60:63], v[16:19], a[104:111], v1
    ds_read_b128 v[84:87], v4 offset:11264
    v_smfmac_f32_16x16x64_bf16 v[56:59], v[20:23], a[112:119], v1
    v_smfmac_f32_16x16x64_bf16 v[60:63], v[20:23], a[120:127], v1
    s_waitcnt lgkmcnt(4)
    s_barrier
    ds_read_b128 v[24:27], v8 offset:0
    ds_read_b128 v[28:31], v8 offset:1024
    v_smfmac_f32_16x16x64_bf16 v[64:67], v[16:19], a[192:199], v1
    ds_read_b128 v[32:35], v8 offset:6144
    v_smfmac_f32_16x16x64_bf16 v[68:71], v[16:19], a[200:207], v1
    ds_read_b128 v[36:39], v8 offset:7168
    v_smfmac_f32_16x16x64_bf16 v[64:67], v[20:23], a[208:215], v1
    ds_read_b128 v[40:43], v8 offset:4096
    v_smfmac_f32_16x16x64_bf16 v[68:71], v[20:23], a[216:223], v1
    s_waitcnt vmcnt(0)
    ds_read_b128 v[44:47], v8 offset:5120
    global_load_dwordx4 v[104:107], v7, s[80:81] offset:0 sc1
    s_waitcnt lgkmcnt(5)
    v_smfmac_f32_16x16x64_bf16 v[48:51], v[24:27], a[0:7], v1
    global_load_dwordx4 v[108:111], v7, s[80:81] offset:1024 sc1
    v_smfmac_f32_16x16x64_bf16 v[52:55], v[24:27], a[8:15], v1
    ds_read_b128 v[88:91], v4 offset:12288
    s_waitcnt lgkmcnt(5)
    v_smfmac_f32_16x16x64_bf16 v[48:51], v[28:31], a[16:23], v1
    ds_read_b128 v[92:95], v4 offset:13312
    v_smfmac_f32_16x16x64_bf16 v[52:55], v[28:31], a[24:31], v1
    ds_read_b128 v[96:99], v4 offset:14336
    s_waitcnt lgkmcnt(6)
    v_smfmac_f32_16x16x64_bf16 v[48:51], v[32:35], a[32:39], v1
    ds_read_b128 v[100:103], v4 offset:15360
    v_smfmac_f32_16x16x64_bf16 v[52:55], v[32:35], a[40:47], v1
    s_waitcnt lgkmcnt(6)
    v_smfmac_f32_16x16x64_bf16 v[48:51], v[36:39], a[48:55], v1
    global_load_dwordx4 v[128:131], v7, s[78:79] offset:0 sc1
    v_smfmac_f32_16x16x64_bf16 v[52:55], v[36:39], a[56:63], v1
    s_waitcnt lgkmcnt(5)
    v_smfmac_f32_16x16x64_bf16 v[48:51], v[40:43], a[64:71], v1
    global_load_dwordx4 v[132:135], v7, s[78:79] offset:1024 sc1
    v_smfmac_f32_16x16x64_bf16 v[52:55], v[40:43], a[72:79], v1
    s_waitcnt lgkmcnt(4)
    v_smfmac_f32_16x16x64_bf16 v[48:51], v[44:47], a[80:87], v1
    s_mov_b64 exec, s[44:45]
    global_store_dword v3, v112, s[36:37] sc1
    s_mov_b64 exec, -1
    v_smfmac_f32_16x16x64_bf16 v[52:55], v[44:47], a[88:95], v1
    v_smfmac_f32_16x16x64_bf16 v[56:59], v[24:27], v[72:79], v1
    v_smfmac_f32_16x16x64_bf16 v[60:63], v[24:27], v[80:87], v1
    ds_read_b128 v[72:75], v8 offset:12288
    s_waitcnt lgkmcnt(3)
    v_permlane32_swap_b32 v48, v52
    v_smfmac_f32_16x16x64_bf16 v[56:59], v[28:31], v[88:95], v1
    global_store_dwordx4 v7, v[112:115], s[70:71] offset:0 sc1
    s_waitcnt lgkmcnt(1)
    v_permlane32_swap_b32 v49, v53
    v_smfmac_f32_16x16x64_bf16 v[60:63], v[28:31], v[96:103], v1
    ds_read_b128 v[76:79], v8 offset:16384
    v_permlane32_swap_b32 v50, v54
    v_smfmac_f32_16x16x64_bf16 v[56:59], v[32:35], a[128:135], v1
    ds_read_b128 v[80:83], v8 offset:13312
    v_permlane32_swap_b32 v51, v55
    v_smfmac_f32_16x16x64_bf16 v[60:63], v[32:35], a[136:143], v1
    ds_read_b128 v[84:87], v8 offset:17408
    v_add_f32 v48, v48, v52
    v_smfmac_f32_16x16x64_bf16 v[56:59], v[36:39], a[144:151], v1
    ds_read_b128 v[88:91], v8 offset:14336
    v_add_f32 v49, v49, v53
    v_smfmac_f32_16x16x64_bf16 v[60:63], v[36:39], a[152:159], v1
    ds_read_b128 v[92:95], v8 offset:18432
    v_add_f32 v50, v50, v54
    v_smfmac_f32_16x16x64_bf16 v[56:59], v[40:43], a[160:167], v1
    global_store_dwordx4 v7, v[112:115], s[70:71] offset:1024 sc1
    v_add_f32 v51, v51, v55
    v_smfmac_f32_16x16x64_bf16 v[60:63], v[40:43], a[168:175], v1
    ds_read_b128 v[96:99], v8 offset:15360
    v_cvt_pk_bf16_f32 v52, v48, v49
    v_smfmac_f32_16x16x64_bf16 v[56:59], v[44:47], a[176:183], v1
    ds_read_b128 v[100:103], v8 offset:19456
    v_cvt_pk_bf16_f32 v53, v50, v51
    v_smfmac_f32_16x16x64_bf16 v[60:63], v[44:47], a[184:191], v1
    ds_write_b64 v5, v[52:53]
    v_smfmac_f32_16x16x64_bf16 v[64:67], v[24:27], a[224:231], v1
    v_smfmac_f32_16x16x64_bf16 v[68:71], v[24:27], a[232:239], v1
    global_load_dword v0, v9, s[26:27] sc1
    v_permlane32_swap_b32 v56, v60
    v_smfmac_f32_16x16x64_bf16 v[64:67], v[28:31], a[240:247], v1
    v_permlane32_swap_b32 v57, v61
    v_smfmac_f32_16x16x64_bf16 v[68:71], v[28:31], a[248:255], v1
    v_permlane32_swap_b32 v58, v62
    v_smfmac_f32_16x16x64_bf16 v[64:67], v[32:35], v[136:143], v1
    v_permlane32_swap_b32 v59, v63
    v_smfmac_f32_16x16x64_bf16 v[68:71], v[32:35], v[144:151], v1
    s_waitcnt lgkmcnt(0)
    s_barrier
    ds_read_b64_tr_b16 v[112:113], v6 offset:0
    ds_read_b64_tr_b16 v[114:115], v6 offset:64
    v_add_f32 v56, v56, v60
    v_smfmac_f32_16x16x64_bf16 v[64:67], v[36:39], v[152:159], v1
    ds_read_b64_tr_b16 v[116:117], v6 offset:512
    ds_read_b64_tr_b16 v[118:119], v6 offset:576
    v_add_f32 v57, v57, v61
    v_smfmac_f32_16x16x64_bf16 v[68:71], v[36:39], v[160:167], v1
    ds_read_b64_tr_b16 v[120:121], v6 offset:1024
    ds_read_b64_tr_b16 v[122:123], v6 offset:1088
    v_add_f32 v58, v58, v62
    v_smfmac_f32_16x16x64_bf16 v[64:67], v[40:43], v[168:175], v1
    ds_read_b64_tr_b16 v[124:125], v6 offset:1536
    ds_read_b64_tr_b16 v[126:127], v6 offset:1600
    v_add_f32 v59, v59, v63
    v_smfmac_f32_16x16x64_bf16 v[68:71], v[40:43], v[176:183], v1
    v_cvt_pk_bf16_f32 v60, v56, v57
    v_cvt_pk_bf16_f32 v61, v58, v59
    v_smfmac_f32_16x16x64_bf16 v[64:67], v[44:47], v[184:191], v1
    ds_write_b64 v5, v[60:61] offset:2048
    v_smfmac_f32_16x16x64_bf16 v[68:71], v[44:47], v[192:199], v1
    s_waitcnt lgkmcnt(7)
    v_mfma_f32_16x16x32_bf16 v[48:51], v[72:75], v[112:115], 0
    v_mfma_f32_16x16x32_bf16 v[52:55], v[76:79], v[112:115], 0
    s_waitcnt lgkmcnt(5)
    v_cvt_pk_bf16_f32 v64, v64, v65
    v_cvt_pk_bf16_f32 v65, v66, v67
    v_mfma_f32_16x16x32_bf16 v[48:51], v[80:83], v[116:119], v[48:51]
    v_cvt_pk_bf16_f32 v66, v68, v69
    v_cvt_pk_bf16_f32 v67, v70, v71
    v_mfma_f32_16x16x32_bf16 v[52:55], v[84:87], v[116:119], v[52:55]
    global_store_dwordx4 v7, v[64:67], s[82:83] offset:1024 sc1
    s_waitcnt lgkmcnt(3)
    v_mfma_f32_16x16x32_bf16 v[48:51], v[88:91], v[120:123], v[48:51]
    s_waitcnt lgkmcnt(0)
    s_barrier
    ds_read_b64_tr_b16 v[16:17], v6 offset:2048
    ds_read_b64_tr_b16 v[18:19], v6 offset:2112
    v_mfma_f32_16x16x32_bf16 v[52:55], v[92:95], v[120:123], v[52:55]
    ds_read_b64_tr_b16 v[20:21], v6 offset:2560
    ds_read_b64_tr_b16 v[22:23], v6 offset:2624
    ds_read_b64_tr_b16 v[24:25], v6 offset:3072
    ds_read_b64_tr_b16 v[26:27], v6 offset:3136
    v_mov_b64 v[68:69], s[86:87]
    v_mfma_f32_16x16x32_bf16 v[48:51], v[96:99], v[124:127], v[48:51]
    ds_read_b64_tr_b16 v[28:29], v6 offset:3584
    ds_read_b64_tr_b16 v[30:31], v6 offset:3648
    v_mov_b64 v[70:71], s[86:87]
    v_mfma_f32_16x16x32_bf16 v[52:55], v[100:103], v[124:127], v[52:55]
    ds_read_b128 v[32:35], v4 offset:26624
    s_waitcnt lgkmcnt(7)
    v_mov_b64 v[62:63], s[98:99]
    v_mfma_f32_16x16x32_bf16 v[56:59], v[16:19], v[112:115], 0
    ds_read_b128 v[36:39], v4 offset:27648
    s_waitcnt lgkmcnt(6)
    v_max3_f32 v13, v48, v49, v50
    v_mfma_f32_16x16x32_bf16 v[56:59], v[20:23], v[116:119], v[56:59]
    global_store_dwordx4 v7, v[20:23], s[82:83] sc1
    s_waitcnt lgkmcnt(4)
    v_max3_f32 v13, v13, v51, v52
    v_max3_f32 v15, v53, v54, v55
    v_mfma_f32_16x16x32_bf16 v[56:59], v[24:27], v[120:123], v[56:59]
    ds_read_b128 v[40:43], v4 offset:24576
    s_waitcnt lgkmcnt(3)
    v_max_f32 v14, v13, v15
    v_max_f32 v13, v13, v15
    v_mfma_f32_16x16x32_bf16 v[56:59], v[28:31], v[124:127], v[56:59]
    ds_read_b128 v[44:47], v4 offset:25600
    s_cmp_eq_u32 s64, 63
    s_cbranch_scc1 L_chain_fin
    v_permlane32_swap_b32 v13, v14
    v_max_f32 v13, v13, v14
    s_nop 2
    v_max3_f32 v13, v13, v56, v57
    v_max3_f32 v13, v13, v58, v59
    v_mov_b32 v14, v13
    s_nop 1
    v_permlane16_swap_b32 v13, v14
    v_max_f32 v13, v13, v14
    v_mul_f32 v14, s84, v13
    v_pk_fma_f32 v[48:49], v[48:49], s[84:85], v[14:15] op_sel_hi:[1,1,0] neg_lo:[0,0,1] neg_hi:[0,0,1]
    v_pk_fma_f32 v[50:51], v[50:51], s[84:85], v[14:15] op_sel_hi:[1,1,0] neg_lo:[0,0,1] neg_hi:[0,0,1]
    v_pk_fma_f32 v[52:53], v[52:53], s[84:85], v[14:15] op_sel_hi:[1,1,0] neg_lo:[0,0,1] neg_hi:[0,0,1]
    v_pk_fma_f32 v[54:55], v[54:55], s[84:85], v[14:15] op_sel_hi:[1,1,0] neg_lo:[0,0,1] neg_hi:[0,0,1]
    v_pk_fma_f32 v[56:57], v[56:57], s[84:85], v[14:15] op_sel_hi:[1,1,0] neg_lo:[0,0,1] neg_hi:[0,0,1]
    v_pk_fma_f32 v[58:59], v[58:59], s[84:85], v[14:15] op_sel_hi:[1,1,0] neg_lo:[0,0,1] neg_hi:[0,0,1]
    v_exp_f32 v48, v48
    v_exp_f32 v49, v49
    v_exp_f32 v50, v50
    v_exp_f32 v51, v51
    v_exp_f32 v52, v52
    v_exp_f32 v53, v53
    v_exp_f32 v54, v54
    v_exp_f32 v55, v55
    v_cvt_pk_bf16_f32 v48, v48, v49
    v_cvt_pk_bf16_f32 v49, v50, v51
    v_cvt_pk_bf16_f32 v50, v52, v53
    v_cvt_pk_bf16_f32 v51, v54, v55
    v_exp_f32 v56, v56
    v_exp_f32 v57, v57
    v_mfma_f32_16x16x32_bf16 v[120:123], v[68:71], v[48:51], 0
    s_waitcnt vmcnt(8)
    v_exp_f32 v58, v58
    v_mfma_f32_16x16x32_bf16 v[112:115], v[104:107], v[48:51], 0
    v_exp_f32 v59, v59
    v_mfma_f32_16x16x32_bf16 v[116:119], v[108:111], v[48:51], 0
    v_cvt_pk_bf16_f32 v56, v56, v57
    v_cvt_pk_bf16_f32 v57, v58, v59
    v_mov_b64 v[68:69], 0
    v_mov_b64 v[70:71], 0
    v_mfma_f32_16x16x16_bf16 v[120:123], v[62:63], v[56:57], v[120:123]
    ds_read_b128 v[80:83], v4 offset:18432
    v_mov_b64 v[58:59], 0
    v_mfma_f32_16x16x16_bf16 v[112:115], v[64:65], v[56:57], v[112:115]
    ds_read_b128 v[84:87], v4 offset:19456
    v_mov_b64 v[60:61], 0
    v_mfma_f32_16x16x16_bf16 v[116:119], v[66:67], v[56:57], v[116:119]
    ds_read_b128 v[72:75], v4 offset:16384
    v_rcp_f32 v14, v120
    v_mov_b64 v[62:63], 0
    v_mov_b64 v[56:57], 0
    v_mov_b64 v[64:65], 0
    v_mov_b64 v[66:67], 0
    v_pk_mul_f32 v[112:113], v[112:113], v[14:15] op_sel_hi:[1,0]
    v_pk_mul_f32 v[114:115], v[114:115], v[14:15] op_sel_hi:[1,0]
    v_pk_mul_f32 v[116:117], v[116:117], v[14:15] op_sel_hi:[1,0]
    v_pk_mul_f32 v[118:119], v[118:119], v[14:15] op_sel_hi:[1,0]
    v_cvt_pk_bf16_f32 v48, v112, v116
    v_cvt_pk_bf16_f32 v49, v113, v117
    v_cvt_pk_bf16_f32 v50, v114, v118
    v_cvt_pk_bf16_f32 v51, v115, v119
    ds_write_b128 v7, v[48:51]
    s_nop 0
    v_smfmac_f32_16x16x64_bf16 v[56:59], v[48:51], v[208:215], v1
    ds_read_b128 v[104:107], v4 offset:32768
    v_smfmac_f32_16x16x64_bf16 v[60:63], v[48:51], v[240:247], v1
    ds_read_b128 v[108:111], v4 offset:33792
    s_waitcnt lgkmcnt(4)
    v_smfmac_f32_16x16x64_bf16 v[64:67], v[48:51], v[80:87], v1
    s_waitcnt lgkmcnt(2)
    s_barrier
    ds_read_b128 v[112:115], v8 offset:0
    ds_read_b128 v[120:123], v8 offset:4096
    ds_read_b128 v[124:127], v8 offset:6144
    ds_read_b128 v[76:79], v4 offset:17408
    ds_read_b128 v[88:91], v4 offset:20480
    v_smfmac_f32_16x16x64_bf16 v[68:71], v[48:51], v[32:39], v1
    s_waitcnt lgkmcnt(4)
    v_smfmac_f32_16x16x64_bf16 v[56:59], v[112:115], v[200:207], v1
    ds_read_b128 v[92:95], v4 offset:21504
    s_waitcnt lgkmcnt(4)
    v_smfmac_f32_16x16x64_bf16 v[56:59], v[120:123], v[216:223], v1
    ds_read_b128 v[96:99], v4 offset:22528
    s_waitcnt lgkmcnt(4)
    v_smfmac_f32_16x16x64_bf16 v[56:59], v[124:127], v[224:231], v1
    ds_read_b128 v[100:103], v4 offset:23552
    v_smfmac_f32_16x16x64_bf16 v[60:63], v[112:115], v[232:239], v1
    ds_read_b128 v[16:19], v4 offset:28672
    v_smfmac_f32_16x16x64_bf16 v[60:63], v[120:123], v[248:255], v1
    ds_read_b128 v[20:23], v4 offset:29696
    v_cvt_pk_bf16_f32 v56, v56, v57
    v_cvt_pk_bf16_f32 v57, v58, v59
    v_smfmac_f32_16x16x64_bf16 v[60:63], v[124:127], v[104:111], v1
    global_store_dwordx2 v2, v[56:57], s[66:67] offset:-4096 sc1
    s_waitcnt lgkmcnt(6)
    v_smfmac_f32_16x16x64_bf16 v[64:67], v[112:115], v[72:79], v1
    ds_read_b128 v[24:27], v4 offset:30720
    s_waitcnt lgkmcnt(5)
    v_smfmac_f32_16x16x64_bf16 v[64:67], v[120:123], v[88:95], v1
    ds_read_b128 v[28:31], v4 offset:31744
    s_waitcnt lgkmcnt(4)
    v_cvt_pk_bf16_f32 v60, v60, v61
    v_cvt_pk_bf16_f32 v61, v62, v63
    v_smfmac_f32_16x16x64_bf16 v[64:67], v[124:127], v[96:103], v1
    global_store_dwordx2 v2, v[60:61], s[66:67] offset:-2048 sc1
    v_smfmac_f32_16x16x64_bf16 v[68:71], v[112:115], v[40:47], v1
    ds_read_b128 v[72:75], v4 offset:0
    s_waitcnt lgkmcnt(3)
    v_smfmac_f32_16x16x64_bf16 v[68:71], v[120:123], v[16:23], v1
    ds_read_b128 v[76:79], v4 offset:1024
    s_waitcnt lgkmcnt(2)
    v_cvt_pk_bf16_f32 v64, v64, v65
    v_cvt_pk_bf16_f32 v65, v66, v67
    v_smfmac_f32_16x16x64_bf16 v[68:71], v[124:127], v[24:31], v1
    global_store_dwordx2 v2, v[64:65], s[66:67] offset:0 sc1
    s_nop 6
    v_cvt_pk_bf16_f32 v68, v68, v69
    v_cvt_pk_bf16_f32 v69, v70, v71
    global_store_dwordx2 v2, v[68:69], s[66:67] offset:2048 sc1
    ds_read_b128 v[80:83], v4 offset:2048
    ds_read_b128 v[84:87], v4 offset:3072
    ds_read_b128 v[88:91], v4 offset:4096
    ds_read_b128 v[92:95], v4 offset:5120
    ds_read_b128 v[96:99], v4 offset:6144
    ds_read_b128 v[100:103], v4 offset:7168
    ds_read_b128 v[104:107], v8 offset:20480
    v_mov_b64 v[48:49], 0
    v_mov_b64 v[50:51], 0
    v_mov_b64 v[52:53], 0
    v_mov_b64 v[54:55], 0
    v_mov_b64 v[56:57], 0
    v_mov_b64 v[58:59], 0
    v_mov_b64 v[60:61], 0
    v_mov_b64 v[62:63], 0
    v_mov_b64 v[64:65], 0
    v_mov_b64 v[66:67], 0
    v_mov_b64 v[68:69], 0
    v_mov_b64 v[70:71], 0
    s_lshr_b32 s42, s100, 5
    s_add_u32 s76, s46, s42
    s_addc_u32 s77, s47, 0
    s_sub_u32 s74, s76, 0x22000
    s_subb_u32 s75, s77, 0
    s_add_u32 s42, s42, 0x6000
    s_and_b32 s42, s42, 0x6000
    s_add_u32 s36, s46, s42
    s_addc_u32 s37, s47, 0
    s_add_u32 s64, s64, 1
    v_add_u32 v9, v9, v10
    v_add_u32 v11, 4, v11
    s_add_u32 s80, s80, 0x40000
    s_addc_u32 s81, s81, 0
    s_add_u32 s78, s78, 0x40000
    s_addc_u32 s79, s79, 0
    s_add_u32 s82, s82, 0x40000
    s_addc_u32 s83, s83, 0
    s_nop 0
    s_nop 0
    global_load_dwordx4 v[112:115], v12, s[68:69] sc1
    global_load_dwordx4 v[116:119], v12, s[68:69] offset:1024 sc1
    v_mov_b32 v14, 0
    s_nop 2
    v_mov_b32 v14, 0
    s_nop 2
    v_mov_b32 v14, 0
    s_nop 2
    v_mov_b32 v14, 0
    s_nop 2
    v_mov_b32 v14, 0
    s_nop 2
    v_mov_b32 v14, 0
    s_nop 2
    v_mov_b32 v14, 0
    s_nop 2
    v_mov_b32 v14, 0
    s_nop 2
    v_mov_b32 v14, 0
    s_nop 2
    global_load_dwordx4 v[112:115], v12, s[68:69] sc1
    global_load_dwordx4 v[116:119], v12, s[68:69] offset:1024 sc1
    s_waitcnt lgkmcnt(0)
    s_waitcnt vmcnt(10)
    ds_write_b128 v7, v[128:131] offset:12288
    ds_write_b128 v7, v[132:135] offset:13312
    v_mov_b32 v14, 0
    s_nop 2
    s_waitcnt vmcnt(2)
    v_max3_u32 v14, v112, v113, v114
    v_max3_u32 v15, v115, v116, v117
    v_max3_u32 v14, v14, v118, v119
    v_max_u32 v14, v14, v15
    v_cmp_eq_u32 vcc, -1, v14
    s_cbranch_vccnz L_hop1_s1
L_hop1_oks1:
    v_mfma_f32_16x16x32_bf16 v[108:111], v[112:115], v[104:107], 0
    v_mfma_f32_16x16x32_bf16 v[108:111], v[116:119], v[104:107], v[108:111]
    s_nop 7
    v_add_f32 v108, v108, v109
    v_add_f32 v110, v110, v111
    s_nop 1
    v_permlane32_swap_b32 v108, v110
    v_add_f32 v108, v108, v110
    s_nop 1
    v_mov_b32_dpp v109, v108 row_shl:4 row_mask:0xf bank_mask:0xf
    v_cvt_pk_bf16_f32 v108, v108, v109
    s_mov_b64 exec, s[44:45]
    global_store_dword v3, v108, s[76:77] sc1
    s_mov_b64 exec, -1
    s_mov_b64 s[70:71], s[68:69]
    s_add_u32 s100, s100, 0x40000
    s_and_b32 s100, s100, 0xc0000
    s_add_u32 s42, s100, s101
    s_add_u32 s68, s72, s42
    s_addc_u32 s69, s73, 0
    s_add_u32 s42, s100, 0x23000
    s_add_u32 s66, s72, s42
    s_addc_u32 s67, s73, 0
    v_readlane_b32 s41, v0, 48
    s_nop 0
    s_cmp_eq_u32 s41, 0x01010101
    s_cbranch_scc0 L_flag_slows1
L_flag_oks1:
    v_mov_b32 v14, 0
    s_nop 2
    v_mov_b32 v14, 0
    s_nop 2
    v_mov_b32 v14, 0
    s_nop 2
    v_mov_b32 v14, 0
    s_nop 2
    v_mov_b32 v14, 0
    s_nop 2
    v_mov_b32 v14, 0
    s_nop 2
    v_mov_b32 v14, 0
    s_nop 2
    global_load_dwordx4 v[16:19], v7, s[74:75] sc1
    global_load_dwordx4 v[20:23], v7, s[74:75] offset:1024 sc1
    v_mov_b32 v14, 0
    s_nop 2
    v_mov_b32 v14, 0
    s_nop 2
    v_mov_b32 v14, 0
    s_nop 2
    v_mov_b32 v14, 0
    s_nop 2
    v_mov_b32 v14, 0
    s_nop 2
    v_mov_b32 v14, 0
    s_nop 2
    v_mov_b32 v14, 0
    s_nop 2
    v_mov_b32 v14, 0
    s_nop 2
    v_mov_b32 v14, 0
    s_nop 2
    global_load_dwordx4 v[16:19], v7, s[74:75] sc1
    global_load_dwordx4 v[20:23], v7, s[74:75] offset:1024 sc1
    v_mov_b32 v14, 0
    s_nop 2
    v_mov_b32 v14, 0
    s_nop 2
    v_mov_b32 v14, 0
    s_nop 2
    s_waitcnt lgkmcnt(0)
    s_waitcnt vmcnt(2)
    v_max3_u32 v14, v16, v17, v18
    v_max3_u32 v15, v19, v20, v21
    v_max3_u32 v14, v14, v22, v23
    v_max_u32 v14, v14, v15
    v_cmp_eq_u32 vcc, -1, v14
    s_cbranch_vccz L_steps1
L_hop2_s1:
    s_mov_b64 exec, vcc
    global_load_dwordx4 v[16:19], v7, s[74:75] sc1
    global_load_dwordx4 v[20:23], v7, s[74:75] offset:1024 sc1
    s_mov_b64 exec, -1
    v_max3_u32 v14, v16, v17, v18
    v_max3_u32 v15, v19, v20, v21
    v_max3_u32 v14, v14, v22, v23
    v_max_u32 v14, v14, v15
    v_cmp_eq_u32 vcc, -1, v14
    s_cbranch_vccz L_steps1
    v_max3_u32 v14, v16, v17, v18
    v_max3_u32 v15, v19, v20, v21
    v_max3_u32 v14, v14, v22, v23
    v_max_u32 v14, v14, v15
    v_cmp_eq_u32 vcc, -1, v14
    s_cbranch_vccz L_steps1
    s_mov_b64 exec, vcc
    global_load_dwordx4 v[16:19], v7, s[74:75] sc1
    global_load_dwordx4 v[20:23], v7, s[74:75] offset:1024 sc1
    s_mov_b64 exec, -1
    v_max3_u32 v14, v16, v17, v18
    v_max3_u32 v15, v19, v20, v21
    v_max3_u32 v14, v14, v22, v23
    v_max_u32 v14, v14, v15
    v_cmp_eq_u32 vcc, -1, v14
    s_cbranch_vccz L_steps1
    v_max3_u32 v14, v16, v17, v18
    v_max3_u32 v15, v19, v20, v21
    v_max3_u32 v14, v14, v22, v23
    v_max_u32 v14, v14, v15
    v_cmp_eq_u32 vcc, -1, v14
    s_cbranch_vccz L_steps1
    s_waitcnt vmcnt(32)
    s_add_u32 s39, s39, 1
    s_cmp_gt_u32 s39, 0x400000
    s_cbranch_scc1 L_fail
    s_branch L_hop2_s1
L_hop1_s1:
    s_mov_b64 exec, vcc
    global_load_dwordx4 v[112:115], v12, s[68:69] sc1
    global_load_dwordx4 v[116:119], v12, s[68:69] offset:1024 sc1
    s_mov_b64 exec, -1
    v_max3_u32 v14, v112, v113, v114
    v_max3_u32 v15, v115, v116, v117
    v_max3_u32 v14, v14, v118, v119
    v_max_u32 v14, v14, v15
    v_cmp_eq_u32 vcc, -1, v14
    s_cbranch_vccz L_hop1_oks1
    v_max3_u32 v14, v112, v113, v114
    v_max3_u32 v15, v115, v116, v117
    v_max3_u32 v14, v14, v118, v119
    v_max_u32 v14, v14, v15
    v_cmp_eq_u32 vcc, -1, v14
    s_cbranch_vccz L_hop1_oks1
    s_mov_b64 exec, vcc
    global_load_dwordx4 v[112:115], v12, s[68:69] sc1
    global_load_dwordx4 v[116:119], v12, s[68:69] offset:1024 sc1
    s_mov_b64 exec, -1
    v_max3_u32 v14, v112, v113, v114
    v_max3_u32 v15, v115, v116, v117
    v_max3_u32 v14, v14, v118, v119
    v_max_u32 v14, v14, v15
    v_cmp_eq_u32 vcc, -1, v14
    s_cbranch_vccz L_hop1_oks1
    v_max3_u32 v14, v112, v113, v114
    v_max3_u32 v15, v115, v116, v117
    v_max3_u32 v14, v14, v118, v119
    v_max_u32 v14, v14, v15
    v_cmp_eq_u32 vcc, -1, v14
    s_cbranch_vccz L_hop1_oks1
    s_waitcnt vmcnt(32)
    s_add_u32 s39, s39, 1
    s_cmp_gt_u32 s39, 0x400000
    s_cbranch_scc1 L_fail
    s_branch L_hop1_s1
L_flag_slows1:
    s_cmp_ge_u32 s64, 63
    s_cbranch_scc1 L_flag_oks1
    s_lshl_b32 s40, s29, 6
    s_add_u32 s40, s40, s64
    s_lshl_b32 s40, s40, 2
    s_add_u32 s40, s40, 0x400004
    v_mov_b32 v14, s40
    v_mov_b32 v15, 0x01010101
L_wf_14:
    global_load_dword v0, v14, s[26:27] sc1
    s_add_u32 s39, s39, 1
    s_cmp_gt_u32 s39, 0x400000
    s_cbranch_scc1 L_fail
    s_sleep 1
    s_waitcnt vmcnt(0)
    v_cmp_ne_u32 vcc, v15, v0
    s_cbranch_vccnz L_wf_14
    s_branch L_flag_oks1
L_entrys2:
    ds_read_b128 v[72:75], v4 offset:0
    ds_read_b128 v[76:79], v4 offset:1024
    ds_read_b128 v[80:83], v4 offset:2048
    ds_read_b128 v[84:87], v4 offset:3072
    ds_read_b128 v[88:91], v4 offset:4096
    ds_read_b128 v[92:95], v4 offset:5120
    ds_read_b128 v[96:99], v4 offset:6144
    ds_read_b128 v[100:103], v4 offset:7168
    v_mov_b64 v[48:49], 0
    v_mov_b64 v[50:51], 0
    v_mov_b64 v[52:53], 0
    v_mov_b64 v[54:55], 0
    v_mov_b64 v[56:57], 0
    v_mov_b64 v[58:59], 0
    v_mov_b64 v[60:61], 0
    v_mov_b64 v[62:63], 0
    v_mov_b64 v[64:65], 0
    v_mov_b64 v[66:67], 0
    v_mov_b64 v[68:69], 0
    v_mov_b64 v[70:71], 0
    s_mov_b64 s[70:71], s[68:69]
    s_add_u32 s100, s100, 0x40000
    s_and_b32 s100, s100, 0xc0000
    s_add_u32 s42, s100, s101
    s_add_u32 s68, s72, s42
    s_addc_u32 s69, s73, 0
    s_add_u32 s42, s100, 0x23000
    s_add_u32 s66, s72, s42
    s_addc_u32 s67, s73, 0
    s_add_u32 s36, s46, 0x4000
    s_addc_u32 s37, s47, 0
    s_lshl_b32 s40, s29, 8
    s_add_u32 s40, s40, 0x400004
    v_mov_b32 v14, s40
    v_mov_b32 v15, 0x01010101
    v_readlane_b32 s41, v0, 48
    s_nop 0
    s_cmp_eq_u32 s41, 0x01010101
    s_cbranch_scc1 L_e1s2
L_wf_15:
    global_load_dword v0, v14, s[26:27] sc1
    s_add_u32 s39, s39, 1
    s_cmp_gt_u32 s39, 0x400000
    s_cbranch_scc1 L_fail
    s_sleep 1
    s_waitcnt vmcnt(0)
    v_cmp_ne_u32 vcc, v15, v0
    s_cbranch_vccnz L_wf_15
L_e1s2:
    s_waitcnt lgkmcnt(0)
.p2align 6
L_steps2:
    v_smfmac_f32_16x16x64_bf16 v[48:51], v[16:19], v[72:79], v1
    ds_write_b128 v7, v[16:19]
    v_smfmac_f32_16x16x64_bf16 v[52:55], v[16:19], v[80:87], v1
    ds_write_b128 v7, v[20:23] offset:1024
    v_smfmac_f32_16x16x64_bf16 v[48:51], v[20:23], v[88:95], v1
    ds_read_b128 v[72:75], v4 offset:8192
    v_smfmac_f32_16x16x64_bf16 v[52:55], v[20:23], v[96:103], v1
    ds_read_b128 v[76:79], v4 offset:9216
    v_mov_b64 v[112:113], -1
    v_smfmac_f32_16x16x64_bf16 v[56:59], v[16:19], a[96:103], v1
    ds_read_b128 v[80:83], v4 offset:10240
    v_mov_b64 v[114:115], -1
    v_smfmac_f32_16x16x64_bf16 v[60:63], v[16:19], a[104:111], v1
    ds_read_b128 v[84:87], v4 offset:11264
    v_smfmac_f32_16x16x64_bf16 v[56:59], v[20:23], a[112:119], v1
    v_smfmac_f32_16x16x64_bf16 v[60:63], v[20:23], a[120:127], v1
    s_waitcnt lgkmcnt(4)
    s_barrier
    ds_read_b128 v[24:27], v8 offset:6144
    ds_read_b128 v[28:31], v8 offset:7168
    v_smfmac_f32_16x16x64_bf16 v[64:67], v[16:19], a[192:199], v1
    ds_read_b128 v[32:35], v8 offset:0
    v_smfmac_f32_16x16x64_bf16 v[68:71], v[16:19], a[200:207], v1
    ds_read_b128 v[36:39], v8 offset:1024
    v_smfmac_f32_16x16x64_bf16 v[64:67], v[20:23], a[208:215], v1
    ds_read_b128 v[40:43], v8 offset:2048
    v_smfmac_f32_16x16x64_bf16 v[68:71], v[20:23], a[216:223], v1
    s_waitcnt vmcnt(0)
    ds_read_b128 v[44:47], v8 offset:3072
    global_load_dwordx4 v[104:107], v7, s[80:81] offset:0 sc1
    s_waitcnt lgkmcnt(5)
    v_smfmac_f32_16x16x64_bf16 v[48:51], v[24:27], a[0:7], v1
    global_load_dwordx4 v[108:111], v7, s[80:81] offset:1024 sc1
    v_smfmac_f32_16x16x64_bf16 v[52:55], v[24:27], a[8:15], v1
    ds_read_b128 v[88:91], v4 offset:12288
    s_waitcnt lgkmcnt(5)
    v_smfmac_f32_16x16x64_bf16 v[48:51], v[28:31], a[16:23], v1
    ds_read_b128 v[92:95], v4 offset:13312
    v_smfmac_f32_16x16x64_bf16 v[52:55], v[28:31], a[24:31], v1
    ds_read_b128 v[96:99], v4 offset:14336
    s_waitcnt lgkmcnt(6)
    v_smfmac_f32_16x16x64_bf16 v[48:51], v[32:35], a[32:39], v1
    ds_read_b128 v[100:103], v4 offset:15360
    v_smfmac_f32_16x16x64_bf16 v[52:55], v[32:35], a[40:47], v1
    global_load_dwordx4 v[128:131], v7, s[78:79] offset:0 sc1
    s_waitcnt lgkmcnt(6)
    v_smfmac_f32_16x16x64_bf16 v[48:51], v[36:39], a[48:55], v1
    v_smfmac_f32_16x16x64_bf16 v[52:55], v[36:39], a[56:63], v1
    global_load_dwordx4 v[132:135], v7, s[78:79] offset:1024 sc1
    s_waitcnt lgkmcnt(5)
    v_smfmac_f32_16x16x64_bf16 v[48:51], v[40:43], a[64:71], v1
    v_smfmac_f32_16x16x64_bf16 v[52:55], v[40:43], a[72:79], v1
    s_waitcnt lgkmcnt(4)
    v_smfmac_f32_16x16x64_bf16 v[48:51], v[44:47], a[80:87], v1
    s_mov_b64 exec, s[44:45]
    global_store_dword v3, v112, s[36:37] sc1
    s_mov_b64 exec, -1
    v_smfmac_f32_16x16x64_bf16 v[52:55], v[44:47], a[88:95], v1
    v_smfmac_f32_16x16x64_bf16 v[56:59], v[24:27], v[72:79], v1
    v_smfmac_f32_16x16x64_bf16 v[60:63], v[24:27], v[80:87], v1
    ds_read_b128 v[72:75], v8 offset:12288
    s_waitcnt lgkmcnt(3)
    v_permlane32_swap_b32 v48, v52
    v_smfmac_f32_16x16x64_bf16 v[56:59], v[28:31], v[88:95], v1
    ds_read_b128 v[76:79], v8 offset:16384
    s_waitcnt lgkmcnt(2)
    v_permlane32_swap_b32 v49, v53
    v_smfmac_f32_16x16x64_bf16 v[60:63], v[28:31], v[96:103], v1
    global_store_dwordx4 v7, v[112:115], s[70:71] offset:0 sc1
    v_permlane32_swap_b32 v50, v54
    v_smfmac_f32_16x16x64_bf16 v[56:59], v[32:35], a[128:135], v1
    ds_read_b128 v[80:83], v8 offset:13312
    v_permlane32_swap_b32 v51, v55
    v_smfmac_f32_16x16x64_bf16 v[60:63], v[32:35], a[136:143], v1
    ds_read_b128 v[84:87], v8 offset:17408
    v_add_f32 v48, v48, v52
    v_smfmac_f32_16x16x64_bf16 v[56:59], v[36:39], a[144:151], v1
    ds_read_b128 v[88:91], v8 offset:14336
    v_add_f32 v49, v49, v53
    v_smfmac_f32_16x16x64_bf16 v[60:63], v[36:39], a[152:159], v1
    ds_read_b128 v[92:95], v8 offset:18432
    v_add_f32 v50, v50, v54
    v_smfmac_f32_16x16x64_bf16 v[56:59], v[40:43], a[160:167], v1
    ds_read_b128 v[96:99], v8 offset:15360
    v_add_f32 v51, v51, v55
    v_smfmac_f32_16x16x64_bf16 v[60:63], v[40:43], a[168:175], v1
    global_store_dwordx4 v7, v[112:115], s[70:71] offset:1024 sc1
    v_cvt_pk_bf16_f32 v52, v48, v49
    v_smfmac_f32_16x16x64_bf16 v[56:59], v[44:47], a[176:183], v1
    ds_read_b128 v[100:103], v8 offset:19456
    v_cvt_pk_bf16_f32 v53, v50, v51
    v_smfmac_f32_16x16x64_bf16 v[60:63], v[44:47], a[184:191], v1
    ds_write_b64 v5, v[52:53]
    v_smfmac_f32_16x16x64_bf16 v[64:67], v[24:27], a[224:231], v1
    v_smfmac_f32_16x16x64_bf16 v[68:71], v[24:27], a[232:239], v1
    global_load_dword v0, v9, s[26:27] sc1
    v_permlane32_swap_b32 v56, v60
    v_smfmac_f32_16x16x64_bf16 v[64:67], v[28:31], a[240:247], v1
    v_permlane32_swap_b32 v57, v61
    v_smfmac_f32_16x16x64_bf16 v[68:71], v[28:31], a[248:255], v1
    v_permlane32_swap_b32 v58, v62
    v_smfmac_f32_16x16x64_bf16 v[64:67], v[32:35], v[136:143], v1
    v_permlane32_swap_b32 v59, v63
    v_smfmac_f32_16x16x64_bf16 v[68:71], v[32:35], v[144:151], v1
    s_waitcnt lgkmcnt(0)
    s_barrier
    ds_read_b64_tr_b16 v[112:113], v6 offset:0
    ds_read_b64_tr_b16 v[114:115], v6 offset:64
    v_add_f32 v56, v56, v60
    v_smfmac_f32_16x16x64_bf16 v[64:67], v[36:39], v[152:159], v1
    ds_read_b64_tr_b16 v[116:117], v6 offset:512
    ds_read_b64_tr_b16 v[118:119], v6 offset:576
    v_add_f32 v57, v57, v61
    v_smfmac_f32_16x16x64_bf16 v[68:71], v[36:39], v[160:167], v1
    ds_read_b64_tr_b16 v[120:121], v6 offset:1024
    ds_read_b64_tr_b16 v[122:123], v6 offset:1088
    v_add_f32 v58, v58, v62
    v_smfmac_f32_16x16x64_bf16 v[64:67], v[40:43], v[168:175], v1
    ds_read_b64_tr_b16 v[124:125], v6 offset:1536
    ds_read_b64_tr_b16 v[126:127], v6 offset:1600
    v_add_f32 v59, v59, v63
    v_smfmac_f32_16x16x64_bf16 v[68:71], v[40:43], v[176:183], v1
    v_cvt_pk_bf16_f32 v60, v56, v57
    v_cvt_pk_bf16_f32 v61, v58, v59
    v_smfmac_f32_16x16x64_bf16 v[64:67], v[44:47], v[184:191], v1
    ds_write_b64 v5, v[60:61] offset:2048
    v_smfmac_f32_16x16x64_bf16 v[68:71], v[44:47], v[192:199], v1
    s_waitcnt lgkmcnt(7)
    v_mfma_f32_16x16x32_bf16 v[48:51], v[72:75], v[112:115], 0
    v_mfma_f32_16x16x32_bf16 v[52:55], v[76:79], v[112:115], 0
    s_waitcnt lgkmcnt(5)
    v_cvt_pk_bf16_f32 v64, v64, v65
    v_cvt_pk_bf16_f32 v65, v66, v67
    v_mfma_f32_16x16x32_bf16 v[48:51], v[80:83], v[116:119], v[48:51]
    v_cvt_pk_bf16_f32 v66, v68, v69
    v_cvt_pk_bf16_f32 v67, v70, v71
    v_mfma_f32_16x16x32_bf16 v[52:55], v[84:87], v[116:119], v[52:55]
    global_store_dwordx4 v7, v[64:67], s[82:83] offset:1024 sc1
    s_waitcnt lgkmcnt(3)
    v_mfma_f32_16x16x32_bf16 v[48:51], v[88:91], v[120:123], v[48:51]
    s_waitcnt lgkmcnt(0)
    s_barrier
    ds_read_b64_tr_b16 v[16:17], v6 offset:2048
    ds_read_b64_tr_b16 v[18:19], v6 offset:2112
    v_mfma_f32_16x16x32_bf16 v[52:55], v[92:95], v[120:123], v[52:55]
    ds_read_b64_tr_b16 v[20:21], v6 offset:2560
    ds_read_b64_tr_b16 v[22:23], v6 offset:2624
    ds_read_b64_tr_b16 v[24:25], v6 offset:3072
    ds_read_b64_tr_b16 v[26:27], v6 offset:3136
    v_mov_b64 v[68:69], s[86:87]
    v_mfma_f32_16x16x32_bf16 v[48:51], v[96:99], v[124:127], v[48:51]
    ds_read_b64_tr_b16 v[28:29], v6 offset:3584
    ds_read_b64_tr_b16 v[30:31], v6 offset:3648
    v_mov_b64 v[70:71], s[86:87]
    v_mfma_f32_16x16x32_bf16 v[52:55], v[100:103], v[124:127], v[52:55]
    ds_read_b128 v[32:35], v4 offset:28672
    s_waitcnt lgkmcnt(7)
    v_mov_b64 v[62:63], s[98:99]
    v_mfma_f32_16x16x32_bf16 v[56:59], v[16:19], v[112:115], 0
    ds_read_b128 v[36:39], v4 offset:29696
    s_waitcnt lgkmcnt(6)
    v_max3_f32 v13, v48, v49, v50
    v_mfma_f32_16x16x32_bf16 v[56:59], v[20:23], v[116:119], v[56:59]
    ds_read_b128 v[40:43], v4 offset:24576
    s_waitcnt lgkmcnt(5)
    v_max3_f32 v13, v13, v51, v52
    v_max3_f32 v15, v53, v54, v55
    v_mfma_f32_16x16x32_bf16 v[56:59], v[24:27], v[120:123], v[56:59]
    global_store_dwordx4 v7, v[24:27], s[82:83] sc1
    s_waitcnt lgkmcnt(3)
    v_max_f32 v14, v13, v15
    v_max_f32 v13, v13, v15
    v_mfma_f32_16x16x32_bf16 v[56:59], v[28:31], v[124:127], v[56:59]
    ds_read_b128 v[44:47], v4 offset:25600
    s_cmp_eq_u32 s64, 63
    s_cbranch_scc1 L_chain_fin
    v_permlane32_swap_b32 v13, v14
    v_max_f32 v13, v13, v14
    s_nop 2
    v_max3_f32 v13, v13, v56, v57
    v_max3_f32 v13, v13, v58, v59
    v_mov_b32 v14, v13
    s_nop 1
    v_permlane16_swap_b32 v13, v14
    v_max_f32 v13, v13, v14
    v_mul_f32 v14, s84, v13
    v_pk_fma_f32 v[48:49], v[48:49], s[84:85], v[14:15] op_sel_hi:[1,1,0] neg_lo:[0,0,1] neg_hi:[0,0,1]
    v_pk_fma_f32 v[50:51], v[50:51], s[84:85], v[14:15] op_sel_hi:[1,1,0] neg_lo:[0,0,1] neg_hi:[0,0,1]
    v_pk_fma_f32 v[52:53], v[52:53], s[84:85], v[14:15] op_sel_hi:[1,1,0] neg_lo:[0,0,1] neg_hi:[0,0,1]
    v_pk_fma_f32 v[54:55], v[54:55], s[84:85], v[14:15] op_sel_hi:[1,1,0] neg_lo:[0,0,1] neg_hi:[0,0,1]
    v_pk_fma_f32 v[56:57], v[56:57], s[84:85], v[14:15] op_sel_hi:[1,1,0] neg_lo:[0,0,1] neg_hi:[0,0,1]
    v_pk_fma_f32 v[58:59], v[58:59], s[84:85], v[14:15] op_sel_hi:[1,1,0] neg_lo:[0,0,1] neg_hi:[0,0,1]
    v_exp_f32 v48, v48
    v_exp_f32 v49, v49
    v_exp_f32 v50, v50
    v_exp_f32 v51, v51
    v_exp_f32 v52, v52
    v_exp_f32 v53, v53
    v_exp_f32 v54, v54
    v_exp_f32 v55, v55
    v_cvt_pk_bf16_f32 v48, v48, v49
    v_cvt_pk_bf16_f32 v49, v50, v51
    v_cvt_pk_bf16_f32 v50, v52, v53
    v_cvt_pk_bf16_f32 v51, v54, v55
    v_exp_f32 v56, v56
    v_exp_f32 v57, v57
    v_mfma_f32_16x16x32_bf16 v[120:123], v[68:71], v[48:51], 0
    s_waitcnt vmcnt(8)
    v_exp_f32 v58, v58
    v_mfma_f32_16x16x32_bf16 v[112:115], v[104:107], v[48:51], 0
    v_exp_f32 v59, v59
    v_mfma_f32_16x16x32_bf16 v[116:119], v[108:111], v[48:51], 0
    v_cvt_pk_bf16_f32 v56, v56, v57
    v_cvt_pk_bf16_f32 v57, v58, v59
    v_mov_b64 v[68:69], 0
    v_mov_b64 v[70:71], 0
    v_mfma_f32_16x16x16_bf16 v[120:123], v[62:63], v[56:57], v[120:123]
    ds_read_b128 v[88:91], v4 offset:20480
    v_mov_b64 v[58:59], 0
    v_mfma_f32_16x16x16_bf16 v[112:115], v[64:65], v[56:57], v[112:115]
    ds_read_b128 v[92:95], v4 offset:21504
    v_mov_b64 v[60:61], 0
    v_mfma_f32_16x16x16_bf16 v[116:119], v[66:67], v[56:57], v[116:119]
    ds_read_b128 v[72:75], v4 offset:16384
    v_rcp_f32 v14, v120
    v_mov_b64 v[62:63], 0
    v_mov_b64 v[56:57], 0
    v_mov_b64 v[64:65], 0
    v_mov_b64 v[66:67], 0
    v_pk_mul_f32 v[112:113], v[112:113], v[14:15] op_sel_hi:[1,0]
    v_pk_mul_f32 v[114:115], v[114:115], v[14:15] op_sel_hi:[1,0]
    v_pk_mul_f32 v[116:117], v[116:117], v[14:15] op_sel_hi:[1,0]
    v_pk_mul_f32 v[118:119], v[118:119], v[14:15] op_sel_hi:[1,0]
    v_cvt_pk_bf16_f32 v48, v112, v116
    v_cvt_pk_bf16_f32 v49, v113, v117
    v_cvt_pk_bf16_f32 v50, v114, v118
    v_cvt_pk_bf16_f32 v51, v115, v119
    ds_write_b128 v7, v[48:51]
    s_nop 0
    v_smfmac_f32_16x16x64_bf16 v[56:59], v[48:51], v[216:223], v1
    ds_read_b128 v[104:107], v4 offset:32768
    v_smfmac_f32_16x16x64_bf16 v[60:63], v[48:51], v[248:255], v1
    ds_read_b128 v[108:111], v4 offset:33792
    s_waitcnt lgkmcnt(4)
    v_smfmac_f32_16x16x64_bf16 v[64:67], v[48:51], v[88:95], v1
    s_waitcnt lgkmcnt(2)
    s_barrier
    ds_read_b128 v[112:115], v8 offset:0
    ds_read_b128 v[116:119], v8 offset:2048
    ds_read_b128 v[124:127], v8 offset:6144
    ds_read_b128 v[76:79], v4 offset:17408
    ds_read_b128 v[80:83], v4 offset:18432
    v_smfmac_f32_16x16x64_bf16 v[68:71], v[48:51], v[32:39], v1
    s_waitcnt lgkmcnt(4)
    v_smfmac_f32_16x16x64_bf16 v[56:59], v[112:115], v[200:207], v1
    ds_read_b128 v[84:87], v4 offset:19456
    s_waitcnt lgkmcnt(4)
    v_smfmac_f32_16x16x64_bf16 v[56:59], v[116:119], v[208:215], v1
    ds_read_b128 v[96:99], v4 offset:22528
    s_waitcnt lgkmcnt(4)
    v_smfmac_f32_16x16x64_bf16 v[56:59], v[124:127], v[224:231], v1
    ds_read_b128 v[100:103], v4 offset:23552
    v_smfmac_f32_16x16x64_bf16 v[60:63], v[112:115], v[232:239], v1
    ds_read_b128 v[16:19], v4 offset:26624
    v_smfmac_f32_16x16x64_bf16 v[60:63], v[116:119], v[240:247], v1
    ds_read_b128 v[20:23], v4 offset:27648
    v_cvt_pk_bf16_f32 v56, v56, v57
    v_cvt_pk_bf16_f32 v57, v58, v59
    v_smfmac_f32_16x16x64_bf16 v[60:63], v[124:127], v[104:111], v1
    global_store_dwordx2 v2, v[56:57], s[66:67] offset:-4096 sc1
    s_waitcnt lgkmcnt(6)
    v_smfmac_f32_16x16x64_bf16 v[64:67], v[112:115], v[72:79], v1
    ds_read_b128 v[24:27], v4 offset:30720
    s_waitcnt lgkmcnt(5)
    v_smfmac_f32_16x16x64_bf16 v[64:67], v[116:119], v[80:87], v1
    ds_read_b128 v[28:31], v4 offset:31744
    s_waitcnt lgkmcnt(4)
    v_cvt_pk_bf16_f32 v60, v60, v61
    v_cvt_pk_bf16_f32 v61, v62, v63
    v_smfmac_f32_16x16x64_bf16 v[64:67], v[124:127], v[96:103], v1
    global_store_dwordx2 v2, v[60:61], s[66:67] offset:-2048 sc1
    v_smfmac_f32_16x16x64_bf16 v[68:71], v[112:115], v[40:47], v1
    ds_read_b128 v[72:75], v4 offset:0
    s_waitcnt lgkmcnt(3)
    v_smfmac_f32_16x16x64_bf16 v[68:71], v[116:119], v[16:23], v1
    ds_read_b128 v[76:79], v4 offset:1024
    s_waitcnt lgkmcnt(2)
    v_cvt_pk_bf16_f32 v64, v64, v65
    v_cvt_pk_bf16_f32 v65, v66, v67
    v_smfmac_f32_16x16x64_bf16 v[68:71], v[124:127], v[24:31], v1
    global_store_dwordx2 v2, v[64:65], s[66:67] offset:0 sc1
    s_nop 6
    v_cvt_pk_bf16_f32 v68, v68, v69
    v_cvt_pk_bf16_f32 v69, v70, v71
    global_store_dwordx2 v2, v[68:69], s[66:67] offset:2048 sc1
    ds_read_b128 v[80:83], v4 offset:2048
    ds_read_b128 v[84:87], v4 offset:3072
    ds_read_b128 v[88:91], v4 offset:4096
    ds_read_b128 v[92:95], v4 offset:5120
    ds_read_b128 v[96:99], v4 offset:6144
    ds_read_b128 v[100:103], v4 offset:7168
    ds_read_b128 v[104:107], v8 offset:20480
    v_mov_b64 v[48:49], 0
    v_mov_b64 v[50:51], 0
    v_mov_b64 v[52:53], 0
    v_mov_b64 v[54:55], 0
    v_mov_b64 v[56:57], 0
    v_mov_b64 v[58:59], 0
    v_mov_b64 v[60:61], 0
    v_mov_b64 v[62:63], 0
    v_mov_b64 v[64:65], 0
    v_mov_b64 v[66:67], 0
    v_mov_b64 v[68:69], 0
    v_mov_b64 v[70:71], 0
    s_lshr_b32 s42, s100, 5
    s_add_u32 s76, s46, s42
    s_addc_u32 s77, s47, 0
    s_sub_u32 s74, s76, 0x22000
    s_subb_u32 s75, s77, 0
    s_add_u32 s42, s42, 0x6000
    s_and_b32 s42, s42, 0x6000
    s_add_u32 s36, s46, s42
    s_addc_u32 s37, s47, 0
    s_add_u32 s64, s64, 1
    v_add_u32 v9, v9, v10
    v_add_u32 v11, 4, v11
    s_add_u32 s80, s80, 0x40000
    s_addc_u32 s81, s81, 0
    s_add_u32 s78, s78, 0x40000
    s_addc_u32 s79, s79, 0
    s_add_u32 s82, s82, 0x40000
    s_addc_u32 s83, s83, 0
    s_nop 0
    s_nop 0
    v_mov_b32 v14, 0
    s_nop 2
    v_mov_b32 v14, 0
    s_nop 2
    v_mov_b32 v14, 0
    s_nop 2
    global_load_dwordx4 v[112:115], v12, s[68:69] sc1
    global_load_dwordx4 v[116:119], v12, s[68:69] offset:1024 sc1
    v_mov_b32 v14, 0
    s_nop 2
    v_mov_b32 v14, 0
    s_nop 2
    v_mov_b32 v14, 0
    s_nop 2
    v_mov_b32 v14, 0
    s_nop 2
    v_mov_b32 v14, 0
    s_nop 2
    v_mov_b32 v14, 0
    s_nop 2
    v_mov_b32 v14, 0
    s_nop 2
    v_mov_b32 v14, 0
    s_nop 2
    v_mov_b32 v14, 0
    s_nop 2
    global_load_dwordx4 v[112:115], v12, s[68:69] sc1
    global_load_dwordx4 v[116:119], v12, s[68:69] offset:1024 sc1
    s_waitcnt lgkmcnt(0)
    s_waitcnt vmcnt(10)
    ds_write_b128 v7, v[128:131] offset:12288
    ds_write_b128 v7, v[132:135] offset:13312
    v_mov_b32 v14, 0
    s_nop 2
    s_waitcnt vmcnt(2)
    v_max3_u32 v14, v112, v113, v114
    v_max3_u32 v15, v115, v116, v117
    v_max3_u32 v14, v14, v118, v119
    v_max_u32 v14, v14, v15
    v_cmp_eq_u32 vcc, -1, v14
    s_cbranch_vccnz L_hop1_s2
L_hop1_oks2:
    v_mfma_f32_16x16x32_bf16 v[108:111], v[112:115], v[104:107], 0
    v_mfma_f32_16x16x32_bf16 v[108:111], v[116:119], v[104:107], v[108:111]
    s_nop 7
    v_add_f32 v108, v108, v109
    v_add_f32 v110, v110, v111
    s_nop 1
    v_permlane32_swap_b32 v108, v110
    v_add_f32 v108, v108, v110
    s_nop 1
    v_mov_b32_dpp v109, v108 row_shl:4 row_mask:0xf bank_mask:0xf
    v_cvt_pk_bf16_f32 v108, v108, v109
    s_mov_b64 exec, s[44:45]
    global_store_dword v3, v108, s[76:77] sc1
    s_mov_b64 exec, -1
    s_mov_b64 s[70:71], s[68:69]
    s_add_u32 s100, s100, 0x40000
    s_and_b32 s100, s100, 0xc0000
    s_add_u32 s42, s100, s101
    s_add_u32 s68, s72, s42
    s_addc_u32 s69, s73, 0
    s_add_u32 s42, s100, 0x23000
    s_add_u32 s66, s72, s42
    s_addc_u32 s67, s73, 0
    v_readlane_b32 s41, v0, 48
    s_nop 0
    s_cmp_eq_u32 s41, 0x01010101
    s_cbranch_scc0 L_flag_slows2
L_flag_oks2:
    v_mov_b32 v14, 0
    s_nop 2
    v_mov_b32 v14, 0
    s_nop 2
    v_mov_b32 v14, 0
    s_nop 2
    v_mov_b32 v14, 0
    s_nop 2
    v_mov_b32 v14, 0
    s_nop 2
    v_mov_b32 v14, 0
    s_nop 2
    v_mov_b32 v14, 0
    s_nop 2
    global_load_dwordx4 v[16:19], v7, s[74:75] sc1
    global_load_dwordx4 v[20:23], v7, s[74:75] offset:1024 sc1
    v_mov_b32 v14, 0
    s_nop 2
    v_mov_b32 v14, 0
    s_nop 2
    v_mov_b32 v14, 0
    s_nop 2
    v_mov_b32 v14, 0
    s_nop 2
    v_mov_b32 v14, 0
    s_nop 2
    v_mov_b32 v14, 0
    s_nop 2
    v_mov_b32 v14, 0
    s_nop 2
    v_mov_b32 v14, 0
    s_nop 2
    v_mov_b32 v14, 0
    s_nop 2
    global_load_dwordx4 v[16:19], v7, s[74:75] sc1
    global_load_dwordx4 v[20:23], v7, s[74:75] offset:1024 sc1
    v_mov_b32 v14, 0
    s_nop 2
    v_mov_b32 v14, 0
    s_nop 2
    v_mov_b32 v14, 0
    s_nop 2
    s_waitcnt lgkmcnt(0)
    s_waitcnt vmcnt(2)
    v_max3_u32 v14, v16, v17, v18
    v_max3_u32 v15, v19, v20, v21
    v_max3_u32 v14, v14, v22, v23
    v_max_u32 v14, v14, v15
    v_cmp_eq_u32 vcc, -1, v14
    s_cbranch_vccz L_steps2
L_hop2_s2:
    s_mov_b64 exec, vcc
    global_load_dwordx4 v[16:19], v7, s[74:75] sc1
    global_load_dwordx4 v[20:23], v7, s[74:75] offset:1024 sc1
    s_mov_b64 exec, -1
    v_max3_u32 v14, v16, v17, v18
    v_max3_u32 v15, v19, v20, v21
    v_max3_u32 v14, v14, v22, v23
    v_max_u32 v14, v14, v15
    v_cmp_eq_u32 vcc, -1, v14
    s_cbranch_vccz L_steps2
    v_max3_u32 v14, v16, v17, v18
    v_max3_u32 v15, v19, v20, v21
    v_max3_u32 v14, v14, v22, v23
    v_max_u32 v14, v14, v15
    v_cmp_eq_u32 vcc, -1, v14
    s_cbranch_vccz L_steps2
    s_mov_b64 exec, vcc
    global_load_dwordx4 v[16:19], v7, s[74:75] sc1
    global_load_dwordx4 v[20:23], v7, s[74:75] offset:1024 sc1
    s_mov_b64 exec, -1
    v_max3_u32 v14, v16, v17, v18
    v_max3_u32 v15, v19, v20, v21
    v_max3_u32 v14, v14, v22, v23
    v_max_u32 v14, v14, v15
    v_cmp_eq_u32 vcc, -1, v14
    s_cbranch_vccz L_steps2
    v_max3_u32 v14, v16, v17, v18
    v_max3_u32 v15, v19, v20, v21
    v_max3_u32 v14, v14, v22, v23
    v_max_u32 v14, v14, v15
    v_cmp_eq_u32 vcc, -1, v14
    s_cbranch_vccz L_steps2
    s_waitcnt vmcnt(32)
    s_add_u32 s39, s39, 1
    s_cmp_gt_u32 s39, 0x400000
    s_cbranch_scc1 L_fail
    s_branch L_hop2_s2
L_hop1_s2:
    s_mov_b64 exec, vcc
    global_load_dwordx4 v[112:115], v12, s[68:69] sc1
    global_load_dwordx4 v[116:119], v12, s[68:69] offset:1024 sc1
    s_mov_b64 exec, -1
    v_max3_u32 v14, v112, v113, v114
    v_max3_u32 v15, v115, v116, v117
    v_max3_u32 v14, v14, v118, v119
    v_max_u32 v14, v14, v15
    v_cmp_eq_u32 vcc, -1, v14
    s_cbranch_vccz L_hop1_oks2
    v_max3_u32 v14, v112, v113, v114
    v_max3_u32 v15, v115, v116, v117
    v_max3_u32 v14, v14, v118, v119
    v_max_u32 v14, v14, v15
    v_cmp_eq_u32 vcc, -1, v14
    s_cbranch_vccz L_hop1_oks2
    s_mov_b64 exec, vcc
    global_load_dwordx4 v[112:115], v12, s[68:69] sc1
    global_load_dwordx4 v[116:119], v12, s[68:69] offset:1024 sc1
    s_mov_b64 exec, -1
    v_max3_u32 v14, v112, v113, v114
    v_max3_u32 v15, v115, v116, v117
    v_max3_u32 v14, v14, v118, v119
    v_max_u32 v14, v14, v15
    v_cmp_eq_u32 vcc, -1, v14
    s_cbranch_vccz L_hop1_oks2
    v_max3_u32 v14, v112, v113, v114
    v_max3_u32 v15, v115, v116, v117
    v_max3_u32 v14, v14, v118, v119
    v_max_u32 v14, v14, v15
    v_cmp_eq_u32 vcc, -1, v14
    s_cbranch_vccz L_hop1_oks2
    s_waitcnt vmcnt(32)
    s_add_u32 s39, s39, 1
    s_cmp_gt_u32 s39, 0x400000
    s_cbranch_scc1 L_fail
    s_branch L_hop1_s2
L_flag_slows2:
    s_cmp_ge_u32 s64, 63
    s_cbranch_scc1 L_flag_oks2
    s_lshl_b32 s40, s29, 6
    s_add_u32 s40, s40, s64
    s_lshl_b32 s40, s40, 2
    s_add_u32 s40, s40, 0x400004
    v_mov_b32 v14, s40
    v_mov_b32 v15, 0x01010101
L_wf_16:
    global_load_dword v0, v14, s[26:27] sc1
    s_add_u32 s39, s39, 1
    s_cmp_gt_u32 s39, 0x400000
    s_cbranch_scc1 L_fail
    s_sleep 1
    s_waitcnt vmcnt(0)
    v_cmp_ne_u32 vcc, v15, v0
    s_cbranch_vccnz L_wf_16
    s_branch L_flag_oks2
L_entrys3:
    ds_read_b128 v[72:75], v4 offset:0
    ds_read_b128 v[76:79], v4 offset:1024
    ds_read_b128 v[80:83], v4 offset:2048
    ds_read_b128 v[84:87], v4 offset:3072
    ds_read_b128 v[88:91], v4 offset:4096
    ds_read_b128 v[92:95], v4 offset:5120
    ds_read_b128 v[96:99], v4 offset:6144
    ds_read_b128 v[100:103], v4 offset:7168
    v_mov_b64 v[48:49], 0
    v_mov_b64 v[50:51], 0
    v_mov_b64 v[52:53], 0
    v_mov_b64 v[54:55], 0
    v_mov_b64 v[56:57], 0
    v_mov_b64 v[58:59], 0
    v_mov_b64 v[60:61], 0
    v_mov_b64 v[62:63], 0
    v_mov_b64 v[64:65], 0
    v_mov_b64 v[66:67], 0
    v_mov_b64 v[68:69], 0
    v_mov_b64 v[70:71], 0
    s_mov_b64 s[70:71], s[68:69]
    s_add_u32 s100, s100, 0x40000
    s_and_b32 s100, s100, 0xc0000
    s_add_u32 s42, s100, s101
    s_add_u32 s68, s72, s42
    s_addc_u32 s69, s73, 0
    s_add_u32 s42, s100, 0x23000
    s_add_u32 s66, s72, s42
    s_addc_u32 s67, s73, 0
    s_add_u32 s36, s46, 0x4000
    s_addc_u32 s37, s47, 0
    s_lshl_b32 s40, s29, 8
    s_add_u32 s40, s40, 0x400004
    v_mov_b32 v14, s40
    v_mov_b32 v15, 0x01010101
    v_readlane_b32 s41, v0, 48
    s_nop 0
    s_cmp_eq_u32 s41, 0x01010101
    s_cbranch_scc1 L_e1s3
L_wf_17:
    global_load_dword v0, v14, s[26:27] sc1
    s_add_u32 s39, s39, 1
    s_cmp_gt_u32 s39, 0x400000
    s_cbranch_scc1 L_fail
    s_sleep 1
    s_waitcnt vmcnt(0)
    v_cmp_ne_u32 vcc, v15, v0
    s_cbranch_vccnz L_wf_17
L_e1s3:
    s_waitcnt lgkmcnt(0)
.p2align 6
L_steps3:
    v_smfmac_f32_16x16x64_bf16 v[48:51], v[16:19], v[72:79], v1
    ds_write_b128 v7, v[16:19]
    v_smfmac_f32_16x16x64_bf16 v[52:55], v[16:19], v[80:87], v1
    ds_write_b128 v7, v[20:23] offset:1024
    v_smfmac_f32_16x16x64_bf16 v[48:51], v[20:23], v[88:95], v1
    ds_read_b128 v[72:75], v4 offset:8192
    v_smfmac_f32_16x16x64_bf16 v[52:55], v[20:23], v[96:103], v1
    ds_read_b128 v[76:79], v4 offset:9216
    v_mov_b64 v[112:113], -1
    v_smfmac_f32_16x16x64_bf16 v[56:59], v[16:19], a[96:103], v1
    ds_read_b128 v[80:83], v4 offset:10240
    v_mov_b64 v[114:115], -1
    v_smfmac_f32_16x16x64_bf16 v[60:63], v[16:19], a[104:111], v1
    ds_read_b128 v[84:87], v4 offset:11264
    v_smfmac_f32_16x16x64_bf16 v[56:59], v[20:23], a[112:119], v1
    v_smfmac_f32_16x16x64_bf16 v[60:63], v[20:23], a[120:127], v1
    s_waitcnt lgkmcnt(4)
    s_barrier
    ds_read_b128 v[24:27], v8 offset:4096
    ds_read_b128 v[28:31], v8 offset:5120
    v_smfmac_f32_16x16x64_bf16 v[64:67], v[16:19], a[192:199], v1
    ds_read_b128 v[32:35], v8 offset:2048
    v_smfmac_f32_16x16x64_bf16 v[68:71], v[16:19], a[200:207], v1
    ds_read_b128 v[36:39], v8 offset:3072
    v_smfmac_f32_16x16x64_bf16 v[64:67], v[20:23], a[208:215], v1
    ds_read_b128 v[40:43], v8 offset:0
    v_smfmac_f32_16x16x64_bf16 v[68:71], v[20:23], a[216:223], v1
    s_waitcnt vmcnt(0)
    ds_read_b128 v[44:47], v8 offset:1024
    global_load_dwordx4 v[104:107], v7, s[80:81] offset:0 sc1
    s_waitcnt lgkmcnt(5)
    v_smfmac_f32_16x16x64_bf16 v[48:51], v[24:27], a[0:7], v1
    global_load_dwordx4 v[108:111], v7, s[80:81] offset:1024 sc1
    v_smfmac_f32_16x16x64_bf16 v[52:55], v[24:27], a[8:15], v1
    ds_read_b128 v[88:91], v4 offset:12288
    s_waitcnt lgkmcnt(5)
    v_smfmac_f32_16x16x64_bf16 v[48:51], v[28:31], a[16:23], v1
    ds_read_b128 v[92:95], v4 offset:13312
    v_smfmac_f32_16x16x64_bf16 v[52:55], v[28:31], a[24:31], v1
    ds_read_b128 v[96:99], v4 offset:14336
    s_waitcnt lgkmcnt(6)
    v_smfmac_f32_16x16x64_bf16 v[48:51], v[32:35], a[32:39], v1
    ds_read_b128 v[100:103], v4 offset:15360
    v_smfmac_f32_16x16x64_bf16 v[52:55], v[32:35], a[40:47], v1
    s_waitcnt lgkmcnt(6)
    v_smfmac_f32_16x16x64_bf16 v[48:51], v[36:39], a[48:55], v1
    global_load_dwordx4 v[128:131], v7, s[78:79] offset:0 sc1
    v_smfmac_f32_16x16x64_bf16 v[52:55], v[36:39], a[56:63], v1
    s_waitcnt lgkmcnt(5)
    v_smfmac_f32_16x16x64_bf16 v[48:51], v[40:43], a[64:71], v1
    global_load_dwordx4 v[132:135], v7, s[78:79] offset:1024 sc1
    v_smfmac_f32_16x16x64_bf16 v[52:55], v[40:43], a[72:79], v1
    s_waitcnt lgkmcnt(4)
    v_smfmac_f32_16x16x64_bf16 v[48:51], v[44:47], a[80:87], v1
    s_mov_b64 exec, s[44:45]
    global_store_dword v3, v112, s[36:37] sc1
    s_mov_b64 exec, -1
    v_smfmac_f32_16x16x64_bf16 v[52:55], v[44:47], a[88:95], v1
    v_smfmac_f32_16x16x64_bf16 v[56:59], v[24:27], v[72:79], v1
    v_smfmac_f32_16x16x64_bf16 v[60:63], v[24:27], v[80:87], v1
    ds_read_b128 v[72:75], v8 offset:12288
    s_waitcnt lgkmcnt(3)
    v_permlane32_swap_b32 v48, v52
    v_smfmac_f32_16x16x64_bf16 v[56:59], v[28:31], v[88:95], v1
    ds_read_b128 v[76:79], v8 offset:16384
    s_waitcnt lgkmcnt(2)
    v_permlane32_swap_b32 v49, v53
    v_smfmac_f32_16x16x64_bf16 v[60:63], v[28:31], v[96:103], v1
    ds_read_b128 v[80:83], v8 offset:13312
    v_permlane32_swap_b32 v50, v54
    v_smfmac_f32_16x16x64_bf16 v[56:59], v[32:35], a[128:135], v1
    global_store_dwordx4 v7, v[112:115], s[70:71] offset:0 sc1
    v_permlane32_swap_b32 v51, v55
    v_smfmac_f32_16x16x64_bf16 v[60:63], v[32:35], a[136:143], v1
    ds_read_b128 v[84:87], v8 offset:17408
    v_add_f32 v48, v48, v52
    v_smfmac_f32_16x16x64_bf16 v[56:59], v[36:39], a[144:151], v1
    ds_read_b128 v[88:91], v8 offset:14336
    v_add_f32 v49, v49, v53
    v_smfmac_f32_16x16x64_bf16 v[60:63], v[36:39], a[152:159], v1
    ds_read_b128 v[92:95], v8 offset:18432
    v_add_f32 v50, v50, v54
    v_smfmac_f32_16x16x64_bf16 v[56:59], v[40:43], a[160:167], v1
    ds_read_b128 v[96:99], v8 offset:15360
    v_add_f32 v51, v51, v55
    v_smfmac_f32_16x16x64_bf16 v[60:63], v[40:43], a[168:175], v1
    ds_read_b128 v[100:103], v8 offset:19456
    v_cvt_pk_bf16_f32 v52, v48, v49
    v_smfmac_f32_16x16x64_bf16 v[56:59], v[44:47], a[176:183], v1
    global_store_dwordx4 v7, v[112:115], s[70:71] offset:1024 sc1
    v_cvt_pk_bf16_f32 v53, v50, v51
    v_smfmac_f32_16x16x64_bf16 v[60:63], v[44:47], a[184:191], v1
    ds_write_b64 v5, v[52:53]
    v_smfmac_f32_16x16x64_bf16 v[64:67], v[24:27], a[224:231], v1
    v_smfmac_f32_16x16x64_bf16 v[68:71], v[24:27], a[232:239], v1
    global_load_dword v0, v9, s[26:27] sc1
    v_permlane32_swap_b32 v56, v60
    v_smfmac_f32_16x16x64_bf16 v[64:67], v[28:31], a[240:247], v1
    v_permlane32_swap_b32 v57, v61
    v_smfmac_f32_16x16x64_bf16 v[68:71], v[28:31], a[248:255], v1
    v_permlane32_swap_b32 v58, v62
    v_smfmac_f32_16x16x64_bf16 v[64:67], v[32:35], v[136:143], v1
    v_permlane32_swap_b32 v59, v63
    v_smfmac_f32_16x16x64_bf16 v[68:71], v[32:35], v[144:151], v1
    s_waitcnt lgkmcnt(0)
    s_barrier
    ds_read_b64_tr_b16 v[112:113], v6 offset:0
    ds_read_b64_tr_b16 v[114:115], v6 offset:64
    v_add_f32 v56, v56, v60
    v_smfmac_f32_16x16x64_bf16 v[64:67], v[36:39], v[152:159], v1
    ds_read_b64_tr_b16 v[116:117], v6 offset:512
    ds_read_b64_tr_b16 v[118:119], v6 offset:576
    v_add_f32 v57, v57, v61
    v_smfmac_f32_16x16x64_bf16 v[68:71], v[36:39], v[160:167], v1
    ds_read_b64_tr_b16 v[120:121], v6 offset:1024
    ds_read_b64_tr_b16 v[122:123], v6 offset:1088
    v_add_f32 v58, v58, v62
    v_smfmac_f32_16x16x64_bf16 v[64:67], v[40:43], v[168:175], v1
    ds_read_b64_tr_b16 v[124:125], v6 offset:1536
    ds_read_b64_tr_b16 v[126:127], v6 offset:1600
    v_add_f32 v59, v59, v63
    v_smfmac_f32_16x16x64_bf16 v[68:71], v[40:43], v[176:183], v1
    v_cvt_pk_bf16_f32 v60, v56, v57
    v_cvt_pk_bf16_f32 v61, v58, v59
    v_smfmac_f32_16x16x64_bf16 v[64:67], v[44:47], v[184:191], v1
    ds_write_b64 v5, v[60:61] offset:2048
    v_smfmac_f32_16x16x64_bf16 v[68:71], v[44:47], v[192:199], v1
    s_waitcnt lgkmcnt(7)
    v_mfma_f32_16x16x32_bf16 v[48:51], v[72:75], v[112:115], 0
    v_mfma_f32_16x16x32_bf16 v[52:55], v[76:79], v[112:115], 0
    s_waitcnt lgkmcnt(5)
    v_cvt_pk_bf16_f32 v64, v64, v65
    v_cvt_pk_bf16_f32 v65, v66, v67
    v_mfma_f32_16x16x32_bf16 v[48:51], v[80:83], v[116:119], v[48:51]
    v_cvt_pk_bf16_f32 v66, v68, v69
    v_cvt_pk_bf16_f32 v67, v70, v71
    v_mfma_f32_16x16x32_bf16 v[52:55], v[84:87], v[116:119], v[52:55]
    global_store_dwordx4 v7, v[64:67], s[82:83] offset:1024 sc1
    s_waitcnt lgkmcnt(3)
    v_mfma_f32_16x16x32_bf16 v[48:51], v[88:91], v[120:123], v[48:51]
    s_waitcnt lgkmcnt(0)
    s_barrier
    ds_read_b64_tr_b16 v[16:17], v6 offset:2048
    ds_read_b64_tr_b16 v[18:19], v6 offset:2112
    v_mfma_f32_16x16x32_bf16 v[52:55], v[92:95], v[120:123], v[52:55]
    ds_read_b64_tr_b16 v[20:21], v6 offset:2560
    ds_read_b64_tr_b16 v[22:23], v6 offset:2624
    ds_read_b64_tr_b16 v[24:25], v6 offset:3072
    ds_read_b64_tr_b16 v[26:27], v6 offset:3136
    v_mov_b64 v[68:69], s[86:87]
    v_mfma_f32_16x16x32_bf16 v[48:51], v[96:99], v[124:127], v[48:51]
    ds_read_b64_tr_b16 v[28:29], v6 offset:3584
    ds_read_b64_tr_b16 v[30:31], v6 offset:3648
    v_mov_b64 v[70:71], s[86:87]
    v_mfma_f32_16x16x32_bf16 v[52:55], v[100:103], v[124:127], v[52:55]
    ds_read_b128 v[32:35], v4 offset:30720
    s_waitcnt lgkmcnt(7)
    v_mov_b64 v[62:63], s[98:99]
    v_mfma_f32_16x16x32_bf16 v[56:59], v[16:19], v[112:115], 0
    ds_read_b128 v[36:39], v4 offset:31744
    s_waitcnt lgkmcnt(6)
    v_max3_f32 v13, v48, v49, v50
    v_mfma_f32_16x16x32_bf16 v[56:59], v[20:23], v[116:119], v[56:59]
    ds_read_b128 v[40:43], v4 offset:24576
    s_waitcnt lgkmcnt(5)
    v_max3_f32 v13, v13, v51, v52
    v_max3_f32 v15, v53, v54, v55
    v_mfma_f32_16x16x32_bf16 v[56:59], v[24:27], v[120:123], v[56:59]
    ds_read_b128 v[44:47], v4 offset:25600
    s_waitcnt lgkmcnt(4)
    v_max_f32 v14, v13, v15
    v_max_f32 v13, v13, v15
    v_mfma_f32_16x16x32_bf16 v[56:59], v[28:31], v[124:127], v[56:59]
    global_store_dwordx4 v7, v[28:31], s[82:83] sc1
    s_cmp_eq_u32 s64, 63
    s_cbranch_scc1 L_chain_fin
    v_permlane32_swap_b32 v13, v14
    v_max_f32 v13, v13, v14
    s_nop 2
    v_max3_f32 v13, v13, v56, v57
    v_max3_f32 v13, v13, v58, v59
    v_mov_b32 v14, v13
    s_nop 1
    v_permlane16_swap_b32 v13, v14
    v_max_f32 v13, v13, v14
    v_mul_f32 v14, s84, v13
    v_pk_fma_f32 v[48:49], v[48:49], s[84:85], v[14:15] op_sel_hi:[1,1,0] neg_lo:[0,0,1] neg_hi:[0,0,1]
    v_pk_fma_f32 v[50:51], v[50:51], s[84:85], v[14:15] op_sel_hi:[1,1,0] neg_lo:[0,0,1] neg_hi:[0,0,1]
    v_pk_fma_f32 v[52:53], v[52:53], s[84:85], v[14:15] op_sel_hi:[1,1,0] neg_lo:[0,0,1] neg_hi:[0,0,1]
    v_pk_fma_f32 v[54:55], v[54:55], s[84:85], v[14:15] op_sel_hi:[1,1,0] neg_lo:[0,0,1] neg_hi:[0,0,1]
    v_pk_fma_f32 v[56:57], v[56:57], s[84:85], v[14:15] op_sel_hi:[1,1,0] neg_lo:[0,0,1] neg_hi:[0,0,1]
    v_pk_fma_f32 v[58:59], v[58:59], s[84:85], v[14:15] op_sel_hi:[1,1,0] neg_lo:[0,0,1] neg_hi:[0,0,1]
    v_exp_f32 v48, v48
    v_exp_f32 v49, v49
    v_exp_f32 v50, v50
    v_exp_f32 v51, v51
    v_exp_f32 v52, v52
    v_exp_f32 v53, v53
    v_exp_f32 v54, v54
    v_exp_f32 v55, v55
    v_cvt_pk_bf16_f32 v48, v48, v49
    v_cvt_pk_bf16_f32 v49, v50, v51
    v_cvt_pk_bf16_f32 v50, v52, v53
    v_cvt_pk_bf16_f32 v51, v54, v55
    v_exp_f32 v56, v56
    v_exp_f32 v57, v57
    v_mfma_f32_16x16x32_bf16 v[120:123], v[68:71], v[48:51], 0
    s_waitcnt vmcnt(8)
    v_exp_f32 v58, v58
    v_mfma_f32_16x16x32_bf16 v[112:115], v[104:107], v[48:51], 0
    v_exp_f32 v59, v59
    v_mfma_f32_16x16x32_bf16 v[116:119], v[108:111], v[48:51], 0
    v_cvt_pk_bf16_f32 v56, v56, v57
    v_cvt_pk_bf16_f32 v57, v58, v59
    v_mov_b64 v[68:69], 0
    v_mov_b64 v[70:71], 0
    v_mfma_f32_16x16x16_bf16 v[120:123], v[62:63], v[56:57], v[120:123]
    ds_read_b128 v[96:99], v4 offset:22528
    v_mov_b64 v[58:59], 0
    v_mfma_f32_16x16x16_bf16 v[112:115], v[64:65], v[56:57], v[112:115]
    ds_read_b128 v[100:103], v4 offset:23552
    v_mov_b64 v[60:61], 0
    v_mfma_f32_16x16x16_bf16 v[116:119], v[66:67], v[56:57], v[116:119]
    ds_read_b128 v[72:75], v4 offset:16384
    v_rcp_f32 v14, v120
    v_mov_b64 v[62:63], 0
    v_mov_b64 v[56:57], 0
    v_mov_b64 v[64:65], 0
    v_mov_b64 v[66:67], 0
    v_pk_mul_f32 v[112:113], v[112:113], v[14:15] op_sel_hi:[1,0]
    v_pk_mul_f32 v[114:115], v[114:115], v[14:15] op_sel_hi:[1,0]
    v_pk_mul_f32 v[116:117], v[116:117], v[14:15] op_sel_hi:[1,0]
    v_pk_mul_f32 v[118:119], v[118:119], v[14:15] op_sel_hi:[1,0]
    v_cvt_pk_bf16_f32 v48, v112, v116
    v_cvt_pk_bf16_f32 v49, v113, v117
    v_cvt_pk_bf16_f32 v50, v114, v118
    v_cvt_pk_bf16_f32 v51, v115, v119
    ds_write_b128 v7, v[48:51]
    ds_read_b128 v[104:107], v4 offset:32768
    ds_read_b128 v[108:111], v4 offset:33792
    v_smfmac_f32_16x16x64_bf16 v[56:59], v[48:51], v[224:231], v1
    s_waitcnt lgkmcnt(4)
    v_smfmac_f32_16x16x64_bf16 v[64:67], v[48:51], v[96:103], v1
    v_smfmac_f32_16x16x64_bf16 v[68:71], v[48:51], v[32:39], v1
    s_waitcnt lgkmcnt(2)
    s_barrier
    ds_read_b128 v[112:115], v8 offset:0
    ds_read_b128 v[116:119], v8 offset:2048
    ds_read_b128 v[120:123], v8 offset:4096
    ds_read_b128 v[76:79], v4 offset:17408
    ds_read_b128 v[80:83], v4 offset:18432
    s_waitcnt lgkmcnt(5)
    v_smfmac_f32_16x16x64_bf16 v[60:63], v[48:51], v[104:111], v1
    s_waitcnt lgkmcnt(4)
    v_smfmac_f32_16x16x64_bf16 v[56:59], v[112:115], v[200:207], v1
    ds_read_b128 v[84:87], v4 offset:19456
    s_waitcnt lgkmcnt(4)
    v_smfmac_f32_16x16x64_bf16 v[56:59], v[116:119], v[208:215], v1
    ds_read_b128 v[88:91], v4 offset:20480
    s_waitcnt lgkmcnt(4)
    v_smfmac_f32_16x16x64_bf16 v[56:59], v[120:123], v[216:223], v1
    ds_read_b128 v[92:95], v4 offset:21504
    v_smfmac_f32_16x16x64_bf16 v[60:63], v[112:115], v[232:239], v1
    ds_read_b128 v[16:19], v4 offset:26624
    v_smfmac_f32_16x16x64_bf16 v[60:63], v[116:119], v[240:247], v1
    ds_read_b128 v[20:23], v4 offset:27648
    v_cvt_pk_bf16_f32 v56, v56, v57
    v_cvt_pk_bf16_f32 v57, v58, v59
    v_smfmac_f32_16x16x64_bf16 v[60:63], v[120:123], v[248:255], v1
    global_store_dwordx2 v2, v[56:57], s[66:67] offset:-4096 sc1
    s_waitcnt lgkmcnt(6)
    v_smfmac_f32_16x16x64_bf16 v[64:67], v[112:115], v[72:79], v1
    ds_read_b128 v[24:27], v4 offset:28672
    s_waitcnt lgkmcnt(5)
    v_smfmac_f32_16x16x64_bf16 v[64:67], v[116:119], v[80:87], v1
    ds_read_b128 v[28:31], v4 offset:29696
    s_waitcnt lgkmcnt(4)
    v_cvt_pk_bf16_f32 v60, v60, v61
    v_cvt_pk_bf16_f32 v61, v62, v63
    v_smfmac_f32_16x16x64_bf16 v[64:67], v[120:123], v[88:95], v1
    global_store_dwordx2 v2, v[60:61], s[66:67] offset:-2048 sc1
    v_smfmac_f32_16x16x64_bf16 v[68:71], v[112:115], v[40:47], v1
    ds_read_b128 v[72:75], v4 offset:0
    s_waitcnt lgkmcnt(3)
    v_smfmac_f32_16x16x64_bf16 v[68:71], v[116:119], v[16:23], v1
    ds_read_b128 v[76:79], v4 offset:1024
    s_waitcnt lgkmcnt(2)
    v_cvt_pk_bf16_f32 v64, v64, v65
    v_cvt_pk_bf16_f32 v65, v66, v67
    v_smfmac_f32_16x16x64_bf16 v[68:71], v[120:123], v[24:31], v1
    global_store_dwordx2 v2, v[64:65], s[66:67] offset:0 sc1
    s_nop 6
    v_cvt_pk_bf16_f32 v68, v68, v69
    v_cvt_pk_bf16_f32 v69, v70, v71
    global_store_dwordx2 v2, v[68:69], s[66:67] offset:2048 sc1
    ds_read_b128 v[80:83], v4 offset:2048
    ds_read_b128 v[84:87], v4 offset:3072
    ds_read_b128 v[88:91], v4 offset:4096
    ds_read_b128 v[92:95], v4 offset:5120
    ds_read_b128 v[96:99], v4 offset:6144
    ds_read_b128 v[100:103], v4 offset:7168
    ds_read_b128 v[104:107], v8 offset:20480
    v_mov_b64 v[48:49], 0
    v_mov_b64 v[50:51], 0
    v_mov_b64 v[52:53], 0
    v_mov_b64 v[54:55], 0
    v_mov_b64 v[56:57], 0
    v_mov_b64 v[58:59], 0
    v_mov_b64 v[60:61], 0
    v_mov_b64 v[62:63], 0
    v_mov_b64 v[64:65], 0
    v_mov_b64 v[66:67], 0
    v_mov_b64 v[68:69], 0
    v_mov_b64 v[70:71], 0
    s_lshr_b32 s42, s100, 5
    s_add_u32 s76, s46, s42
    s_addc_u32 s77, s47, 0
    s_sub_u32 s74, s76, 0x22000
    s_subb_u32 s75, s77, 0
    s_add_u32 s42, s42, 0x6000
    s_and_b32 s42, s42, 0x6000
    s_add_u32 s36, s46, s42
    s_addc_u32 s37, s47, 0
    s_add_u32 s64, s64, 1
    v_add_u32 v9, v9, v10
    v_add_u32 v11, 4, v11
    s_add_u32 s80, s80, 0x40000
    s_addc_u32 s81, s81, 0
    s_add_u32 s78, s78, 0x40000
    s_addc_u32 s79, s79, 0
    s_add_u32 s82, s82, 0x40000
    s_addc_u32 s83, s83, 0
    s_nop 0
    s_nop 0
    v_mov_b32 v14, 0
    s_nop 2
    v_mov_b32 v14, 0
    s_nop 2
    v_mov_b32 v14, 0
    s_nop 2
    v_mov_b32 v14, 0
    s_nop 2
    v_mov_b32 v14, 0
    s_nop 2
    v_mov_b32 v14, 0
    s_nop 2
    global_load_dwordx4 v[112:115], v12, s[68:69] sc1
    global_load_dwordx4 v[116:119], v12, s[68:69] offset:1024 sc1
    v_mov_b32 v14, 0
    s_nop 2
    v_mov_b32 v14, 0
    s_nop 2
    v_mov_b32 v14, 0
    s_nop 2
    v_mov_b32 v14, 0
    s_nop 2
    v_mov_b32 v14, 0
    s_nop 2
    v_mov_b32 v14, 0
    s_nop 2
    v_mov_b32 v14, 0
    s_nop 2
    v_mov_b32 v14, 0
    s_nop 2
    v_mov_b32 v14, 0
    s_nop 2
    global_load_dwordx4 v[112:115], v12, s[68:69] sc1
    global_load_dwordx4 v[116:119], v12, s[68:69] offset:1024 sc1
    s_waitcnt lgkmcnt(0)
    s_waitcnt vmcnt(10)
    ds_write_b128 v7, v[128:131] offset:12288
    ds_write_b128 v7, v[132:135] offset:13312
    v_mov_b32 v14, 0
    s_nop 2
    s_waitcnt vmcnt(2)
    v_max3_u32 v14, v112, v113, v114
    v_max3_u32 v15, v115, v116, v117
    v_max3_u32 v14, v14, v118, v119
    v_max_u32 v14, v14, v15
    v_cmp_eq_u32 vcc, -1, v14
    s_cbranch_vccnz L_hop1_s3
L_hop1_oks3:
    v_mfma_f32_16x16x32_bf16 v[108:111], v[112:115], v[104:107], 0
    v_mfma_f32_16x16x32_bf16 v[108:111], v[116:119], v[104:107], v[108:111]
    s_nop 7
    v_add_f32 v108, v108, v109
    v_add_f32 v110, v110, v111
    s_nop 1
    v_permlane32_swap_b32 v108, v110
    v_add_f32 v108, v108, v110
    s_nop 1
    v_mov_b32_dpp v109, v108 row_shl:4 row_mask:0xf bank_mask:0xf
    v_cvt_pk_bf16_f32 v108, v108, v109
    s_mov_b64 exec, s[44:45]
    global_store_dword v3, v108, s[76:77] sc1
    s_mov_b64 exec, -1
    s_mov_b64 s[70:71], s[68:69]
    s_add_u32 s100, s100, 0x40000
    s_and_b32 s100, s100, 0xc0000
    s_add_u32 s42, s100, s101
    s_add_u32 s68, s72, s42
    s_addc_u32 s69, s73, 0
    s_add_u32 s42, s100, 0x23000
    s_add_u32 s66, s72, s42
    s_addc_u32 s67, s73, 0
    v_readlane_b32 s41, v0, 48
    s_nop 0
    s_cmp_eq_u32 s41, 0x01010101
    s_cbranch_scc0 L_flag_slows3
L_flag_oks3:
    v_mov_b32 v14, 0
    s_nop 2
    v_mov_b32 v14, 0
    s_nop 2
    v_mov_b32 v14, 0
    s_nop 2
    v_mov_b32 v14, 0
    s_nop 2
    v_mov_b32 v14, 0
    s_nop 2
    v_mov_b32 v14, 0
    s_nop 2
    v_mov_b32 v14, 0
    s_nop 2
    global_load_dwordx4 v[16:19], v7, s[74:75] sc1
    global_load_dwordx4 v[20:23], v7, s[74:75] offset:1024 sc1
    v_mov_b32 v14, 0
    s_nop 2
    v_mov_b32 v14, 0
    s_nop 2
    v_mov_b32 v14, 0
    s_nop 2
    v_mov_b32 v14, 0
    s_nop 2
    v_mov_b32 v14, 0
    s_nop 2
    v_mov_b32 v14, 0
    s_nop 2
    v_mov_b32 v14, 0
    s_nop 2
    v_mov_b32 v14, 0
    s_nop 2
    v_mov_b32 v14, 0
    s_nop 2
    global_load_dwordx4 v[16:19], v7, s[74:75] sc1
    global_load_dwordx4 v[20:23], v7, s[74:75] offset:1024 sc1
    v_mov_b32 v14, 0
    s_nop 2
    v_mov_b32 v14, 0
    s_nop 2
    v_mov_b32 v14, 0
    s_nop 2
    s_waitcnt lgkmcnt(0)
    s_waitcnt vmcnt(2)
    v_max3_u32 v14, v16, v17, v18
    v_max3_u32 v15, v19, v20, v21
    v_max3_u32 v14, v14, v22, v23
    v_max_u32 v14, v14, v15
    v_cmp_eq_u32 vcc, -1, v14
    s_cbranch_vccz L_steps3
L_hop2_s3:
    s_mov_b64 exec, vcc
    global_load_dwordx4 v[16:19], v7, s[74:75] sc1
    global_load_dwordx4 v[20:23], v7, s[74:75] offset:1024 sc1
    s_mov_b64 exec, -1
    v_max3_u32 v14, v16, v17, v18
    v_max3_u32 v15, v19, v20, v21
    v_max3_u32 v14, v14, v22, v23
    v_max_u32 v14, v14, v15
    v_cmp_eq_u32 vcc, -1, v14
    s_cbranch_vccz L_steps3
    v_max3_u32 v14, v16, v17, v18
    v_max3_u32 v15, v19, v20, v21
    v_max3_u32 v14, v14, v22, v23
    v_max_u32 v14, v14, v15
    v_cmp_eq_u32 vcc, -1, v14
    s_cbranch_vccz L_steps3
    s_mov_b64 exec, vcc
    global_load_dwordx4 v[16:19], v7, s[74:75] sc1
    global_load_dwordx4 v[20:23], v7, s[74:75] offset:1024 sc1
    s_mov_b64 exec, -1
    v_max3_u32 v14, v16, v17, v18
    v_max3_u32 v15, v19, v20, v21
    v_max3_u32 v14, v14, v22, v23
    v_max_u32 v14, v14, v15
    v_cmp_eq_u32 vcc, -1, v14
    s_cbranch_vccz L_steps3
    v_max3_u32 v14, v16, v17, v18
    v_max3_u32 v15, v19, v20, v21
    v_max3_u32 v14, v14, v22, v23
    v_max_u32 v14, v14, v15
    v_cmp_eq_u32 vcc, -1, v14
    s_cbranch_vccz L_steps3
    s_waitcnt vmcnt(32)
    s_add_u32 s39, s39, 1
    s_cmp_gt_u32 s39, 0x400000
    s_cbranch_scc1 L_fail
    s_branch L_hop2_s3
L_hop1_s3:
    s_mov_b64 exec, vcc
    global_load_dwordx4 v[112:115], v12, s[68:69] sc1
    global_load_dwordx4 v[116:119], v12, s[68:69] offset:1024 sc1
    s_mov_b64 exec, -1
    v_max3_u32 v14, v112, v113, v114
    v_max3_u32 v15, v115, v116, v117
    v_max3_u32 v14, v14, v118, v119
    v_max_u32 v14, v14, v15
    v_cmp_eq_u32 vcc, -1, v14
    s_cbranch_vccz L_hop1_oks3
    v_max3_u32 v14, v112, v113, v114
    v_max3_u32 v15, v115, v116, v117
    v_max3_u32 v14, v14, v118, v119
    v_max_u32 v14, v14, v15
    v_cmp_eq_u32 vcc, -1, v14
    s_cbranch_vccz L_hop1_oks3
    s_mov_b64 exec, vcc
    global_load_dwordx4 v[112:115], v12, s[68:69] sc1
    global_load_dwordx4 v[116:119], v12, s[68:69] offset:1024 sc1
    s_mov_b64 exec, -1
    v_max3_u32 v14, v112, v113, v114
    v_max3_u32 v15, v115, v116, v117
    v_max3_u32 v14, v14, v118, v119
    v_max_u32 v14, v14, v15
    v_cmp_eq_u32 vcc, -1, v14
    s_cbranch_vccz L_hop1_oks3
    v_max3_u32 v14, v112, v113, v114
    v_max3_u32 v15, v115, v116, v117
    v_max3_u32 v14, v14, v118, v119
    v_max_u32 v14, v14, v15
    v_cmp_eq_u32 vcc, -1, v14
    s_cbranch_vccz L_hop1_oks3
    s_waitcnt vmcnt(32)
    s_add_u32 s39, s39, 1
    s_cmp_gt_u32 s39, 0x400000
    s_cbranch_scc1 L_fail
    s_branch L_hop1_s3
L_flag_slows3:
    s_cmp_ge_u32 s64, 63
    s_cbranch_scc1 L_flag_oks3
    s_lshl_b32 s40, s29, 6
    s_add_u32 s40, s40, s64
    s_lshl_b32 s40, s40, 2
    s_add_u32 s40, s40, 0x400004
    v_mov_b32 v14, s40
    v_mov_b32 v15, 0x01010101
L_wf_18:
    global_load_dword v0, v14, s[26:27] sc1
    s_add_u32 s39, s39, 1
    s_cmp_gt_u32 s39, 0x400000
    s_cbranch_scc1 L_fail
    s_sleep 1
    s_waitcnt vmcnt(0)
    v_cmp_ne_u32 vcc, v15, v0
    s_cbranch_vccnz L_wf_18
    s_branch L_flag_oks3
L_chain_fin:
    s_waitcnt vmcnt(0)
    s_barrier
    s_cmp_lg_u32 s28, 0
    s_cbranch_scc1 L_fin2
    s_mov_b64 exec, 1
    global_store_dword v11, v1, s[26:27] offset:4 sc1
    s_mov_b64 exec, -1
L_fin2:
    s_endpgm
L_worker:
    s_sub_u32 s31, s96, 32
    v_and_b32 v1, 15, v0
    v_lshrrev_b32 v2, 4, v0
    v_lshlrev_b32 v8, 4, v0
    v_add_u32 v9, 4096, v8
    v_add_u32 v10, 8192, v8
    v_add_u32 v11, 12288, v8
    v_add_u32 v12, 16384, v8
    v_add_u32 v13, 20480, v8
    v_add_u32 v14, 24576, v8
    v_add_u32 v15, 28672, v8
    s_mul_i32 s64, s31, 9363
    s_lshr_b32 s64, s64, 16
    s_mul_i32 s40, s64, 7
    s_sub_u32 s65, s31, s40
    s_cmp_lg_u32 s31, 2
    s_cbranch_scc1 L_nofi
    s_lshl_b32 s40, s28, 10
    s_add_u32 s40, s40, 0x400000
    v_add_u32 v3, s40, v8
    v_mov_b64 v[16:17], 0
    v_mov_b64 v[18:19], 0
    global_store_dwordx4 v3, v[16:19], s[26:27] sc1
    v_add_u32 v3, 4096, v3
    global_store_dwordx4 v3, v[16:19], s[26:27] sc1
    v_add_u32 v3, 4096, v3
    global_store_dwordx4 v3, v[16:19], s[26:27] sc1
    v_add_u32 v3, 4096, v3
    global_store_dwordx4 v3, v[16:19], s[26:27] sc1
    v_add_u32 v3, 4096, v3
    global_store_dwordx4 v3, v[16:19], s[26:27] sc1
    v_add_u32 v3, 4096, v3
    global_store_dwordx4 v3, v[16:19], s[26:27] sc1
    v_add_u32 v3, 4096, v3
    global_store_dwordx4 v3, v[16:19], s[26:27] sc1
    v_add_u32 v3, 4096, v3
    global_store_dwordx4 v3, v[16:19], s[26:27] sc1
    v_add_u32 v3, 4096, v3
    global_store_dwordx4 v3, v[16:19], s[26:27] sc1
    v_add_u32 v3, 4096, v3
    global_store_dwordx4 v3, v[16:19], s[26:27] sc1
    v_add_u32 v3, 4096, v3
    global_store_dwordx4 v3, v[16:19], s[26:27] sc1
    v_add_u32 v3, 4096, v3
    global_store_dwordx4 v3, v[16:19], s[26:27] sc1
    v_add_u32 v3, 4096, v3
    s_waitcnt vmcnt(0)
    s_barrier
    s_cmp_lg_u32 s28, 0
    s_cbranch_scc1 L_da_19
    v_mov_b32 v3, 176
    v_mov_b32 v4, 1
    s_mov_b64 exec, 1
    global_atomic_add v3, v4, s[24:25] sc1
    s_mov_b64 exec, -1
L_da_19:
L_nofi:
    s_cmp_lt_u32 s65, 3
    s_cbranch_scc1 L_noln
    s_sub_u32 s66, s65, 3
    s_lshl_b32 s66, s66, 5
    s_add_u32 s66, s66, s64
    s_lshl_b32 s40, s66, 14
    s_lshl_b32 s41, s28, 8
    s_add_u32 s41, s41, s40
    v_lshlrev_b32 v65, 10, v1
    v_lshl_add_u32 v65, v2, 4, v65
    v_add_u32 v65, s41, v65
    global_load_dwordx4 v[48:51], v65, s[4:5] offset:0
    global_load_dwordx4 v[52:55], v65, s[4:5] offset:64
    global_load_dwordx4 v[56:59], v65, s[4:5] offset:128
    global_load_dwordx4 v[60:63], v65, s[4:5] offset:192
    v_lshlrev_b32 v66, 2, v1
    v_add_u32 v66, 140000, v66
    s_lshl_b32 s41, s28, 6
    v_add_u32 v67, s41, v66
    s_waitcnt vmcnt(0)
    v_lshlrev_b32 v16, 16, v48
    v_and_b32 v17, 0xffff0000, v48
    v_lshlrev_b32 v18, 16, v49
    v_and_b32 v19, 0xffff0000, v49
    v_lshlrev_b32 v20, 16, v50
    v_and_b32 v21, 0xffff0000, v50
    v_lshlrev_b32 v22, 16, v51
    v_and_b32 v23, 0xffff0000, v51
    v_lshlrev_b32 v24, 16, v52
    v_and_b32 v25, 0xffff0000, v52
    v_lshlrev_b32 v26, 16, v53
    v_and_b32 v27, 0xffff0000, v53
    v_lshlrev_b32 v28, 16, v54
    v_and_b32 v29, 0xffff0000, v54
    v_lshlrev_b32 v30, 16, v55
    v_and_b32 v31, 0xffff0000, v55
    v_lshlrev_b32 v32, 16, v56
    v_and_b32 v33, 0xffff0000, v56
    v_lshlrev_b32 v34, 16, v57
    v_and_b32 v35, 0xffff0000, v57
    v_lshlrev_b32 v36, 16, v58
    v_and_b32 v37, 0xffff0000, v58
    v_lshlrev_b32 v38, 16, v59
    v_and_b32 v39, 0xffff0000, v59
    v_lshlrev_b32 v40, 16, v60
    v_and_b32 v41, 0xffff0000, v60
    v_lshlrev_b32 v42, 16, v61
    v_and_b32 v43, 0xffff0000, v61
    v_lshlrev_b32 v44, 16, v62
    v_and_b32 v45, 0xffff0000, v62
    v_lshlrev_b32 v46, 16, v63
    v_and_b32 v47, 0xffff0000, v63
    v_add_f32 v68, v16, v17
    v_add_f32 v68, v68, v18
    v_add_f32 v68, v68, v19
    v_add_f32 v68, v68, v20
    v_add_f32 v68, v68, v21
    v_add_f32 v68, v68, v22
    v_add_f32 v68, v68, v23
    v_add_f32 v68, v68, v24
    v_add_f32 v68, v68, v25
    v_add_f32 v68, v68, v26
    v_add_f32 v68, v68, v27
    v_add_f32 v68, v68, v28
    v_add_f32 v68, v68, v29
    v_add_f32 v68, v68, v30
    v_add_f32 v68, v68, v31
    v_add_f32 v68, v68, v32
    v_add_f32 v68, v68, v33
    v_add_f32 v68, v68, v34
    v_add_f32 v68, v68, v35
    v_add_f32 v68, v68, v36
    v_add_f32 v68, v68, v37
    v_add_f32 v68, v68, v38
    v_add_f32 v68, v68, v39
    v_add_f32 v68, v68, v40
    v_add_f32 v68, v68, v41
    v_add_f32 v68, v68, v42
    v_add_f32 v68, v68, v43
    v_add_f32 v68, v68, v44
    v_add_f32 v68, v68, v45
    v_add_f32 v68, v68, v46
    v_add_f32 v68, v68, v47
    v_mov_b32 v69, v68
    s_nop 1
    v_permlane16_swap_b32 v68, v69
    v_add_f32 v68, v68, v69
    v_mov_b32 v69, v68
    s_nop 1
    v_permlane32_swap_b32 v68, v69
    v_add_f32 v68, v68, v69
    ds_write_b32 v67, v68
    s_waitcnt lgkmcnt(0)
    s_barrier
    ds_read_b32 v70, v66 offset:0
    ds_read_b32 v71, v66 offset:64
    ds_read_b32 v72, v66 offset:128
    ds_read_b32 v73, v66 offset:192
    s_waitcnt lgkmcnt(0)
    v_add_f32 v70, v70, v71
    v_add_f32 v72, v72, v73
    v_add_f32 v70, v70, v72
    v_mul_f32 v70, 0x3b000000, v70
    v_sub_f32 v69, v16, v70
    v_mul_f32 v68, v69, v69
    v_sub_f32 v69, v17, v70
    v_fmac_f32 v68, v69, v69
    v_sub_f32 v69, v18, v70
    v_fmac_f32 v68, v69, v69
    v_sub_f32 v69, v19, v70
    v_fmac_f32 v68, v69, v69
    v_sub_f32 v69, v20, v70
    v_fmac_f32 v68, v69, v69
    v_sub_f32 v69, v21, v70
    v_fmac_f32 v68, v69, v69
    v_sub_f32 v69, v22, v70
    v_fmac_f32 v68, v69, v69
    v_sub_f32 v69, v23, v70
    v_fmac_f32 v68, v69, v69
    v_sub_f32 v69, v24, v70
    v_fmac_f32 v68, v69, v69
    v_sub_f32 v69, v25, v70
    v_fmac_f32 v68, v69, v69
    v_sub_f32 v69, v26, v70
    v_fmac_f32 v68, v69, v69
    v_sub_f32 v69, v27, v70
    v_fmac_f32 v68, v69, v69
    v_sub_f32 v69, v28, v70
    v_fmac_f32 v68, v69, v69
    v_sub_f32 v69, v29, v70
    v_fmac_f32 v68, v69, v69
    v_sub_f32 v69, v30, v70
    v_fmac_f32 v68, v69, v69
    v_sub_f32 v69, v31, v70
    v_fmac_f32 v68, v69, v69
    v_sub_f32 v69, v32, v70
    v_fmac_f32 v68, v69, v69
    v_sub_f32 v69, v33, v70
    v_fmac_f32 v68, v69, v69
    v_sub_f32 v69, v34, v70
    v_fmac_f32 v68, v69, v69
    v_sub_f32 v69, v35, v70
    v_fmac_f32 v68, v69, v69
    v_sub_f32 v69, v36, v70
    v_fmac_f32 v68, v69, v69
    v_sub_f32 v69, v37, v70
    v_fmac_f32 v68, v69, v69
    v_sub_f32 v69, v38, v70
    v_fmac_f32 v68, v69, v69
    v_sub_f32 v69, v39, v70
    v_fmac_f32 v68, v69, v69
    v_sub_f32 v69, v40, v70
    v_fmac_f32 v68, v69, v69
    v_sub_f32 v69, v41, v70
    v_fmac_f32 v68, v69, v69
    v_sub_f32 v69, v42, v70
    v_fmac_f32 v68, v69, v69
    v_sub_f32 v69, v43, v70
    v_fmac_f32 v68, v69, v69
    v_sub_f32 v69, v44, v70
    v_fmac_f32 v68, v69, v69
    v_sub_f32 v69, v45, v70
    v_fmac_f32 v68, v69, v69
    v_sub_f32 v69, v46, v70
    v_fmac_f32 v68, v69, v69
    v_sub_f32 v69, v47, v70
    v_fmac_f32 v68, v69, v69
    v_mov_b32 v69, v68
    s_nop 1
    v_permlane16_swap_b32 v68, v69
    v_add_f32 v68, v68, v69
    v_mov_b32 v69, v68
    s_nop 1
    v_permlane32_swap_b32 v68, v69
    v_add_f32 v68, v68, v69
    ds_write_b32 v67, v68 offset:256
    s_waitcnt lgkmcnt(0)
    s_barrier
    ds_read_b32 v71, v66 offset:256
    ds_read_b32 v72, v66 offset:320
    ds_read_b32 v73, v66 offset:384
    ds_read_b32 v74, v66 offset:448
    s_waitcnt lgkmcnt(0)
    v_add_f32 v71, v71, v72
    v_add_f32 v73, v73, v74
    v_add_f32 v71, v71, v73
    v_mul_f32 v71, 0x3b000000, v71
    v_cvt_pk_bf16_f32 v71, v71, v71
    v_and_b32 v71, 0xffff0000, v71
    v_add_f32 v71, 0x3727c5ac, v71
    v_cvt_pk_bf16_f32 v71, v71, v71
    v_and_b32 v71, 0xffff0000, v71
    v_sqrt_f32 v71, v71
    s_nop 0
    v_cvt_pk_bf16_f32 v71, v71, v71
    v_and_b32 v71, 0xffff0000, v71
    v_rcp_f32 v72, v71
    v_cvt_pk_bf16_f32 v70, v70, v70
    v_and_b32 v70, 0xffff0000, v70
    v_sub_f32 v16, v16, v70
    v_sub_f32 v17, v17, v70
    v_cvt_pk_bf16_f32 v68, v16, v17
    v_lshlrev_b32 v16, 16, v68
    v_and_b32 v17, 0xffff0000, v68
    v_mul_f32 v68, v16, v72
    v_fma_f32 v69, -v68, v71, v16
    v_fma_f32 v16, v69, v72, v68
    v_mul_f32 v68, v17, v72
    v_fma_f32 v69, -v68, v71, v17
    v_fma_f32 v17, v69, v72, v68
    v_cvt_pk_bf16_f32 v48, v16, v17
    v_sub_f32 v18, v18, v70
    v_sub_f32 v19, v19, v70
    v_cvt_pk_bf16_f32 v68, v18, v19
    v_lshlrev_b32 v18, 16, v68
    v_and_b32 v19, 0xffff0000, v68
    v_mul_f32 v68, v18, v72
    v_fma_f32 v69, -v68, v71, v18
    v_fma_f32 v18, v69, v72, v68
    v_mul_f32 v68, v19, v72
    v_fma_f32 v69, -v68, v71, v19
    v_fma_f32 v19, v69, v72, v68
    v_cvt_pk_bf16_f32 v49, v18, v19
    v_sub_f32 v20, v20, v70
    v_sub_f32 v21, v21, v70
    v_cvt_pk_bf16_f32 v68, v20, v21
    v_lshlrev_b32 v20, 16, v68
    v_and_b32 v21, 0xffff0000, v68
    v_mul_f32 v68, v20, v72
    v_fma_f32 v69, -v68, v71, v20
    v_fma_f32 v20, v69, v72, v68
    v_mul_f32 v68, v21, v72
    v_fma_f32 v69, -v68, v71, v21
    v_fma_f32 v21, v69, v72, v68
    v_cvt_pk_bf16_f32 v50, v20, v21
    v_sub_f32 v22, v22, v70
    v_sub_f32 v23, v23, v70
    v_cvt_pk_bf16_f32 v68, v22, v23
    v_lshlrev_b32 v22, 16, v68
    v_and_b32 v23, 0xffff0000, v68
    v_mul_f32 v68, v22, v72
    v_fma_f32 v69, -v68, v71, v22
    v_fma_f32 v22, v69, v72, v68
    v_mul_f32 v68, v23, v72
    v_fma_f32 v69, -v68, v71, v23
    v_fma_f32 v23, v69, v72, v68
    v_cvt_pk_bf16_f32 v51, v22, v23
    v_sub_f32 v24, v24, v70
    v_sub_f32 v25, v25, v70
    v_cvt_pk_bf16_f32 v68, v24, v25
    v_lshlrev_b32 v24, 16, v68
    v_and_b32 v25, 0xffff0000, v68
    v_mul_f32 v68, v24, v72
    v_fma_f32 v69, -v68, v71, v24
    v_fma_f32 v24, v69, v72, v68
    v_mul_f32 v68, v25, v72
    v_fma_f32 v69, -v68, v71, v25
    v_fma_f32 v25, v69, v72, v68
    v_cvt_pk_bf16_f32 v52, v24, v25
    v_sub_f32 v26, v26, v70
    v_sub_f32 v27, v27, v70
    v_cvt_pk_bf16_f32 v68, v26, v27
    v_lshlrev_b32 v26, 16, v68
    v_and_b32 v27, 0xffff0000, v68
    v_mul_f32 v68, v26, v72
    v_fma_f32 v69, -v68, v71, v26
    v_fma_f32 v26, v69, v72, v68
    v_mul_f32 v68, v27, v72
    v_fma_f32 v69, -v68, v71, v27
    v_fma_f32 v27, v69, v72, v68
    v_cvt_pk_bf16_f32 v53, v26, v27
    v_sub_f32 v28, v28, v70
    v_sub_f32 v29, v29, v70
    v_cvt_pk_bf16_f32 v68, v28, v29
    v_lshlrev_b32 v28, 16, v68
    v_and_b32 v29, 0xffff0000, v68
    v_mul_f32 v68, v28, v72
    v_fma_f32 v69, -v68, v71, v28
    v_fma_f32 v28, v69, v72, v68
    v_mul_f32 v68, v29, v72
    v_fma_f32 v69, -v68, v71, v29
    v_fma_f32 v29, v69, v72, v68
    v_cvt_pk_bf16_f32 v54, v28, v29
    v_sub_f32 v30, v30, v70
    v_sub_f32 v31, v31, v70
    v_cvt_pk_bf16_f32 v68, v30, v31
    v_lshlrev_b32 v30, 16, v68
    v_and_b32 v31, 0xffff0000, v68
    v_mul_f32 v68, v30, v72
    v_fma_f32 v69, -v68, v71, v30
    v_fma_f32 v30, v69, v72, v68
    v_mul_f32 v68, v31, v72
    v_fma_f32 v69, -v68, v71, v31
    v_fma_f32 v31, v69, v72, v68
    v_cvt_pk_bf16_f32 v55, v30, v31
    v_sub_f32 v32, v32, v70
    v_sub_f32 v33, v33, v70
    v_cvt_pk_bf16_f32 v68, v32, v33
    v_lshlrev_b32 v32, 16, v68
    v_and_b32 v33, 0xffff0000, v68
    v_mul_f32 v68, v32, v72
    v_fma_f32 v69, -v68, v71, v32
    v_fma_f32 v32, v69, v72, v68
    v_mul_f32 v68, v33, v72
    v_fma_f32 v69, -v68, v71, v33
    v_fma_f32 v33, v69, v72, v68
    v_cvt_pk_bf16_f32 v56, v32, v33
    v_sub_f32 v34, v34, v70
    v_sub_f32 v35, v35, v70
    v_cvt_pk_bf16_f32 v68, v34, v35
    v_lshlrev_b32 v34, 16, v68
    v_and_b32 v35, 0xffff0000, v68
    v_mul_f32 v68, v34, v72
    v_fma_f32 v69, -v68, v71, v34
    v_fma_f32 v34, v69, v72, v68
    v_mul_f32 v68, v35, v72
    v_fma_f32 v69, -v68, v71, v35
    v_fma_f32 v35, v69, v72, v68
    v_cvt_pk_bf16_f32 v57, v34, v35
    v_sub_f32 v36, v36, v70
    v_sub_f32 v37, v37, v70
    v_cvt_pk_bf16_f32 v68, v36, v37
    v_lshlrev_b32 v36, 16, v68
    v_and_b32 v37, 0xffff0000, v68
    v_mul_f32 v68, v36, v72
    v_fma_f32 v69, -v68, v71, v36
    v_fma_f32 v36, v69, v72, v68
    v_mul_f32 v68, v37, v72
    v_fma_f32 v69, -v68, v71, v37
    v_fma_f32 v37, v69, v72, v68
    v_cvt_pk_bf16_f32 v58, v36, v37
    v_sub_f32 v38, v38, v70
    v_sub_f32 v39, v39, v70
    v_cvt_pk_bf16_f32 v68, v38, v39
    v_lshlrev_b32 v38, 16, v68
    v_and_b32 v39, 0xffff0000, v68
    v_mul_f32 v68, v38, v72
    v_fma_f32 v69, -v68, v71, v38
    v_fma_f32 v38, v69, v72, v68
    v_mul_f32 v68, v39, v72
    v_fma_f32 v69, -v68, v71, v39
    v_fma_f32 v39, v69, v72, v68
    v_cvt_pk_bf16_f32 v59, v38, v39
    v_sub_f32 v40, v40, v70
    v_sub_f32 v41, v41, v70
    v_cvt_pk_bf16_f32 v68, v40, v41
    v_lshlrev_b32 v40, 16, v68
    v_and_b32 v41, 0xffff0000, v68
    v_mul_f32 v68, v40, v72
    v_fma_f32 v69, -v68, v71, v40
    v_fma_f32 v40, v69, v72, v68
    v_mul_f32 v68, v41, v72
    v_fma_f32 v69, -v68, v71, v41
    v_fma_f32 v41, v69, v72, v68
    v_cvt_pk_bf16_f32 v60, v40, v41
    v_sub_f32 v42, v42, v70
    v_sub_f32 v43, v43, v70
    v_cvt_pk_bf16_f32 v68, v42, v43
    v_lshlrev_b32 v42, 16, v68
    v_and_b32 v43, 0xffff0000, v68
    v_mul_f32 v68, v42, v72
    v_fma_f32 v69, -v68, v71, v42
    v_fma_f32 v42, v69, v72, v68
    v_mul_f32 v68, v43, v72
    v_fma_f32 v69, -v68, v71, v43
    v_fma_f32 v43, v69, v72, v68
    v_cvt_pk_bf16_f32 v61, v42, v43
    v_sub_f32 v44, v44, v70
    v_sub_f32 v45, v45, v70
    v_cvt_pk_bf16_f32 v68, v44, v45
    v_lshlrev_b32 v44, 16, v68
    v_and_b32 v45, 0xffff0000, v68
    v_mul_f32 v68, v44, v72
    v_fma_f32 v69, -v68, v71, v44
    v_fma_f32 v44, v69, v72, v68
    v_mul_f32 v68, v45, v72
    v_fma_f32 v69, -v68, v71, v45
    v_fma_f32 v45, v69, v72, v68
    v_cvt_pk_bf16_f32 v62, v44, v45
    v_sub_f32 v46, v46, v70
    v_sub_f32 v47, v47, v70
    v_cvt_pk_bf16_f32 v68, v46, v47
    v_lshlrev_b32 v46, 16, v68
    v_and_b32 v47, 0xffff0000, v68
    v_mul_f32 v68, v46, v72
    v_fma_f32 v69, -v68, v71, v46
    v_fma_f32 v46, v69, v72, v68
    v_mul_f32 v68, v47, v72
    v_fma_f32 v69, -v68, v71, v47
    v_fma_f32 v47, v69, v72, v68
    v_cvt_pk_bf16_f32 v63, v46, v47
    s_lshl_b32 s41, s28, 12
    s_add_u32 s41, s41, s40
    v_lshlrev_b32 v65, 4, v0
    v_add_u32 v65, s41, v65
    global_store_dwordx4 v65, v[48:51], s[26:27] offset:0 sc1
    global_store_dwordx4 v65, v[52:55], s[26:27] offset:1024 sc1
    global_store_dwordx4 v65, v[56:59], s[26:27] offset:2048 sc1
    global_store_dwordx4 v65, v[60:63], s[26:27] offset:3072 sc1
    s_waitcnt vmcnt(0)
    s_barrier
    s_cmp_lg_u32 s28, 0
    s_cbranch_scc1 L_da_20
    v_mov_b32 v3, 160
    v_mov_b32 v4, 1
    s_mov_b64 exec, 1
    global_atomic_add v3, v4, s[24:25] sc1
    s_mov_b64 exec, -1
L_da_20:
L_noln:
    s_mov_b32 s48, s8
    s_and_b32 s49, s9, 0xffff
    s_mov_b32 s50, 0x400000
    s_mov_b32 s51, 0x20000
    s_mov_b32 s52, s10
    s_and_b32 s53, s11, 0xffff
    s_mov_b32 s54, 0x400000
    s_mov_b32 s55, 0x20000
    s_mov_b32 s56, s12
    s_and_b32 s57, s13, 0xffff
    s_mov_b32 s58, 0x400000
    s_mov_b32 s59, 0x20000
    s_lshl_b32 s40, s64, 8
    s_lshl_b32 s41, s28, 19
    s_add_u32 s40, s40, s41
    v_lshlrev_b32 v3, 13, v2
    v_lshl_add_u32 v3, v1, 4, v3
    v_add_u32 v3, s40, v3
    s_lshl_b32 s40, s28, 6
    v_lshlrev_b32 v4, 11, v2
    v_lshl_add_u32 v4, v1, 2, v4
    v_add_u32 v4, s40, v4
    v_add_u32 v5, 0x10000, v4
    s_lshl_b32 s40, s28, 14
    s_add_u32 m0, s40, 0x0
    s_mov_b32 s36, 0x0
    buffer_load_dwordx4 v3, s[52:55], s36 offen  lds
    s_add_u32 m0, m0, 1024
    s_add_u32 s36, s36, 32768
    buffer_load_dwordx4 v3, s[52:55], s36 offen  lds
    s_add_u32 m0, m0, 1024
    s_add_u32 s36, s36, 32768
    buffer_load_dwordx4 v3, s[52:55], s36 offen  lds
    s_add_u32 m0, m0, 1024
    s_add_u32 s36, s36, 32768
    buffer_load_dwordx4 v3, s[52:55], s36 offen  lds
    s_add_u32 m0, m0, 1024
    s_add_u32 s36, s36, 32768
    buffer_load_dwordx4 v3, s[52:55], s36 offen  lds
    s_add_u32 m0, m0, 1024
    s_add_u32 s36, s36, 32768
    buffer_load_dwordx4 v3, s[52:55], s36 offen  lds
    s_add_u32 m0, m0, 1024
    s_add_u32 s36, s36, 32768
    buffer_load_dwordx4 v3, s[52:55], s36 offen  lds
    s_add_u32 m0, m0, 1024
    s_add_u32 s36, s36, 32768
    buffer_load_dwordx4 v3, s[52:55], s36 offen  lds
    s_add_u32 m0, m0, 1024
    s_add_u32 s36, s36, 32768
    buffer_load_dwordx4 v3, s[52:55], s36 offen  lds
    s_add_u32 m0, m0, 1024
    s_add_u32 s36, s36, 32768
    buffer_load_dwordx4 v3, s[52:55], s36 offen  lds
    s_add_u32 m0, m0, 1024
    s_add_u32 s36, s36, 32768
    buffer_load_dwordx4 v3, s[52:55], s36 offen  lds
    s_add_u32 m0, m0, 1024
    s_add_u32 s36, s36, 32768
    buffer_load_dwordx4 v3, s[52:55], s36 offen  lds
    s_add_u32 m0, m0, 1024
    s_add_u32 s36, s36, 32768
    buffer_load_dwordx4 v3, s[52:55], s36 offen  lds
    s_add_u32 m0, m0, 1024
    s_add_u32 s36, s36, 32768
    buffer_load_dwordx4 v3, s[52:55], s36 offen  lds
    s_add_u32 m0, m0, 1024
    s_add_u32 s36, s36, 32768
    buffer_load_dwordx4 v3, s[52:55], s36 offen  lds
    s_add_u32 m0, m0, 1024
    s_add_u32 s36, s36, 32768
    buffer_load_dwordx4 v3, s[52:55], s36 offen  lds
    s_lshl_b32 s40, s28, 14
    s_add_u32 m0, s40, 0x10000
    s_mov_b32 s36, 0x200000
    buffer_load_dwordx4 v3, s[52:55], s36 offen  lds
    s_add_u32 m0, m0, 1024
    s_add_u32 s36, s36, 32768
    buffer_load_dwordx4 v3, s[52:55], s36 offen  lds
    s_add_u32 m0, m0, 1024
    s_add_u32 s36, s36, 32768
    buffer_load_dwordx4 v3, s[52:55], s36 offen  lds
    s_add_u32 m0, m0, 1024
    s_add_u32 s36, s36, 32768
    buffer_load_dwordx4 v3, s[52:55], s36 offen  lds
    s_add_u32 m0, m0, 1024
    s_add_u32 s36, s36, 32768
    buffer_load_dwordx4 v3, s[52:55], s36 offen  lds
    s_add_u32 m0, m0, 1024
    s_add_u32 s36, s36, 32768
    buffer_load_dwordx4 v3, s[52:55], s36 offen  lds
    s_add_u32 m0, m0, 1024
    s_add_u32 s36, s36, 32768
    buffer_load_dwordx4 v3, s[52:55], s36 offen  lds
    s_add_u32 m0, m0, 1024
    s_add_u32 s36, s36, 32768
    buffer_load_dwordx4 v3, s[52:55], s36 offen  lds
    s_add_u32 m0, m0, 1024
    s_add_u32 s36, s36, 32768
    buffer_load_dwordx4 v3, s[52:55], s36 offen  lds
    s_add_u32 m0, m0, 1024
    s_add_u32 s36, s36, 32768
    buffer_load_dwordx4 v3, s[52:55], s36 offen  lds
    s_add_u32 m0, m0, 1024
    s_add_u32 s36, s36, 32768
    buffer_load_dwordx4 v3, s[52:55], s36 offen  lds
    s_add_u32 m0, m0, 1024
    s_add_u32 s36, s36, 32768
    buffer_load_dwordx4 v3, s[52:55], s36 offen  lds
    s_add_u32 m0, m0, 1024
    s_add_u32 s36, s36, 32768
    buffer_load_dwordx4 v3, s[52:55], s36 offen  lds
    s_add_u32 m0, m0, 1024
    s_add_u32 s36, s36, 32768
    buffer_load_dwordx4 v3, s[52:55], s36 offen  lds
    s_add_u32 m0, m0, 1024
    s_add_u32 s36, s36, 32768
    buffer_load_dwordx4 v3, s[52:55], s36 offen  lds
    s_add_u32 m0, m0, 1024
    s_add_u32 s36, s36, 32768
    buffer_load_dwordx4 v3, s[52:55], s36 offen  lds
    s_waitcnt vmcnt(16)
    s_barrier
    ds_read2st64_b32 v[20:21], v4 offset0:0 offset1:1
    ds_read2st64_b32 v[22:23], v4 offset0:2 offset1:3
    ds_read2st64_b32 v[24:25], v4 offset0:4 offset1:5
    ds_read2st64_b32 v[26:27], v4 offset0:6 offset1:7
    ds_read2st64_b32 v[28:29], v4 offset0:32 offset1:33
    ds_read2st64_b32 v[30:31], v4 offset0:34 offset1:35
    ds_read2st64_b32 v[32:33], v4 offset0:36 offset1:37
    ds_read2st64_b32 v[34:35], v4 offset0:38 offset1:39
    ds_read2st64_b32 v[36:37], v4 offset0:64 offset1:65
    ds_read2st64_b32 v[38:39], v4 offset0:66 offset1:67
    ds_read2st64_b32 v[40:41], v4 offset0:68 offset1:69
    ds_read2st64_b32 v[42:43], v4 offset0:70 offset1:71
    s_waitcnt lgkmcnt(11)
    v_perm_b32 v16, v21, v20, s37
    v_accvgpr_write_b32 a128, v16
    v_perm_b32 v17, v21, v20, s38
    v_accvgpr_write_b32 a192, v17
    ds_read2st64_b32 v[20:21], v4 offset0:96 offset1:97
    s_waitcnt lgkmcnt(11)
    v_perm_b32 v16, v23, v22, s37
    v_accvgpr_write_b32 a129, v16
    v_perm_b32 v17, v23, v22, s38
    v_accvgpr_write_b32 a193, v17
    ds_read2st64_b32 v[22:23], v4 offset0:98 offset1:99
    s_waitcnt lgkmcnt(11)
    v_perm_b32 v16, v25, v24, s37
    v_accvgpr_write_b32 a130, v16
    v_perm_b32 v17, v25, v24, s38
    v_accvgpr_write_b32 a194, v17
    ds_read2st64_b32 v[24:25], v4 offset0:100 offset1:101
    s_waitcnt lgkmcnt(11)
    v_perm_b32 v16, v27, v26, s37
    v_accvgpr_write_b32 a131, v16
    v_perm_b32 v17, v27, v26, s38
    v_accvgpr_write_b32 a195, v17
    ds_read2st64_b32 v[26:27], v4 offset0:102 offset1:103
    s_waitcnt lgkmcnt(11)
    v_perm_b32 v16, v29, v28, s37
    v_accvgpr_write_b32 a132, v16
    v_perm_b32 v17, v29, v28, s38
    v_accvgpr_write_b32 a196, v17
    ds_read2st64_b32 v[28:29], v4 offset0:128 offset1:129
    s_waitcnt lgkmcnt(11)
    v_perm_b32 v16, v31, v30, s37
    v_accvgpr_write_b32 a133, v16
    v_perm_b32 v17, v31, v30, s38
    v_accvgpr_write_b32 a197, v17
    ds_read2st64_b32 v[30:31], v4 offset0:130 offset1:131
    s_waitcnt lgkmcnt(11)
    v_perm_b32 v16, v33, v32, s37
    v_accvgpr_write_b32 a134, v16
    v_perm_b32 v17, v33, v32, s38
    v_accvgpr_write_b32 a198, v17
    ds_read2st64_b32 v[32:33], v4 offset0:132 offset1:133
    s_waitcnt lgkmcnt(11)
    v_perm_b32 v16, v35, v34, s37
    v_accvgpr_write_b32 a135, v16
    v_perm_b32 v17, v35, v34, s38
    v_accvgpr_write_b32 a199, v17
    ds_read2st64_b32 v[34:35], v4 offset0:134 offset1:135
    s_waitcnt lgkmcnt(11)
    v_perm_b32 v16, v37, v36, s37
    v_accvgpr_write_b32 a136, v16
    v_perm_b32 v17, v37, v36, s38
    v_accvgpr_write_b32 a200, v17
    ds_read2st64_b32 v[36:37], v4 offset0:160 offset1:161
    s_waitcnt lgkmcnt(11)
    v_perm_b32 v16, v39, v38, s37
    v_accvgpr_write_b32 a137, v16
    v_perm_b32 v17, v39, v38, s38
    v_accvgpr_write_b32 a201, v17
    ds_read2st64_b32 v[38:39], v4 offset0:162 offset1:163
    s_waitcnt lgkmcnt(11)
    v_perm_b32 v16, v41, v40, s37
    v_accvgpr_write_b32 a138, v16
    v_perm_b32 v17, v41, v40, s38
    v_accvgpr_write_b32 a202, v17
    ds_read2st64_b32 v[40:41], v4 offset0:164 offset1:165
    s_waitcnt lgkmcnt(11)
    v_perm_b32 v16, v43, v42, s37
    v_accvgpr_write_b32 a139, v16
    v_perm_b32 v17, v43, v42, s38
    v_accvgpr_write_b32 a203, v17
    ds_read2st64_b32 v[42:43], v4 offset0:166 offset1:167
    s_waitcnt lgkmcnt(11)
    v_perm_b32 v16, v21, v20, s37
    v_accvgpr_write_b32 a140, v16
    v_perm_b32 v17, v21, v20, s38
    v_accvgpr_write_b32 a204, v17
    ds_read2st64_b32 v[20:21], v4 offset0:192 offset1:193
    s_waitcnt lgkmcnt(11)
    v_perm_b32 v16, v23, v22, s37
    v_accvgpr_write_b32 a141, v16
    v_perm_b32 v17, v23, v22, s38
    v_accvgpr_write_b32 a205, v17
    ds_read2st64_b32 v[22:23], v4 offset0:194 offset1:195
    s_waitcnt lgkmcnt(11)
    v_perm_b32 v16, v25, v24, s37
    v_accvgpr_write_b32 a142, v16
    v_perm_b32 v17, v25, v24, s38
    v_accvgpr_write_b32 a206, v17
    ds_read2st64_b32 v[24:25], v4 offset0:196 offset1:197
    s_waitcnt lgkmcnt(11)
    v_perm_b32 v16, v27, v26, s37
    v_accvgpr_write_b32 a143, v16
    v_perm_b32 v17, v27, v26, s38
    v_accvgpr_write_b32 a207, v17
    ds_read2st64_b32 v[26:27], v4 offset0:198 offset1:199
    s_waitcnt lgkmcnt(11)
    v_perm_b32 v16, v29, v28, s37
    v_accvgpr_write_b32 a144, v16
    v_perm_b32 v17, v29, v28, s38
    v_accvgpr_write_b32 a208, v17
    ds_read2st64_b32 v[28:29], v4 offset0:224 offset1:225
    s_waitcnt lgkmcnt(11)
    v_perm_b32 v16, v31, v30, s37
    v_accvgpr_write_b32 a145, v16
    v_perm_b32 v17, v31, v30, s38
    v_accvgpr_write_b32 a209, v17
    ds_read2st64_b32 v[30:31], v4 offset0:226 offset1:227
    s_waitcnt lgkmcnt(11)
    v_perm_b32 v16, v33, v32, s37
    v_accvgpr_write_b32 a146, v16
    v_perm_b32 v17, v33, v32, s38
    v_accvgpr_write_b32 a210, v17
    ds_read2st64_b32 v[32:33], v4 offset0:228 offset1:229
    s_waitcnt lgkmcnt(11)
    v_perm_b32 v16, v35, v34, s37
    v_accvgpr_write_b32 a147, v16
    v_perm_b32 v17, v35, v34, s38
    v_accvgpr_write_b32 a211, v17
    ds_read2st64_b32 v[34:35], v4 offset0:230 offset1:231
    s_waitcnt lgkmcnt(11)
    v_perm_b32 v16, v37, v36, s37
    v_accvgpr_write_b32 a148, v16
    v_perm_b32 v17, v37, v36, s38
    v_accvgpr_write_b32 a212, v17
    s_waitcnt lgkmcnt(10)
    v_perm_b32 v16, v39, v38, s37
    v_accvgpr_write_b32 a149, v16
    v_perm_b32 v17, v39, v38, s38
    v_accvgpr_write_b32 a213, v17
    s_waitcnt lgkmcnt(9)
    v_perm_b32 v16, v41, v40, s37
    v_accvgpr_write_b32 a150, v16
    v_perm_b32 v17, v41, v40, s38
    v_accvgpr_write_b32 a214, v17
    s_waitcnt lgkmcnt(8)
    v_perm_b32 v16, v43, v42, s37
    v_accvgpr_write_b32 a151, v16
    v_perm_b32 v17, v43, v42, s38
    v_accvgpr_write_b32 a215, v17
    s_waitcnt lgkmcnt(7)
    v_perm_b32 v16, v21, v20, s37
    v_accvgpr_write_b32 a152, v16
    v_perm_b32 v17, v21, v20, s38
    v_accvgpr_write_b32 a216, v17
    s_waitcnt lgkmcnt(6)
    v_perm_b32 v16, v23, v22, s37
    v_accvgpr_write_b32 a153, v16
    v_perm_b32 v17, v23, v22, s38
    v_accvgpr_write_b32 a217, v17
    s_waitcnt lgkmcnt(5)
    v_perm_b32 v16, v25, v24, s37
    v_accvgpr_write_b32 a154, v16
    v_perm_b32 v17, v25, v24, s38
    v_accvgpr_write_b32 a218, v17
    s_waitcnt lgkmcnt(4)
    v_perm_b32 v16, v27, v26, s37
    v_accvgpr_write_b32 a155, v16
    v_perm_b32 v17, v27, v26, s38
    v_accvgpr_write_b32 a219, v17
    s_waitcnt lgkmcnt(3)
    v_perm_b32 v16, v29, v28, s37
    v_accvgpr_write_b32 a156, v16
    v_perm_b32 v17, v29, v28, s38
    v_accvgpr_write_b32 a220, v17
    s_waitcnt lgkmcnt(2)
    v_perm_b32 v16, v31, v30, s37
    v_accvgpr_write_b32 a157, v16
    v_perm_b32 v17, v31, v30, s38
    v_accvgpr_write_b32 a221, v17
    s_waitcnt lgkmcnt(1)
    v_perm_b32 v16, v33, v32, s37
    v_accvgpr_write_b32 a158, v16
    v_perm_b32 v17, v33, v32, s38
    v_accvgpr_write_b32 a222, v17
    s_waitcnt lgkmcnt(0)
    v_perm_b32 v16, v35, v34, s37
    v_accvgpr_write_b32 a159, v16
    v_perm_b32 v17, v35, v34, s38
    v_accvgpr_write_b32 a223, v17
    s_barrier
    s_lshl_b32 s40, s28, 14
    s_add_u32 m0, s40, 0x0
    s_mov_b32 s36, 0x0
    buffer_load_dwordx4 v3, s[56:59], s36 offen  lds
    s_add_u32 m0, m0, 1024
    s_add_u32 s36, s36, 32768
    buffer_load_dwordx4 v3, s[56:59], s36 offen  lds
    s_add_u32 m0, m0, 1024
    s_add_u32 s36, s36, 32768
    buffer_load_dwordx4 v3, s[56:59], s36 offen  lds
    s_add_u32 m0, m0, 1024
    s_add_u32 s36, s36, 32768
    buffer_load_dwordx4 v3, s[56:59], s36 offen  lds
    s_add_u32 m0, m0, 1024
    s_add_u32 s36, s36, 32768
    buffer_load_dwordx4 v3, s[56:59], s36 offen  lds
    s_add_u32 m0, m0, 1024
    s_add_u32 s36, s36, 32768
    buffer_load_dwordx4 v3, s[56:59], s36 offen  lds
    s_add_u32 m0, m0, 1024
    s_add_u32 s36, s36, 32768
    buffer_load_dwordx4 v3, s[56:59], s36 offen  lds
    s_add_u32 m0, m0, 1024
    s_add_u32 s36, s36, 32768
    buffer_load_dwordx4 v3, s[56:59], s36 offen  lds
    s_add_u32 m0, m0, 1024
    s_add_u32 s36, s36, 32768
    buffer_load_dwordx4 v3, s[56:59], s36 offen  lds
    s_add_u32 m0, m0, 1024
    s_add_u32 s36, s36, 32768
    buffer_load_dwordx4 v3, s[56:59], s36 offen  lds
    s_add_u32 m0, m0, 1024
    s_add_u32 s36, s36, 32768
    buffer_load_dwordx4 v3, s[56:59], s36 offen  lds
    s_add_u32 m0, m0, 1024
    s_add_u32 s36, s36, 32768
    buffer_load_dwordx4 v3, s[56:59], s36 offen  lds
    s_add_u32 m0, m0, 1024
    s_add_u32 s36, s36, 32768
    buffer_load_dwordx4 v3, s[56:59], s36 offen  lds
    s_add_u32 m0, m0, 1024
    s_add_u32 s36, s36, 32768
    buffer_load_dwordx4 v3, s[56:59], s36 offen  lds
    s_add_u32 m0, m0, 1024
    s_add_u32 s36, s36, 32768
    buffer_load_dwordx4 v3, s[56:59], s36 offen  lds
    s_add_u32 m0, m0, 1024
    s_add_u32 s36, s36, 32768
    buffer_load_dwordx4 v3, s[56:59], s36 offen  lds
    s_waitcnt vmcnt(16)
    s_barrier
    ds_read2st64_b32 v[20:21], v5 offset0:0 offset1:1
    ds_read2st64_b32 v[22:23], v5 offset0:2 offset1:3
    ds_read2st64_b32 v[24:25], v5 offset0:4 offset1:5
    ds_read2st64_b32 v[26:27], v5 offset0:6 offset1:7
    ds_read2st64_b32 v[28:29], v5 offset0:32 offset1:33
    ds_read2st64_b32 v[30:31], v5 offset0:34 offset1:35
    ds_read2st64_b32 v[32:33], v5 offset0:36 offset1:37
    ds_read2st64_b32 v[34:35], v5 offset0:38 offset1:39
    ds_read2st64_b32 v[36:37], v5 offset0:64 offset1:65
    ds_read2st64_b32 v[38:39], v5 offset0:66 offset1:67
    ds_read2st64_b32 v[40:41], v5 offset0:68 offset1:69
    ds_read2st64_b32 v[42:43], v5 offset0:70 offset1:71
    s_waitcnt lgkmcnt(11)
    v_perm_b32 v16, v21, v20, s37
    v_accvgpr_write_b32 a160, v16
    v_perm_b32 v17, v21, v20, s38
    v_accvgpr_write_b32 a224, v17
    ds_read2st64_b32 v[20:21], v5 offset0:96 offset1:97
    s_waitcnt lgkmcnt(11)
    v_perm_b32 v16, v23, v22, s37
    v_accvgpr_write_b32 a161, v16
    v_perm_b32 v17, v23, v22, s38
    v_accvgpr_write_b32 a225, v17
    ds_read2st64_b32 v[22:23], v5 offset0:98 offset1:99
    s_waitcnt lgkmcnt(11)
    v_perm_b32 v16, v25, v24, s37
    v_accvgpr_write_b32 a162, v16
    v_perm_b32 v17, v25, v24, s38
    v_accvgpr_write_b32 a226, v17
    ds_read2st64_b32 v[24:25], v5 offset0:100 offset1:101
    s_waitcnt lgkmcnt(11)
    v_perm_b32 v16, v27, v26, s37
    v_accvgpr_write_b32 a163, v16
    v_perm_b32 v17, v27, v26, s38
    v_accvgpr_write_b32 a227, v17
    ds_read2st64_b32 v[26:27], v5 offset0:102 offset1:103
    s_waitcnt lgkmcnt(11)
    v_perm_b32 v16, v29, v28, s37
    v_accvgpr_write_b32 a164, v16
    v_perm_b32 v17, v29, v28, s38
    v_accvgpr_write_b32 a228, v17
    ds_read2st64_b32 v[28:29], v5 offset0:128 offset1:129
    s_waitcnt lgkmcnt(11)
    v_perm_b32 v16, v31, v30, s37
    v_accvgpr_write_b32 a165, v16
    v_perm_b32 v17, v31, v30, s38
    v_accvgpr_write_b32 a229, v17
    ds_read2st64_b32 v[30:31], v5 offset0:130 offset1:131
    s_waitcnt lgkmcnt(11)
    v_perm_b32 v16, v33, v32, s37
    v_accvgpr_write_b32 a166, v16
    v_perm_b32 v17, v33, v32, s38
    v_accvgpr_write_b32 a230, v17
    ds_read2st64_b32 v[32:33], v5 offset0:132 offset1:133
    s_waitcnt lgkmcnt(11)
    v_perm_b32 v16, v35, v34, s37
    v_accvgpr_write_b32 a167, v16
    v_perm_b32 v17, v35, v34, s38
    v_accvgpr_write_b32 a231, v17
    ds_read2st64_b32 v[34:35], v5 offset0:134 offset1:135
    s_waitcnt lgkmcnt(11)
    v_perm_b32 v16, v37, v36, s37
    v_accvgpr_write_b32 a168, v16
    v_perm_b32 v17, v37, v36, s38
    v_accvgpr_write_b32 a232, v17
    ds_read2st64_b32 v[36:37], v5 offset0:160 offset1:161
    s_waitcnt lgkmcnt(11)
    v_perm_b32 v16, v39, v38, s37
    v_accvgpr_write_b32 a169, v16
    v_perm_b32 v17, v39, v38, s38
    v_accvgpr_write_b32 a233, v17
    ds_read2st64_b32 v[38:39], v5 offset0:162 offset1:163
    s_waitcnt lgkmcnt(11)
    v_perm_b32 v16, v41, v40, s37
    v_accvgpr_write_b32 a170, v16
    v_perm_b32 v17, v41, v40, s38
    v_accvgpr_write_b32 a234, v17
    ds_read2st64_b32 v[40:41], v5 offset0:164 offset1:165
    s_waitcnt lgkmcnt(11)
    v_perm_b32 v16, v43, v42, s37
    v_accvgpr_write_b32 a171, v16
    v_perm_b32 v17, v43, v42, s38
    v_accvgpr_write_b32 a235, v17
    ds_read2st64_b32 v[42:43], v5 offset0:166 offset1:167
    s_waitcnt lgkmcnt(11)
    v_perm_b32 v16, v21, v20, s37
    v_accvgpr_write_b32 a172, v16
    v_perm_b32 v17, v21, v20, s38
    v_accvgpr_write_b32 a236, v17
    ds_read2st64_b32 v[20:21], v5 offset0:192 offset1:193
    s_waitcnt lgkmcnt(11)
    v_perm_b32 v16, v23, v22, s37
    v_accvgpr_write_b32 a173, v16
    v_perm_b32 v17, v23, v22, s38
    v_accvgpr_write_b32 a237, v17
    ds_read2st64_b32 v[22:23], v5 offset0:194 offset1:195
    s_waitcnt lgkmcnt(11)
    v_perm_b32 v16, v25, v24, s37
    v_accvgpr_write_b32 a174, v16
    v_perm_b32 v17, v25, v24, s38
    v_accvgpr_write_b32 a238, v17
    ds_read2st64_b32 v[24:25], v5 offset0:196 offset1:197
    s_waitcnt lgkmcnt(11)
    v_perm_b32 v16, v27, v26, s37
    v_accvgpr_write_b32 a175, v16
    v_perm_b32 v17, v27, v26, s38
    v_accvgpr_write_b32 a239, v17
    ds_read2st64_b32 v[26:27], v5 offset0:198 offset1:199
    s_waitcnt lgkmcnt(11)
    v_perm_b32 v16, v29, v28, s37
    v_accvgpr_write_b32 a176, v16
    v_perm_b32 v17, v29, v28, s38
    v_accvgpr_write_b32 a240, v17
    ds_read2st64_b32 v[28:29], v5 offset0:224 offset1:225
    s_waitcnt lgkmcnt(11)
    v_perm_b32 v16, v31, v30, s37
    v_accvgpr_write_b32 a177, v16
    v_perm_b32 v17, v31, v30, s38
    v_accvgpr_write_b32 a241, v17
    ds_read2st64_b32 v[30:31], v5 offset0:226 offset1:227
    s_waitcnt lgkmcnt(11)
    v_perm_b32 v16, v33, v32, s37
    v_accvgpr_write_b32 a178, v16
    v_perm_b32 v17, v33, v32, s38
    v_accvgpr_write_b32 a242, v17
    ds_read2st64_b32 v[32:33], v5 offset0:228 offset1:229
    s_waitcnt lgkmcnt(11)
    v_perm_b32 v16, v35, v34, s37
    v_accvgpr_write_b32 a179, v16
    v_perm_b32 v17, v35, v34, s38
    v_accvgpr_write_b32 a243, v17
    ds_read2st64_b32 v[34:35], v5 offset0:230 offset1:231
    s_waitcnt lgkmcnt(11)
    v_perm_b32 v16, v37, v36, s37
    v_accvgpr_write_b32 a180, v16
    v_perm_b32 v17, v37, v36, s38
    v_accvgpr_write_b32 a244, v17
    s_waitcnt lgkmcnt(10)
    v_perm_b32 v16, v39, v38, s37
    v_accvgpr_write_b32 a181, v16
    v_perm_b32 v17, v39, v38, s38
    v_accvgpr_write_b32 a245, v17
    s_waitcnt lgkmcnt(9)
    v_perm_b32 v16, v41, v40, s37
    v_accvgpr_write_b32 a182, v16
    v_perm_b32 v17, v41, v40, s38
    v_accvgpr_write_b32 a246, v17
    s_waitcnt lgkmcnt(8)
    v_perm_b32 v16, v43, v42, s37
    v_accvgpr_write_b32 a183, v16
    v_perm_b32 v17, v43, v42, s38
    v_accvgpr_write_b32 a247, v17
    s_waitcnt lgkmcnt(7)
    v_perm_b32 v16, v21, v20, s37
    v_accvgpr_write_b32 a184, v16
    v_perm_b32 v17, v21, v20, s38
    v_accvgpr_write_b32 a248, v17
    s_waitcnt lgkmcnt(6)
    v_perm_b32 v16, v23, v22, s37
    v_accvgpr_write_b32 a185, v16
    v_perm_b32 v17, v23, v22, s38
    v_accvgpr_write_b32 a249, v17
    s_waitcnt lgkmcnt(5)
    v_perm_b32 v16, v25, v24, s37
    v_accvgpr_write_b32 a186, v16
    v_perm_b32 v17, v25, v24, s38
    v_accvgpr_write_b32 a250, v17
    s_waitcnt lgkmcnt(4)
    v_perm_b32 v16, v27, v26, s37
    v_accvgpr_write_b32 a187, v16
    v_perm_b32 v17, v27, v26, s38
    v_accvgpr_write_b32 a251, v17
    s_waitcnt lgkmcnt(3)
    v_perm_b32 v16, v29, v28, s37
    v_accvgpr_write_b32 a188, v16
    v_perm_b32 v17, v29, v28, s38
    v_accvgpr_write_b32 a252, v17
    s_waitcnt lgkmcnt(2)
    v_perm_b32 v16, v31, v30, s37
    v_accvgpr_write_b32 a189, v16
    v_perm_b32 v17, v31, v30, s38
    v_accvgpr_write_b32 a253, v17
    s_waitcnt lgkmcnt(1)
    v_perm_b32 v16, v33, v32, s37
    v_accvgpr_write_b32 a190, v16
    v_perm_b32 v17, v33, v32, s38
    v_accvgpr_write_b32 a254, v17
    s_waitcnt lgkmcnt(0)
    v_perm_b32 v16, v35, v34, s37
    v_accvgpr_write_b32 a191, v16
    v_perm_b32 v17, v35, v34, s38
    v_accvgpr_write_b32 a255, v17
    s_barrier
    s_lshl_b32 s40, s28, 14
    s_add_u32 m0, s40, 0x10000
    s_mov_b32 s36, 0x200000
    buffer_load_dwordx4 v3, s[56:59], s36 offen  lds
    s_add_u32 m0, m0, 1024
    s_add_u32 s36, s36, 32768
    buffer_load_dwordx4 v3, s[56:59], s36 offen  lds
    s_add_u32 m0, m0, 1024
    s_add_u32 s36, s36, 32768
    buffer_load_dwordx4 v3, s[56:59], s36 offen  lds
    s_add_u32 m0, m0, 1024
    s_add_u32 s36, s36, 32768
    buffer_load_dwordx4 v3, s[56:59], s36 offen  lds
    s_add_u32 m0, m0, 1024
    s_add_u32 s36, s36, 32768
    buffer_load_dwordx4 v3, s[56:59], s36 offen  lds
    s_add_u32 m0, m0, 1024
    s_add_u32 s36, s36, 32768
    buffer_load_dwordx4 v3, s[56:59], s36 offen  lds
    s_add_u32 m0, m0, 1024
    s_add_u32 s36, s36, 32768
    buffer_load_dwordx4 v3, s[56:59], s36 offen  lds
    s_add_u32 m0, m0, 1024
    s_add_u32 s36, s36, 32768
    buffer_load_dwordx4 v3, s[56:59], s36 offen  lds
    s_add_u32 m0, m0, 1024
    s_add_u32 s36, s36, 32768
    buffer_load_dwordx4 v3, s[56:59], s36 offen  lds
    s_add_u32 m0, m0, 1024
    s_add_u32 s36, s36, 32768
    buffer_load_dwordx4 v3, s[56:59], s36 offen  lds
    s_add_u32 m0, m0, 1024
    s_add_u32 s36, s36, 32768
    buffer_load_dwordx4 v3, s[56:59], s36 offen  lds
    s_add_u32 m0, m0, 1024
    s_add_u32 s36, s36, 32768
    buffer_load_dwordx4 v3, s[56:59], s36 offen  lds
    s_add_u32 m0, m0, 1024
    s_add_u32 s36, s36, 32768
    buffer_load_dwordx4 v3, s[56:59], s36 offen  lds
    s_add_u32 m0, m0, 1024
    s_add_u32 s36, s36, 32768
    buffer_load_dwordx4 v3, s[56:59], s36 offen  lds
    s_add_u32 m0, m0, 1024
    s_add_u32 s36, s36, 32768
    buffer_load_dwordx4 v3, s[56:59], s36 offen  lds
    s_add_u32 m0, m0, 1024
    s_add_u32 s36, s36, 32768
    buffer_load_dwordx4 v3, s[56:59], s36 offen  lds
    s_waitcnt vmcnt(16)
    s_barrier
    ds_read2st64_b32 v[20:21], v4 offset0:0 offset1:1
    ds_read2st64_b32 v[22:23], v4 offset0:2 offset1:3
    ds_read2st64_b32 v[24:25], v4 offset0:4 offset1:5
    ds_read2st64_b32 v[26:27], v4 offset0:6 offset1:7
    ds_read2st64_b32 v[28:29], v4 offset0:32 offset1:33
    ds_read2st64_b32 v[30:31], v4 offset0:34 offset1:35
    ds_read2st64_b32 v[32:33], v4 offset0:36 offset1:37
    ds_read2st64_b32 v[34:35], v4 offset0:38 offset1:39
    ds_read2st64_b32 v[36:37], v4 offset0:64 offset1:65
    ds_read2st64_b32 v[38:39], v4 offset0:66 offset1:67
    ds_read2st64_b32 v[40:41], v4 offset0:68 offset1:69
    ds_read2st64_b32 v[42:43], v4 offset0:70 offset1:71
    s_waitcnt lgkmcnt(11)
    v_perm_b32 v128, v21, v20, s37
    v_perm_b32 v192, v21, v20, s38
    ds_read2st64_b32 v[20:21], v4 offset0:96 offset1:97
    s_waitcnt lgkmcnt(11)
    v_perm_b32 v129, v23, v22, s37
    v_perm_b32 v193, v23, v22, s38
    ds_read2st64_b32 v[22:23], v4 offset0:98 offset1:99
    s_waitcnt lgkmcnt(11)
    v_perm_b32 v130, v25, v24, s37
    v_perm_b32 v194, v25, v24, s38
    ds_read2st64_b32 v[24:25], v4 offset0:100 offset1:101
    s_waitcnt lgkmcnt(11)
    v_perm_b32 v131, v27, v26, s37
    v_perm_b32 v195, v27, v26, s38
    ds_read2st64_b32 v[26:27], v4 offset0:102 offset1:103
    s_waitcnt lgkmcnt(11)
    v_perm_b32 v132, v29, v28, s37
    v_perm_b32 v196, v29, v28, s38
    ds_read2st64_b32 v[28:29], v4 offset0:128 offset1:129
    s_waitcnt lgkmcnt(11)
    v_perm_b32 v133, v31, v30, s37
    v_perm_b32 v197, v31, v30, s38
    ds_read2st64_b32 v[30:31], v4 offset0:130 offset1:131
    s_waitcnt lgkmcnt(11)
    v_perm_b32 v134, v33, v32, s37
    v_perm_b32 v198, v33, v32, s38
    ds_read2st64_b32 v[32:33], v4 offset0:132 offset1:133
    s_waitcnt lgkmcnt(11)
    v_perm_b32 v135, v35, v34, s37
    v_perm_b32 v199, v35, v34, s38
    ds_read2st64_b32 v[34:35], v4 offset0:134 offset1:135
    s_waitcnt lgkmcnt(11)
    v_perm_b32 v136, v37, v36, s37
    v_perm_b32 v200, v37, v36, s38
    ds_read2st64_b32 v[36:37], v4 offset0:160 offset1:161
    s_waitcnt lgkmcnt(11)
    v_perm_b32 v137, v39, v38, s37
    v_perm_b32 v201, v39, v38, s38
    ds_read2st64_b32 v[38:39], v4 offset0:162 offset1:163
    s_waitcnt lgkmcnt(11)
    v_perm_b32 v138, v41, v40, s37
    v_perm_b32 v202, v41, v40, s38
    ds_read2st64_b32 v[40:41], v4 offset0:164 offset1:165
    s_waitcnt lgkmcnt(11)
    v_perm_b32 v139, v43, v42, s37
    v_perm_b32 v203, v43, v42, s38
    ds_read2st64_b32 v[42:43], v4 offset0:166 offset1:167
    s_waitcnt lgkmcnt(11)
    v_perm_b32 v140, v21, v20, s37
    v_perm_b32 v204, v21, v20, s38
    ds_read2st64_b32 v[20:21], v4 offset0:192 offset1:193
    s_waitcnt lgkmcnt(11)
    v_perm_b32 v141, v23, v22, s37
    v_perm_b32 v205, v23, v22, s38
    ds_read2st64_b32 v[22:23], v4 offset0:194 offset1:195
    s_waitcnt lgkmcnt(11)
    v_perm_b32 v142, v25, v24, s37
    v_perm_b32 v206, v25, v24, s38
    ds_read2st64_b32 v[24:25], v4 offset0:196 offset1:197
    s_waitcnt lgkmcnt(11)
    v_perm_b32 v143, v27, v26, s37
    v_perm_b32 v207, v27, v26, s38
    ds_read2st64_b32 v[26:27], v4 offset0:198 offset1:199
    s_waitcnt lgkmcnt(11)
    v_perm_b32 v144, v29, v28, s37
    v_perm_b32 v208, v29, v28, s38
    ds_read2st64_b32 v[28:29], v4 offset0:224 offset1:225
    s_waitcnt lgkmcnt(11)
    v_perm_b32 v145, v31, v30, s37
    v_perm_b32 v209, v31, v30, s38
    ds_read2st64_b32 v[30:31], v4 offset0:226 offset1:227
    s_waitcnt lgkmcnt(11)
    v_perm_b32 v146, v33, v32, s37
    v_perm_b32 v210, v33, v32, s38
    ds_read2st64_b32 v[32:33], v4 offset0:228 offset1:229
    s_waitcnt lgkmcnt(11)
    v_perm_b32 v147, v35, v34, s37
    v_perm_b32 v211, v35, v34, s38
    ds_read2st64_b32 v[34:35], v4 offset0:230 offset1:231
    s_waitcnt lgkmcnt(11)
    v_perm_b32 v148, v37, v36, s37
    v_perm_b32 v212, v37, v36, s38
    s_waitcnt lgkmcnt(10)
    v_perm_b32 v149, v39, v38, s37
    v_perm_b32 v213, v39, v38, s38
    s_waitcnt lgkmcnt(9)
    v_perm_b32 v150, v41, v40, s37
    v_perm_b32 v214, v41, v40, s38
    s_waitcnt lgkmcnt(8)
    v_perm_b32 v151, v43, v42, s37
    v_perm_b32 v215, v43, v42, s38
    s_waitcnt lgkmcnt(7)
    v_perm_b32 v152, v21, v20, s37
    v_perm_b32 v216, v21, v20, s38
    s_waitcnt lgkmcnt(6)
    v_perm_b32 v153, v23, v22, s37
    v_perm_b32 v217, v23, v22, s38
    s_waitcnt lgkmcnt(5)
    v_perm_b32 v154, v25, v24, s37
    v_perm_b32 v218, v25, v24, s38
    s_waitcnt lgkmcnt(4)
    v_perm_b32 v155, v27, v26, s37
    v_perm_b32 v219, v27, v26, s38
    s_waitcnt lgkmcnt(3)
    v_perm_b32 v156, v29, v28, s37
    v_perm_b32 v220, v29, v28, s38
    s_waitcnt lgkmcnt(2)
    v_perm_b32 v157, v31, v30, s37
    v_perm_b32 v221, v31, v30, s38
    s_waitcnt lgkmcnt(1)
    v_perm_b32 v158, v33, v32, s37
    v_perm_b32 v222, v33, v32, s38
    s_waitcnt lgkmcnt(0)
    v_perm_b32 v159, v35, v34, s37
    v_perm_b32 v223, v35, v34, s38
    s_barrier
    s_lshl_b32 s40, s28, 14
    s_add_u32 m0, s40, 0x0
    s_mov_b32 s36, 0x0
    buffer_load_dwordx4 v3, s[48:51], s36 offen  lds
    s_add_u32 m0, m0, 1024
    s_add_u32 s36, s36, 32768
    buffer_load_dwordx4 v3, s[48:51], s36 offen  lds
    s_add_u32 m0, m0, 1024
    s_add_u32 s36, s36, 32768
    buffer_load_dwordx4 v3, s[48:51], s36 offen  lds
    s_add_u32 m0, m0, 1024
    s_add_u32 s36, s36, 32768
    buffer_load_dwordx4 v3, s[48:51], s36 offen  lds
    s_add_u32 m0, m0, 1024
    s_add_u32 s36, s36, 32768
    buffer_load_dwordx4 v3, s[48:51], s36 offen  lds
    s_add_u32 m0, m0, 1024
    s_add_u32 s36, s36, 32768
    buffer_load_dwordx4 v3, s[48:51], s36 offen  lds
    s_add_u32 m0, m0, 1024
    s_add_u32 s36, s36, 32768
    buffer_load_dwordx4 v3, s[48:51], s36 offen  lds
    s_add_u32 m0, m0, 1024
    s_add_u32 s36, s36, 32768
    buffer_load_dwordx4 v3, s[48:51], s36 offen  lds
    s_add_u32 m0, m0, 1024
    s_add_u32 s36, s36, 32768
    buffer_load_dwordx4 v3, s[48:51], s36 offen  lds
    s_add_u32 m0, m0, 1024
    s_add_u32 s36, s36, 32768
    buffer_load_dwordx4 v3, s[48:51], s36 offen  lds
    s_add_u32 m0, m0, 1024
    s_add_u32 s36, s36, 32768
    buffer_load_dwordx4 v3, s[48:51], s36 offen  lds
    s_add_u32 m0, m0, 1024
    s_add_u32 s36, s36, 32768
    buffer_load_dwordx4 v3, s[48:51], s36 offen  lds
    s_add_u32 m0, m0, 1024
    s_add_u32 s36, s36, 32768
    buffer_load_dwordx4 v3, s[48:51], s36 offen  lds
    s_add_u32 m0, m0, 1024
    s_add_u32 s36, s36, 32768
    buffer_load_dwordx4 v3, s[48:51], s36 offen  lds
    s_add_u32 m0, m0, 1024
    s_add_u32 s36, s36, 32768
    buffer_load_dwordx4 v3, s[48:51], s36 offen  lds
    s_add_u32 m0, m0, 1024
    s_add_u32 s36, s36, 32768
    buffer_load_dwordx4 v3, s[48:51], s36 offen  lds
    s_waitcnt vmcnt(16)
    s_barrier
    ds_read2st64_b32 v[20:21], v5 offset0:0 offset1:1
    ds_read2st64_b32 v[22:23], v5 offset0:2 offset1:3
    ds_read2st64_b32 v[24:25], v5 offset0:4 offset1:5
    ds_read2st64_b32 v[26:27], v5 offset0:6 offset1:7
    ds_read2st64_b32 v[28:29], v5 offset0:32 offset1:33
    ds_read2st64_b32 v[30:31], v5 offset0:34 offset1:35
    ds_read2st64_b32 v[32:33], v5 offset0:36 offset1:37
    ds_read2st64_b32 v[34:35], v5 offset0:38 offset1:39
    ds_read2st64_b32 v[36:37], v5 offset0:64 offset1:65
    ds_read2st64_b32 v[38:39], v5 offset0:66 offset1:67
    ds_read2st64_b32 v[40:41], v5 offset0:68 offset1:69
    ds_read2st64_b32 v[42:43], v5 offset0:70 offset1:71
    s_waitcnt lgkmcnt(11)
    v_perm_b32 v160, v21, v20, s37
    v_perm_b32 v224, v21, v20, s38
    ds_read2st64_b32 v[20:21], v5 offset0:96 offset1:97
    s_waitcnt lgkmcnt(11)
    v_perm_b32 v161, v23, v22, s37
    v_perm_b32 v225, v23, v22, s38
    ds_read2st64_b32 v[22:23], v5 offset0:98 offset1:99
    s_waitcnt lgkmcnt(11)
    v_perm_b32 v162, v25, v24, s37
    v_perm_b32 v226, v25, v24, s38
    ds_read2st64_b32 v[24:25], v5 offset0:100 offset1:101
    s_waitcnt lgkmcnt(11)
    v_perm_b32 v163, v27, v26, s37
    v_perm_b32 v227, v27, v26, s38
    ds_read2st64_b32 v[26:27], v5 offset0:102 offset1:103
    s_waitcnt lgkmcnt(11)
    v_perm_b32 v164, v29, v28, s37
    v_perm_b32 v228, v29, v28, s38
    ds_read2st64_b32 v[28:29], v5 offset0:128 offset1:129
    s_waitcnt lgkmcnt(11)
    v_perm_b32 v165, v31, v30, s37
    v_perm_b32 v229, v31, v30, s38
    ds_read2st64_b32 v[30:31], v5 offset0:130 offset1:131
    s_waitcnt lgkmcnt(11)
    v_perm_b32 v166, v33, v32, s37
    v_perm_b32 v230, v33, v32, s38
    ds_read2st64_b32 v[32:33], v5 offset0:132 offset1:133
    s_waitcnt lgkmcnt(11)
    v_perm_b32 v167, v35, v34, s37
    v_perm_b32 v231, v35, v34, s38
    ds_read2st64_b32 v[34:35], v5 offset0:134 offset1:135
    s_waitcnt lgkmcnt(11)
    v_perm_b32 v168, v37, v36, s37
    v_perm_b32 v232, v37, v36, s38
    ds_read2st64_b32 v[36:37], v5 offset0:160 offset1:161
    s_waitcnt lgkmcnt(11)
    v_perm_b32 v169, v39, v38, s37
    v_perm_b32 v233, v39, v38, s38
    ds_read2st64_b32 v[38:39], v5 offset0:162 offset1:163
    s_waitcnt lgkmcnt(11)
    v_perm_b32 v170, v41, v40, s37
    v_perm_b32 v234, v41, v40, s38
    ds_read2st64_b32 v[40:41], v5 offset0:164 offset1:165
    s_waitcnt lgkmcnt(11)
    v_perm_b32 v171, v43, v42, s37
    v_perm_b32 v235, v43, v42, s38
    ds_read2st64_b32 v[42:43], v5 offset0:166 offset1:167
    s_waitcnt lgkmcnt(11)
    v_perm_b32 v172, v21, v20, s37
    v_perm_b32 v236, v21, v20, s38
    ds_read2st64_b32 v[20:21], v5 offset0:192 offset1:193
    s_waitcnt lgkmcnt(11)
    v_perm_b32 v173, v23, v22, s37
    v_perm_b32 v237, v23, v22, s38
    ds_read2st64_b32 v[22:23], v5 offset0:194 offset1:195
    s_waitcnt lgkmcnt(11)
    v_perm_b32 v174, v25, v24, s37
    v_perm_b32 v238, v25, v24, s38
    ds_read2st64_b32 v[24:25], v5 offset0:196 offset1:197
    s_waitcnt lgkmcnt(11)
    v_perm_b32 v175, v27, v26, s37
    v_perm_b32 v239, v27, v26, s38
    ds_read2st64_b32 v[26:27], v5 offset0:198 offset1:199
    s_waitcnt lgkmcnt(11)
    v_perm_b32 v176, v29, v28, s37
    v_perm_b32 v240, v29, v28, s38
    ds_read2st64_b32 v[28:29], v5 offset0:224 offset1:225
    s_waitcnt lgkmcnt(11)
    v_perm_b32 v177, v31, v30, s37
    v_perm_b32 v241, v31, v30, s38
    ds_read2st64_b32 v[30:31], v5 offset0:226 offset1:227
    s_waitcnt lgkmcnt(11)
    v_perm_b32 v178, v33, v32, s37
    v_perm_b32 v242, v33, v32, s38
    ds_read2st64_b32 v[32:33], v5 offset0:228 offset1:229
    s_waitcnt lgkmcnt(11)
    v_perm_b32 v179, v35, v34, s37
    v_perm_b32 v243, v35, v34, s38
    ds_read2st64_b32 v[34:35], v5 offset0:230 offset1:231
    s_waitcnt lgkmcnt(11)
    v_perm_b32 v180, v37, v36, s37
    v_perm_b32 v244, v37, v36, s38
    s_waitcnt lgkmcnt(10)
    v_perm_b32 v181, v39, v38, s37
    v_perm_b32 v245, v39, v38, s38
    s_waitcnt lgkmcnt(9)
    v_perm_b32 v182, v41, v40, s37
    v_perm_b32 v246, v41, v40, s38
    s_waitcnt lgkmcnt(8)
    v_perm_b32 v183, v43, v42, s37
    v_perm_b32 v247, v43, v42, s38
    s_waitcnt lgkmcnt(7)
    v_perm_b32 v184, v21, v20, s37
    v_perm_b32 v248, v21, v20, s38
    s_waitcnt lgkmcnt(6)
    v_perm_b32 v185, v23, v22, s37
    v_perm_b32 v249, v23, v22, s38
    s_waitcnt lgkmcnt(5)
    v_perm_b32 v186, v25, v24, s37
    v_perm_b32 v250, v25, v24, s38
    s_waitcnt lgkmcnt(4)
    v_perm_b32 v187, v27, v26, s37
    v_perm_b32 v251, v27, v26, s38
    s_waitcnt lgkmcnt(3)
    v_perm_b32 v188, v29, v28, s37
    v_perm_b32 v252, v29, v28, s38
    s_waitcnt lgkmcnt(2)
    v_perm_b32 v189, v31, v30, s37
    v_perm_b32 v253, v31, v30, s38
    s_waitcnt lgkmcnt(1)
    v_perm_b32 v190, v33, v32, s37
    v_perm_b32 v254, v33, v32, s38
    s_waitcnt lgkmcnt(0)
    v_perm_b32 v191, v35, v34, s37
    v_perm_b32 v255, v35, v34, s38
    s_barrier
    s_lshl_b32 s40, s28, 14
    s_add_u32 m0, s40, 0x10000
    s_mov_b32 s36, 0x200000
    buffer_load_dwordx4 v3, s[48:51], s36 offen  lds
    s_add_u32 m0, m0, 1024
    s_add_u32 s36, s36, 32768
    buffer_load_dwordx4 v3, s[48:51], s36 offen  lds
    s_add_u32 m0, m0, 1024
    s_add_u32 s36, s36, 32768
    buffer_load_dwordx4 v3, s[48:51], s36 offen  lds
    s_add_u32 m0, m0, 1024
    s_add_u32 s36, s36, 32768
    buffer_load_dwordx4 v3, s[48:51], s36 offen  lds
    s_add_u32 m0, m0, 1024
    s_add_u32 s36, s36, 32768
    buffer_load_dwordx4 v3, s[48:51], s36 offen  lds
    s_add_u32 m0, m0, 1024
    s_add_u32 s36, s36, 32768
    buffer_load_dwordx4 v3, s[48:51], s36 offen  lds
    s_add_u32 m0, m0, 1024
    s_add_u32 s36, s36, 32768
    buffer_load_dwordx4 v3, s[48:51], s36 offen  lds
    s_add_u32 m0, m0, 1024
    s_add_u32 s36, s36, 32768
    buffer_load_dwordx4 v3, s[48:51], s36 offen  lds
    s_add_u32 m0, m0, 1024
    s_add_u32 s36, s36, 32768
    buffer_load_dwordx4 v3, s[48:51], s36 offen  lds
    s_add_u32 m0, m0, 1024
    s_add_u32 s36, s36, 32768
    buffer_load_dwordx4 v3, s[48:51], s36 offen  lds
    s_add_u32 m0, m0, 1024
    s_add_u32 s36, s36, 32768
    buffer_load_dwordx4 v3, s[48:51], s36 offen  lds
    s_add_u32 m0, m0, 1024
    s_add_u32 s36, s36, 32768
    buffer_load_dwordx4 v3, s[48:51], s36 offen  lds
    s_add_u32 m0, m0, 1024
    s_add_u32 s36, s36, 32768
    buffer_load_dwordx4 v3, s[48:51], s36 offen  lds
    s_add_u32 m0, m0, 1024
    s_add_u32 s36, s36, 32768
    buffer_load_dwordx4 v3, s[48:51], s36 offen  lds
    s_add_u32 m0, m0, 1024
    s_add_u32 s36, s36, 32768
    buffer_load_dwordx4 v3, s[48:51], s36 offen  lds
    s_add_u32 m0, m0, 1024
    s_add_u32 s36, s36, 32768
    buffer_load_dwordx4 v3, s[48:51], s36 offen  lds
    s_waitcnt vmcnt(16)
    s_barrier
    ds_read2st64_b32 v[20:21], v4 offset0:0 offset1:1
    ds_read2st64_b32 v[22:23], v4 offset0:2 offset1:3
    ds_read2st64_b32 v[24:25], v4 offset0:4 offset1:5
    ds_read2st64_b32 v[26:27], v4 offset0:6 offset1:7
    ds_read2st64_b32 v[28:29], v4 offset0:32 offset1:33
    ds_read2st64_b32 v[30:31], v4 offset0:34 offset1:35
    ds_read2st64_b32 v[32:33], v4 offset0:36 offset1:37
    ds_read2st64_b32 v[34:35], v4 offset0:38 offset1:39
    ds_read2st64_b32 v[36:37], v4 offset0:64 offset1:65
    ds_read2st64_b32 v[38:39], v4 offset0:66 offset1:67
    ds_read2st64_b32 v[40:41], v4 offset0:68 offset1:69
    ds_read2st64_b32 v[42:43], v4 offset0:70 offset1:71
    s_waitcnt lgkmcnt(11)
    v_perm_b32 v16, v21, v20, s37
    v_accvgpr_write_b32 a0, v16
    v_perm_b32 v17, v21, v20, s38
    v_accvgpr_write_b32 a64, v17
    ds_read2st64_b32 v[20:21], v4 offset0:96 offset1:97
    s_waitcnt lgkmcnt(11)
    v_perm_b32 v16, v23, v22, s37
    v_accvgpr_write_b32 a1, v16
    v_perm_b32 v17, v23, v22, s38
    v_accvgpr_write_b32 a65, v17
    ds_read2st64_b32 v[22:23], v4 offset0:98 offset1:99
    s_waitcnt lgkmcnt(11)
    v_perm_b32 v16, v25, v24, s37
    v_accvgpr_write_b32 a2, v16
    v_perm_b32 v17, v25, v24, s38
    v_accvgpr_write_b32 a66, v17
    ds_read2st64_b32 v[24:25], v4 offset0:100 offset1:101
    s_waitcnt lgkmcnt(11)
    v_perm_b32 v16, v27, v26, s37
    v_accvgpr_write_b32 a3, v16
    v_perm_b32 v17, v27, v26, s38
    v_accvgpr_write_b32 a67, v17
    ds_read2st64_b32 v[26:27], v4 offset0:102 offset1:103
    s_waitcnt lgkmcnt(11)
    v_perm_b32 v16, v29, v28, s37
    v_accvgpr_write_b32 a4, v16
    v_perm_b32 v17, v29, v28, s38
    v_accvgpr_write_b32 a68, v17
    ds_read2st64_b32 v[28:29], v4 offset0:128 offset1:129
    s_waitcnt lgkmcnt(11)
    v_perm_b32 v16, v31, v30, s37
    v_accvgpr_write_b32 a5, v16
    v_perm_b32 v17, v31, v30, s38
    v_accvgpr_write_b32 a69, v17
    ds_read2st64_b32 v[30:31], v4 offset0:130 offset1:131
    s_waitcnt lgkmcnt(11)
    v_perm_b32 v16, v33, v32, s37
    v_accvgpr_write_b32 a6, v16
    v_perm_b32 v17, v33, v32, s38
    v_accvgpr_write_b32 a70, v17
    ds_read2st64_b32 v[32:33], v4 offset0:132 offset1:133
    s_waitcnt lgkmcnt(11)
    v_perm_b32 v16, v35, v34, s37
    v_accvgpr_write_b32 a7, v16
    v_perm_b32 v17, v35, v34, s38
    v_accvgpr_write_b32 a71, v17
    ds_read2st64_b32 v[34:35], v4 offset0:134 offset1:135
    s_waitcnt lgkmcnt(11)
    v_perm_b32 v16, v37, v36, s37
    v_accvgpr_write_b32 a8, v16
    v_perm_b32 v17, v37, v36, s38
    v_accvgpr_write_b32 a72, v17
    ds_read2st64_b32 v[36:37], v4 offset0:160 offset1:161
    s_waitcnt lgkmcnt(11)
    v_perm_b32 v16, v39, v38, s37
    v_accvgpr_write_b32 a9, v16
    v_perm_b32 v17, v39, v38, s38
    v_accvgpr_write_b32 a73, v17
    ds_read2st64_b32 v[38:39], v4 offset0:162 offset1:163
    s_waitcnt lgkmcnt(11)
    v_perm_b32 v16, v41, v40, s37
    v_accvgpr_write_b32 a10, v16
    v_perm_b32 v17, v41, v40, s38
    v_accvgpr_write_b32 a74, v17
    ds_read2st64_b32 v[40:41], v4 offset0:164 offset1:165
    s_waitcnt lgkmcnt(11)
    v_perm_b32 v16, v43, v42, s37
    v_accvgpr_write_b32 a11, v16
    v_perm_b32 v17, v43, v42, s38
    v_accvgpr_write_b32 a75, v17
    ds_read2st64_b32 v[42:43], v4 offset0:166 offset1:167
    s_waitcnt lgkmcnt(11)
    v_perm_b32 v16, v21, v20, s37
    v_accvgpr_write_b32 a12, v16
    v_perm_b32 v17, v21, v20, s38
    v_accvgpr_write_b32 a76, v17
    ds_read2st64_b32 v[20:21], v4 offset0:192 offset1:193
    s_waitcnt lgkmcnt(11)
    v_perm_b32 v16, v23, v22, s37
    v_accvgpr_write_b32 a13, v16
    v_perm_b32 v17, v23, v22, s38
    v_accvgpr_write_b32 a77, v17
    ds_read2st64_b32 v[22:23], v4 offset0:194 offset1:195
    s_waitcnt lgkmcnt(11)
    v_perm_b32 v16, v25, v24, s37
    v_accvgpr_write_b32 a14, v16
    v_perm_b32 v17, v25, v24, s38
    v_accvgpr_write_b32 a78, v17
    ds_read2st64_b32 v[24:25], v4 offset0:196 offset1:197
    s_waitcnt lgkmcnt(11)
    v_perm_b32 v16, v27, v26, s37
    v_accvgpr_write_b32 a15, v16
    v_perm_b32 v17, v27, v26, s38
    v_accvgpr_write_b32 a79, v17
    ds_read2st64_b32 v[26:27], v4 offset0:198 offset1:199
    s_waitcnt lgkmcnt(11)
    v_perm_b32 v16, v29, v28, s37
    v_accvgpr_write_b32 a16, v16
    v_perm_b32 v17, v29, v28, s38
    v_accvgpr_write_b32 a80, v17
    ds_read2st64_b32 v[28:29], v4 offset0:224 offset1:225
    s_waitcnt lgkmcnt(11)
    v_perm_b32 v16, v31, v30, s37
    v_accvgpr_write_b32 a17, v16
    v_perm_b32 v17, v31, v30, s38
    v_accvgpr_write_b32 a81, v17
    ds_read2st64_b32 v[30:31], v4 offset0:226 offset1:227
    s_waitcnt lgkmcnt(11)
    v_perm_b32 v16, v33, v32, s37
    v_accvgpr_write_b32 a18, v16
    v_perm_b32 v17, v33, v32, s38
    v_accvgpr_write_b32 a82, v17
    ds_read2st64_b32 v[32:33], v4 offset0:228 offset1:229
    s_waitcnt lgkmcnt(11)
    v_perm_b32 v16, v35, v34, s37
    v_accvgpr_write_b32 a19, v16
    v_perm_b32 v17, v35, v34, s38
    v_accvgpr_write_b32 a83, v17
    ds_read2st64_b32 v[34:35], v4 offset0:230 offset1:231
    s_waitcnt lgkmcnt(11)
    v_perm_b32 v16, v37, v36, s37
    v_accvgpr_write_b32 a20, v16
    v_perm_b32 v17, v37, v36, s38
    v_accvgpr_write_b32 a84, v17
    s_waitcnt lgkmcnt(10)
    v_perm_b32 v16, v39, v38, s37
    v_accvgpr_write_b32 a21, v16
    v_perm_b32 v17, v39, v38, s38
    v_accvgpr_write_b32 a85, v17
    s_waitcnt lgkmcnt(9)
    v_perm_b32 v16, v41, v40, s37
    v_accvgpr_write_b32 a22, v16
    v_perm_b32 v17, v41, v40, s38
    v_accvgpr_write_b32 a86, v17
    s_waitcnt lgkmcnt(8)
    v_perm_b32 v16, v43, v42, s37
    v_accvgpr_write_b32 a23, v16
    v_perm_b32 v17, v43, v42, s38
    v_accvgpr_write_b32 a87, v17
    s_waitcnt lgkmcnt(7)
    v_perm_b32 v16, v21, v20, s37
    v_accvgpr_write_b32 a24, v16
    v_perm_b32 v17, v21, v20, s38
    v_accvgpr_write_b32 a88, v17
    s_waitcnt lgkmcnt(6)
    v_perm_b32 v16, v23, v22, s37
    v_accvgpr_write_b32 a25, v16
    v_perm_b32 v17, v23, v22, s38
    v_accvgpr_write_b32 a89, v17
    s_waitcnt lgkmcnt(5)
    v_perm_b32 v16, v25, v24, s37
    v_accvgpr_write_b32 a26, v16
    v_perm_b32 v17, v25, v24, s38
    v_accvgpr_write_b32 a90, v17
    s_waitcnt lgkmcnt(4)
    v_perm_b32 v16, v27, v26, s37
    v_accvgpr_write_b32 a27, v16
    v_perm_b32 v17, v27, v26, s38
    v_accvgpr_write_b32 a91, v17
    s_waitcnt lgkmcnt(3)
    v_perm_b32 v16, v29, v28, s37
    v_accvgpr_write_b32 a28, v16
    v_perm_b32 v17, v29, v28, s38
    v_accvgpr_write_b32 a92, v17
    s_waitcnt lgkmcnt(2)
    v_perm_b32 v16, v31, v30, s37
    v_accvgpr_write_b32 a29, v16
    v_perm_b32 v17, v31, v30, s38
    v_accvgpr_write_b32 a93, v17
    s_waitcnt lgkmcnt(1)
    v_perm_b32 v16, v33, v32, s37
    v_accvgpr_write_b32 a30, v16
    v_perm_b32 v17, v33, v32, s38
    v_accvgpr_write_b32 a94, v17
    s_waitcnt lgkmcnt(0)
    v_perm_b32 v16, v35, v34, s37
    v_accvgpr_write_b32 a31, v16
    v_perm_b32 v17, v35, v34, s38
    v_accvgpr_write_b32 a95, v17
    s_waitcnt vmcnt(0)
    s_barrier
    ds_read2st64_b32 v[20:21], v5 offset0:0 offset1:1
    ds_read2st64_b32 v[22:23], v5 offset0:2 offset1:3
    ds_read2st64_b32 v[24:25], v5 offset0:4 offset1:5
    ds_read2st64_b32 v[26:27], v5 offset0:6 offset1:7
    ds_read2st64_b32 v[28:29], v5 offset0:32 offset1:33
    ds_read2st64_b32 v[30:31], v5 offset0:34 offset1:35
    ds_read2st64_b32 v[32:33], v5 offset0:36 offset1:37
    ds_read2st64_b32 v[34:35], v5 offset0:38 offset1:39
    ds_read2st64_b32 v[36:37], v5 offset0:64 offset1:65
    ds_read2st64_b32 v[38:39], v5 offset0:66 offset1:67
    ds_read2st64_b32 v[40:41], v5 offset0:68 offset1:69
    ds_read2st64_b32 v[42:43], v5 offset0:70 offset1:71
    s_waitcnt lgkmcnt(11)
    v_perm_b32 v16, v21, v20, s37
    v_accvgpr_write_b32 a32, v16
    v_perm_b32 v17, v21, v20, s38
    v_accvgpr_write_b32 a96, v17
    ds_read2st64_b32 v[20:21], v5 offset0:96 offset1:97
    s_waitcnt lgkmcnt(11)
    v_perm_b32 v16, v23, v22, s37
    v_accvgpr_write_b32 a33, v16
    v_perm_b32 v17, v23, v22, s38
    v_accvgpr_write_b32 a97, v17
    ds_read2st64_b32 v[22:23], v5 offset0:98 offset1:99
    s_waitcnt lgkmcnt(11)
    v_perm_b32 v16, v25, v24, s37
    v_accvgpr_write_b32 a34, v16
    v_perm_b32 v17, v25, v24, s38
    v_accvgpr_write_b32 a98, v17
    ds_read2st64_b32 v[24:25], v5 offset0:100 offset1:101
    s_waitcnt lgkmcnt(11)
    v_perm_b32 v16, v27, v26, s37
    v_accvgpr_write_b32 a35, v16
    v_perm_b32 v17, v27, v26, s38
    v_accvgpr_write_b32 a99, v17
    ds_read2st64_b32 v[26:27], v5 offset0:102 offset1:103
    s_waitcnt lgkmcnt(11)
    v_perm_b32 v16, v29, v28, s37
    v_accvgpr_write_b32 a36, v16
    v_perm_b32 v17, v29, v28, s38
    v_accvgpr_write_b32 a100, v17
    ds_read2st64_b32 v[28:29], v5 offset0:128 offset1:129
    s_waitcnt lgkmcnt(11)
    v_perm_b32 v16, v31, v30, s37
    v_accvgpr_write_b32 a37, v16
    v_perm_b32 v17, v31, v30, s38
    v_accvgpr_write_b32 a101, v17
    ds_read2st64_b32 v[30:31], v5 offset0:130 offset1:131
    s_waitcnt lgkmcnt(11)
    v_perm_b32 v16, v33, v32, s37
    v_accvgpr_write_b32 a38, v16
    v_perm_b32 v17, v33, v32, s38
    v_accvgpr_write_b32 a102, v17
    ds_read2st64_b32 v[32:33], v5 offset0:132 offset1:133
    s_waitcnt lgkmcnt(11)
    v_perm_b32 v16, v35, v34, s37
    v_accvgpr_write_b32 a39, v16
    v_perm_b32 v17, v35, v34, s38
    v_accvgpr_write_b32 a103, v17
    ds_read2st64_b32 v[34:35], v5 offset0:134 offset1:135
    s_waitcnt lgkmcnt(11)
    v_perm_b32 v16, v37, v36, s37
    v_accvgpr_write_b32 a40, v16
    v_perm_b32 v17, v37, v36, s38
    v_accvgpr_write_b32 a104, v17
    ds_read2st64_b32 v[36:37], v5 offset0:160 offset1:161
    s_waitcnt lgkmcnt(11)
    v_perm_b32 v16, v39, v38, s37
    v_accvgpr_write_b32 a41, v16
    v_perm_b32 v17, v39, v38, s38
    v_accvgpr_write_b32 a105, v17
    ds_read2st64_b32 v[38:39], v5 offset0:162 offset1:163
    s_waitcnt lgkmcnt(11)
    v_perm_b32 v16, v41, v40, s37
    v_accvgpr_write_b32 a42, v16
    v_perm_b32 v17, v41, v40, s38
    v_accvgpr_write_b32 a106, v17
    ds_read2st64_b32 v[40:41], v5 offset0:164 offset1:165
    s_waitcnt lgkmcnt(11)
    v_perm_b32 v16, v43, v42, s37
    v_accvgpr_write_b32 a43, v16
    v_perm_b32 v17, v43, v42, s38
    v_accvgpr_write_b32 a107, v17
    ds_read2st64_b32 v[42:43], v5 offset0:166 offset1:167
    s_waitcnt lgkmcnt(11)
    v_perm_b32 v16, v21, v20, s37
    v_accvgpr_write_b32 a44, v16
    v_perm_b32 v17, v21, v20, s38
    v_accvgpr_write_b32 a108, v17
    ds_read2st64_b32 v[20:21], v5 offset0:192 offset1:193
    s_waitcnt lgkmcnt(11)
    v_perm_b32 v16, v23, v22, s37
    v_accvgpr_write_b32 a45, v16
    v_perm_b32 v17, v23, v22, s38
    v_accvgpr_write_b32 a109, v17
    ds_read2st64_b32 v[22:23], v5 offset0:194 offset1:195
    s_waitcnt lgkmcnt(11)
    v_perm_b32 v16, v25, v24, s37
    v_accvgpr_write_b32 a46, v16
    v_perm_b32 v17, v25, v24, s38
    v_accvgpr_write_b32 a110, v17
    ds_read2st64_b32 v[24:25], v5 offset0:196 offset1:197
    s_waitcnt lgkmcnt(11)
    v_perm_b32 v16, v27, v26, s37
    v_accvgpr_write_b32 a47, v16
    v_perm_b32 v17, v27, v26, s38
    v_accvgpr_write_b32 a111, v17
    ds_read2st64_b32 v[26:27], v5 offset0:198 offset1:199
    s_waitcnt lgkmcnt(11)
    v_perm_b32 v16, v29, v28, s37
    v_accvgpr_write_b32 a48, v16
    v_perm_b32 v17, v29, v28, s38
    v_accvgpr_write_b32 a112, v17
    ds_read2st64_b32 v[28:29], v5 offset0:224 offset1:225
    s_waitcnt lgkmcnt(11)
    v_perm_b32 v16, v31, v30, s37
    v_accvgpr_write_b32 a49, v16
    v_perm_b32 v17, v31, v30, s38
    v_accvgpr_write_b32 a113, v17
    ds_read2st64_b32 v[30:31], v5 offset0:226 offset1:227
    s_waitcnt lgkmcnt(11)
    v_perm_b32 v16, v33, v32, s37
    v_accvgpr_write_b32 a50, v16
    v_perm_b32 v17, v33, v32, s38
    v_accvgpr_write_b32 a114, v17
    ds_read2st64_b32 v[32:33], v5 offset0:228 offset1:229
    s_waitcnt lgkmcnt(11)
    v_perm_b32 v16, v35, v34, s37
    v_accvgpr_write_b32 a51, v16
    v_perm_b32 v17, v35, v34, s38
    v_accvgpr_write_b32 a115, v17
    ds_read2st64_b32 v[34:35], v5 offset0:230 offset1:231
    s_waitcnt lgkmcnt(11)
    v_perm_b32 v16, v37, v36, s37
    v_accvgpr_write_b32 a52, v16
    v_perm_b32 v17, v37, v36, s38
    v_accvgpr_write_b32 a116, v17
    s_waitcnt lgkmcnt(10)
    v_perm_b32 v16, v39, v38, s37
    v_accvgpr_write_b32 a53, v16
    v_perm_b32 v17, v39, v38, s38
    v_accvgpr_write_b32 a117, v17
    s_waitcnt lgkmcnt(9)
    v_perm_b32 v16, v41, v40, s37
    v_accvgpr_write_b32 a54, v16
    v_perm_b32 v17, v41, v40, s38
    v_accvgpr_write_b32 a118, v17
    s_waitcnt lgkmcnt(8)
    v_perm_b32 v16, v43, v42, s37
    v_accvgpr_write_b32 a55, v16
    v_perm_b32 v17, v43, v42, s38
    v_accvgpr_write_b32 a119, v17
    s_waitcnt lgkmcnt(7)
    v_perm_b32 v16, v21, v20, s37
    v_accvgpr_write_b32 a56, v16
    v_perm_b32 v17, v21, v20, s38
    v_accvgpr_write_b32 a120, v17
    s_waitcnt lgkmcnt(6)
    v_perm_b32 v16, v23, v22, s37
    v_accvgpr_write_b32 a57, v16
    v_perm_b32 v17, v23, v22, s38
    v_accvgpr_write_b32 a121, v17
    s_waitcnt lgkmcnt(5)
    v_perm_b32 v16, v25, v24, s37
    v_accvgpr_write_b32 a58, v16
    v_perm_b32 v17, v25, v24, s38
    v_accvgpr_write_b32 a122, v17
    s_waitcnt lgkmcnt(4)
    v_perm_b32 v16, v27, v26, s37
    v_accvgpr_write_b32 a59, v16
    v_perm_b32 v17, v27, v26, s38
    v_accvgpr_write_b32 a123, v17
    s_waitcnt lgkmcnt(3)
    v_perm_b32 v16, v29, v28, s37
    v_accvgpr_write_b32 a60, v16
    v_perm_b32 v17, v29, v28, s38
    v_accvgpr_write_b32 a124, v17
    s_waitcnt lgkmcnt(2)
    v_perm_b32 v16, v31, v30, s37
    v_accvgpr_write_b32 a61, v16
    v_perm_b32 v17, v31, v30, s38
    v_accvgpr_write_b32 a125, v17
    s_waitcnt lgkmcnt(1)
    v_perm_b32 v16, v33, v32, s37
    v_accvgpr_write_b32 a62, v16
    v_perm_b32 v17, v33, v32, s38
    v_accvgpr_write_b32 a126, v17
    s_waitcnt lgkmcnt(0)
    v_perm_b32 v16, v35, v34, s37
    v_accvgpr_write_b32 a63, v16
    v_perm_b32 v17, v35, v34, s38
    v_accvgpr_write_b32 a127, v17
    v_mov_b32 v16, 176
L_wf_21:
    global_load_dword v17, v16, s[24:25] sc1
    s_add_u32 s39, s39, 1
    s_cmp_gt_u32 s39, 0x400000
    s_cbranch_scc1 L_fail
    s_sleep 1
    s_waitcnt vmcnt(0)
    v_cmp_ne_u32 vcc, 1, v17
    s_cbranch_vccnz L_wf_21
    v_mov_b32 v16, 160
    s_mov_b32 s40, 128
L_wf_22:
    global_load_dword v17, v16, s[24:25] sc1
    s_add_u32 s39, s39, 1
    s_cmp_gt_u32 s39, 0x400000
    s_cbranch_scc1 L_fail
    s_sleep 1
    s_waitcnt vmcnt(0)
    v_cmp_ne_u32 vcc, s40, v17
    s_cbranch_vccnz L_wf_22
    s_mov_b32 s66, s65
    s_lshl_b32 s40, s66, 15
    s_add_u32 s68, s26, s40
    s_addc_u32 s69, s27, 0
    global_load_dwordx4 v[16:19], v8, s[68:69] offset:0 sc1
    global_load_dwordx4 v[20:23], v12, s[68:69] offset:0 sc1
    global_load_dwordx4 v[24:27], v8, s[68:69] offset:1024 sc1
    global_load_dwordx4 v[28:31], v12, s[68:69] offset:1024 sc1
    global_load_dwordx4 v[32:35], v8, s[68:69] offset:2048 sc1
    global_load_dwordx4 v[36:39], v12, s[68:69] offset:2048 sc1
    global_load_dwordx4 v[40:43], v8, s[68:69] offset:3072 sc1
    global_load_dwordx4 v[44:47], v12, s[68:69] offset:3072 sc1
    s_lshl_b32 s40, s64, 8
    s_add_u32 s40, s40, s28
    s_add_u32 s40, s40, 0x400000
    v_mov_b32 v5, s40
    v_mov_b32 v6, 1
    s_mov_b32 s47, 0
    s_waitcnt vmcnt(0)
L_qkv_seg:
    s_waitcnt vmcnt(6)
    s_add_u32 s68, s68, 4096
    s_addc_u32 s69, s69, 0
    global_load_dwordx4 v[48:51], v8, s[68:69] offset:0 sc1
    global_load_dwordx4 v[52:55], v12, s[68:69] offset:0 sc1
    global_load_dwordx4 v[56:59], v8, s[68:69] offset:1024 sc1
    global_load_dwordx4 v[60:63], v12, s[68:69] offset:1024 sc1
    global_load_dwordx4 v[64:67], v8, s[68:69] offset:2048 sc1
    global_load_dwordx4 v[68:71], v12, s[68:69] offset:2048 sc1
    global_load_dwordx4 v[72:75], v8, s[68:69] offset:3072 sc1
    global_load_dwordx4 v[76:79], v12, s[68:69] offset:3072 sc1
    v_mfma_f32_16x16x32_bf16 v[96:99], a[128:131], v[16:19], 0
    v_mfma_f32_16x16x32_bf16 v[112:115], v[16:19], v[128:131], 0
    v_mfma_f32_16x16x32_bf16 v[80:83], a[0:3], v[16:19], 0
    v_mfma_f32_16x16x32_bf16 v[104:107], a[192:195], v[16:19], 0
    v_mfma_f32_16x16x32_bf16 v[116:119], v[16:19], v[192:195], 0
    v_mfma_f32_16x16x32_bf16 v[88:91], a[64:67], v[16:19], 0
    v_mfma_f32_16x16x32_bf16 v[100:103], a[128:131], v[20:23], 0
    v_mfma_f32_16x16x32_bf16 v[120:123], v[20:23], v[128:131], 0
    v_mfma_f32_16x16x32_bf16 v[84:87], a[0:3], v[20:23], 0
    v_mfma_f32_16x16x32_bf16 v[108:111], a[192:195], v[20:23], 0
    v_mfma_f32_16x16x32_bf16 v[124:127], v[20:23], v[192:195], 0
    v_mfma_f32_16x16x32_bf16 v[92:95], a[64:67], v[20:23], 0
    v_mfma_f32_16x16x32_bf16 v[96:99], a[132:135], v[24:27], v[96:99]
    v_mfma_f32_16x16x32_bf16 v[112:115], v[24:27], v[132:135], v[112:115]
    v_mfma_f32_16x16x32_bf16 v[80:83], a[4:7], v[24:27], v[80:83]
    v_mfma_f32_16x16x32_bf16 v[104:107], a[196:199], v[24:27], v[104:107]
    v_mfma_f32_16x16x32_bf16 v[116:119], v[24:27], v[196:199], v[116:119]
    v_mfma_f32_16x16x32_bf16 v[88:91], a[68:71], v[24:27], v[88:91]
    v_mfma_f32_16x16x32_bf16 v[100:103], a[132:135], v[28:31], v[100:103]
    v_mfma_f32_16x16x32_bf16 v[120:123], v[28:31], v[132:135], v[120:123]
    v_mfma_f32_16x16x32_bf16 v[84:87], a[4:7], v[28:31], v[84:87]
    v_mfma_f32_16x16x32_bf16 v[108:111], a[196:199], v[28:31], v[108:111]
    v_mfma_f32_16x16x32_bf16 v[124:127], v[28:31], v[196:199], v[124:127]
    v_mfma_f32_16x16x32_bf16 v[92:95], a[68:71], v[28:31], v[92:95]
    v_mfma_f32_16x16x32_bf16 v[96:99], a[136:139], v[32:35], v[96:99]
    v_mfma_f32_16x16x32_bf16 v[112:115], v[32:35], v[136:139], v[112:115]
    v_mfma_f32_16x16x32_bf16 v[80:83], a[8:11], v[32:35], v[80:83]
    v_mfma_f32_16x16x32_bf16 v[104:107], a[200:203], v[32:35], v[104:107]
    v_mfma_f32_16x16x32_bf16 v[116:119], v[32:35], v[200:203], v[116:119]
    v_mfma_f32_16x16x32_bf16 v[88:91], a[72:75], v[32:35], v[88:91]
    v_mfma_f32_16x16x32_bf16 v[100:103], a[136:139], v[36:39], v[100:103]
    v_mfma_f32_16x16x32_bf16 v[120:123], v[36:39], v[136:139], v[120:123]
    v_mfma_f32_16x16x32_bf16 v[84:87], a[8:11], v[36:39], v[84:87]
    v_mfma_f32_16x16x32_bf16 v[108:111], a[200:203], v[36:39], v[108:111]
    v_mfma_f32_16x16x32_bf16 v[124:127], v[36:39], v[200:203], v[124:127]
    v_mfma_f32_16x16x32_bf16 v[92:95], a[72:75], v[36:39], v[92:95]
    v_mfma_f32_16x16x32_bf16 v[96:99], a[140:143], v[40:43], v[96:99]
    v_mfma_f32_16x16x32_bf16 v[112:115], v[40:43], v[140:143], v[112:115]
    v_mfma_f32_16x16x32_bf16 v[80:83], a[12:15], v[40:43], v[80:83]
    v_mfma_f32_16x16x32_bf16 v[104:107], a[204:207], v[40:43], v[104:107]
    v_mfma_f32_16x16x32_bf16 v[116:119], v[40:43], v[204:207], v[116:119]
    v_mfma_f32_16x16x32_bf16 v[88:91], a[76:79], v[40:43], v[88:91]
    v_mfma_f32_16x16x32_bf16 v[100:103], a[140:143], v[44:47], v[100:103]
    v_mfma_f32_16x16x32_bf16 v[120:123], v[44:47], v[140:143], v[120:123]
    v_mfma_f32_16x16x32_bf16 v[84:87], a[12:15], v[44:47], v[84:87]
    v_mfma_f32_16x16x32_bf16 v[108:111], a[204:207], v[44:47], v[108:111]
    v_mfma_f32_16x16x32_bf16 v[124:127], v[44:47], v[204:207], v[124:127]
    v_mfma_f32_16x16x32_bf16 v[92:95], a[76:79], v[44:47], v[92:95]
    s_waitcnt vmcnt(0)
    s_cmp_eq_u32 s47, 0
    s_cbranch_scc1 L_qkv_nofl
    s_mov_b64 exec, 1
    global_store_byte v4, v6, s[26:27] sc1
    s_mov_b64 exec, -1
L_qkv_nofl:
    s_add_u32 s68, s68, 4096
    s_addc_u32 s69, s69, 0
    global_load_dwordx4 v[16:19], v8, s[68:69] offset:0 sc1
    global_load_dwordx4 v[20:23], v12, s[68:69] offset:0 sc1
    global_load_dwordx4 v[24:27], v8, s[68:69] offset:1024 sc1
    global_load_dwordx4 v[28:31], v12, s[68:69] offset:1024 sc1
    global_load_dwordx4 v[32:35], v8, s[68:69] offset:2048 sc1
    global_load_dwordx4 v[36:39], v12, s[68:69] offset:2048 sc1
    global_load_dwordx4 v[40:43], v8, s[68:69] offset:3072 sc1
    global_load_dwordx4 v[44:47], v12, s[68:69] offset:3072 sc1
    v_mfma_f32_16x16x32_bf16 v[96:99], a[144:147], v[48:51], v[96:99]
    v_mfma_f32_16x16x32_bf16 v[112:115], v[48:51], v[144:147], v[112:115]
    v_mfma_f32_16x16x32_bf16 v[80:83], a[16:19], v[48:51], v[80:83]
    v_mfma_f32_16x16x32_bf16 v[104:107], a[208:211], v[48:51], v[104:107]
    v_mfma_f32_16x16x32_bf16 v[116:119], v[48:51], v[208:211], v[116:119]
    v_mfma_f32_16x16x32_bf16 v[88:91], a[80:83], v[48:51], v[88:91]
    v_mfma_f32_16x16x32_bf16 v[100:103], a[144:147], v[52:55], v[100:103]
    v_mfma_f32_16x16x32_bf16 v[120:123], v[52:55], v[144:147], v[120:123]
    v_mfma_f32_16x16x32_bf16 v[84:87], a[16:19], v[52:55], v[84:87]
    v_mfma_f32_16x16x32_bf16 v[108:111], a[208:211], v[52:55], v[108:111]
    v_mfma_f32_16x16x32_bf16 v[124:127], v[52:55], v[208:211], v[124:127]
    v_mfma_f32_16x16x32_bf16 v[92:95], a[80:83], v[52:55], v[92:95]
    v_mfma_f32_16x16x32_bf16 v[96:99], a[148:151], v[56:59], v[96:99]
    v_mfma_f32_16x16x32_bf16 v[112:115], v[56:59], v[148:151], v[112:115]
    v_mfma_f32_16x16x32_bf16 v[80:83], a[20:23], v[56:59], v[80:83]
    v_mfma_f32_16x16x32_bf16 v[104:107], a[212:215], v[56:59], v[104:107]
    v_mfma_f32_16x16x32_bf16 v[116:119], v[56:59], v[212:215], v[116:119]
    v_mfma_f32_16x16x32_bf16 v[88:91], a[84:87], v[56:59], v[88:91]
    v_mfma_f32_16x16x32_bf16 v[100:103], a[148:151], v[60:63], v[100:103]
    v_mfma_f32_16x16x32_bf16 v[120:123], v[60:63], v[148:151], v[120:123]
    v_mfma_f32_16x16x32_bf16 v[84:87], a[20:23], v[60:63], v[84:87]
    v_mfma_f32_16x16x32_bf16 v[108:111], a[212:215], v[60:63], v[108:111]
    v_mfma_f32_16x16x32_bf16 v[124:127], v[60:63], v[212:215], v[124:127]
    v_mfma_f32_16x16x32_bf16 v[92:95], a[84:87], v[60:63], v[92:95]
    v_mfma_f32_16x16x32_bf16 v[96:99], a[152:155], v[64:67], v[96:99]
    v_mfma_f32_16x16x32_bf16 v[112:115], v[64:67], v[152:155], v[112:115]
    v_mfma_f32_16x16x32_bf16 v[80:83], a[24:27], v[64:67], v[80:83]
    v_mfma_f32_16x16x32_bf16 v[104:107], a[216:219], v[64:67], v[104:107]
    v_mfma_f32_16x16x32_bf16 v[116:119], v[64:67], v[216:219], v[116:119]
    v_mfma_f32_16x16x32_bf16 v[88:91], a[88:91], v[64:67], v[88:91]
    v_mfma_f32_16x16x32_bf16 v[100:103], a[152:155], v[68:71], v[100:103]
    v_mfma_f32_16x16x32_bf16 v[120:123], v[68:71], v[152:155], v[120:123]
    v_mfma_f32_16x16x32_bf16 v[84:87], a[24:27], v[68:71], v[84:87]
    v_mfma_f32_16x16x32_bf16 v[108:111], a[216:219], v[68:71], v[108:111]
    v_mfma_f32_16x16x32_bf16 v[124:127], v[68:71], v[216:219], v[124:127]
    v_mfma_f32_16x16x32_bf16 v[92:95], a[88:91], v[68:71], v[92:95]
    v_mfma_f32_16x16x32_bf16 v[96:99], a[156:159], v[72:75], v[96:99]
    v_mfma_f32_16x16x32_bf16 v[112:115], v[72:75], v[156:159], v[112:115]
    v_mfma_f32_16x16x32_bf16 v[80:83], a[28:31], v[72:75], v[80:83]
    v_mfma_f32_16x16x32_bf16 v[104:107], a[220:223], v[72:75], v[104:107]
    v_mfma_f32_16x16x32_bf16 v[116:119], v[72:75], v[220:223], v[116:119]
    v_mfma_f32_16x16x32_bf16 v[88:91], a[92:95], v[72:75], v[88:91]
    v_mfma_f32_16x16x32_bf16 v[100:103], a[156:159], v[76:79], v[100:103]
    v_mfma_f32_16x16x32_bf16 v[120:123], v[76:79], v[156:159], v[120:123]
    v_mfma_f32_16x16x32_bf16 v[84:87], a[28:31], v[76:79], v[84:87]
    v_mfma_f32_16x16x32_bf16 v[108:111], a[220:223], v[76:79], v[108:111]
    v_mfma_f32_16x16x32_bf16 v[124:127], v[76:79], v[220:223], v[124:127]
    v_mfma_f32_16x16x32_bf16 v[92:95], a[92:95], v[76:79], v[92:95]
    s_waitcnt vmcnt(0)
    s_add_u32 s68, s68, 4096
    s_addc_u32 s69, s69, 0
    global_load_dwordx4 v[48:51], v8, s[68:69] offset:0 sc1
    global_load_dwordx4 v[52:55], v12, s[68:69] offset:0 sc1
    global_load_dwordx4 v[56:59], v8, s[68:69] offset:1024 sc1
    global_load_dwordx4 v[60:63], v12, s[68:69] offset:1024 sc1
    global_load_dwordx4 v[64:67], v8, s[68:69] offset:2048 sc1
    global_load_dwordx4 v[68:71], v12, s[68:69] offset:2048 sc1
    global_load_dwordx4 v[72:75], v8, s[68:69] offset:3072 sc1
    global_load_dwordx4 v[76:79], v12, s[68:69] offset:3072 sc1
    v_mfma_f32_16x16x32_bf16 v[96:99], a[160:163], v[16:19], v[96:99]
    v_mfma_f32_16x16x32_bf16 v[112:115], v[16:19], v[160:163], v[112:115]
    v_mfma_f32_16x16x32_bf16 v[80:83], a[32:35], v[16:19], v[80:83]
    v_mfma_f32_16x16x32_bf16 v[104:107], a[224:227], v[16:19], v[104:107]
    v_mfma_f32_16x16x32_bf16 v[116:119], v[16:19], v[224:227], v[116:119]
    v_mfma_f32_16x16x32_bf16 v[88:91], a[96:99], v[16:19], v[88:91]
    v_mfma_f32_16x16x32_bf16 v[100:103], a[160:163], v[20:23], v[100:103]
    v_mfma_f32_16x16x32_bf16 v[120:123], v[20:23], v[160:163], v[120:123]
    v_mfma_f32_16x16x32_bf16 v[84:87], a[32:35], v[20:23], v[84:87]
    v_mfma_f32_16x16x32_bf16 v[108:111], a[224:227], v[20:23], v[108:111]
    v_mfma_f32_16x16x32_bf16 v[124:127], v[20:23], v[224:227], v[124:127]
    v_mfma_f32_16x16x32_bf16 v[92:95], a[96:99], v[20:23], v[92:95]
    v_mfma_f32_16x16x32_bf16 v[96:99], a[164:167], v[24:27], v[96:99]
    v_mfma_f32_16x16x32_bf16 v[112:115], v[24:27], v[164:167], v[112:115]
    v_mfma_f32_16x16x32_bf16 v[80:83], a[36:39], v[24:27], v[80:83]
    v_mfma_f32_16x16x32_bf16 v[104:107], a[228:231], v[24:27], v[104:107]
    v_mfma_f32_16x16x32_bf16 v[116:119], v[24:27], v[228:231], v[116:119]
    v_mfma_f32_16x16x32_bf16 v[88:91], a[100:103], v[24:27], v[88:91]
    v_mfma_f32_16x16x32_bf16 v[100:103], a[164:167], v[28:31], v[100:103]
    v_mfma_f32_16x16x32_bf16 v[120:123], v[28:31], v[164:167], v[120:123]
    v_mfma_f32_16x16x32_bf16 v[84:87], a[36:39], v[28:31], v[84:87]
    v_mfma_f32_16x16x32_bf16 v[108:111], a[228:231], v[28:31], v[108:111]
    v_mfma_f32_16x16x32_bf16 v[124:127], v[28:31], v[228:231], v[124:127]
    v_mfma_f32_16x16x32_bf16 v[92:95], a[100:103], v[28:31], v[92:95]
    v_mfma_f32_16x16x32_bf16 v[96:99], a[168:171], v[32:35], v[96:99]
    v_mfma_f32_16x16x32_bf16 v[112:115], v[32:35], v[168:171], v[112:115]
    v_mfma_f32_16x16x32_bf16 v[80:83], a[40:43], v[32:35], v[80:83]
    v_mfma_f32_16x16x32_bf16 v[104:107], a[232:235], v[32:35], v[104:107]
    v_mfma_f32_16x16x32_bf16 v[116:119], v[32:35], v[232:235], v[116:119]
    v_mfma_f32_16x16x32_bf16 v[88:91], a[104:107], v[32:35], v[88:91]
    v_mfma_f32_16x16x32_bf16 v[100:103], a[168:171], v[36:39], v[100:103]
    v_mfma_f32_16x16x32_bf16 v[120:123], v[36:39], v[168:171], v[120:123]
    v_mfma_f32_16x16x32_bf16 v[84:87], a[40:43], v[36:39], v[84:87]
    v_mfma_f32_16x16x32_bf16 v[108:111], a[232:235], v[36:39], v[108:111]
    v_mfma_f32_16x16x32_bf16 v[124:127], v[36:39], v[232:235], v[124:127]
    v_mfma_f32_16x16x32_bf16 v[92:95], a[104:107], v[36:39], v[92:95]
    v_mfma_f32_16x16x32_bf16 v[96:99], a[172:175], v[40:43], v[96:99]
    v_mfma_f32_16x16x32_bf16 v[112:115], v[40:43], v[172:175], v[112:115]
    v_mfma_f32_16x16x32_bf16 v[80:83], a[44:47], v[40:43], v[80:83]
    v_mfma_f32_16x16x32_bf16 v[104:107], a[236:239], v[40:43], v[104:107]
    v_mfma_f32_16x16x32_bf16 v[116:119], v[40:43], v[236:239], v[116:119]
    v_mfma_f32_16x16x32_bf16 v[88:91], a[108:111], v[40:43], v[88:91]
    v_mfma_f32_16x16x32_bf16 v[100:103], a[172:175], v[44:47], v[100:103]
    v_mfma_f32_16x16x32_bf16 v[120:123], v[44:47], v[172:175], v[120:123]
    v_mfma_f32_16x16x32_bf16 v[84:87], a[44:47], v[44:47], v[84:87]
    v_mfma_f32_16x16x32_bf16 v[108:111], a[236:239], v[44:47], v[108:111]
    v_mfma_f32_16x16x32_bf16 v[124:127], v[44:47], v[236:239], v[124:127]
    v_mfma_f32_16x16x32_bf16 v[92:95], a[108:111], v[44:47], v[92:95]
    s_waitcnt vmcnt(0)
    s_add_u32 s68, s68, 217088
    s_addc_u32 s69, s69, 0
    global_load_dwordx4 v[16:19], v8, s[68:69] offset:0 sc1
    global_load_dwordx4 v[20:23], v12, s[68:69] offset:0 sc1
    global_load_dwordx4 v[24:27], v8, s[68:69] offset:1024 sc1
    global_load_dwordx4 v[28:31], v12, s[68:69] offset:1024 sc1
    global_load_dwordx4 v[32:35], v8, s[68:69] offset:2048 sc1
    global_load_dwordx4 v[36:39], v12, s[68:69] offset:2048 sc1
    global_load_dwordx4 v[40:43], v8, s[68:69] offset:3072 sc1
    global_load_dwordx4 v[44:47], v12, s[68:69] offset:3072 sc1
    v_mfma_f32_16x16x32_bf16 v[96:99], a[176:179], v[48:51], v[96:99]
    v_mfma_f32_16x16x32_bf16 v[112:115], v[48:51], v[176:179], v[112:115]
    v_mfma_f32_16x16x32_bf16 v[80:83], a[48:51], v[48:51], v[80:83]
    v_mfma_f32_16x16x32_bf16 v[104:107], a[240:243], v[48:51], v[104:107]
    v_mfma_f32_16x16x32_bf16 v[116:119], v[48:51], v[240:243], v[116:119]
    v_mfma_f32_16x16x32_bf16 v[88:91], a[112:115], v[48:51], v[88:91]
    v_mfma_f32_16x16x32_bf16 v[100:103], a[176:179], v[52:55], v[100:103]
    v_mfma_f32_16x16x32_bf16 v[120:123], v[52:55], v[176:179], v[120:123]
    v_mfma_f32_16x16x32_bf16 v[84:87], a[48:51], v[52:55], v[84:87]
    v_mfma_f32_16x16x32_bf16 v[108:111], a[240:243], v[52:55], v[108:111]
    v_mfma_f32_16x16x32_bf16 v[124:127], v[52:55], v[240:243], v[124:127]
    v_mfma_f32_16x16x32_bf16 v[92:95], a[112:115], v[52:55], v[92:95]
    v_mfma_f32_16x16x32_bf16 v[96:99], a[180:183], v[56:59], v[96:99]
    v_mfma_f32_16x16x32_bf16 v[112:115], v[56:59], v[180:183], v[112:115]
    v_mfma_f32_16x16x32_bf16 v[80:83], a[52:55], v[56:59], v[80:83]
    v_mfma_f32_16x16x32_bf16 v[104:107], a[244:247], v[56:59], v[104:107]
    v_mfma_f32_16x16x32_bf16 v[116:119], v[56:59], v[244:247], v[116:119]
    v_mfma_f32_16x16x32_bf16 v[88:91], a[116:119], v[56:59], v[88:91]
    v_mfma_f32_16x16x32_bf16 v[100:103], a[180:183], v[60:63], v[100:103]
    v_mfma_f32_16x16x32_bf16 v[120:123], v[60:63], v[180:183], v[120:123]
    v_mfma_f32_16x16x32_bf16 v[84:87], a[52:55], v[60:63], v[84:87]
    v_mfma_f32_16x16x32_bf16 v[108:111], a[244:247], v[60:63], v[108:111]
    v_mfma_f32_16x16x32_bf16 v[124:127], v[60:63], v[244:247], v[124:127]
    v_mfma_f32_16x16x32_bf16 v[92:95], a[116:119], v[60:63], v[92:95]
    v_mfma_f32_16x16x32_bf16 v[96:99], a[184:187], v[64:67], v[96:99]
    v_mfma_f32_16x16x32_bf16 v[112:115], v[64:67], v[184:187], v[112:115]
    v_mfma_f32_16x16x32_bf16 v[80:83], a[56:59], v[64:67], v[80:83]
    v_mfma_f32_16x16x32_bf16 v[104:107], a[248:251], v[64:67], v[104:107]
    v_mfma_f32_16x16x32_bf16 v[116:119], v[64:67], v[248:251], v[116:119]
    v_mfma_f32_16x16x32_bf16 v[88:91], a[120:123], v[64:67], v[88:91]
    v_mfma_f32_16x16x32_bf16 v[100:103], a[184:187], v[68:71], v[100:103]
    v_mfma_f32_16x16x32_bf16 v[120:123], v[68:71], v[184:187], v[120:123]
    v_mfma_f32_16x16x32_bf16 v[84:87], a[56:59], v[68:71], v[84:87]
    v_mfma_f32_16x16x32_bf16 v[108:111], a[248:251], v[68:71], v[108:111]
    v_mfma_f32_16x16x32_bf16 v[124:127], v[68:71], v[248:251], v[124:127]
    v_mfma_f32_16x16x32_bf16 v[92:95], a[120:123], v[68:71], v[92:95]
    v_mfma_f32_16x16x32_bf16 v[96:99], a[188:191], v[72:75], v[96:99]
    v_mfma_f32_16x16x32_bf16 v[112:115], v[72:75], v[188:191], v[112:115]
    v_mfma_f32_16x16x32_bf16 v[80:83], a[60:63], v[72:75], v[80:83]
    v_mfma_f32_16x16x32_bf16 v[104:107], a[252:255], v[72:75], v[104:107]
    v_mfma_f32_16x16x32_bf16 v[116:119], v[72:75], v[252:255], v[116:119]
    v_mfma_f32_16x16x32_bf16 v[88:91], a[124:127], v[72:75], v[88:91]
    v_mfma_f32_16x16x32_bf16 v[100:103], a[188:191], v[76:79], v[100:103]
    v_mfma_f32_16x16x32_bf16 v[120:123], v[76:79], v[188:191], v[120:123]
    v_mfma_f32_16x16x32_bf16 v[84:87], a[60:63], v[76:79], v[84:87]
    v_mfma_f32_16x16x32_bf16 v[108:111], a[252:255], v[76:79], v[108:111]
    v_mfma_f32_16x16x32_bf16 v[124:127], v[76:79], v[252:255], v[124:127]
    v_mfma_f32_16x16x32_bf16 v[92:95], a[124:127], v[76:79], v[92:95]
    s_lshl_b32 s40, s66, 5
    s_add_u32 s40, s40, s64
    s_lshl_b32 s40, s40, 13
    s_lshl_b32 s41, s28, 10
    s_add_u32 s42, s40, s41
    s_add_u32 s43, s42, s41
    s_add_u32 s70, s26, s42
    s_addc_u32 s71, s27, 0
    s_add_u32 s70, s70, 0x2000000
    s_addc_u32 s71, s71, 0
    s_add_u32 s72, s26, s43
    s_addc_u32 s73, s27, 0
    s_add_u32 s72, s72, 0x3000000
    s_addc_u32 s73, s73, 0
    s_add_u32 s74, s26, s42
    s_addc_u32 s75, s27, 0
    s_add_u32 s74, s74, 0x1000000
    s_addc_u32 s75, s75, 0
    v_cvt_pk_bf16_f32 v96, v96, v104
    v_cvt_pk_bf16_f32 v97, v97, v105
    v_cvt_pk_bf16_f32 v98, v98, v106
    v_cvt_pk_bf16_f32 v99, v99, v107
    global_store_dwordx4 v8, v[96:99], s[70:71] offset:0 sc1
    v_cvt_pk_bf16_f32 v100, v100, v108
    v_cvt_pk_bf16_f32 v101, v101, v109
    v_cvt_pk_bf16_f32 v102, v102, v110
    v_cvt_pk_bf16_f32 v103, v103, v111
    global_store_dwordx4 v9, v[100:103], s[70:71] offset:0 sc1
    v_cvt_pk_bf16_f32 v112, v112, v113
    v_cvt_pk_bf16_f32 v113, v114, v115
    v_cvt_pk_bf16_f32 v114, v120, v121
    v_cvt_pk_bf16_f32 v115, v122, v123
    global_store_dwordx4 v8, v[112:115], s[72:73] offset:0 sc1
    v_cvt_pk_bf16_f32 v116, v116, v117
    v_cvt_pk_bf16_f32 v117, v118, v119
    v_cvt_pk_bf16_f32 v118, v124, v125
    v_cvt_pk_bf16_f32 v119, v126, v127
    global_store_dwordx4 v8, v[116:119], s[72:73] offset:1024 sc1
    v_cvt_pk_bf16_f32 v80, v80, v88
    v_cvt_pk_bf16_f32 v81, v81, v89
    v_cvt_pk_bf16_f32 v82, v82, v90
    v_cvt_pk_bf16_f32 v83, v83, v91
    global_store_dwordx4 v8, v[80:83], s[74:75] offset:0 sc1
    v_cvt_pk_bf16_f32 v84, v84, v92
    v_cvt_pk_bf16_f32 v85, v85, v93
    v_cvt_pk_bf16_f32 v86, v86, v94
    v_cvt_pk_bf16_f32 v87, v87, v95
    global_store_dwordx4 v9, v[84:87], s[74:75] offset:0 sc1
    s_lshl_b32 s40, s66, 2
    v_add_u32 v4, s40, v5
    s_mov_b32 s47, 1
    s_add_u32 s66, s66, 7
    s_cmp_lt_u32 s66, 64
    s_cbranch_scc1 L_qkv_seg
    s_waitcnt vmcnt(0)
    s_mov_b64 exec, 1
    global_store_byte v4, v6, s[26:27] sc1
    s_mov_b64 exec, -1
    s_mov_b32 s48, s16
    s_and_b32 s49, s17, 0xffff
    s_mov_b32 s50, 0x1c0000
    s_mov_b32 s51, 0x20000
    s_mov_b32 s52, s18
    s_and_b32 s53, s19, 0xffff
    s_mov_b32 s54, 0x1c0000
    s_mov_b32 s55, 0x20000
    s_lshr_b32 s40, s31, 3
    s_lshl_b32 s40, s40, 1
    s_and_b32 s41, s28, 1
    s_add_u32 s40, s40, s41
    s_lshl_b32 s41, s40, 6
    v_mul_u32_u24 v3, 28672, v2
    v_lshl_add_u32 v3, v1, 2, v3
    v_add_u32 v3, s41, v3
    s_and_b32 s42, s31, 7
    s_lshl_b32 s42, s42, 1
    s_lshr_b32 s43, s28, 1
    s_add_u32 s42, s42, s43
    s_lshl_b32 s43, s42, 17
    s_add_u32 s68, s26, s43
    s_addc_u32 s69, s27, 0
    s_mul_i32 s43, s42, 458752
    s_lshl_b32 s44, s40, 10
    s_add_u32 s43, s43, s44
    s_add_u32 s70, s26, s43
    s_addc_u32 s71, s27, 0
    s_add_u32 s70, s70, 0x800000
    s_addc_u32 s71, s71, 0
    s_lshl_b32 s42, s42, 7
    s_add_u32 s42, s42, 0x407000
    v_mov_b32 v4, s42
    global_load_dwordx4 v[128:131], v8, s[68:69] offset:0 sc1
    global_load_dwordx4 v[132:135], v8, s[68:69] offset:1024 sc1
    global_load_dwordx4 v[136:139], v8, s[68:69] offset:2048 sc1
    global_load_dwordx4 v[140:143], v8, s[68:69] offset:3072 sc1
    global_load_dwordx4 v[144:147], v9, s[68:69] offset:0 sc1
    global_load_dwordx4 v[148:151], v9, s[68:69] offset:1024 sc1
    global_load_dwordx4 v[152:155], v9, s[68:69] offset:2048 sc1
    global_load_dwordx4 v[156:159], v9, s[68:69] offset:3072 sc1
    global_load_dwordx4 v[160:163], v10, s[68:69] offset:0 sc1
    global_load_dwordx4 v[164:167], v10, s[68:69] offset:1024 sc1
    global_load_dwordx4 v[168:171], v10, s[68:69] offset:2048 sc1
    global_load_dwordx4 v[172:175], v10, s[68:69] offset:3072 sc1
    global_load_dwordx4 v[176:179], v11, s[68:69] offset:0 sc1
    global_load_dwordx4 v[180:183], v11, s[68:69] offset:1024 sc1
    global_load_dwordx4 v[184:187], v11, s[68:69] offset:2048 sc1
    global_load_dwordx4 v[188:191], v11, s[68:69] offset:3072 sc1
    s_waitcnt vmcnt(0)
    s_mov_b32 s36, 0x0
    buffer_load_dword v20, v3, s[48:51], s36 offen
    buffer_load_dword v21, v3, s[48:51], s36 offen offset:3584
    s_mov_b32 s36, 0x1c00
    buffer_load_dword v22, v3, s[48:51], s36 offen
    buffer_load_dword v23, v3, s[48:51], s36 offen offset:3584
    s_mov_b32 s36, 0x3800
    buffer_load_dword v24, v3, s[48:51], s36 offen
    buffer_load_dword v25, v3, s[48:51], s36 offen offset:3584
    s_mov_b32 s36, 0x5400
    buffer_load_dword v26, v3, s[48:51], s36 offen
    buffer_load_dword v27, v3, s[48:51], s36 offen offset:3584
    s_mov_b32 s36, 0x1c000
    buffer_load_dword v28, v3, s[48:51], s36 offen
    buffer_load_dword v29, v3, s[48:51], s36 offen offset:3584
    s_mov_b32 s36, 0x1dc00
    buffer_load_dword v30, v3, s[48:51], s36 offen
    buffer_load_dword v31, v3, s[48:51], s36 offen offset:3584
    s_mov_b32 s36, 0x1f800
    buffer_load_dword v32, v3, s[48:51], s36 offen
    buffer_load_dword v33, v3, s[48:51], s36 offen offset:3584
    s_mov_b32 s36, 0x21400
    buffer_load_dword v34, v3, s[48:51], s36 offen
    buffer_load_dword v35, v3, s[48:51], s36 offen offset:3584
    s_mov_b32 s36, 0x38000
    buffer_load_dword v36, v3, s[48:51], s36 offen
    buffer_load_dword v37, v3, s[48:51], s36 offen offset:3584
    s_mov_b32 s36, 0x39c00
    buffer_load_dword v38, v3, s[48:51], s36 offen
    buffer_load_dword v39, v3, s[48:51], s36 offen offset:3584
    s_mov_b32 s36, 0x3b800
    buffer_load_dword v40, v3, s[48:51], s36 offen
    buffer_load_dword v41, v3, s[48:51], s36 offen offset:3584
    s_mov_b32 s36, 0x3d400
    buffer_load_dword v42, v3, s[48:51], s36 offen
    buffer_load_dword v43, v3, s[48:51], s36 offen offset:3584
    s_mov_b32 s36, 0x54000
    buffer_load_dword v44, v3, s[48:51], s36 offen
    buffer_load_dword v45, v3, s[48:51], s36 offen offset:3584
    s_mov_b32 s36, 0x55c00
    buffer_load_dword v46, v3, s[48:51], s36 offen
    buffer_load_dword v47, v3, s[48:51], s36 offen offset:3584
    s_mov_b32 s36, 0x57800
    buffer_load_dword v48, v3, s[48:51], s36 offen
    buffer_load_dword v49, v3, s[48:51], s36 offen offset:3584
    s_mov_b32 s36, 0x59400
    buffer_load_dword v50, v3, s[48:51], s36 offen
    buffer_load_dword v51, v3, s[48:51], s36 offen offset:3584
    s_mov_b32 s36, 0x70000
    buffer_load_dword v52, v3, s[48:51], s36 offen
    buffer_load_dword v53, v3, s[48:51], s36 offen offset:3584
    s_mov_b32 s36, 0x71c00
    buffer_load_dword v54, v3, s[48:51], s36 offen
    buffer_load_dword v55, v3, s[48:51], s36 offen offset:3584
    s_mov_b32 s36, 0x73800
    buffer_load_dword v56, v3, s[48:51], s36 offen
    buffer_load_dword v57, v3, s[48:51], s36 offen offset:3584
    s_mov_b32 s36, 0x75400
    buffer_load_dword v58, v3, s[48:51], s36 offen
    buffer_load_dword v59, v3, s[48:51], s36 offen offset:3584
    s_mov_b32 s36, 0x8c000
    buffer_load_dword v60, v3, s[48:51], s36 offen
    buffer_load_dword v61, v3, s[48:51], s36 offen offset:3584
    s_mov_b32 s36, 0x8dc00
    buffer_load_dword v62, v3, s[48:51], s36 offen
    buffer_load_dword v63, v3, s[48:51], s36 offen offset:3584
    s_mov_b32 s36, 0x8f800
    buffer_load_dword v64, v3, s[48:51], s36 offen
    buffer_load_dword v65, v3, s[48:51], s36 offen offset:3584
    s_mov_b32 s36, 0x91400
    buffer_load_dword v66, v3, s[48:51], s36 offen
    buffer_load_dword v67, v3, s[48:51], s36 offen offset:3584
    s_mov_b32 s36, 0xa8000
    buffer_load_dword v68, v3, s[48:51], s36 offen
    buffer_load_dword v69, v3, s[48:51], s36 offen offset:3584
    s_mov_b32 s36, 0xa9c00
    buffer_load_dword v70, v3, s[48:51], s36 offen
    buffer_load_dword v71, v3, s[48:51], s36 offen offset:3584
    s_mov_b32 s36, 0xab800
    buffer_load_dword v72, v3, s[48:51], s36 offen
    buffer_load_dword v73, v3, s[48:51], s36 offen offset:3584
    s_mov_b32 s36, 0xad400
    buffer_load_dword v74, v3, s[48:51], s36 offen
    buffer_load_dword v75, v3, s[48:51], s36 offen offset:3584
    s_waitcnt vmcnt(54)
    v_perm_b32 v16, v21, v20, s37
    v_accvgpr_write_b32 a0, v16
    v_perm_b32 v17, v21, v20, s38
    v_accvgpr_write_b32 a64, v17
    s_mov_b32 s36, 0xc4000
    buffer_load_dword v20, v3, s[48:51], s36 offen
    buffer_load_dword v21, v3, s[48:51], s36 offen offset:3584
    s_waitcnt vmcnt(54)
    v_perm_b32 v16, v23, v22, s37
    v_accvgpr_write_b32 a1, v16
    v_perm_b32 v17, v23, v22, s38
    v_accvgpr_write_b32 a65, v17
    s_mov_b32 s36, 0xc5c00
    buffer_load_dword v22, v3, s[48:51], s36 offen
    buffer_load_dword v23, v3, s[48:51], s36 offen offset:3584
    s_waitcnt vmcnt(54)
    v_perm_b32 v16, v25, v24, s37
    v_accvgpr_write_b32 a2, v16
    v_perm_b32 v17, v25, v24, s38
    v_accvgpr_write_b32 a66, v17
    s_mov_b32 s36, 0xc7800
    buffer_load_dword v24, v3, s[48:51], s36 offen
    buffer_load_dword v25, v3, s[48:51], s36 offen offset:3584
    s_waitcnt vmcnt(54)
    v_perm_b32 v16, v27, v26, s37
    v_accvgpr_write_b32 a3, v16
    v_perm_b32 v17, v27, v26, s38
    v_accvgpr_write_b32 a67, v17
    s_mov_b32 s36, 0xc9400
    buffer_load_dword v26, v3, s[48:51], s36 offen
    buffer_load_dword v27, v3, s[48:51], s36 offen offset:3584
    s_waitcnt vmcnt(54)
    v_perm_b32 v16, v29, v28, s37
    v_accvgpr_write_b32 a4, v16
    v_perm_b32 v17, v29, v28, s38
    v_accvgpr_write_b32 a68, v17
    s_mov_b32 s36, 0xe0000
    buffer_load_dword v28, v3, s[48:51], s36 offen
    buffer_load_dword v29, v3, s[48:51], s36 offen offset:3584
    s_waitcnt vmcnt(54)
    v_perm_b32 v16, v31, v30, s37
    v_accvgpr_write_b32 a5, v16
    v_perm_b32 v17, v31, v30, s38
    v_accvgpr_write_b32 a69, v17
    s_mov_b32 s36, 0xe1c00
    buffer_load_dword v30, v3, s[48:51], s36 offen
    buffer_load_dword v31, v3, s[48:51], s36 offen offset:3584
    s_waitcnt vmcnt(54)
    v_perm_b32 v16, v33, v32, s37
    v_accvgpr_write_b32 a6, v16
    v_perm_b32 v17, v33, v32, s38
    v_accvgpr_write_b32 a70, v17
    s_mov_b32 s36, 0xe3800
    buffer_load_dword v32, v3, s[48:51], s36 offen
    buffer_load_dword v33, v3, s[48:51], s36 offen offset:3584
    s_waitcnt vmcnt(54)
    v_perm_b32 v16, v35, v34, s37
    v_accvgpr_write_b32 a7, v16
    v_perm_b32 v17, v35, v34, s38
    v_accvgpr_write_b32 a71, v17
    s_mov_b32 s36, 0xe5400
    buffer_load_dword v34, v3, s[48:51], s36 offen
    buffer_load_dword v35, v3, s[48:51], s36 offen offset:3584
    s_waitcnt vmcnt(54)
    v_perm_b32 v16, v37, v36, s37
    v_accvgpr_write_b32 a8, v16
    v_perm_b32 v17, v37, v36, s38
    v_accvgpr_write_b32 a72, v17
    s_mov_b32 s36, 0xfc000
    buffer_load_dword v36, v3, s[48:51], s36 offen
    buffer_load_dword v37, v3, s[48:51], s36 offen offset:3584
    s_waitcnt vmcnt(54)
    v_perm_b32 v16, v39, v38, s37
    v_accvgpr_write_b32 a9, v16
    v_perm_b32 v17, v39, v38, s38
    v_accvgpr_write_b32 a73, v17
    s_mov_b32 s36, 0xfdc00
    buffer_load_dword v38, v3, s[48:51], s36 offen
    buffer_load_dword v39, v3, s[48:51], s36 offen offset:3584
    s_waitcnt vmcnt(54)
    v_perm_b32 v16, v41, v40, s37
    v_accvgpr_write_b32 a10, v16
    v_perm_b32 v17, v41, v40, s38
    v_accvgpr_write_b32 a74, v17
    s_mov_b32 s36, 0xff800
    buffer_load_dword v40, v3, s[48:51], s36 offen
    buffer_load_dword v41, v3, s[48:51], s36 offen offset:3584
    s_waitcnt vmcnt(54)
    v_perm_b32 v16, v43, v42, s37
    v_accvgpr_write_b32 a11, v16
    v_perm_b32 v17, v43, v42, s38
    v_accvgpr_write_b32 a75, v17
    s_mov_b32 s36, 0x101400
    buffer_load_dword v42, v3, s[48:51], s36 offen
    buffer_load_dword v43, v3, s[48:51], s36 offen offset:3584
    s_waitcnt vmcnt(54)
    v_perm_b32 v16, v45, v44, s37
    v_accvgpr_write_b32 a12, v16
    v_perm_b32 v17, v45, v44, s38
    v_accvgpr_write_b32 a76, v17
    s_mov_b32 s36, 0x118000
    buffer_load_dword v44, v3, s[48:51], s36 offen
    buffer_load_dword v45, v3, s[48:51], s36 offen offset:3584
    s_waitcnt vmcnt(54)
    v_perm_b32 v16, v47, v46, s37
    v_accvgpr_write_b32 a13, v16
    v_perm_b32 v17, v47, v46, s38
    v_accvgpr_write_b32 a77, v17
    s_mov_b32 s36, 0x119c00
    buffer_load_dword v46, v3, s[48:51], s36 offen
    buffer_load_dword v47, v3, s[48:51], s36 offen offset:3584
    s_waitcnt vmcnt(54)
    v_perm_b32 v16, v49, v48, s37
    v_accvgpr_write_b32 a14, v16
    v_perm_b32 v17, v49, v48, s38
    v_accvgpr_write_b32 a78, v17
    s_mov_b32 s36, 0x11b800
    buffer_load_dword v48, v3, s[48:51], s36 offen
    buffer_load_dword v49, v3, s[48:51], s36 offen offset:3584
    s_waitcnt vmcnt(54)
    v_perm_b32 v16, v51, v50, s37
    v_accvgpr_write_b32 a15, v16
    v_perm_b32 v17, v51, v50, s38
    v_accvgpr_write_b32 a79, v17
    s_mov_b32 s36, 0x11d400
    buffer_load_dword v50, v3, s[48:51], s36 offen
    buffer_load_dword v51, v3, s[48:51], s36 offen offset:3584
    s_waitcnt vmcnt(54)
    v_perm_b32 v16, v53, v52, s37
    v_accvgpr_write_b32 a16, v16
    v_perm_b32 v17, v53, v52, s38
    v_accvgpr_write_b32 a80, v17
    s_mov_b32 s36, 0x134000
    buffer_load_dword v52, v3, s[48:51], s36 offen
    buffer_load_dword v53, v3, s[48:51], s36 offen offset:3584
    s_waitcnt vmcnt(54)
    v_perm_b32 v16, v55, v54, s37
    v_accvgpr_write_b32 a17, v16
    v_perm_b32 v17, v55, v54, s38
    v_accvgpr_write_b32 a81, v17
    s_mov_b32 s36, 0x135c00
    buffer_load_dword v54, v3, s[48:51], s36 offen
    buffer_load_dword v55, v3, s[48:51], s36 offen offset:3584
    s_waitcnt vmcnt(54)
    v_perm_b32 v16, v57, v56, s37
    v_accvgpr_write_b32 a18, v16
    v_perm_b32 v17, v57, v56, s38
    v_accvgpr_write_b32 a82, v17
    s_mov_b32 s36, 0x137800
    buffer_load_dword v56, v3, s[48:51], s36 offen
    buffer_load_dword v57, v3, s[48:51], s36 offen offset:3584
    s_waitcnt vmcnt(54)
    v_perm_b32 v16, v59, v58, s37
    v_accvgpr_write_b32 a19, v16
    v_perm_b32 v17, v59, v58, s38
    v_accvgpr_write_b32 a83, v17
    s_mov_b32 s36, 0x139400
    buffer_load_dword v58, v3, s[48:51], s36 offen
    buffer_load_dword v59, v3, s[48:51], s36 offen offset:3584
    s_waitcnt vmcnt(54)
    v_perm_b32 v16, v61, v60, s37
    v_accvgpr_write_b32 a20, v16
    v_perm_b32 v17, v61, v60, s38
    v_accvgpr_write_b32 a84, v17
    s_mov_b32 s36, 0x150000
    buffer_load_dword v60, v3, s[48:51], s36 offen
    buffer_load_dword v61, v3, s[48:51], s36 offen offset:3584
    s_waitcnt vmcnt(54)
    v_perm_b32 v16, v63, v62, s37
    v_accvgpr_write_b32 a21, v16
    v_perm_b32 v17, v63, v62, s38
    v_accvgpr_write_b32 a85, v17
    s_mov_b32 s36, 0x151c00
    buffer_load_dword v62, v3, s[48:51], s36 offen
    buffer_load_dword v63, v3, s[48:51], s36 offen offset:3584
    s_waitcnt vmcnt(54)
    v_perm_b32 v16, v65, v64, s37
    v_accvgpr_write_b32 a22, v16
    v_perm_b32 v17, v65, v64, s38
    v_accvgpr_write_b32 a86, v17
    s_mov_b32 s36, 0x153800
    buffer_load_dword v64, v3, s[48:51], s36 offen
    buffer_load_dword v65, v3, s[48:51], s36 offen offset:3584
    s_waitcnt vmcnt(54)
    v_perm_b32 v16, v67, v66, s37
    v_accvgpr_write_b32 a23, v16
    v_perm_b32 v17, v67, v66, s38
    v_accvgpr_write_b32 a87, v17
    s_mov_b32 s36, 0x155400
    buffer_load_dword v66, v3, s[48:51], s36 offen
    buffer_load_dword v67, v3, s[48:51], s36 offen offset:3584
    s_waitcnt vmcnt(54)
    v_perm_b32 v16, v69, v68, s37
    v_accvgpr_write_b32 a24, v16
    v_perm_b32 v17, v69, v68, s38
    v_accvgpr_write_b32 a88, v17
    s_mov_b32 s36, 0x16c000
    buffer_load_dword v68, v3, s[48:51], s36 offen
    buffer_load_dword v69, v3, s[48:51], s36 offen offset:3584
    s_waitcnt vmcnt(54)
    v_perm_b32 v16, v71, v70, s37
    v_accvgpr_write_b32 a25, v16
    v_perm_b32 v17, v71, v70, s38
    v_accvgpr_write_b32 a89, v17
    s_mov_b32 s36, 0x16dc00
    buffer_load_dword v70, v3, s[48:51], s36 offen
    buffer_load_dword v71, v3, s[48:51], s36 offen offset:3584
    s_waitcnt vmcnt(54)
    v_perm_b32 v16, v73, v72, s37
    v_accvgpr_write_b32 a26, v16
    v_perm_b32 v17, v73, v72, s38
    v_accvgpr_write_b32 a90, v17
    s_mov_b32 s36, 0x16f800
    buffer_load_dword v72, v3, s[48:51], s36 offen
    buffer_load_dword v73, v3, s[48:51], s36 offen offset:3584
    s_waitcnt vmcnt(54)
    v_perm_b32 v16, v75, v74, s37
    v_accvgpr_write_b32 a27, v16
    v_perm_b32 v17, v75, v74, s38
    v_accvgpr_write_b32 a91, v17
    s_mov_b32 s36, 0x171400
    buffer_load_dword v74, v3, s[48:51], s36 offen
    buffer_load_dword v75, v3, s[48:51], s36 offen offset:3584
    s_waitcnt vmcnt(54)
    v_perm_b32 v16, v21, v20, s37
    v_accvgpr_write_b32 a28, v16
    v_perm_b32 v17, v21, v20, s38
    v_accvgpr_write_b32 a92, v17
    s_mov_b32 s36, 0x188000
    buffer_load_dword v20, v3, s[48:51], s36 offen
    buffer_load_dword v21, v3, s[48:51], s36 offen offset:3584
    s_waitcnt vmcnt(54)
    v_perm_b32 v16, v23, v22, s37
    v_accvgpr_write_b32 a29, v16
    v_perm_b32 v17, v23, v22, s38
    v_accvgpr_write_b32 a93, v17
    s_mov_b32 s36, 0x189c00
    buffer_load_dword v22, v3, s[48:51], s36 offen
    buffer_load_dword v23, v3, s[48:51], s36 offen offset:3584
    s_waitcnt vmcnt(54)
    v_perm_b32 v16, v25, v24, s37
    v_accvgpr_write_b32 a30, v16
    v_perm_b32 v17, v25, v24, s38
    v_accvgpr_write_b32 a94, v17
    s_mov_b32 s36, 0x18b800
    buffer_load_dword v24, v3, s[48:51], s36 offen
    buffer_load_dword v25, v3, s[48:51], s36 offen offset:3584
    s_waitcnt vmcnt(54)
    v_perm_b32 v16, v27, v26, s37
    v_accvgpr_write_b32 a31, v16
    v_perm_b32 v17, v27, v26, s38
    v_accvgpr_write_b32 a95, v17
    s_mov_b32 s36, 0x18d400
    buffer_load_dword v26, v3, s[48:51], s36 offen
    buffer_load_dword v27, v3, s[48:51], s36 offen offset:3584
    s_waitcnt vmcnt(54)
    v_perm_b32 v16, v29, v28, s37
    v_accvgpr_write_b32 a32, v16
    v_perm_b32 v17, v29, v28, s38
    v_accvgpr_write_b32 a96, v17
    s_mov_b32 s36, 0x1a4000
    buffer_load_dword v28, v3, s[48:51], s36 offen
    buffer_load_dword v29, v3, s[48:51], s36 offen offset:3584
    s_waitcnt vmcnt(54)
    v_perm_b32 v16, v31, v30, s37
    v_accvgpr_write_b32 a33, v16
    v_perm_b32 v17, v31, v30, s38
    v_accvgpr_write_b32 a97, v17
    s_mov_b32 s36, 0x1a5c00
    buffer_load_dword v30, v3, s[48:51], s36 offen
    buffer_load_dword v31, v3, s[48:51], s36 offen offset:3584
    s_waitcnt vmcnt(54)
    v_perm_b32 v16, v33, v32, s37
    v_accvgpr_write_b32 a34, v16
    v_perm_b32 v17, v33, v32, s38
    v_accvgpr_write_b32 a98, v17
    s_mov_b32 s36, 0x1a7800
    buffer_load_dword v32, v3, s[48:51], s36 offen
    buffer_load_dword v33, v3, s[48:51], s36 offen offset:3584
    s_waitcnt vmcnt(54)
    v_perm_b32 v16, v35, v34, s37
    v_accvgpr_write_b32 a35, v16
    v_perm_b32 v17, v35, v34, s38
    v_accvgpr_write_b32 a99, v17
    s_mov_b32 s36, 0x1a9400
    buffer_load_dword v34, v3, s[48:51], s36 offen
    buffer_load_dword v35, v3, s[48:51], s36 offen offset:3584
    s_waitcnt vmcnt(54)
    v_perm_b32 v16, v37, v36, s37
    v_accvgpr_write_b32 a36, v16
    v_perm_b32 v17, v37, v36, s38
    v_accvgpr_write_b32 a100, v17
    s_mov_b32 s36, 0x0
    buffer_load_dword v36, v3, s[52:55], s36 offen
    buffer_load_dword v37, v3, s[52:55], s36 offen offset:3584
    s_waitcnt vmcnt(54)
    v_perm_b32 v16, v39, v38, s37
    v_accvgpr_write_b32 a37, v16
    v_perm_b32 v17, v39, v38, s38
    v_accvgpr_write_b32 a101, v17
    s_mov_b32 s36, 0x1c00
    buffer_load_dword v38, v3, s[52:55], s36 offen
    buffer_load_dword v39, v3, s[52:55], s36 offen offset:3584
    s_waitcnt vmcnt(54)
    v_perm_b32 v16, v41, v40, s37
    v_accvgpr_write_b32 a38, v16
    v_perm_b32 v17, v41, v40, s38
    v_accvgpr_write_b32 a102, v17
    s_mov_b32 s36, 0x3800
    buffer_load_dword v40, v3, s[52:55], s36 offen
    buffer_load_dword v41, v3, s[52:55], s36 offen offset:3584
    s_waitcnt vmcnt(54)
    v_perm_b32 v16, v43, v42, s37
    v_accvgpr_write_b32 a39, v16
    v_perm_b32 v17, v43, v42, s38
    v_accvgpr_write_b32 a103, v17
    s_mov_b32 s36, 0x5400
    buffer_load_dword v42, v3, s[52:55], s36 offen
    buffer_load_dword v43, v3, s[52:55], s36 offen offset:3584
    s_waitcnt vmcnt(54)
    v_perm_b32 v16, v45, v44, s37
    v_accvgpr_write_b32 a40, v16
    v_perm_b32 v17, v45, v44, s38
    v_accvgpr_write_b32 a104, v17
    s_mov_b32 s36, 0x1c000
    buffer_load_dword v44, v3, s[52:55], s36 offen
    buffer_load_dword v45, v3, s[52:55], s36 offen offset:3584
    s_waitcnt vmcnt(54)
    v_perm_b32 v16, v47, v46, s37
    v_accvgpr_write_b32 a41, v16
    v_perm_b32 v17, v47, v46, s38
    v_accvgpr_write_b32 a105, v17
    s_mov_b32 s36, 0x1dc00
    buffer_load_dword v46, v3, s[52:55], s36 offen
    buffer_load_dword v47, v3, s[52:55], s36 offen offset:3584
    s_waitcnt vmcnt(54)
    v_perm_b32 v16, v49, v48, s37
    v_accvgpr_write_b32 a42, v16
    v_perm_b32 v17, v49, v48, s38
    v_accvgpr_write_b32 a106, v17
    s_mov_b32 s36, 0x1f800
    buffer_load_dword v48, v3, s[52:55], s36 offen
    buffer_load_dword v49, v3, s[52:55], s36 offen offset:3584
    s_waitcnt vmcnt(54)
    v_perm_b32 v16, v51, v50, s37
    v_accvgpr_write_b32 a43, v16
    v_perm_b32 v17, v51, v50, s38
    v_accvgpr_write_b32 a107, v17
    s_mov_b32 s36, 0x21400
    buffer_load_dword v50, v3, s[52:55], s36 offen
    buffer_load_dword v51, v3, s[52:55], s36 offen offset:3584
    s_waitcnt vmcnt(54)
    v_perm_b32 v16, v53, v52, s37
    v_accvgpr_write_b32 a44, v16
    v_perm_b32 v17, v53, v52, s38
    v_accvgpr_write_b32 a108, v17
    s_mov_b32 s36, 0x38000
    buffer_load_dword v52, v3, s[52:55], s36 offen
    buffer_load_dword v53, v3, s[52:55], s36 offen offset:3584
    s_waitcnt vmcnt(54)
    v_perm_b32 v16, v55, v54, s37
    v_accvgpr_write_b32 a45, v16
    v_perm_b32 v17, v55, v54, s38
    v_accvgpr_write_b32 a109, v17
    s_mov_b32 s36, 0x39c00
    buffer_load_dword v54, v3, s[52:55], s36 offen
    buffer_load_dword v55, v3, s[52:55], s36 offen offset:3584
    s_waitcnt vmcnt(54)
    v_perm_b32 v16, v57, v56, s37
    v_accvgpr_write_b32 a46, v16
    v_perm_b32 v17, v57, v56, s38
    v_accvgpr_write_b32 a110, v17
    s_mov_b32 s36, 0x3b800
    buffer_load_dword v56, v3, s[52:55], s36 offen
    buffer_load_dword v57, v3, s[52:55], s36 offen offset:3584
    s_waitcnt vmcnt(54)
    v_perm_b32 v16, v59, v58, s37
    v_accvgpr_write_b32 a47, v16
    v_perm_b32 v17, v59, v58, s38
    v_accvgpr_write_b32 a111, v17
    s_mov_b32 s36, 0x3d400
    buffer_load_dword v58, v3, s[52:55], s36 offen
    buffer_load_dword v59, v3, s[52:55], s36 offen offset:3584
    s_waitcnt vmcnt(54)
    v_perm_b32 v16, v61, v60, s37
    v_accvgpr_write_b32 a48, v16
    v_perm_b32 v17, v61, v60, s38
    v_accvgpr_write_b32 a112, v17
    s_mov_b32 s36, 0x54000
    buffer_load_dword v60, v3, s[52:55], s36 offen
    buffer_load_dword v61, v3, s[52:55], s36 offen offset:3584
    s_waitcnt vmcnt(54)
    v_perm_b32 v16, v63, v62, s37
    v_accvgpr_write_b32 a49, v16
    v_perm_b32 v17, v63, v62, s38
    v_accvgpr_write_b32 a113, v17
    s_mov_b32 s36, 0x55c00
    buffer_load_dword v62, v3, s[52:55], s36 offen
    buffer_load_dword v63, v3, s[52:55], s36 offen offset:3584
    s_waitcnt vmcnt(54)
    v_perm_b32 v16, v65, v64, s37
    v_accvgpr_write_b32 a50, v16
    v_perm_b32 v17, v65, v64, s38
    v_accvgpr_write_b32 a114, v17
    s_mov_b32 s36, 0x57800
    buffer_load_dword v64, v3, s[52:55], s36 offen
    buffer_load_dword v65, v3, s[52:55], s36 offen offset:3584
    s_waitcnt vmcnt(54)
    v_perm_b32 v16, v67, v66, s37
    v_accvgpr_write_b32 a51, v16
    v_perm_b32 v17, v67, v66, s38
    v_accvgpr_write_b32 a115, v17
    s_mov_b32 s36, 0x59400
    buffer_load_dword v66, v3, s[52:55], s36 offen
    buffer_load_dword v67, v3, s[52:55], s36 offen offset:3584
    s_waitcnt vmcnt(54)
    v_perm_b32 v16, v69, v68, s37
    v_accvgpr_write_b32 a52, v16
    v_perm_b32 v17, v69, v68, s38
    v_accvgpr_write_b32 a116, v17
    s_mov_b32 s36, 0x70000
    buffer_load_dword v68, v3, s[52:55], s36 offen
    buffer_load_dword v69, v3, s[52:55], s36 offen offset:3584
    s_waitcnt vmcnt(54)
    v_perm_b32 v16, v71, v70, s37
    v_accvgpr_write_b32 a53, v16
    v_perm_b32 v17, v71, v70, s38
    v_accvgpr_write_b32 a117, v17
    s_mov_b32 s36, 0x71c00
    buffer_load_dword v70, v3, s[52:55], s36 offen
    buffer_load_dword v71, v3, s[52:55], s36 offen offset:3584
    s_waitcnt vmcnt(54)
    v_perm_b32 v16, v73, v72, s37
    v_accvgpr_write_b32 a54, v16
    v_perm_b32 v17, v73, v72, s38
    v_accvgpr_write_b32 a118, v17
    s_mov_b32 s36, 0x73800
    buffer_load_dword v72, v3, s[52:55], s36 offen
    buffer_load_dword v73, v3, s[52:55], s36 offen offset:3584
    s_waitcnt vmcnt(54)
    v_perm_b32 v16, v75, v74, s37
    v_accvgpr_write_b32 a55, v16
    v_perm_b32 v17, v75, v74, s38
    v_accvgpr_write_b32 a119, v17
    s_mov_b32 s36, 0x75400
    buffer_load_dword v74, v3, s[52:55], s36 offen
    buffer_load_dword v75, v3, s[52:55], s36 offen offset:3584
    s_waitcnt vmcnt(54)
    v_perm_b32 v16, v21, v20, s37
    v_accvgpr_write_b32 a56, v16
    v_perm_b32 v17, v21, v20, s38
    v_accvgpr_write_b32 a120, v17
    s_mov_b32 s36, 0x8c000
    buffer_load_dword v20, v3, s[52:55], s36 offen
    buffer_load_dword v21, v3, s[52:55], s36 offen offset:3584
    s_waitcnt vmcnt(54)
    v_perm_b32 v16, v23, v22, s37
    v_accvgpr_write_b32 a57, v16
    v_perm_b32 v17, v23, v22, s38
    v_accvgpr_write_b32 a121, v17
    s_mov_b32 s36, 0x8dc00
    buffer_load_dword v22, v3, s[52:55], s36 offen
    buffer_load_dword v23, v3, s[52:55], s36 offen offset:3584
    s_waitcnt vmcnt(54)
    v_perm_b32 v16, v25, v24, s37
    v_accvgpr_write_b32 a58, v16
    v_perm_b32 v17, v25, v24, s38
    v_accvgpr_write_b32 a122, v17
    s_mov_b32 s36, 0x8f800
    buffer_load_dword v24, v3, s[52:55], s36 offen
    buffer_load_dword v25, v3, s[52:55], s36 offen offset:3584
    s_waitcnt vmcnt(54)
    v_perm_b32 v16, v27, v26, s37
    v_accvgpr_write_b32 a59, v16
    v_perm_b32 v17, v27, v26, s38
    v_accvgpr_write_b32 a123, v17
    s_mov_b32 s36, 0x91400
    buffer_load_dword v26, v3, s[52:55], s36 offen
    buffer_load_dword v27, v3, s[52:55], s36 offen offset:3584
    s_waitcnt vmcnt(54)
    v_perm_b32 v16, v29, v28, s37
    v_accvgpr_write_b32 a60, v16
    v_perm_b32 v17, v29, v28, s38
    v_accvgpr_write_b32 a124, v17
    s_mov_b32 s36, 0xa8000
    buffer_load_dword v28, v3, s[52:55], s36 offen
    buffer_load_dword v29, v3, s[52:55], s36 offen offset:3584
    s_waitcnt vmcnt(54)
    v_perm_b32 v16, v31, v30, s37
    v_accvgpr_write_b32 a61, v16
    v_perm_b32 v17, v31, v30, s38
    v_accvgpr_write_b32 a125, v17
    s_mov_b32 s36, 0xa9c00
    buffer_load_dword v30, v3, s[52:55], s36 offen
    buffer_load_dword v31, v3, s[52:55], s36 offen offset:3584
    s_waitcnt vmcnt(54)
    v_perm_b32 v16, v33, v32, s37
    v_accvgpr_write_b32 a62, v16
    v_perm_b32 v17, v33, v32, s38
    v_accvgpr_write_b32 a126, v17
    s_mov_b32 s36, 0xab800
    buffer_load_dword v32, v3, s[52:55], s36 offen
    buffer_load_dword v33, v3, s[52:55], s36 offen offset:3584
    s_waitcnt vmcnt(54)
    v_perm_b32 v16, v35, v34, s37
    v_accvgpr_write_b32 a63, v16
    v_perm_b32 v17, v35, v34, s38
    v_accvgpr_write_b32 a127, v17
    s_mov_b32 s36, 0xad400
    buffer_load_dword v34, v3, s[52:55], s36 offen
    buffer_load_dword v35, v3, s[52:55], s36 offen offset:3584
    s_waitcnt vmcnt(54)
    v_perm_b32 v16, v37, v36, s37
    v_accvgpr_write_b32 a128, v16
    v_perm_b32 v17, v37, v36, s38
    v_accvgpr_write_b32 a192, v17
    s_mov_b32 s36, 0xc4000
    buffer_load_dword v36, v3, s[52:55], s36 offen
    buffer_load_dword v37, v3, s[52:55], s36 offen offset:3584
    s_waitcnt vmcnt(54)
    v_perm_b32 v16, v39, v38, s37
    v_accvgpr_write_b32 a129, v16
    v_perm_b32 v17, v39, v38, s38
    v_accvgpr_write_b32 a193, v17
    s_mov_b32 s36, 0xc5c00
    buffer_load_dword v38, v3, s[52:55], s36 offen
    buffer_load_dword v39, v3, s[52:55], s36 offen offset:3584
    s_waitcnt vmcnt(54)
    v_perm_b32 v16, v41, v40, s37
    v_accvgpr_write_b32 a130, v16
    v_perm_b32 v17, v41, v40, s38
    v_accvgpr_write_b32 a194, v17
    s_mov_b32 s36, 0xc7800
    buffer_load_dword v40, v3, s[52:55], s36 offen
    buffer_load_dword v41, v3, s[52:55], s36 offen offset:3584
    s_waitcnt vmcnt(54)
    v_perm_b32 v16, v43, v42, s37
    v_accvgpr_write_b32 a131, v16
    v_perm_b32 v17, v43, v42, s38
    v_accvgpr_write_b32 a195, v17
    s_mov_b32 s36, 0xc9400
    buffer_load_dword v42, v3, s[52:55], s36 offen
    buffer_load_dword v43, v3, s[52:55], s36 offen offset:3584
    s_waitcnt vmcnt(54)
    v_perm_b32 v16, v45, v44, s37
    v_accvgpr_write_b32 a132, v16
    v_perm_b32 v17, v45, v44, s38
    v_accvgpr_write_b32 a196, v17
    s_mov_b32 s36, 0xe0000
    buffer_load_dword v44, v3, s[52:55], s36 offen
    buffer_load_dword v45, v3, s[52:55], s36 offen offset:3584
    s_waitcnt vmcnt(54)
    v_perm_b32 v16, v47, v46, s37
    v_accvgpr_write_b32 a133, v16
    v_perm_b32 v17, v47, v46, s38
    v_accvgpr_write_b32 a197, v17
    s_mov_b32 s36, 0xe1c00
    buffer_load_dword v46, v3, s[52:55], s36 offen
    buffer_load_dword v47, v3, s[52:55], s36 offen offset:3584
    s_waitcnt vmcnt(54)
    v_perm_b32 v16, v49, v48, s37
    v_accvgpr_write_b32 a134, v16
    v_perm_b32 v17, v49, v48, s38
    v_accvgpr_write_b32 a198, v17
    s_mov_b32 s36, 0xe3800
    buffer_load_dword v48, v3, s[52:55], s36 offen
    buffer_load_dword v49, v3, s[52:55], s36 offen offset:3584
    s_waitcnt vmcnt(54)
    v_perm_b32 v16, v51, v50, s37
    v_accvgpr_write_b32 a135, v16
    v_perm_b32 v17, v51, v50, s38
    v_accvgpr_write_b32 a199, v17
    s_mov_b32 s36, 0xe5400
    buffer_load_dword v50, v3, s[52:55], s36 offen
    buffer_load_dword v51, v3, s[52:55], s36 offen offset:3584
    s_waitcnt vmcnt(54)
    v_perm_b32 v16, v53, v52, s37
    v_accvgpr_write_b32 a136, v16
    v_perm_b32 v17, v53, v52, s38
    v_accvgpr_write_b32 a200, v17
    s_mov_b32 s36, 0xfc000
    buffer_load_dword v52, v3, s[52:55], s36 offen
    buffer_load_dword v53, v3, s[52:55], s36 offen offset:3584
    s_waitcnt vmcnt(54)
    v_perm_b32 v16, v55, v54, s37
    v_accvgpr_write_b32 a137, v16
    v_perm_b32 v17, v55, v54, s38
    v_accvgpr_write_b32 a201, v17
    s_mov_b32 s36, 0xfdc00
    buffer_load_dword v54, v3, s[52:55], s36 offen
    buffer_load_dword v55, v3, s[52:55], s36 offen offset:3584
    s_waitcnt vmcnt(54)
    v_perm_b32 v16, v57, v56, s37
    v_accvgpr_write_b32 a138, v16
    v_perm_b32 v17, v57, v56, s38
    v_accvgpr_write_b32 a202, v17
    s_mov_b32 s36, 0xff800
    buffer_load_dword v56, v3, s[52:55], s36 offen
    buffer_load_dword v57, v3, s[52:55], s36 offen offset:3584
    s_waitcnt vmcnt(54)
    v_perm_b32 v16, v59, v58, s37
    v_accvgpr_write_b32 a139, v16
    v_perm_b32 v17, v59, v58, s38
    v_accvgpr_write_b32 a203, v17
    s_mov_b32 s36, 0x101400
    buffer_load_dword v58, v3, s[52:55], s36 offen
    buffer_load_dword v59, v3, s[52:55], s36 offen offset:3584
    s_waitcnt vmcnt(54)
    v_perm_b32 v16, v61, v60, s37
    v_accvgpr_write_b32 a140, v16
    v_perm_b32 v17, v61, v60, s38
    v_accvgpr_write_b32 a204, v17
    s_mov_b32 s36, 0x118000
    buffer_load_dword v60, v3, s[52:55], s36 offen
    buffer_load_dword v61, v3, s[52:55], s36 offen offset:3584
    s_waitcnt vmcnt(54)
    v_perm_b32 v16, v63, v62, s37
    v_accvgpr_write_b32 a141, v16
    v_perm_b32 v17, v63, v62, s38
    v_accvgpr_write_b32 a205, v17
    s_mov_b32 s36, 0x119c00
    buffer_load_dword v62, v3, s[52:55], s36 offen
    buffer_load_dword v63, v3, s[52:55], s36 offen offset:3584
    s_waitcnt vmcnt(54)
    v_perm_b32 v16, v65, v64, s37
    v_accvgpr_write_b32 a142, v16
    v_perm_b32 v17, v65, v64, s38
    v_accvgpr_write_b32 a206, v17
    s_mov_b32 s36, 0x11b800
    buffer_load_dword v64, v3, s[52:55], s36 offen
    buffer_load_dword v65, v3, s[52:55], s36 offen offset:3584
    s_waitcnt vmcnt(54)
    v_perm_b32 v16, v67, v66, s37
    v_accvgpr_write_b32 a143, v16
    v_perm_b32 v17, v67, v66, s38
    v_accvgpr_write_b32 a207, v17
    s_mov_b32 s36, 0x11d400
    buffer_load_dword v66, v3, s[52:55], s36 offen
    buffer_load_dword v67, v3, s[52:55], s36 offen offset:3584
    s_waitcnt vmcnt(54)
    v_perm_b32 v16, v69, v68, s37
    v_accvgpr_write_b32 a144, v16
    v_perm_b32 v17, v69, v68, s38
    v_accvgpr_write_b32 a208, v17
    s_mov_b32 s36, 0x134000
    buffer_load_dword v68, v3, s[52:55], s36 offen
    buffer_load_dword v69, v3, s[52:55], s36 offen offset:3584
    s_waitcnt vmcnt(54)
    v_perm_b32 v16, v71, v70, s37
    v_accvgpr_write_b32 a145, v16
    v_perm_b32 v17, v71, v70, s38
    v_accvgpr_write_b32 a209, v17
    s_mov_b32 s36, 0x135c00
    buffer_load_dword v70, v3, s[52:55], s36 offen
    buffer_load_dword v71, v3, s[52:55], s36 offen offset:3584
    s_waitcnt vmcnt(54)
    v_perm_b32 v16, v73, v72, s37
    v_accvgpr_write_b32 a146, v16
    v_perm_b32 v17, v73, v72, s38
    v_accvgpr_write_b32 a210, v17
    s_mov_b32 s36, 0x137800
    buffer_load_dword v72, v3, s[52:55], s36 offen
    buffer_load_dword v73, v3, s[52:55], s36 offen offset:3584
    s_waitcnt vmcnt(54)
    v_perm_b32 v16, v75, v74, s37
    v_accvgpr_write_b32 a147, v16
    v_perm_b32 v17, v75, v74, s38
    v_accvgpr_write_b32 a211, v17
    s_mov_b32 s36, 0x139400
    buffer_load_dword v74, v3, s[52:55], s36 offen
    buffer_load_dword v75, v3, s[52:55], s36 offen offset:3584
    s_waitcnt vmcnt(54)
    v_perm_b32 v16, v21, v20, s37
    v_accvgpr_write_b32 a148, v16
    v_perm_b32 v17, v21, v20, s38
    v_accvgpr_write_b32 a212, v17
    s_mov_b32 s36, 0x150000
    buffer_load_dword v20, v3, s[52:55], s36 offen
    buffer_load_dword v21, v3, s[52:55], s36 offen offset:3584
    s_waitcnt vmcnt(54)
    v_perm_b32 v16, v23, v22, s37
    v_accvgpr_write_b32 a149, v16
    v_perm_b32 v17, v23, v22, s38
    v_accvgpr_write_b32 a213, v17
    s_mov_b32 s36, 0x151c00
    buffer_load_dword v22, v3, s[52:55], s36 offen
    buffer_load_dword v23, v3, s[52:55], s36 offen offset:3584
    s_waitcnt vmcnt(54)
    v_perm_b32 v16, v25, v24, s37
    v_accvgpr_write_b32 a150, v16
    v_perm_b32 v17, v25, v24, s38
    v_accvgpr_write_b32 a214, v17
    s_mov_b32 s36, 0x153800
    buffer_load_dword v24, v3, s[52:55], s36 offen
    buffer_load_dword v25, v3, s[52:55], s36 offen offset:3584
    s_waitcnt vmcnt(54)
    v_perm_b32 v16, v27, v26, s37
    v_accvgpr_write_b32 a151, v16
    v_perm_b32 v17, v27, v26, s38
    v_accvgpr_write_b32 a215, v17
    s_mov_b32 s36, 0x155400
    buffer_load_dword v26, v3, s[52:55], s36 offen
    buffer_load_dword v27, v3, s[52:55], s36 offen offset:3584
    s_waitcnt vmcnt(54)
    v_perm_b32 v16, v29, v28, s37
    v_accvgpr_write_b32 a152, v16
    v_perm_b32 v17, v29, v28, s38
    v_accvgpr_write_b32 a216, v17
    s_mov_b32 s36, 0x16c000
    buffer_load_dword v28, v3, s[52:55], s36 offen
    buffer_load_dword v29, v3, s[52:55], s36 offen offset:3584
    s_waitcnt vmcnt(54)
    v_perm_b32 v16, v31, v30, s37
    v_accvgpr_write_b32 a153, v16
    v_perm_b32 v17, v31, v30, s38
    v_accvgpr_write_b32 a217, v17
    s_mov_b32 s36, 0x16dc00
    buffer_load_dword v30, v3, s[52:55], s36 offen
    buffer_load_dword v31, v3, s[52:55], s36 offen offset:3584
    s_waitcnt vmcnt(54)
    v_perm_b32 v16, v33, v32, s37
    v_accvgpr_write_b32 a154, v16
    v_perm_b32 v17, v33, v32, s38
    v_accvgpr_write_b32 a218, v17
    s_mov_b32 s36, 0x16f800
    buffer_load_dword v32, v3, s[52:55], s36 offen
    buffer_load_dword v33, v3, s[52:55], s36 offen offset:3584
    s_waitcnt vmcnt(54)
    v_perm_b32 v16, v35, v34, s37
    v_accvgpr_write_b32 a155, v16
    v_perm_b32 v17, v35, v34, s38
    v_accvgpr_write_b32 a219, v17
    s_mov_b32 s36, 0x171400
    buffer_load_dword v34, v3, s[52:55], s36 offen
    buffer_load_dword v35, v3, s[52:55], s36 offen offset:3584
    s_waitcnt vmcnt(54)
    v_perm_b32 v16, v37, v36, s37
    v_accvgpr_write_b32 a156, v16
    v_perm_b32 v17, v37, v36, s38
    v_accvgpr_write_b32 a220, v17
    s_mov_b32 s36, 0x188000
    buffer_load_dword v36, v3, s[52:55], s36 offen
    buffer_load_dword v37, v3, s[52:55], s36 offen offset:3584
    s_waitcnt vmcnt(54)
    v_perm_b32 v16, v39, v38, s37
    v_accvgpr_write_b32 a157, v16
    v_perm_b32 v17, v39, v38, s38
    v_accvgpr_write_b32 a221, v17
    s_mov_b32 s36, 0x189c00
    buffer_load_dword v38, v3, s[52:55], s36 offen
    buffer_load_dword v39, v3, s[52:55], s36 offen offset:3584
    s_waitcnt vmcnt(54)
    v_perm_b32 v16, v41, v40, s37
    v_accvgpr_write_b32 a158, v16
    v_perm_b32 v17, v41, v40, s38
    v_accvgpr_write_b32 a222, v17
    s_mov_b32 s36, 0x18b800
    buffer_load_dword v40, v3, s[52:55], s36 offen
    buffer_load_dword v41, v3, s[52:55], s36 offen offset:3584
    s_waitcnt vmcnt(54)
    v_perm_b32 v16, v43, v42, s37
    v_accvgpr_write_b32 a159, v16
    v_perm_b32 v17, v43, v42, s38
    v_accvgpr_write_b32 a223, v17
    s_mov_b32 s36, 0x18d400
    buffer_load_dword v42, v3, s[52:55], s36 offen
    buffer_load_dword v43, v3, s[52:55], s36 offen offset:3584
    s_waitcnt vmcnt(54)
    v_perm_b32 v16, v45, v44, s37
    v_accvgpr_write_b32 a160, v16
    v_perm_b32 v17, v45, v44, s38
    v_accvgpr_write_b32 a224, v17
    s_mov_b32 s36, 0x1a4000
    buffer_load_dword v44, v3, s[52:55], s36 offen
    buffer_load_dword v45, v3, s[52:55], s36 offen offset:3584
    s_waitcnt vmcnt(54)
    v_perm_b32 v16, v47, v46, s37
    v_accvgpr_write_b32 a161, v16
    v_perm_b32 v17, v47, v46, s38
    v_accvgpr_write_b32 a225, v17
    s_mov_b32 s36, 0x1a5c00
    buffer_load_dword v46, v3, s[52:55], s36 offen
    buffer_load_dword v47, v3, s[52:55], s36 offen offset:3584
    s_waitcnt vmcnt(54)
    v_perm_b32 v16, v49, v48, s37
    v_accvgpr_write_b32 a162, v16
    v_perm_b32 v17, v49, v48, s38
    v_accvgpr_write_b32 a226, v17
    s_mov_b32 s36, 0x1a7800
    buffer_load_dword v48, v3, s[52:55], s36 offen
    buffer_load_dword v49, v3, s[52:55], s36 offen offset:3584
    s_waitcnt vmcnt(54)
    v_perm_b32 v16, v51, v50, s37
    v_accvgpr_write_b32 a163, v16
    v_perm_b32 v17, v51, v50, s38
    v_accvgpr_write_b32 a227, v17
    s_mov_b32 s36, 0x1a9400
    buffer_load_dword v50, v3, s[52:55], s36 offen
    buffer_load_dword v51, v3, s[52:55], s36 offen offset:3584
    s_waitcnt vmcnt(54)
    v_perm_b32 v16, v53, v52, s37
    v_accvgpr_write_b32 a164, v16
    v_perm_b32 v17, v53, v52, s38
    v_accvgpr_write_b32 a228, v17
    s_waitcnt vmcnt(52)
    v_perm_b32 v16, v55, v54, s37
    v_accvgpr_write_b32 a165, v16
    v_perm_b32 v17, v55, v54, s38
    v_accvgpr_write_b32 a229, v17
    s_waitcnt vmcnt(50)
    v_perm_b32 v16, v57, v56, s37
    v_accvgpr_write_b32 a166, v16
    v_perm_b32 v17, v57, v56, s38
    v_accvgpr_write_b32 a230, v17
    s_waitcnt vmcnt(48)
    v_perm_b32 v16, v59, v58, s37
    v_accvgpr_write_b32 a167, v16
    v_perm_b32 v17, v59, v58, s38
    v_accvgpr_write_b32 a231, v17
    s_waitcnt vmcnt(46)
    v_perm_b32 v16, v61, v60, s37
    v_accvgpr_write_b32 a168, v16
    v_perm_b32 v17, v61, v60, s38
    v_accvgpr_write_b32 a232, v17
    s_waitcnt vmcnt(44)
    v_perm_b32 v16, v63, v62, s37
    v_accvgpr_write_b32 a169, v16
    v_perm_b32 v17, v63, v62, s38
    v_accvgpr_write_b32 a233, v17
    s_waitcnt vmcnt(42)
    v_perm_b32 v16, v65, v64, s37
    v_accvgpr_write_b32 a170, v16
    v_perm_b32 v17, v65, v64, s38
    v_accvgpr_write_b32 a234, v17
    s_waitcnt vmcnt(40)
    v_perm_b32 v16, v67, v66, s37
    v_accvgpr_write_b32 a171, v16
    v_perm_b32 v17, v67, v66, s38
    v_accvgpr_write_b32 a235, v17
    s_waitcnt vmcnt(38)
    v_perm_b32 v16, v69, v68, s37
    v_accvgpr_write_b32 a172, v16
    v_perm_b32 v17, v69, v68, s38
    v_accvgpr_write_b32 a236, v17
    s_waitcnt vmcnt(36)
    v_perm_b32 v16, v71, v70, s37
    v_accvgpr_write_b32 a173, v16
    v_perm_b32 v17, v71, v70, s38
    v_accvgpr_write_b32 a237, v17
    s_waitcnt vmcnt(34)
    v_perm_b32 v16, v73, v72, s37
    v_accvgpr_write_b32 a174, v16
    v_perm_b32 v17, v73, v72, s38
    v_accvgpr_write_b32 a238, v17
    s_waitcnt vmcnt(32)
    v_perm_b32 v16, v75, v74, s37
    v_accvgpr_write_b32 a175, v16
    v_perm_b32 v17, v75, v74, s38
    v_accvgpr_write_b32 a239, v17
    s_waitcnt vmcnt(30)
    v_perm_b32 v16, v21, v20, s37
    v_accvgpr_write_b32 a176, v16
    v_perm_b32 v17, v21, v20, s38
    v_accvgpr_write_b32 a240, v17
    s_waitcnt vmcnt(28)
    v_perm_b32 v16, v23, v22, s37
    v_accvgpr_write_b32 a177, v16
    v_perm_b32 v17, v23, v22, s38
    v_accvgpr_write_b32 a241, v17
    s_waitcnt vmcnt(26)
    v_perm_b32 v16, v25, v24, s37
    v_accvgpr_write_b32 a178, v16
    v_perm_b32 v17, v25, v24, s38
    v_accvgpr_write_b32 a242, v17
    s_waitcnt vmcnt(24)
    v_perm_b32 v16, v27, v26, s37
    v_accvgpr_write_b32 a179, v16
    v_perm_b32 v17, v27, v26, s38
    v_accvgpr_write_b32 a243, v17
    s_waitcnt vmcnt(22)
    v_perm_b32 v16, v29, v28, s37
    v_accvgpr_write_b32 a180, v16
    v_perm_b32 v17, v29, v28, s38
    v_accvgpr_write_b32 a244, v17
    s_waitcnt vmcnt(20)
    v_perm_b32 v16, v31, v30, s37
    v_accvgpr_write_b32 a181, v16
    v_perm_b32 v17, v31, v30, s38
    v_accvgpr_write_b32 a245, v17
    s_waitcnt vmcnt(18)
    v_perm_b32 v16, v33, v32, s37
    v_accvgpr_write_b32 a182, v16
    v_perm_b32 v17, v33, v32, s38
    v_accvgpr_write_b32 a246, v17
    s_waitcnt vmcnt(16)
    v_perm_b32 v16, v35, v34, s37
    v_accvgpr_write_b32 a183, v16
    v_perm_b32 v17, v35, v34, s38
    v_accvgpr_write_b32 a247, v17
    s_waitcnt vmcnt(14)
    v_perm_b32 v16, v37, v36, s37
    v_accvgpr_write_b32 a184, v16
    v_perm_b32 v17, v37, v36, s38
    v_accvgpr_write_b32 a248, v17
    s_waitcnt vmcnt(12)
    v_perm_b32 v16, v39, v38, s37
    v_accvgpr_write_b32 a185, v16
    v_perm_b32 v17, v39, v38, s38
    v_accvgpr_write_b32 a249, v17
    s_waitcnt vmcnt(10)
    v_perm_b32 v16, v41, v40, s37
    v_accvgpr_write_b32 a186, v16
    v_perm_b32 v17, v41, v40, s38
    v_accvgpr_write_b32 a250, v17
    s_waitcnt vmcnt(8)
    v_perm_b32 v16, v43, v42, s37
    v_accvgpr_write_b32 a187, v16
    v_perm_b32 v17, v43, v42, s38
    v_accvgpr_write_b32 a251, v17
    s_waitcnt vmcnt(6)
    v_perm_b32 v16, v45, v44, s37
    v_accvgpr_write_b32 a188, v16
    v_perm_b32 v17, v45, v44, s38
    v_accvgpr_write_b32 a252, v17
    s_waitcnt vmcnt(4)
    v_perm_b32 v16, v47, v46, s37
    v_accvgpr_write_b32 a189, v16
    v_perm_b32 v17, v47, v46, s38
    v_accvgpr_write_b32 a253, v17
    s_waitcnt vmcnt(2)
    v_perm_b32 v16, v49, v48, s37
    v_accvgpr_write_b32 a190, v16
    v_perm_b32 v17, v49, v48, s38
    v_accvgpr_write_b32 a254, v17
    s_waitcnt vmcnt(0)
    v_perm_b32 v16, v51, v50, s37
    v_accvgpr_write_b32 a191, v16
    v_perm_b32 v17, v51, v50, s38
    v_accvgpr_write_b32 a255, v17
    s_mov_b32 s66, 0
L_d1:
    s_waitcnt vmcnt(1)
    s_add_u32 s68, s68, 16384
    s_addc_u32 s69, s69, 0
    global_load_dwordx4 v[192:195], v8, s[68:69] offset:0 sc1
    global_load_dwordx4 v[196:199], v8, s[68:69] offset:1024 sc1
    global_load_dwordx4 v[200:203], v8, s[68:69] offset:2048 sc1
    global_load_dwordx4 v[204:207], v8, s[68:69] offset:3072 sc1
    global_load_dwordx4 v[208:211], v9, s[68:69] offset:0 sc1
    global_load_dwordx4 v[212:215], v9, s[68:69] offset:1024 sc1
    global_load_dwordx4 v[216:219], v9, s[68:69] offset:2048 sc1
    global_load_dwordx4 v[220:223], v9, s[68:69] offset:3072 sc1
    global_load_dwordx4 v[224:227], v10, s[68:69] offset:0 sc1
    global_load_dwordx4 v[228:231], v10, s[68:69] offset:1024 sc1
    global_load_dwordx4 v[232:235], v10, s[68:69] offset:2048 sc1
    global_load_dwordx4 v[236:239], v10, s[68:69] offset:3072 sc1
    global_load_dwordx4 v[240:243], v11, s[68:69] offset:0 sc1
    global_load_dwordx4 v[244:247], v11, s[68:69] offset:1024 sc1
    global_load_dwordx4 v[248:251], v11, s[68:69] offset:2048 sc1
    global_load_dwordx4 v[252:255], v11, s[68:69] offset:3072 sc1
    v_mfma_f32_16x16x32_bf16 v[80:83], a[0:3], v[128:131], 0
    v_mfma_f32_16x16x32_bf16 v[84:87], a[64:67], v[128:131], 0
    v_mfma_f32_16x16x32_bf16 v[88:91], a[128:131], v[128:131], 0
    v_mfma_f32_16x16x32_bf16 v[92:95], a[192:195], v[128:131], 0
    v_mfma_f32_16x16x32_bf16 v[80:83], a[4:7], v[132:135], v[80:83]
    v_mfma_f32_16x16x32_bf16 v[84:87], a[68:71], v[132:135], v[84:87]
    v_mfma_f32_16x16x32_bf16 v[88:91], a[132:135], v[132:135], v[88:91]
    v_mfma_f32_16x16x32_bf16 v[92:95], a[196:199], v[132:135], v[92:95]
    v_mfma_f32_16x16x32_bf16 v[80:83], a[8:11], v[136:139], v[80:83]
    v_mfma_f32_16x16x32_bf16 v[84:87], a[72:75], v[136:139], v[84:87]
    v_mfma_f32_16x16x32_bf16 v[88:91], a[136:139], v[136:139], v[88:91]
    v_mfma_f32_16x16x32_bf16 v[92:95], a[200:203], v[136:139], v[92:95]
    v_mfma_f32_16x16x32_bf16 v[80:83], a[12:15], v[140:143], v[80:83]
    v_mfma_f32_16x16x32_bf16 v[84:87], a[76:79], v[140:143], v[84:87]
    v_mfma_f32_16x16x32_bf16 v[88:91], a[140:143], v[140:143], v[88:91]
    v_mfma_f32_16x16x32_bf16 v[92:95], a[204:207], v[140:143], v[92:95]
    v_mfma_f32_16x16x32_bf16 v[80:83], a[16:19], v[144:147], v[80:83]
    v_mfma_f32_16x16x32_bf16 v[84:87], a[80:83], v[144:147], v[84:87]
    v_mfma_f32_16x16x32_bf16 v[88:91], a[144:147], v[144:147], v[88:91]
    v_mfma_f32_16x16x32_bf16 v[92:95], a[208:211], v[144:147], v[92:95]
    v_mfma_f32_16x16x32_bf16 v[80:83], a[20:23], v[148:151], v[80:83]
    v_mfma_f32_16x16x32_bf16 v[84:87], a[84:87], v[148:151], v[84:87]
    v_mfma_f32_16x16x32_bf16 v[88:91], a[148:151], v[148:151], v[88:91]
    v_mfma_f32_16x16x32_bf16 v[92:95], a[212:215], v[148:151], v[92:95]
    v_mfma_f32_16x16x32_bf16 v[80:83], a[24:27], v[152:155], v[80:83]
    v_mfma_f32_16x16x32_bf16 v[84:87], a[88:91], v[152:155], v[84:87]
    v_mfma_f32_16x16x32_bf16 v[88:91], a[152:155], v[152:155], v[88:91]
    v_mfma_f32_16x16x32_bf16 v[92:95], a[216:219], v[152:155], v[92:95]
    v_mfma_f32_16x16x32_bf16 v[80:83], a[28:31], v[156:159], v[80:83]
    v_mfma_f32_16x16x32_bf16 v[84:87], a[92:95], v[156:159], v[84:87]
    v_mfma_f32_16x16x32_bf16 v[88:91], a[156:159], v[156:159], v[88:91]
    v_mfma_f32_16x16x32_bf16 v[92:95], a[220:223], v[156:159], v[92:95]
    v_mfma_f32_16x16x32_bf16 v[80:83], a[32:35], v[160:163], v[80:83]
    v_mfma_f32_16x16x32_bf16 v[84:87], a[96:99], v[160:163], v[84:87]
    v_mfma_f32_16x16x32_bf16 v[88:91], a[160:163], v[160:163], v[88:91]
    v_mfma_f32_16x16x32_bf16 v[92:95], a[224:227], v[160:163], v[92:95]
    v_mfma_f32_16x16x32_bf16 v[80:83], a[36:39], v[164:167], v[80:83]
    v_mfma_f32_16x16x32_bf16 v[84:87], a[100:103], v[164:167], v[84:87]
    v_mfma_f32_16x16x32_bf16 v[88:91], a[164:167], v[164:167], v[88:91]
    v_mfma_f32_16x16x32_bf16 v[92:95], a[228:231], v[164:167], v[92:95]
    v_mfma_f32_16x16x32_bf16 v[80:83], a[40:43], v[168:171], v[80:83]
    v_mfma_f32_16x16x32_bf16 v[84:87], a[104:107], v[168:171], v[84:87]
    v_mfma_f32_16x16x32_bf16 v[88:91], a[168:171], v[168:171], v[88:91]
    v_mfma_f32_16x16x32_bf16 v[92:95], a[232:235], v[168:171], v[92:95]
    v_mfma_f32_16x16x32_bf16 v[80:83], a[44:47], v[172:175], v[80:83]
    v_mfma_f32_16x16x32_bf16 v[84:87], a[108:111], v[172:175], v[84:87]
    v_mfma_f32_16x16x32_bf16 v[88:91], a[172:175], v[172:175], v[88:91]
    v_mfma_f32_16x16x32_bf16 v[92:95], a[236:239], v[172:175], v[92:95]
    v_mfma_f32_16x16x32_bf16 v[80:83], a[48:51], v[176:179], v[80:83]
    v_mfma_f32_16x16x32_bf16 v[84:87], a[112:115], v[176:179], v[84:87]
    v_mfma_f32_16x16x32_bf16 v[88:91], a[176:179], v[176:179], v[88:91]
    v_mfma_f32_16x16x32_bf16 v[92:95], a[240:243], v[176:179], v[92:95]
    v_mfma_f32_16x16x32_bf16 v[80:83], a[52:55], v[180:183], v[80:83]
    v_mfma_f32_16x16x32_bf16 v[84:87], a[116:119], v[180:183], v[84:87]
    v_mfma_f32_16x16x32_bf16 v[88:91], a[180:183], v[180:183], v[88:91]
    v_mfma_f32_16x16x32_bf16 v[92:95], a[244:247], v[180:183], v[92:95]
    v_mfma_f32_16x16x32_bf16 v[80:83], a[56:59], v[184:187], v[80:83]
    v_mfma_f32_16x16x32_bf16 v[84:87], a[120:123], v[184:187], v[84:87]
    v_mfma_f32_16x16x32_bf16 v[88:91], a[184:187], v[184:187], v[88:91]
    v_mfma_f32_16x16x32_bf16 v[92:95], a[248:251], v[184:187], v[92:95]
    v_mfma_f32_16x16x32_bf16 v[80:83], a[60:63], v[188:191], v[80:83]
    v_mfma_f32_16x16x32_bf16 v[84:87], a[124:127], v[188:191], v[84:87]
    v_mfma_f32_16x16x32_bf16 v[88:91], a[188:191], v[188:191], v[88:91]
    v_mfma_f32_16x16x32_bf16 v[92:95], a[252:255], v[188:191], v[92:95]
    s_nop 0
    v_cvt_pk_bf16_f32 v16, v80, v84
    s_nop 5
    v_cvt_pk_bf16_f32 v17, v88, v92
    v_lshlrev_b32 v18, 16, v16
    v_and_b32 v16, 0xffff0000, v16
    v_lshlrev_b32 v19, 16, v17
    v_and_b32 v17, 0xffff0000, v17
    v_mul_f32 v18, v18, v19
    v_mul_f32 v16, v16, v17
    v_cvt_pk_bf16_f32 v96, v18, v16
    v_cvt_pk_bf16_f32 v16, v81, v85
    v_cvt_pk_bf16_f32 v17, v89, v93
    v_lshlrev_b32 v18, 16, v16
    v_and_b32 v16, 0xffff0000, v16
    v_lshlrev_b32 v19, 16, v17
    v_and_b32 v17, 0xffff0000, v17
    v_mul_f32 v18, v18, v19
    v_mul_f32 v16, v16, v17
    v_cvt_pk_bf16_f32 v97, v18, v16
    v_cvt_pk_bf16_f32 v16, v82, v86
    v_cvt_pk_bf16_f32 v17, v90, v94
    v_lshlrev_b32 v18, 16, v16
    v_and_b32 v16, 0xffff0000, v16
    v_lshlrev_b32 v19, 16, v17
    v_and_b32 v17, 0xffff0000, v17
    v_mul_f32 v18, v18, v19
    v_mul_f32 v16, v16, v17
    v_cvt_pk_bf16_f32 v98, v18, v16
    v_cvt_pk_bf16_f32 v16, v83, v87
    v_cvt_pk_bf16_f32 v17, v91, v95
    v_lshlrev_b32 v18, 16, v16
    v_and_b32 v16, 0xffff0000, v16
    v_lshlrev_b32 v19, 16, v17
    v_and_b32 v17, 0xffff0000, v17
    v_mul_f32 v18, v18, v19
    v_mul_f32 v16, v16, v17
    v_cvt_pk_bf16_f32 v99, v18, v16
    global_store_dwordx4 v8, v[96:99], s[70:71] offset:0 sc1
    s_add_u32 s70, s70, 57344
    s_addc_u32 s71, s71, 0
    s_waitcnt vmcnt(1)
    s_add_u32 s68, s68, 16384
    s_addc_u32 s69, s69, 0
    global_load_dwordx4 v[128:131], v8, s[68:69] offset:0 sc1
    global_load_dwordx4 v[132:135], v8, s[68:69] offset:1024 sc1
    global_load_dwordx4 v[136:139], v8, s[68:69] offset:2048 sc1
    global_load_dwordx4 v[140:143], v8, s[68:69] offset:3072 sc1
    global_load_dwordx4 v[144:147], v9, s[68:69] offset:0 sc1
    global_load_dwordx4 v[148:151], v9, s[68:69] offset:1024 sc1
    global_load_dwordx4 v[152:155], v9, s[68:69] offset:2048 sc1
    global_load_dwordx4 v[156:159], v9, s[68:69] offset:3072 sc1
    global_load_dwordx4 v[160:163], v10, s[68:69] offset:0 sc1
    global_load_dwordx4 v[164:167], v10, s[68:69] offset:1024 sc1
    global_load_dwordx4 v[168:171], v10, s[68:69] offset:2048 sc1
    global_load_dwordx4 v[172:175], v10, s[68:69] offset:3072 sc1
    global_load_dwordx4 v[176:179], v11, s[68:69] offset:0 sc1
    global_load_dwordx4 v[180:183], v11, s[68:69] offset:1024 sc1
    global_load_dwordx4 v[184:187], v11, s[68:69] offset:2048 sc1
    global_load_dwordx4 v[188:191], v11, s[68:69] offset:3072 sc1
    v_mfma_f32_16x16x32_bf16 v[80:83], a[0:3], v[192:195], 0
    v_mfma_f32_16x16x32_bf16 v[84:87], a[64:67], v[192:195], 0
    v_mfma_f32_16x16x32_bf16 v[88:91], a[128:131], v[192:195], 0
    v_mfma_f32_16x16x32_bf16 v[92:95], a[192:195], v[192:195], 0
    v_mfma_f32_16x16x32_bf16 v[80:83], a[4:7], v[196:199], v[80:83]
    v_mfma_f32_16x16x32_bf16 v[84:87], a[68:71], v[196:199], v[84:87]
    v_mfma_f32_16x16x32_bf16 v[88:91], a[132:135], v[196:199], v[88:91]
    v_mfma_f32_16x16x32_bf16 v[92:95], a[196:199], v[196:199], v[92:95]
    v_mfma_f32_16x16x32_bf16 v[80:83], a[8:11], v[200:203], v[80:83]
    v_mfma_f32_16x16x32_bf16 v[84:87], a[72:75], v[200:203], v[84:87]
    v_mfma_f32_16x16x32_bf16 v[88:91], a[136:139], v[200:203], v[88:91]
    v_mfma_f32_16x16x32_bf16 v[92:95], a[200:203], v[200:203], v[92:95]
    v_mfma_f32_16x16x32_bf16 v[80:83], a[12:15], v[204:207], v[80:83]
    v_mfma_f32_16x16x32_bf16 v[84:87], a[76:79], v[204:207], v[84:87]
    v_mfma_f32_16x16x32_bf16 v[88:91], a[140:143], v[204:207], v[88:91]
    v_mfma_f32_16x16x32_bf16 v[92:95], a[204:207], v[204:207], v[92:95]
    v_mfma_f32_16x16x32_bf16 v[80:83], a[16:19], v[208:211], v[80:83]
    v_mfma_f32_16x16x32_bf16 v[84:87], a[80:83], v[208:211], v[84:87]
    v_mfma_f32_16x16x32_bf16 v[88:91], a[144:147], v[208:211], v[88:91]
    v_mfma_f32_16x16x32_bf16 v[92:95], a[208:211], v[208:211], v[92:95]
    v_mfma_f32_16x16x32_bf16 v[80:83], a[20:23], v[212:215], v[80:83]
    v_mfma_f32_16x16x32_bf16 v[84:87], a[84:87], v[212:215], v[84:87]
    v_mfma_f32_16x16x32_bf16 v[88:91], a[148:151], v[212:215], v[88:91]
    v_mfma_f32_16x16x32_bf16 v[92:95], a[212:215], v[212:215], v[92:95]
    v_mfma_f32_16x16x32_bf16 v[80:83], a[24:27], v[216:219], v[80:83]
    v_mfma_f32_16x16x32_bf16 v[84:87], a[88:91], v[216:219], v[84:87]
    v_mfma_f32_16x16x32_bf16 v[88:91], a[152:155], v[216:219], v[88:91]
    v_mfma_f32_16x16x32_bf16 v[92:95], a[216:219], v[216:219], v[92:95]
    v_mfma_f32_16x16x32_bf16 v[80:83], a[28:31], v[220:223], v[80:83]
    v_mfma_f32_16x16x32_bf16 v[84:87], a[92:95], v[220:223], v[84:87]
    v_mfma_f32_16x16x32_bf16 v[88:91], a[156:159], v[220:223], v[88:91]
    v_mfma_f32_16x16x32_bf16 v[92:95], a[220:223], v[220:223], v[92:95]
    v_mfma_f32_16x16x32_bf16 v[80:83], a[32:35], v[224:227], v[80:83]
    v_mfma_f32_16x16x32_bf16 v[84:87], a[96:99], v[224:227], v[84:87]
    v_mfma_f32_16x16x32_bf16 v[88:91], a[160:163], v[224:227], v[88:91]
    v_mfma_f32_16x16x32_bf16 v[92:95], a[224:227], v[224:227], v[92:95]
    v_mfma_f32_16x16x32_bf16 v[80:83], a[36:39], v[228:231], v[80:83]
    v_mfma_f32_16x16x32_bf16 v[84:87], a[100:103], v[228:231], v[84:87]
    v_mfma_f32_16x16x32_bf16 v[88:91], a[164:167], v[228:231], v[88:91]
    v_mfma_f32_16x16x32_bf16 v[92:95], a[228:231], v[228:231], v[92:95]
    v_mfma_f32_16x16x32_bf16 v[80:83], a[40:43], v[232:235], v[80:83]
    v_mfma_f32_16x16x32_bf16 v[84:87], a[104:107], v[232:235], v[84:87]
    v_mfma_f32_16x16x32_bf16 v[88:91], a[168:171], v[232:235], v[88:91]
    v_mfma_f32_16x16x32_bf16 v[92:95], a[232:235], v[232:235], v[92:95]
    v_mfma_f32_16x16x32_bf16 v[80:83], a[44:47], v[236:239], v[80:83]
    v_mfma_f32_16x16x32_bf16 v[84:87], a[108:111], v[236:239], v[84:87]
    v_mfma_f32_16x16x32_bf16 v[88:91], a[172:175], v[236:239], v[88:91]
    v_mfma_f32_16x16x32_bf16 v[92:95], a[236:239], v[236:239], v[92:95]
    v_mfma_f32_16x16x32_bf16 v[80:83], a[48:51], v[240:243], v[80:83]
    v_mfma_f32_16x16x32_bf16 v[84:87], a[112:115], v[240:243], v[84:87]
    v_mfma_f32_16x16x32_bf16 v[88:91], a[176:179], v[240:243], v[88:91]
    v_mfma_f32_16x16x32_bf16 v[92:95], a[240:243], v[240:243], v[92:95]
    v_mfma_f32_16x16x32_bf16 v[80:83], a[52:55], v[244:247], v[80:83]
    v_mfma_f32_16x16x32_bf16 v[84:87], a[116:119], v[244:247], v[84:87]
    v_mfma_f32_16x16x32_bf16 v[88:91], a[180:183], v[244:247], v[88:91]
    v_mfma_f32_16x16x32_bf16 v[92:95], a[244:247], v[244:247], v[92:95]
    v_mfma_f32_16x16x32_bf16 v[80:83], a[56:59], v[248:251], v[80:83]
    v_mfma_f32_16x16x32_bf16 v[84:87], a[120:123], v[248:251], v[84:87]
    v_mfma_f32_16x16x32_bf16 v[88:91], a[184:187], v[248:251], v[88:91]
    v_mfma_f32_16x16x32_bf16 v[92:95], a[248:251], v[248:251], v[92:95]
    v_mfma_f32_16x16x32_bf16 v[80:83], a[60:63], v[252:255], v[80:83]
    v_mfma_f32_16x16x32_bf16 v[84:87], a[124:127], v[252:255], v[84:87]
    v_mfma_f32_16x16x32_bf16 v[88:91], a[188:191], v[252:255], v[88:91]
    v_mfma_f32_16x16x32_bf16 v[92:95], a[252:255], v[252:255], v[92:95]
    s_nop 0
    v_cvt_pk_bf16_f32 v16, v80, v84
    s_nop 5
    v_cvt_pk_bf16_f32 v17, v88, v92
    v_lshlrev_b32 v18, 16, v16
    v_and_b32 v16, 0xffff0000, v16
    v_lshlrev_b32 v19, 16, v17
    v_and_b32 v17, 0xffff0000, v17
    v_mul_f32 v18, v18, v19
    v_mul_f32 v16, v16, v17
    v_cvt_pk_bf16_f32 v100, v18, v16
    v_cvt_pk_bf16_f32 v16, v81, v85
    v_cvt_pk_bf16_f32 v17, v89, v93
    v_lshlrev_b32 v18, 16, v16
    v_and_b32 v16, 0xffff0000, v16
    v_lshlrev_b32 v19, 16, v17
    v_and_b32 v17, 0xffff0000, v17
    v_mul_f32 v18, v18, v19
    v_mul_f32 v16, v16, v17
    v_cvt_pk_bf16_f32 v101, v18, v16
    v_cvt_pk_bf16_f32 v16, v82, v86
    v_cvt_pk_bf16_f32 v17, v90, v94
    v_lshlrev_b32 v18, 16, v16
    v_and_b32 v16, 0xffff0000, v16
    v_lshlrev_b32 v19, 16, v17
    v_and_b32 v17, 0xffff0000, v17
    v_mul_f32 v18, v18, v19
    v_mul_f32 v16, v16, v17
    v_cvt_pk_bf16_f32 v102, v18, v16
    v_cvt_pk_bf16_f32 v16, v83, v87
    v_cvt_pk_bf16_f32 v17, v91, v95
    v_lshlrev_b32 v18, 16, v16
    v_and_b32 v16, 0xffff0000, v16
    v_lshlrev_b32 v19, 16, v17
    v_and_b32 v17, 0xffff0000, v17
    v_mul_f32 v18, v18, v19
    v_mul_f32 v16, v16, v17
    v_cvt_pk_bf16_f32 v103, v18, v16
    global_store_dwordx4 v8, v[100:103], s[70:71] offset:0 sc1
    s_add_u32 s70, s70, 57344
    s_addc_u32 s71, s71, 0
    s_add_u32 s66, s66, 2
    s_cmp_lt_u32 s66, 8
    s_cbranch_scc1 L_d1
    s_waitcnt vmcnt(0)
    s_mov_b64 exec, 1
    global_atomic_add v4, v6, s[26:27] sc1
    s_mov_b64 exec, -1
    s_cmp_lt_u32 s31, 32
    s_cbranch_scc1 L_Erole
    s_lshr_b32 s76, s31, 5
    s_sub_u32 s76, s76, 1
    s_bfe_u32 s77, s31, 0x10004
    s_and_b32 s78, s31, 15
    s_mov_b32 s48, s20
    s_and_b32 s49, s21, 0xffff
    s_mov_b32 s50, 0x1c0000
    s_mov_b32 s51, 0x20000
    s_mul_i32 s40, s28, 458752
    s_lshl_b32 s41, s78, 6
    s_add_u32 s40, s40, s41
    v_lshlrev_b32 v3, 13, v2
    v_lshl_add_u32 v3, v1, 2, v3
    v_add_u32 v3, s40, v3
    s_mov_b32 s36, 0x0
    buffer_load_dword v20, v3, s[48:51], s36 offen
    buffer_load_dword v21, v3, s[48:51], s36 offen offset:1024
    buffer_load_dword v22, v3, s[48:51], s36 offen offset:2048
    buffer_load_dword v23, v3, s[48:51], s36 offen offset:3072
    s_mov_b32 s36, 0x1000
    buffer_load_dword v24, v3, s[48:51], s36 offen
    buffer_load_dword v25, v3, s[48:51], s36 offen offset:1024
    buffer_load_dword v26, v3, s[48:51], s36 offen offset:2048
    buffer_load_dword v27, v3, s[48:51], s36 offen offset:3072
    s_mov_b32 s36, 0x8000
    buffer_load_dword v28, v3, s[48:51], s36 offen
    buffer_load_dword v29, v3, s[48:51], s36 offen offset:1024
    buffer_load_dword v30, v3, s[48:51], s36 offen offset:2048
    buffer_load_dword v31, v3, s[48:51], s36 offen offset:3072
    s_mov_b32 s36, 0x9000
    buffer_load_dword v32, v3, s[48:51], s36 offen
    buffer_load_dword v33, v3, s[48:51], s36 offen offset:1024
    buffer_load_dword v34, v3, s[48:51], s36 offen offset:2048
    buffer_load_dword v35, v3, s[48:51], s36 offen offset:3072
    s_mov_b32 s36, 0x10000
    buffer_load_dword v36, v3, s[48:51], s36 offen
    buffer_load_dword v37, v3, s[48:51], s36 offen offset:1024
    buffer_load_dword v38, v3, s[48:51], s36 offen offset:2048
    buffer_load_dword v39, v3, s[48:51], s36 offen offset:3072
    s_mov_b32 s36, 0x11000
    buffer_load_dword v40, v3, s[48:51], s36 offen
    buffer_load_dword v41, v3, s[48:51], s36 offen offset:1024
    buffer_load_dword v42, v3, s[48:51], s36 offen offset:2048
    buffer_load_dword v43, v3, s[48:51], s36 offen offset:3072
    s_mov_b32 s36, 0x18000
    buffer_load_dword v44, v3, s[48:51], s36 offen
    buffer_load_dword v45, v3, s[48:51], s36 offen offset:1024
    buffer_load_dword v46, v3, s[48:51], s36 offen offset:2048
    buffer_load_dword v47, v3, s[48:51], s36 offen offset:3072
    s_mov_b32 s36, 0x19000
    buffer_load_dword v48, v3, s[48:51], s36 offen
    buffer_load_dword v49, v3, s[48:51], s36 offen offset:1024
    buffer_load_dword v50, v3, s[48:51], s36 offen offset:2048
    buffer_load_dword v51, v3, s[48:51], s36 offen offset:3072
    s_mov_b32 s36, 0x20000
    buffer_load_dword v52, v3, s[48:51], s36 offen
    buffer_load_dword v53, v3, s[48:51], s36 offen offset:1024
    buffer_load_dword v54, v3, s[48:51], s36 offen offset:2048
    buffer_load_dword v55, v3, s[48:51], s36 offen offset:3072
    s_mov_b32 s36, 0x21000
    buffer_load_dword v56, v3, s[48:51], s36 offen
    buffer_load_dword v57, v3, s[48:51], s36 offen offset:1024
    buffer_load_dword v58, v3, s[48:51], s36 offen offset:2048
    buffer_load_dword v59, v3, s[48:51], s36 offen offset:3072
    s_mov_b32 s36, 0x28000
    buffer_load_dword v60, v3, s[48:51], s36 offen
    buffer_load_dword v61, v3, s[48:51], s36 offen offset:1024
    buffer_load_dword v62, v3, s[48:51], s36 offen offset:2048
    buffer_load_dword v63, v3, s[48:51], s36 offen offset:3072
    s_mov_b32 s36, 0x29000
    buffer_load_dword v64, v3, s[48:51], s36 offen
    buffer_load_dword v65, v3, s[48:51], s36 offen offset:1024
    buffer_load_dword v66, v3, s[48:51], s36 offen offset:2048
    buffer_load_dword v67, v3, s[48:51], s36 offen offset:3072
    s_mov_b32 s36, 0x30000
    buffer_load_dword v68, v3, s[48:51], s36 offen
    buffer_load_dword v69, v3, s[48:51], s36 offen offset:1024
    buffer_load_dword v70, v3, s[48:51], s36 offen offset:2048
    buffer_load_dword v71, v3, s[48:51], s36 offen offset:3072
    s_mov_b32 s36, 0x31000
    buffer_load_dword v72, v3, s[48:51], s36 offen
    buffer_load_dword v73, v3, s[48:51], s36 offen offset:1024
    buffer_load_dword v74, v3, s[48:51], s36 offen offset:2048
    buffer_load_dword v75, v3, s[48:51], s36 offen offset:3072
    s_waitcnt vmcnt(54)
    v_perm_b32 v16, v21, v20, s37
    v_accvgpr_write_b32 a0, v16
    v_perm_b32 v17, v21, v20, s38
    v_accvgpr_write_b32 a56, v17
    s_mov_b32 s36, 0x38000
    buffer_load_dword v20, v3, s[48:51], s36 offen
    buffer_load_dword v21, v3, s[48:51], s36 offen offset:1024
    s_waitcnt vmcnt(54)
    v_perm_b32 v16, v23, v22, s37
    v_accvgpr_write_b32 a1, v16
    v_perm_b32 v17, v23, v22, s38
    v_accvgpr_write_b32 a57, v17
    buffer_load_dword v22, v3, s[48:51], s36 offen offset:2048
    buffer_load_dword v23, v3, s[48:51], s36 offen offset:3072
    s_waitcnt vmcnt(54)
    v_perm_b32 v16, v25, v24, s37
    v_accvgpr_write_b32 a2, v16
    v_perm_b32 v17, v25, v24, s38
    v_accvgpr_write_b32 a58, v17
    s_mov_b32 s36, 0x39000
    buffer_load_dword v24, v3, s[48:51], s36 offen
    buffer_load_dword v25, v3, s[48:51], s36 offen offset:1024
    s_waitcnt vmcnt(54)
    v_perm_b32 v16, v27, v26, s37
    v_accvgpr_write_b32 a3, v16
    v_perm_b32 v17, v27, v26, s38
    v_accvgpr_write_b32 a59, v17
    buffer_load_dword v26, v3, s[48:51], s36 offen offset:2048
    buffer_load_dword v27, v3, s[48:51], s36 offen offset:3072
    s_waitcnt vmcnt(54)
    v_perm_b32 v16, v29, v28, s37
    v_accvgpr_write_b32 a4, v16
    v_perm_b32 v17, v29, v28, s38
    v_accvgpr_write_b32 a60, v17
    s_mov_b32 s36, 0x40000
    buffer_load_dword v28, v3, s[48:51], s36 offen
    buffer_load_dword v29, v3, s[48:51], s36 offen offset:1024
    s_waitcnt vmcnt(54)
    v_perm_b32 v16, v31, v30, s37
    v_accvgpr_write_b32 a5, v16
    v_perm_b32 v17, v31, v30, s38
    v_accvgpr_write_b32 a61, v17
    buffer_load_dword v30, v3, s[48:51], s36 offen offset:2048
    buffer_load_dword v31, v3, s[48:51], s36 offen offset:3072
    s_waitcnt vmcnt(54)
    v_perm_b32 v16, v33, v32, s37
    v_accvgpr_write_b32 a6, v16
    v_perm_b32 v17, v33, v32, s38
    v_accvgpr_write_b32 a62, v17
    s_mov_b32 s36, 0x41000
    buffer_load_dword v32, v3, s[48:51], s36 offen
    buffer_load_dword v33, v3, s[48:51], s36 offen offset:1024
    s_waitcnt vmcnt(54)
    v_perm_b32 v16, v35, v34, s37
    v_accvgpr_write_b32 a7, v16
    v_perm_b32 v17, v35, v34, s38
    v_accvgpr_write_b32 a63, v17
    buffer_load_dword v34, v3, s[48:51], s36 offen offset:2048
    buffer_load_dword v35, v3, s[48:51], s36 offen offset:3072
    s_waitcnt vmcnt(54)
    v_perm_b32 v16, v37, v36, s37
    v_accvgpr_write_b32 a8, v16
    v_perm_b32 v17, v37, v36, s38
    v_accvgpr_write_b32 a64, v17
    s_mov_b32 s36, 0x48000
    buffer_load_dword v36, v3, s[48:51], s36 offen
    buffer_load_dword v37, v3, s[48:51], s36 offen offset:1024
    s_waitcnt vmcnt(54)
    v_perm_b32 v16, v39, v38, s37
    v_accvgpr_write_b32 a9, v16
    v_perm_b32 v17, v39, v38, s38
    v_accvgpr_write_b32 a65, v17
    buffer_load_dword v38, v3, s[48:51], s36 offen offset:2048
    buffer_load_dword v39, v3, s[48:51], s36 offen offset:3072
    s_waitcnt vmcnt(54)
    v_perm_b32 v16, v41, v40, s37
    v_accvgpr_write_b32 a10, v16
    v_perm_b32 v17, v41, v40, s38
    v_accvgpr_write_b32 a66, v17
    s_mov_b32 s36, 0x49000
    buffer_load_dword v40, v3, s[48:51], s36 offen
    buffer_load_dword v41, v3, s[48:51], s36 offen offset:1024
    s_waitcnt vmcnt(54)
    v_perm_b32 v16, v43, v42, s37
    v_accvgpr_write_b32 a11, v16
    v_perm_b32 v17, v43, v42, s38
    v_accvgpr_write_b32 a67, v17
    buffer_load_dword v42, v3, s[48:51], s36 offen offset:2048
    buffer_load_dword v43, v3, s[48:51], s36 offen offset:3072
    s_waitcnt vmcnt(54)
    v_perm_b32 v16, v45, v44, s37
    v_accvgpr_write_b32 a12, v16
    v_perm_b32 v17, v45, v44, s38
    v_accvgpr_write_b32 a68, v17
    s_mov_b32 s36, 0x50000
    buffer_load_dword v44, v3, s[48:51], s36 offen
    buffer_load_dword v45, v3, s[48:51], s36 offen offset:1024
    s_waitcnt vmcnt(54)
    v_perm_b32 v16, v47, v46, s37
    v_accvgpr_write_b32 a13, v16
    v_perm_b32 v17, v47, v46, s38
    v_accvgpr_write_b32 a69, v17
    buffer_load_dword v46, v3, s[48:51], s36 offen offset:2048
    buffer_load_dword v47, v3, s[48:51], s36 offen offset:3072
    s_waitcnt vmcnt(54)
    v_perm_b32 v16, v49, v48, s37
    v_accvgpr_write_b32 a14, v16
    v_perm_b32 v17, v49, v48, s38
    v_accvgpr_write_b32 a70, v17
    s_mov_b32 s36, 0x51000
    buffer_load_dword v48, v3, s[48:51], s36 offen
    buffer_load_dword v49, v3, s[48:51], s36 offen offset:1024
    s_waitcnt vmcnt(54)
    v_perm_b32 v16, v51, v50, s37
    v_accvgpr_write_b32 a15, v16
    v_perm_b32 v17, v51, v50, s38
    v_accvgpr_write_b32 a71, v17
    buffer_load_dword v50, v3, s[48:51], s36 offen offset:2048
    buffer_load_dword v51, v3, s[48:51], s36 offen offset:3072
    s_waitcnt vmcnt(54)
    v_perm_b32 v16, v53, v52, s37
    v_accvgpr_write_b32 a16, v16
    v_perm_b32 v17, v53, v52, s38
    v_accvgpr_write_b32 a72, v17
    s_mov_b32 s36, 0x58000
    buffer_load_dword v52, v3, s[48:51], s36 offen
    buffer_load_dword v53, v3, s[48:51], s36 offen offset:1024
    s_waitcnt vmcnt(54)
    v_perm_b32 v16, v55, v54, s37
    v_accvgpr_write_b32 a17, v16
    v_perm_b32 v17, v55, v54, s38
    v_accvgpr_write_b32 a73, v17
    buffer_load_dword v54, v3, s[48:51], s36 offen offset:2048
    buffer_load_dword v55, v3, s[48:51], s36 offen offset:3072
    s_waitcnt vmcnt(54)
    v_perm_b32 v16, v57, v56, s37
    v_accvgpr_write_b32 a18, v16
    v_perm_b32 v17, v57, v56, s38
    v_accvgpr_write_b32 a74, v17
    s_mov_b32 s36, 0x59000
    buffer_load_dword v56, v3, s[48:51], s36 offen
    buffer_load_dword v57, v3, s[48:51], s36 offen offset:1024
    s_waitcnt vmcnt(54)
    v_perm_b32 v16, v59, v58, s37
    v_accvgpr_write_b32 a19, v16
    v_perm_b32 v17, v59, v58, s38
    v_accvgpr_write_b32 a75, v17
    buffer_load_dword v58, v3, s[48:51], s36 offen offset:2048
    buffer_load_dword v59, v3, s[48:51], s36 offen offset:3072
    s_waitcnt vmcnt(54)
    v_perm_b32 v16, v61, v60, s37
    v_accvgpr_write_b32 a20, v16
    v_perm_b32 v17, v61, v60, s38
    v_accvgpr_write_b32 a76, v17
    s_mov_b32 s36, 0x60000
    buffer_load_dword v60, v3, s[48:51], s36 offen
    buffer_load_dword v61, v3, s[48:51], s36 offen offset:1024
    s_waitcnt vmcnt(54)
    v_perm_b32 v16, v63, v62, s37
    v_accvgpr_write_b32 a21, v16
    v_perm_b32 v17, v63, v62, s38
    v_accvgpr_write_b32 a77, v17
    buffer_load_dword v62, v3, s[48:51], s36 offen offset:2048
    buffer_load_dword v63, v3, s[48:51], s36 offen offset:3072
    s_waitcnt vmcnt(54)
    v_perm_b32 v16, v65, v64, s37
    v_accvgpr_write_b32 a22, v16
    v_perm_b32 v17, v65, v64, s38
    v_accvgpr_write_b32 a78, v17
    s_mov_b32 s36, 0x61000
    buffer_load_dword v64, v3, s[48:51], s36 offen
    buffer_load_dword v65, v3, s[48:51], s36 offen offset:1024
    s_waitcnt vmcnt(54)
    v_perm_b32 v16, v67, v66, s37
    v_accvgpr_write_b32 a23, v16
    v_perm_b32 v17, v67, v66, s38
    v_accvgpr_write_b32 a79, v17
    buffer_load_dword v66, v3, s[48:51], s36 offen offset:2048
    buffer_load_dword v67, v3, s[48:51], s36 offen offset:3072
    s_waitcnt vmcnt(54)
    v_perm_b32 v16, v69, v68, s37
    v_accvgpr_write_b32 a24, v16
    v_perm_b32 v17, v69, v68, s38
    v_accvgpr_write_b32 a80, v17
    s_mov_b32 s36, 0x68000
    buffer_load_dword v68, v3, s[48:51], s36 offen
    buffer_load_dword v69, v3, s[48:51], s36 offen offset:1024
    s_waitcnt vmcnt(54)
    v_perm_b32 v16, v71, v70, s37
    v_accvgpr_write_b32 a25, v16
    v_perm_b32 v17, v71, v70, s38
    v_accvgpr_write_b32 a81, v17
    buffer_load_dword v70, v3, s[48:51], s36 offen offset:2048
    buffer_load_dword v71, v3, s[48:51], s36 offen offset:3072
    s_waitcnt vmcnt(54)
    v_perm_b32 v16, v73, v72, s37
    v_accvgpr_write_b32 a26, v16
    v_perm_b32 v17, v73, v72, s38
    v_accvgpr_write_b32 a82, v17
    s_mov_b32 s36, 0x69000
    buffer_load_dword v72, v3, s[48:51], s36 offen
    buffer_load_dword v73, v3, s[48:51], s36 offen offset:1024
    s_waitcnt vmcnt(54)
    v_perm_b32 v16, v75, v74, s37
    v_accvgpr_write_b32 a27, v16
    v_perm_b32 v17, v75, v74, s38
    v_accvgpr_write_b32 a83, v17
    buffer_load_dword v74, v3, s[48:51], s36 offen offset:2048
    buffer_load_dword v75, v3, s[48:51], s36 offen offset:3072
    s_waitcnt vmcnt(54)
    v_perm_b32 v16, v21, v20, s37
    v_accvgpr_write_b32 a28, v16
    v_perm_b32 v17, v21, v20, s38
    v_accvgpr_write_b32 a84, v17
    s_waitcnt vmcnt(52)
    v_perm_b32 v16, v23, v22, s37
    v_accvgpr_write_b32 a29, v16
    v_perm_b32 v17, v23, v22, s38
    v_accvgpr_write_b32 a85, v17
    s_waitcnt vmcnt(50)
    v_perm_b32 v16, v25, v24, s37
    v_accvgpr_write_b32 a30, v16
    v_perm_b32 v17, v25, v24, s38
    v_accvgpr_write_b32 a86, v17
    s_waitcnt vmcnt(48)
    v_perm_b32 v16, v27, v26, s37
    v_accvgpr_write_b32 a31, v16
    v_perm_b32 v17, v27, v26, s38
    v_accvgpr_write_b32 a87, v17
    s_waitcnt vmcnt(46)
    v_perm_b32 v16, v29, v28, s37
    v_accvgpr_write_b32 a32, v16
    v_perm_b32 v17, v29, v28, s38
    v_accvgpr_write_b32 a88, v17
    s_waitcnt vmcnt(44)
    v_perm_b32 v16, v31, v30, s37
    v_accvgpr_write_b32 a33, v16
    v_perm_b32 v17, v31, v30, s38
    v_accvgpr_write_b32 a89, v17
    s_waitcnt vmcnt(42)
    v_perm_b32 v16, v33, v32, s37
    v_accvgpr_write_b32 a34, v16
    v_perm_b32 v17, v33, v32, s38
    v_accvgpr_write_b32 a90, v17
    s_waitcnt vmcnt(40)
    v_perm_b32 v16, v35, v34, s37
    v_accvgpr_write_b32 a35, v16
    v_perm_b32 v17, v35, v34, s38
    v_accvgpr_write_b32 a91, v17
    s_waitcnt vmcnt(38)
    v_perm_b32 v16, v37, v36, s37
    v_accvgpr_write_b32 a36, v16
    v_perm_b32 v17, v37, v36, s38
    v_accvgpr_write_b32 a92, v17
    s_waitcnt vmcnt(36)
    v_perm_b32 v16, v39, v38, s37
    v_accvgpr_write_b32 a37, v16
    v_perm_b32 v17, v39, v38, s38
    v_accvgpr_write_b32 a93, v17
    s_waitcnt vmcnt(34)
    v_perm_b32 v16, v41, v40, s37
    v_accvgpr_write_b32 a38, v16
    v_perm_b32 v17, v41, v40, s38
    v_accvgpr_write_b32 a94, v17
    s_waitcnt vmcnt(32)
    v_perm_b32 v16, v43, v42, s37
    v_accvgpr_write_b32 a39, v16
    v_perm_b32 v17, v43, v42, s38
    v_accvgpr_write_b32 a95, v17
    s_waitcnt vmcnt(30)
    v_perm_b32 v16, v45, v44, s37
    v_accvgpr_write_b32 a40, v16
    v_perm_b32 v17, v45, v44, s38
    v_accvgpr_write_b32 a96, v17
    s_waitcnt vmcnt(28)
    v_perm_b32 v16, v47, v46, s37
    v_accvgpr_write_b32 a41, v16
    v_perm_b32 v17, v47, v46, s38
    v_accvgpr_write_b32 a97, v17
    s_waitcnt vmcnt(26)
    v_perm_b32 v16, v49, v48, s37
    v_accvgpr_write_b32 a42, v16
    v_perm_b32 v17, v49, v48, s38
    v_accvgpr_write_b32 a98, v17
    s_waitcnt vmcnt(24)
    v_perm_b32 v16, v51, v50, s37
    v_accvgpr_write_b32 a43, v16
    v_perm_b32 v17, v51, v50, s38
    v_accvgpr_write_b32 a99, v17
    s_waitcnt vmcnt(22)
    v_perm_b32 v16, v53, v52, s37
    v_accvgpr_write_b32 a44, v16
    v_perm_b32 v17, v53, v52, s38
    v_accvgpr_write_b32 a100, v17
    s_waitcnt vmcnt(20)
    v_perm_b32 v16, v55, v54, s37
    v_accvgpr_write_b32 a45, v16
    v_perm_b32 v17, v55, v54, s38
    v_accvgpr_write_b32 a101, v17
    s_waitcnt vmcnt(18)
    v_perm_b32 v16, v57, v56, s37
    v_accvgpr_write_b32 a46, v16
    v_perm_b32 v17, v57, v56, s38
    v_accvgpr_write_b32 a102, v17
    s_waitcnt vmcnt(16)
    v_perm_b32 v16, v59, v58, s37
    v_accvgpr_write_b32 a47, v16
    v_perm_b32 v17, v59, v58, s38
    v_accvgpr_write_b32 a103, v17
    s_waitcnt vmcnt(14)
    v_perm_b32 v16, v61, v60, s37
    v_accvgpr_write_b32 a48, v16
    v_perm_b32 v17, v61, v60, s38
    v_accvgpr_write_b32 a104, v17
    s_waitcnt vmcnt(12)
    v_perm_b32 v16, v63, v62, s37
    v_accvgpr_write_b32 a49, v16
    v_perm_b32 v17, v63, v62, s38
    v_accvgpr_write_b32 a105, v17
    s_waitcnt vmcnt(10)
    v_perm_b32 v16, v65, v64, s37
    v_accvgpr_write_b32 a50, v16
    v_perm_b32 v17, v65, v64, s38
    v_accvgpr_write_b32 a106, v17
    s_waitcnt vmcnt(8)
    v_perm_b32 v16, v67, v66, s37
    v_accvgpr_write_b32 a51, v16
    v_perm_b32 v17, v67, v66, s38
    v_accvgpr_write_b32 a107, v17
    s_waitcnt vmcnt(6)
    v_perm_b32 v16, v69, v68, s37
    v_accvgpr_write_b32 a52, v16
    v_perm_b32 v17, v69, v68, s38
    v_accvgpr_write_b32 a108, v17
    s_waitcnt vmcnt(4)
    v_perm_b32 v16, v71, v70, s37
    v_accvgpr_write_b32 a53, v16
    v_perm_b32 v17, v71, v70, s38
    v_accvgpr_write_b32 a109, v17
    s_waitcnt vmcnt(2)
    v_perm_b32 v16, v73, v72, s37
    v_accvgpr_write_b32 a54, v16
    v_perm_b32 v17, v73, v72, s38
    v_accvgpr_write_b32 a110, v17
    s_waitcnt vmcnt(0)
    v_perm_b32 v16, v75, v74, s37
    v_accvgpr_write_b32 a55, v16
    v_perm_b32 v17, v75, v74, s38
    v_accvgpr_write_b32 a111, v17
    v_lshlrev_b32 v4, 7, v1
    v_add_u32 v4, 0x407000, v4
L_wf_23:
    global_load_dword v16, v4, s[26:27] sc1
    s_add_u32 s39, s39, 1
    s_cmp_gt_u32 s39, 0x400000
    s_cbranch_scc1 L_fail
    s_sleep 2
    s_waitcnt vmcnt(0)
    v_cmp_ne_u32 vcc, 56, v16
    s_cbranch_vccnz L_wf_23
    s_lshl_b32 s40, s76, 1
    s_add_u32 s40, s40, s77
    s_mul_i32 s40, s40, 57344
    s_mul_i32 s41, s28, 14336
    s_add_u32 s40, s40, s41
    s_add_u32 s68, s26, s40
    s_addc_u32 s69, s27, 0
    s_add_u32 s68, s68, 0x800000
    s_addc_u32 s69, s69, 0
    s_lshl_b32 s40, s28, 11
    v_add_u32 v4, s40, v8
    global_load_dwordx4 v[128:131], v8, s[68:69] offset:0 sc1
    global_load_dwordx4 v[132:135], v8, s[68:69] offset:1024 sc1
    global_load_dwordx4 v[136:139], v8, s[68:69] offset:2048 sc1
    global_load_dwordx4 v[140:143], v8, s[68:69] offset:3072 sc1
    global_load_dwordx4 v[144:147], v9, s[68:69] offset:0 sc1
    global_load_dwordx4 v[148:151], v9, s[68:69] offset:1024 sc1
    global_load_dwordx4 v[152:155], v9, s[68:69] offset:2048 sc1
    global_load_dwordx4 v[156:159], v9, s[68:69] offset:3072 sc1
    global_load_dwordx4 v[160:163], v10, s[68:69] offset:0 sc1
    global_load_dwordx4 v[164:167], v10, s[68:69] offset:1024 sc1
    global_load_dwordx4 v[168:171], v10, s[68:69] offset:2048 sc1
    global_load_dwordx4 v[172:175], v10, s[68:69] offset:3072 sc1
    global_load_dwordx4 v[176:179], v11, s[68:69] offset:0 sc1
    global_load_dwordx4 v[180:183], v11, s[68:69] offset:1024 sc1
    s_mov_b32 s66, 0
L_d2:
    s_waitcnt vmcnt(0)
    s_add_u32 s68, s68, 688128
    s_addc_u32 s69, s69, 0
    global_load_dwordx4 v[192:195], v8, s[68:69] offset:0 sc1
    global_load_dwordx4 v[196:199], v8, s[68:69] offset:1024 sc1
    global_load_dwordx4 v[200:203], v8, s[68:69] offset:2048 sc1
    global_load_dwordx4 v[204:207], v8, s[68:69] offset:3072 sc1
    global_load_dwordx4 v[208:211], v9, s[68:69] offset:0 sc1
    global_load_dwordx4 v[212:215], v9, s[68:69] offset:1024 sc1
    global_load_dwordx4 v[216:219], v9, s[68:69] offset:2048 sc1
    global_load_dwordx4 v[220:223], v9, s[68:69] offset:3072 sc1
    global_load_dwordx4 v[224:227], v10, s[68:69] offset:0 sc1
    global_load_dwordx4 v[228:231], v10, s[68:69] offset:1024 sc1
    global_load_dwordx4 v[232:235], v10, s[68:69] offset:2048 sc1
    global_load_dwordx4 v[236:239], v10, s[68:69] offset:3072 sc1
    global_load_dwordx4 v[240:243], v11, s[68:69] offset:0 sc1
    global_load_dwordx4 v[244:247], v11, s[68:69] offset:1024 sc1
    v_mfma_f32_16x16x32_bf16 v[80:83], a[0:3], v[128:131], 0
    v_mfma_f32_16x16x32_bf16 v[84:87], a[56:59], v[128:131], 0
    v_mfma_f32_16x16x32_bf16 v[80:83], a[4:7], v[132:135], v[80:83]
    v_mfma_f32_16x16x32_bf16 v[84:87], a[60:63], v[132:135], v[84:87]
    v_mfma_f32_16x16x32_bf16 v[80:83], a[8:11], v[136:139], v[80:83]
    v_mfma_f32_16x16x32_bf16 v[84:87], a[64:67], v[136:139], v[84:87]
    v_mfma_f32_16x16x32_bf16 v[80:83], a[12:15], v[140:143], v[80:83]
    v_mfma_f32_16x16x32_bf16 v[84:87], a[68:71], v[140:143], v[84:87]
    v_mfma_f32_16x16x32_bf16 v[80:83], a[16:19], v[144:147], v[80:83]
    v_mfma_f32_16x16x32_bf16 v[84:87], a[72:75], v[144:147], v[84:87]
    v_mfma_f32_16x16x32_bf16 v[80:83], a[20:23], v[148:151], v[80:83]
    v_mfma_f32_16x16x32_bf16 v[84:87], a[76:79], v[148:151], v[84:87]
    v_mfma_f32_16x16x32_bf16 v[80:83], a[24:27], v[152:155], v[80:83]
    v_mfma_f32_16x16x32_bf16 v[84:87], a[80:83], v[152:155], v[84:87]
    v_mfma_f32_16x16x32_bf16 v[80:83], a[28:31], v[156:159], v[80:83]
    v_mfma_f32_16x16x32_bf16 v[84:87], a[84:87], v[156:159], v[84:87]
    v_mfma_f32_16x16x32_bf16 v[80:83], a[32:35], v[160:163], v[80:83]
    v_mfma_f32_16x16x32_bf16 v[84:87], a[88:91], v[160:163], v[84:87]
    v_mfma_f32_16x16x32_bf16 v[80:83], a[36:39], v[164:167], v[80:83]
    v_mfma_f32_16x16x32_bf16 v[84:87], a[92:95], v[164:167], v[84:87]
    v_mfma_f32_16x16x32_bf16 v[80:83], a[40:43], v[168:171], v[80:83]
    v_mfma_f32_16x16x32_bf16 v[84:87], a[96:99], v[168:171], v[84:87]
    v_mfma_f32_16x16x32_bf16 v[80:83], a[44:47], v[172:175], v[80:83]
    v_mfma_f32_16x16x32_bf16 v[84:87], a[100:103], v[172:175], v[84:87]
    v_mfma_f32_16x16x32_bf16 v[80:83], a[48:51], v[176:179], v[80:83]
    v_mfma_f32_16x16x32_bf16 v[84:87], a[104:107], v[176:179], v[84:87]
    v_mfma_f32_16x16x32_bf16 v[80:83], a[52:55], v[180:183], v[80:83]
    v_mfma_f32_16x16x32_bf16 v[84:87], a[108:111], v[180:183], v[84:87]
    s_nop 4
    ds_write_b128 v4, v[80:83]
    s_nop 1
    ds_write_b128 v4, v[84:87] offset:1024
    v_add_u32 v4, 8192, v4
    s_waitcnt vmcnt(0)
    s_add_u32 s68, s68, 688128
    s_addc_u32 s69, s69, 0
    global_load_dwordx4 v[128:131], v8, s[68:69] offset:0 sc1
    global_load_dwordx4 v[132:135], v8, s[68:69] offset:1024 sc1
    global_load_dwordx4 v[136:139], v8, s[68:69] offset:2048 sc1
    global_load_dwordx4 v[140:143], v8, s[68:69] offset:3072 sc1
    global_load_dwordx4 v[144:147], v9, s[68:69] offset:0 sc1
    global_load_dwordx4 v[148:151], v9, s[68:69] offset:1024 sc1
    global_load_dwordx4 v[152:155], v9, s[68:69] offset:2048 sc1
    global_load_dwordx4 v[156:159], v9, s[68:69] offset:3072 sc1
    global_load_dwordx4 v[160:163], v10, s[68:69] offset:0 sc1
    global_load_dwordx4 v[164:167], v10, s[68:69] offset:1024 sc1
    global_load_dwordx4 v[168:171], v10, s[68:69] offset:2048 sc1
    global_load_dwordx4 v[172:175], v10, s[68:69] offset:3072 sc1
    global_load_dwordx4 v[176:179], v11, s[68:69] offset:0 sc1
    global_load_dwordx4 v[180:183], v11, s[68:69] offset:1024 sc1
    v_mfma_f32_16x16x32_bf16 v[88:91], a[0:3], v[192:195], 0
    v_mfma_f32_16x16x32_bf16 v[92:95], a[56:59], v[192:195], 0
    v_mfma_f32_16x16x32_bf16 v[88:91], a[4:7], v[196:199], v[88:91]
    v_mfma_f32_16x16x32_bf16 v[92:95], a[60:63], v[196:199], v[92:95]
    v_mfma_f32_16x16x32_bf16 v[88:91], a[8:11], v[200:203], v[88:91]
    v_mfma_f32_16x16x32_bf16 v[92:95], a[64:67], v[200:203], v[92:95]
    v_mfma_f32_16x16x32_bf16 v[88:91], a[12:15], v[204:207], v[88:91]
    v_mfma_f32_16x16x32_bf16 v[92:95], a[68:71], v[204:207], v[92:95]
    v_mfma_f32_16x16x32_bf16 v[88:91], a[16:19], v[208:211], v[88:91]
    v_mfma_f32_16x16x32_bf16 v[92:95], a[72:75], v[208:211], v[92:95]
    v_mfma_f32_16x16x32_bf16 v[88:91], a[20:23], v[212:215], v[88:91]
    v_mfma_f32_16x16x32_bf16 v[92:95], a[76:79], v[212:215], v[92:95]
    v_mfma_f32_16x16x32_bf16 v[88:91], a[24:27], v[216:219], v[88:91]
    v_mfma_f32_16x16x32_bf16 v[92:95], a[80:83], v[216:219], v[92:95]
    v_mfma_f32_16x16x32_bf16 v[88:91], a[28:31], v[220:223], v[88:91]
    v_mfma_f32_16x16x32_bf16 v[92:95], a[84:87], v[220:223], v[92:95]
    v_mfma_f32_16x16x32_bf16 v[88:91], a[32:35], v[224:227], v[88:91]
    v_mfma_f32_16x16x32_bf16 v[92:95], a[88:91], v[224:227], v[92:95]
    v_mfma_f32_16x16x32_bf16 v[88:91], a[36:39], v[228:231], v[88:91]
    v_mfma_f32_16x16x32_bf16 v[92:95], a[92:95], v[228:231], v[92:95]
    v_mfma_f32_16x16x32_bf16 v[88:91], a[40:43], v[232:235], v[88:91]
    v_mfma_f32_16x16x32_bf16 v[92:95], a[96:99], v[232:235], v[92:95]
    v_mfma_f32_16x16x32_bf16 v[88:91], a[44:47], v[236:239], v[88:91]
    v_mfma_f32_16x16x32_bf16 v[92:95], a[100:103], v[236:239], v[92:95]
    v_mfma_f32_16x16x32_bf16 v[88:91], a[48:51], v[240:243], v[88:91]
    v_mfma_f32_16x16x32_bf16 v[92:95], a[104:107], v[240:243], v[92:95]
    v_mfma_f32_16x16x32_bf16 v[88:91], a[52:55], v[244:247], v[88:91]
    v_mfma_f32_16x16x32_bf16 v[92:95], a[108:111], v[244:247], v[92:95]
    s_nop 4
    ds_write_b128 v4, v[88:91]
    s_nop 1
    ds_write_b128 v4, v[92:95] offset:1024
    v_add_u32 v4, 8192, v4
    s_add_u32 s66, s66, 2
    s_cmp_lt_u32 s66, 12
    s_cbranch_scc1 L_d2
    s_waitcnt vmcnt(0) lgkmcnt(0)
    s_barrier
    s_lshl_b32 s40, s28, 13
    v_add_u32 v4, s40, v8
    s_lshl_b32 s40, s28, 10
    s_add_u32 s40, s40, 98304
    v_add_u32 v5, s40, v8
    s_mov_b32 s92, 0xbfb8aa3b
    ds_read_b128 v[16:19], v4 offset:0
    ds_read_b128 v[20:23], v4 offset:1024
    ds_read_b128 v[24:27], v4 offset:2048
    ds_read_b128 v[28:31], v4 offset:3072
    ds_read_b128 v[32:35], v4 offset:4096
    ds_read_b128 v[36:39], v4 offset:5120
    ds_read_b128 v[40:43], v4 offset:6144
    ds_read_b128 v[44:47], v4 offset:7168
    s_waitcnt lgkmcnt(0)
    v_add_f32 v16, v16, v24
    v_add_f32 v32, v32, v40
    v_add_f32 v16, v16, v32
    v_cvt_pk_bf16_f32 v16, v16, v16
    v_and_b32 v16, 0xffff0000, v16
    v_mul_f32 v24, s92, v16
    v_exp_f32 v24, v24
    s_nop 0
    v_add_f32 v24, 1.0, v24
    v_rcp_f32 v24, v24
    s_nop 0
    v_mul_f32 v16, v16, v24
    v_add_f32 v17, v17, v25
    v_add_f32 v33, v33, v41
    v_add_f32 v17, v17, v33
    v_cvt_pk_bf16_f32 v17, v17, v17
    v_and_b32 v17, 0xffff0000, v17
    v_mul_f32 v25, s92, v17
    v_exp_f32 v25, v25
    s_nop 0
    v_add_f32 v25, 1.0, v25
    v_rcp_f32 v25, v25
    s_nop 0
    v_mul_f32 v17, v17, v25
    v_add_f32 v18, v18, v26
    v_add_f32 v34, v34, v42
    v_add_f32 v18, v18, v34
    v_cvt_pk_bf16_f32 v18, v18, v18
    v_and_b32 v18, 0xffff0000, v18
    v_mul_f32 v26, s92, v18
    v_exp_f32 v26, v26
    s_nop 0
    v_add_f32 v26, 1.0, v26
    v_rcp_f32 v26, v26
    s_nop 0
    v_mul_f32 v18, v18, v26
    v_add_f32 v19, v19, v27
    v_add_f32 v35, v35, v43
    v_add_f32 v19, v19, v35
    v_cvt_pk_bf16_f32 v19, v19, v19
    v_and_b32 v19, 0xffff0000, v19
    v_mul_f32 v27, s92, v19
    v_exp_f32 v27, v27
    s_nop 0
    v_add_f32 v27, 1.0, v27
    v_rcp_f32 v27, v27
    s_nop 0
    v_mul_f32 v19, v19, v27
    v_add_f32 v20, v20, v28
    v_add_f32 v36, v36, v44
    v_add_f32 v20, v20, v36
    v_cvt_pk_bf16_f32 v20, v20, v20
    v_and_b32 v20, 0xffff0000, v20
    v_mul_f32 v28, s92, v20
    v_exp_f32 v28, v28
    s_nop 0
    v_add_f32 v28, 1.0, v28
    v_rcp_f32 v28, v28
    s_nop 0
    v_mul_f32 v20, v20, v28
    v_add_f32 v21, v21, v29
    v_add_f32 v37, v37, v45
    v_add_f32 v21, v21, v37
    v_cvt_pk_bf16_f32 v21, v21, v21
    v_and_b32 v21, 0xffff0000, v21
    v_mul_f32 v29, s92, v21
    v_exp_f32 v29, v29
    s_nop 0
    v_add_f32 v29, 1.0, v29
    v_rcp_f32 v29, v29
    s_nop 0
    v_mul_f32 v21, v21, v29
    v_add_f32 v22, v22, v30
    v_add_f32 v38, v38, v46
    v_add_f32 v22, v22, v38
    v_cvt_pk_bf16_f32 v22, v22, v22
    v_and_b32 v22, 0xffff0000, v22
    v_mul_f32 v30, s92, v22
    v_exp_f32 v30, v30
    s_nop 0
    v_add_f32 v30, 1.0, v30
    v_rcp_f32 v30, v30
    s_nop 0
    v_mul_f32 v22, v22, v30
    v_add_f32 v23, v23, v31
    v_add_f32 v39, v39, v47
    v_add_f32 v23, v23, v39
    v_cvt_pk_bf16_f32 v23, v23, v23
    v_and_b32 v23, 0xffff0000, v23
    v_mul_f32 v31, s92, v23
    v_exp_f32 v31, v31
    s_nop 0
    v_add_f32 v31, 1.0, v31
    v_rcp_f32 v31, v31
    s_nop 0
    v_mul_f32 v23, v23, v31
    v_cvt_pk_bf16_f32 v48, v16, v20
    v_cvt_pk_bf16_f32 v49, v17, v21
    v_cvt_pk_bf16_f32 v50, v18, v22
    v_cvt_pk_bf16_f32 v51, v19, v23
    ds_write_b128 v5, v[48:51] offset:0
    v_add_u32 v4, 32768, v4
    ds_read_b128 v[16:19], v4 offset:0
    ds_read_b128 v[20:23], v4 offset:1024
    ds_read_b128 v[24:27], v4 offset:2048
    ds_read_b128 v[28:31], v4 offset:3072
    ds_read_b128 v[32:35], v4 offset:4096
    ds_read_b128 v[36:39], v4 offset:5120
    ds_read_b128 v[40:43], v4 offset:6144
    ds_read_b128 v[44:47], v4 offset:7168
    s_waitcnt lgkmcnt(0)
    v_add_f32 v16, v16, v24
    v_add_f32 v32, v32, v40
    v_add_f32 v16, v16, v32
    v_cvt_pk_bf16_f32 v16, v16, v16
    v_and_b32 v16, 0xffff0000, v16
    v_mul_f32 v24, s92, v16
    v_exp_f32 v24, v24
    s_nop 0
    v_add_f32 v24, 1.0, v24
    v_rcp_f32 v24, v24
    s_nop 0
    v_mul_f32 v16, v16, v24
    v_add_f32 v17, v17, v25
    v_add_f32 v33, v33, v41
    v_add_f32 v17, v17, v33
    v_cvt_pk_bf16_f32 v17, v17, v17
    v_and_b32 v17, 0xffff0000, v17
    v_mul_f32 v25, s92, v17
    v_exp_f32 v25, v25
    s_nop 0
    v_add_f32 v25, 1.0, v25
    v_rcp_f32 v25, v25
    s_nop 0
    v_mul_f32 v17, v17, v25
    v_add_f32 v18, v18, v26
    v_add_f32 v34, v34, v42
    v_add_f32 v18, v18, v34
    v_cvt_pk_bf16_f32 v18, v18, v18
    v_and_b32 v18, 0xffff0000, v18
    v_mul_f32 v26, s92, v18
    v_exp_f32 v26, v26
    s_nop 0
    v_add_f32 v26, 1.0, v26
    v_rcp_f32 v26, v26
    s_nop 0
    v_mul_f32 v18, v18, v26
    v_add_f32 v19, v19, v27
    v_add_f32 v35, v35, v43
    v_add_f32 v19, v19, v35
    v_cvt_pk_bf16_f32 v19, v19, v19
    v_and_b32 v19, 0xffff0000, v19
    v_mul_f32 v27, s92, v19
    v_exp_f32 v27, v27
    s_nop 0
    v_add_f32 v27, 1.0, v27
    v_rcp_f32 v27, v27
    s_nop 0
    v_mul_f32 v19, v19, v27
    v_add_f32 v20, v20, v28
    v_add_f32 v36, v36, v44
    v_add_f32 v20, v20, v36
    v_cvt_pk_bf16_f32 v20, v20, v20
    v_and_b32 v20, 0xffff0000, v20
    v_mul_f32 v28, s92, v20
    v_exp_f32 v28, v28
    s_nop 0
    v_add_f32 v28, 1.0, v28
    v_rcp_f32 v28, v28
    s_nop 0
    v_mul_f32 v20, v20, v28
    v_add_f32 v21, v21, v29
    v_add_f32 v37, v37, v45
    v_add_f32 v21, v21, v37
    v_cvt_pk_bf16_f32 v21, v21, v21
    v_and_b32 v21, 0xffff0000, v21
    v_mul_f32 v29, s92, v21
    v_exp_f32 v29, v29
    s_nop 0
    v_add_f32 v29, 1.0, v29
    v_rcp_f32 v29, v29
    s_nop 0
    v_mul_f32 v21, v21, v29
    v_add_f32 v22, v22, v30
    v_add_f32 v38, v38, v46
    v_add_f32 v22, v22, v38
    v_cvt_pk_bf16_f32 v22, v22, v22
    v_and_b32 v22, 0xffff0000, v22
    v_mul_f32 v30, s92, v22
    v_exp_f32 v30, v30
    s_nop 0
    v_add_f32 v30, 1.0, v30
    v_rcp_f32 v30, v30
    s_nop 0
    v_mul_f32 v22, v22, v30
    v_add_f32 v23, v23, v31
    v_add_f32 v39, v39, v47
    v_add_f32 v23, v23, v39
    v_cvt_pk_bf16_f32 v23, v23, v23
    v_and_b32 v23, 0xffff0000, v23
    v_mul_f32 v31, s92, v23
    v_exp_f32 v31, v31
    s_nop 0
    v_add_f32 v31, 1.0, v31
    v_rcp_f32 v31, v31
    s_nop 0
    v_mul_f32 v23, v23, v31
    v_cvt_pk_bf16_f32 v48, v16, v20
    v_cvt_pk_bf16_f32 v49, v17, v21
    v_cvt_pk_bf16_f32 v50, v18, v22
    v_cvt_pk_bf16_f32 v51, v19, v23
    ds_write_b128 v5, v[48:51] offset:4096
    v_add_u32 v4, 32768, v4
    ds_read_b128 v[16:19], v4 offset:0
    ds_read_b128 v[20:23], v4 offset:1024
    ds_read_b128 v[24:27], v4 offset:2048
    ds_read_b128 v[28:31], v4 offset:3072
    ds_read_b128 v[32:35], v4 offset:4096
    ds_read_b128 v[36:39], v4 offset:5120
    ds_read_b128 v[40:43], v4 offset:6144
    ds_read_b128 v[44:47], v4 offset:7168
    s_waitcnt lgkmcnt(0)
    v_add_f32 v16, v16, v24
    v_add_f32 v32, v32, v40
    v_add_f32 v16, v16, v32
    v_cvt_pk_bf16_f32 v16, v16, v16
    v_and_b32 v16, 0xffff0000, v16
    v_mul_f32 v24, s92, v16
    v_exp_f32 v24, v24
    s_nop 0
    v_add_f32 v24, 1.0, v24
    v_rcp_f32 v24, v24
    s_nop 0
    v_mul_f32 v16, v16, v24
    v_add_f32 v17, v17, v25
    v_add_f32 v33, v33, v41
    v_add_f32 v17, v17, v33
    v_cvt_pk_bf16_f32 v17, v17, v17
    v_and_b32 v17, 0xffff0000, v17
    v_mul_f32 v25, s92, v17
    v_exp_f32 v25, v25
    s_nop 0
    v_add_f32 v25, 1.0, v25
    v_rcp_f32 v25, v25
    s_nop 0
    v_mul_f32 v17, v17, v25
    v_add_f32 v18, v18, v26
    v_add_f32 v34, v34, v42
    v_add_f32 v18, v18, v34
    v_cvt_pk_bf16_f32 v18, v18, v18
    v_and_b32 v18, 0xffff0000, v18
    v_mul_f32 v26, s92, v18
    v_exp_f32 v26, v26
    s_nop 0
    v_add_f32 v26, 1.0, v26
    v_rcp_f32 v26, v26
    s_nop 0
    v_mul_f32 v18, v18, v26
    v_add_f32 v19, v19, v27
    v_add_f32 v35, v35, v43
    v_add_f32 v19, v19, v35
    v_cvt_pk_bf16_f32 v19, v19, v19
    v_and_b32 v19, 0xffff0000, v19
    v_mul_f32 v27, s92, v19
    v_exp_f32 v27, v27
    s_nop 0
    v_add_f32 v27, 1.0, v27
    v_rcp_f32 v27, v27
    s_nop 0
    v_mul_f32 v19, v19, v27
    v_add_f32 v20, v20, v28
    v_add_f32 v36, v36, v44
    v_add_f32 v20, v20, v36
    v_cvt_pk_bf16_f32 v20, v20, v20
    v_and_b32 v20, 0xffff0000, v20
    v_mul_f32 v28, s92, v20
    v_exp_f32 v28, v28
    s_nop 0
    v_add_f32 v28, 1.0, v28
    v_rcp_f32 v28, v28
    s_nop 0
    v_mul_f32 v20, v20, v28
    v_add_f32 v21, v21, v29
    v_add_f32 v37, v37, v45
    v_add_f32 v21, v21, v37
    v_cvt_pk_bf16_f32 v21, v21, v21
    v_and_b32 v21, 0xffff0000, v21
    v_mul_f32 v29, s92, v21
    v_exp_f32 v29, v29
    s_nop 0
    v_add_f32 v29, 1.0, v29
    v_rcp_f32 v29, v29
    s_nop 0
    v_mul_f32 v21, v21, v29
    v_add_f32 v22, v22, v30
    v_add_f32 v38, v38, v46
    v_add_f32 v22, v22, v38
    v_cvt_pk_bf16_f32 v22, v22, v22
    v_and_b32 v22, 0xffff0000, v22
    v_mul_f32 v30, s92, v22
    v_exp_f32 v30, v30
    s_nop 0
    v_add_f32 v30, 1.0, v30
    v_rcp_f32 v30, v30
    s_nop 0
    v_mul_f32 v22, v22, v30
    v_add_f32 v23, v23, v31
    v_add_f32 v39, v39, v47
    v_add_f32 v23, v23, v39
    v_cvt_pk_bf16_f32 v23, v23, v23
    v_and_b32 v23, 0xffff0000, v23
    v_mul_f32 v31, s92, v23
    v_exp_f32 v31, v31
    s_nop 0
    v_add_f32 v31, 1.0, v31
    v_rcp_f32 v31, v31
    s_nop 0
    v_mul_f32 v23, v23, v31
    v_cvt_pk_bf16_f32 v48, v16, v20
    v_cvt_pk_bf16_f32 v49, v17, v21
    v_cvt_pk_bf16_f32 v50, v18, v22
    v_cvt_pk_bf16_f32 v51, v19, v23
    ds_write_b128 v5, v[48:51] offset:8192
    v_add_u32 v4, 32768, v4
    s_waitcnt lgkmcnt(0)
    s_barrier
    s_mov_b32 s48, s14
    s_and_b32 s49, s15, 0xffff
    s_mov_b32 s50, 0x400000
    s_mov_b32 s51, 0x20000
    s_lshl_b32 s40, s28, 20
    s_lshl_b32 s41, s78, 6
    s_add_u32 s40, s40, s41
    v_lshlrev_b32 v3, 13, v2
    v_lshl_add_u32 v3, v1, 2, v3
    v_add_u32 v3, s40, v3
    s_mov_b32 s36, 0x0
    buffer_load_dword v20, v3, s[48:51], s36 offen
    buffer_load_dword v21, v3, s[48:51], s36 offen offset:1024
    buffer_load_dword v22, v3, s[48:51], s36 offen offset:2048
    buffer_load_dword v23, v3, s[48:51], s36 offen offset:3072
    s_mov_b32 s36, 0x1000
    buffer_load_dword v24, v3, s[48:51], s36 offen
    buffer_load_dword v25, v3, s[48:51], s36 offen offset:1024
    buffer_load_dword v26, v3, s[48:51], s36 offen offset:2048
    buffer_load_dword v27, v3, s[48:51], s36 offen offset:3072
    s_mov_b32 s36, 0x8000
    buffer_load_dword v28, v3, s[48:51], s36 offen
    buffer_load_dword v29, v3, s[48:51], s36 offen offset:1024
    buffer_load_dword v30, v3, s[48:51], s36 offen offset:2048
    buffer_load_dword v31, v3, s[48:51], s36 offen offset:3072
    s_mov_b32 s36, 0x9000
    buffer_load_dword v32, v3, s[48:51], s36 offen
    buffer_load_dword v33, v3, s[48:51], s36 offen offset:1024
    buffer_load_dword v34, v3, s[48:51], s36 offen offset:2048
    buffer_load_dword v35, v3, s[48:51], s36 offen offset:3072
    s_mov_b32 s36, 0x10000
    buffer_load_dword v36, v3, s[48:51], s36 offen
    buffer_load_dword v37, v3, s[48:51], s36 offen offset:1024
    buffer_load_dword v38, v3, s[48:51], s36 offen offset:2048
    buffer_load_dword v39, v3, s[48:51], s36 offen offset:3072
    s_mov_b32 s36, 0x11000
    buffer_load_dword v40, v3, s[48:51], s36 offen
    buffer_load_dword v41, v3, s[48:51], s36 offen offset:1024
    buffer_load_dword v42, v3, s[48:51], s36 offen offset:2048
    buffer_load_dword v43, v3, s[48:51], s36 offen offset:3072
    s_mov_b32 s36, 0x18000
    buffer_load_dword v44, v3, s[48:51], s36 offen
    buffer_load_dword v45, v3, s[48:51], s36 offen offset:1024
    buffer_load_dword v46, v3, s[48:51], s36 offen offset:2048
    buffer_load_dword v47, v3, s[48:51], s36 offen offset:3072
    s_mov_b32 s36, 0x19000
    buffer_load_dword v48, v3, s[48:51], s36 offen
    buffer_load_dword v49, v3, s[48:51], s36 offen offset:1024
    buffer_load_dword v50, v3, s[48:51], s36 offen offset:2048
    buffer_load_dword v51, v3, s[48:51], s36 offen offset:3072
    s_mov_b32 s36, 0x20000
    buffer_load_dword v52, v3, s[48:51], s36 offen
    buffer_load_dword v53, v3, s[48:51], s36 offen offset:1024
    buffer_load_dword v54, v3, s[48:51], s36 offen offset:2048
    buffer_load_dword v55, v3, s[48:51], s36 offen offset:3072
    s_mov_b32 s36, 0x21000
    buffer_load_dword v56, v3, s[48:51], s36 offen
    buffer_load_dword v57, v3, s[48:51], s36 offen offset:1024
    buffer_load_dword v58, v3, s[48:51], s36 offen offset:2048
    buffer_load_dword v59, v3, s[48:51], s36 offen offset:3072
    s_mov_b32 s36, 0x28000
    buffer_load_dword v60, v3, s[48:51], s36 offen
    buffer_load_dword v61, v3, s[48:51], s36 offen offset:1024
    buffer_load_dword v62, v3, s[48:51], s36 offen offset:2048
    buffer_load_dword v63, v3, s[48:51], s36 offen offset:3072
    s_mov_b32 s36, 0x29000
    buffer_load_dword v64, v3, s[48:51], s36 offen
    buffer_load_dword v65, v3, s[48:51], s36 offen offset:1024
    buffer_load_dword v66, v3, s[48:51], s36 offen offset:2048
    buffer_load_dword v67, v3, s[48:51], s36 offen offset:3072
    s_mov_b32 s36, 0x30000
    buffer_load_dword v68, v3, s[48:51], s36 offen
    buffer_load_dword v69, v3, s[48:51], s36 offen offset:1024
    buffer_load_dword v70, v3, s[48:51], s36 offen offset:2048
    buffer_load_dword v71, v3, s[48:51], s36 offen offset:3072
    s_mov_b32 s36, 0x31000
    buffer_load_dword v72, v3, s[48:51], s36 offen
    buffer_load_dword v73, v3, s[48:51], s36 offen offset:1024
    buffer_load_dword v74, v3, s[48:51], s36 offen offset:2048
    buffer_load_dword v75, v3, s[48:51], s36 offen offset:3072
    s_waitcnt vmcnt(54)
    v_perm_b32 v16, v21, v20, s37
    v_accvgpr_write_b32 a0, v16
    v_perm_b32 v17, v21, v20, s38
    v_accvgpr_write_b32 a128, v17
    s_mov_b32 s36, 0x38000
    buffer_load_dword v20, v3, s[48:51], s36 offen
    buffer_load_dword v21, v3, s[48:51], s36 offen offset:1024
    s_waitcnt vmcnt(54)
    v_perm_b32 v16, v23, v22, s37
    v_accvgpr_write_b32 a1, v16
    v_perm_b32 v17, v23, v22, s38
    v_accvgpr_write_b32 a129, v17
    buffer_load_dword v22, v3, s[48:51], s36 offen offset:2048
    buffer_load_dword v23, v3, s[48:51], s36 offen offset:3072
    s_waitcnt vmcnt(54)
    v_perm_b32 v16, v25, v24, s37
    v_accvgpr_write_b32 a2, v16
    v_perm_b32 v17, v25, v24, s38
    v_accvgpr_write_b32 a130, v17
    s_mov_b32 s36, 0x39000
    buffer_load_dword v24, v3, s[48:51], s36 offen
    buffer_load_dword v25, v3, s[48:51], s36 offen offset:1024
    s_waitcnt vmcnt(54)
    v_perm_b32 v16, v27, v26, s37
    v_accvgpr_write_b32 a3, v16
    v_perm_b32 v17, v27, v26, s38
    v_accvgpr_write_b32 a131, v17
    buffer_load_dword v26, v3, s[48:51], s36 offen offset:2048
    buffer_load_dword v27, v3, s[48:51], s36 offen offset:3072
    s_waitcnt vmcnt(54)
    v_perm_b32 v16, v29, v28, s37
    v_accvgpr_write_b32 a4, v16
    v_perm_b32 v17, v29, v28, s38
    v_accvgpr_write_b32 a132, v17
    s_mov_b32 s36, 0x40000
    buffer_load_dword v28, v3, s[48:51], s36 offen
    buffer_load_dword v29, v3, s[48:51], s36 offen offset:1024
    s_waitcnt vmcnt(54)
    v_perm_b32 v16, v31, v30, s37
    v_accvgpr_write_b32 a5, v16
    v_perm_b32 v17, v31, v30, s38
    v_accvgpr_write_b32 a133, v17
    buffer_load_dword v30, v3, s[48:51], s36 offen offset:2048
    buffer_load_dword v31, v3, s[48:51], s36 offen offset:3072
    s_waitcnt vmcnt(54)
    v_perm_b32 v16, v33, v32, s37
    v_accvgpr_write_b32 a6, v16
    v_perm_b32 v17, v33, v32, s38
    v_accvgpr_write_b32 a134, v17
    s_mov_b32 s36, 0x41000
    buffer_load_dword v32, v3, s[48:51], s36 offen
    buffer_load_dword v33, v3, s[48:51], s36 offen offset:1024
    s_waitcnt vmcnt(54)
    v_perm_b32 v16, v35, v34, s37
    v_accvgpr_write_b32 a7, v16
    v_perm_b32 v17, v35, v34, s38
    v_accvgpr_write_b32 a135, v17
    buffer_load_dword v34, v3, s[48:51], s36 offen offset:2048
    buffer_load_dword v35, v3, s[48:51], s36 offen offset:3072
    s_waitcnt vmcnt(54)
    v_perm_b32 v16, v37, v36, s37
    v_accvgpr_write_b32 a8, v16
    v_perm_b32 v17, v37, v36, s38
    v_accvgpr_write_b32 a136, v17
    s_mov_b32 s36, 0x48000
    buffer_load_dword v36, v3, s[48:51], s36 offen
    buffer_load_dword v37, v3, s[48:51], s36 offen offset:1024
    s_waitcnt vmcnt(54)
    v_perm_b32 v16, v39, v38, s37
    v_accvgpr_write_b32 a9, v16
    v_perm_b32 v17, v39, v38, s38
    v_accvgpr_write_b32 a137, v17
    buffer_load_dword v38, v3, s[48:51], s36 offen offset:2048
    buffer_load_dword v39, v3, s[48:51], s36 offen offset:3072
    s_waitcnt vmcnt(54)
    v_perm_b32 v16, v41, v40, s37
    v_accvgpr_write_b32 a10, v16
    v_perm_b32 v17, v41, v40, s38
    v_accvgpr_write_b32 a138, v17
    s_mov_b32 s36, 0x49000
    buffer_load_dword v40, v3, s[48:51], s36 offen
    buffer_load_dword v41, v3, s[48:51], s36 offen offset:1024
    s_waitcnt vmcnt(54)
    v_perm_b32 v16, v43, v42, s37
    v_accvgpr_write_b32 a11, v16
    v_perm_b32 v17, v43, v42, s38
    v_accvgpr_write_b32 a139, v17
    buffer_load_dword v42, v3, s[48:51], s36 offen offset:2048
    buffer_load_dword v43, v3, s[48:51], s36 offen offset:3072
    s_waitcnt vmcnt(54)
    v_perm_b32 v16, v45, v44, s37
    v_accvgpr_write_b32 a12, v16
    v_perm_b32 v17, v45, v44, s38
    v_accvgpr_write_b32 a140, v17
    s_mov_b32 s36, 0x50000
    buffer_load_dword v44, v3, s[48:51], s36 offen
    buffer_load_dword v45, v3, s[48:51], s36 offen offset:1024
    s_waitcnt vmcnt(54)
    v_perm_b32 v16, v47, v46, s37
    v_accvgpr_write_b32 a13, v16
    v_perm_b32 v17, v47, v46, s38
    v_accvgpr_write_b32 a141, v17
    buffer_load_dword v46, v3, s[48:51], s36 offen offset:2048
    buffer_load_dword v47, v3, s[48:51], s36 offen offset:3072
    s_waitcnt vmcnt(54)
    v_perm_b32 v16, v49, v48, s37
    v_accvgpr_write_b32 a14, v16
    v_perm_b32 v17, v49, v48, s38
    v_accvgpr_write_b32 a142, v17
    s_mov_b32 s36, 0x51000
    buffer_load_dword v48, v3, s[48:51], s36 offen
    buffer_load_dword v49, v3, s[48:51], s36 offen offset:1024
    s_waitcnt vmcnt(54)
    v_perm_b32 v16, v51, v50, s37
    v_accvgpr_write_b32 a15, v16
    v_perm_b32 v17, v51, v50, s38
    v_accvgpr_write_b32 a143, v17
    buffer_load_dword v50, v3, s[48:51], s36 offen offset:2048
    buffer_load_dword v51, v3, s[48:51], s36 offen offset:3072
    s_waitcnt vmcnt(54)
    v_perm_b32 v16, v53, v52, s37
    v_accvgpr_write_b32 a16, v16
    v_perm_b32 v17, v53, v52, s38
    v_accvgpr_write_b32 a144, v17
    s_mov_b32 s36, 0x58000
    buffer_load_dword v52, v3, s[48:51], s36 offen
    buffer_load_dword v53, v3, s[48:51], s36 offen offset:1024
    s_waitcnt vmcnt(54)
    v_perm_b32 v16, v55, v54, s37
    v_accvgpr_write_b32 a17, v16
    v_perm_b32 v17, v55, v54, s38
    v_accvgpr_write_b32 a145, v17
    buffer_load_dword v54, v3, s[48:51], s36 offen offset:2048
    buffer_load_dword v55, v3, s[48:51], s36 offen offset:3072
    s_waitcnt vmcnt(54)
    v_perm_b32 v16, v57, v56, s37
    v_accvgpr_write_b32 a18, v16
    v_perm_b32 v17, v57, v56, s38
    v_accvgpr_write_b32 a146, v17
    s_mov_b32 s36, 0x59000
    buffer_load_dword v56, v3, s[48:51], s36 offen
    buffer_load_dword v57, v3, s[48:51], s36 offen offset:1024
    s_waitcnt vmcnt(54)
    v_perm_b32 v16, v59, v58, s37
    v_accvgpr_write_b32 a19, v16
    v_perm_b32 v17, v59, v58, s38
    v_accvgpr_write_b32 a147, v17
    buffer_load_dword v58, v3, s[48:51], s36 offen offset:2048
    buffer_load_dword v59, v3, s[48:51], s36 offen offset:3072
    s_waitcnt vmcnt(54)
    v_perm_b32 v16, v61, v60, s37
    v_accvgpr_write_b32 a20, v16
    v_perm_b32 v17, v61, v60, s38
    v_accvgpr_write_b32 a148, v17
    s_mov_b32 s36, 0x60000
    buffer_load_dword v60, v3, s[48:51], s36 offen
    buffer_load_dword v61, v3, s[48:51], s36 offen offset:1024
    s_waitcnt vmcnt(54)
    v_perm_b32 v16, v63, v62, s37
    v_accvgpr_write_b32 a21, v16
    v_perm_b32 v17, v63, v62, s38
    v_accvgpr_write_b32 a149, v17
    buffer_load_dword v62, v3, s[48:51], s36 offen offset:2048
    buffer_load_dword v63, v3, s[48:51], s36 offen offset:3072
    s_waitcnt vmcnt(54)
    v_perm_b32 v16, v65, v64, s37
    v_accvgpr_write_b32 a22, v16
    v_perm_b32 v17, v65, v64, s38
    v_accvgpr_write_b32 a150, v17
    s_mov_b32 s36, 0x61000
    buffer_load_dword v64, v3, s[48:51], s36 offen
    buffer_load_dword v65, v3, s[48:51], s36 offen offset:1024
    s_waitcnt vmcnt(54)
    v_perm_b32 v16, v67, v66, s37
    v_accvgpr_write_b32 a23, v16
    v_perm_b32 v17, v67, v66, s38
    v_accvgpr_write_b32 a151, v17
    buffer_load_dword v66, v3, s[48:51], s36 offen offset:2048
    buffer_load_dword v67, v3, s[48:51], s36 offen offset:3072
    s_waitcnt vmcnt(54)
    v_perm_b32 v16, v69, v68, s37
    v_accvgpr_write_b32 a24, v16
    v_perm_b32 v17, v69, v68, s38
    v_accvgpr_write_b32 a152, v17
    s_mov_b32 s36, 0x68000
    buffer_load_dword v68, v3, s[48:51], s36 offen
    buffer_load_dword v69, v3, s[48:51], s36 offen offset:1024
    s_waitcnt vmcnt(54)
    v_perm_b32 v16, v71, v70, s37
    v_accvgpr_write_b32 a25, v16
    v_perm_b32 v17, v71, v70, s38
    v_accvgpr_write_b32 a153, v17
    buffer_load_dword v70, v3, s[48:51], s36 offen offset:2048
    buffer_load_dword v71, v3, s[48:51], s36 offen offset:3072
    s_waitcnt vmcnt(54)
    v_perm_b32 v16, v73, v72, s37
    v_accvgpr_write_b32 a26, v16
    v_perm_b32 v17, v73, v72, s38
    v_accvgpr_write_b32 a154, v17
    s_mov_b32 s36, 0x69000
    buffer_load_dword v72, v3, s[48:51], s36 offen
    buffer_load_dword v73, v3, s[48:51], s36 offen offset:1024
    s_waitcnt vmcnt(54)
    v_perm_b32 v16, v75, v74, s37
    v_accvgpr_write_b32 a27, v16
    v_perm_b32 v17, v75, v74, s38
    v_accvgpr_write_b32 a155, v17
    buffer_load_dword v74, v3, s[48:51], s36 offen offset:2048
    buffer_load_dword v75, v3, s[48:51], s36 offen offset:3072
    s_waitcnt vmcnt(54)
    v_perm_b32 v16, v21, v20, s37
    v_accvgpr_write_b32 a28, v16
    v_perm_b32 v17, v21, v20, s38
    v_accvgpr_write_b32 a156, v17
    s_mov_b32 s36, 0x70000
    buffer_load_dword v20, v3, s[48:51], s36 offen
    buffer_load_dword v21, v3, s[48:51], s36 offen offset:1024
    s_waitcnt vmcnt(54)
    v_perm_b32 v16, v23, v22, s37
    v_accvgpr_write_b32 a29, v16
    v_perm_b32 v17, v23, v22, s38
    v_accvgpr_write_b32 a157, v17
    buffer_load_dword v22, v3, s[48:51], s36 offen offset:2048
    buffer_load_dword v23, v3, s[48:51], s36 offen offset:3072
    s_waitcnt vmcnt(54)
    v_perm_b32 v16, v25, v24, s37
    v_accvgpr_write_b32 a30, v16
    v_perm_b32 v17, v25, v24, s38
    v_accvgpr_write_b32 a158, v17
    s_mov_b32 s36, 0x71000
    buffer_load_dword v24, v3, s[48:51], s36 offen
    buffer_load_dword v25, v3, s[48:51], s36 offen offset:1024
    s_waitcnt vmcnt(54)
    v_perm_b32 v16, v27, v26, s37
    v_accvgpr_write_b32 a31, v16
    v_perm_b32 v17, v27, v26, s38
    v_accvgpr_write_b32 a159, v17
    buffer_load_dword v26, v3, s[48:51], s36 offen offset:2048
    buffer_load_dword v27, v3, s[48:51], s36 offen offset:3072
    s_waitcnt vmcnt(54)
    v_perm_b32 v16, v29, v28, s37
    v_accvgpr_write_b32 a32, v16
    v_perm_b32 v17, v29, v28, s38
    v_accvgpr_write_b32 a160, v17
    s_mov_b32 s36, 0x78000
    buffer_load_dword v28, v3, s[48:51], s36 offen
    buffer_load_dword v29, v3, s[48:51], s36 offen offset:1024
    s_waitcnt vmcnt(54)
    v_perm_b32 v16, v31, v30, s37
    v_accvgpr_write_b32 a33, v16
    v_perm_b32 v17, v31, v30, s38
    v_accvgpr_write_b32 a161, v17
    buffer_load_dword v30, v3, s[48:51], s36 offen offset:2048
    buffer_load_dword v31, v3, s[48:51], s36 offen offset:3072
    s_waitcnt vmcnt(54)
    v_perm_b32 v16, v33, v32, s37
    v_accvgpr_write_b32 a34, v16
    v_perm_b32 v17, v33, v32, s38
    v_accvgpr_write_b32 a162, v17
    s_mov_b32 s36, 0x79000
    buffer_load_dword v32, v3, s[48:51], s36 offen
    buffer_load_dword v33, v3, s[48:51], s36 offen offset:1024
    s_waitcnt vmcnt(54)
    v_perm_b32 v16, v35, v34, s37
    v_accvgpr_write_b32 a35, v16
    v_perm_b32 v17, v35, v34, s38
    v_accvgpr_write_b32 a163, v17
    buffer_load_dword v34, v3, s[48:51], s36 offen offset:2048
    buffer_load_dword v35, v3, s[48:51], s36 offen offset:3072
    s_waitcnt vmcnt(54)
    v_perm_b32 v16, v37, v36, s37
    v_accvgpr_write_b32 a36, v16
    v_perm_b32 v17, v37, v36, s38
    v_accvgpr_write_b32 a164, v17
    s_mov_b32 s36, 0x80000
    buffer_load_dword v36, v3, s[48:51], s36 offen
    buffer_load_dword v37, v3, s[48:51], s36 offen offset:1024
    s_waitcnt vmcnt(54)
    v_perm_b32 v16, v39, v38, s37
    v_accvgpr_write_b32 a37, v16
    v_perm_b32 v17, v39, v38, s38
    v_accvgpr_write_b32 a165, v17
    buffer_load_dword v38, v3, s[48:51], s36 offen offset:2048
    buffer_load_dword v39, v3, s[48:51], s36 offen offset:3072
    s_waitcnt vmcnt(54)
    v_perm_b32 v16, v41, v40, s37
    v_accvgpr_write_b32 a38, v16
    v_perm_b32 v17, v41, v40, s38
    v_accvgpr_write_b32 a166, v17
    s_mov_b32 s36, 0x81000
    buffer_load_dword v40, v3, s[48:51], s36 offen
    buffer_load_dword v41, v3, s[48:51], s36 offen offset:1024
    s_waitcnt vmcnt(54)
    v_perm_b32 v16, v43, v42, s37
    v_accvgpr_write_b32 a39, v16
    v_perm_b32 v17, v43, v42, s38
    v_accvgpr_write_b32 a167, v17
    buffer_load_dword v42, v3, s[48:51], s36 offen offset:2048
    buffer_load_dword v43, v3, s[48:51], s36 offen offset:3072
    s_waitcnt vmcnt(54)
    v_perm_b32 v16, v45, v44, s37
    v_accvgpr_write_b32 a40, v16
    v_perm_b32 v17, v45, v44, s38
    v_accvgpr_write_b32 a168, v17
    s_mov_b32 s36, 0x88000
    buffer_load_dword v44, v3, s[48:51], s36 offen
    buffer_load_dword v45, v3, s[48:51], s36 offen offset:1024
    s_waitcnt vmcnt(54)
    v_perm_b32 v16, v47, v46, s37
    v_accvgpr_write_b32 a41, v16
    v_perm_b32 v17, v47, v46, s38
    v_accvgpr_write_b32 a169, v17
    buffer_load_dword v46, v3, s[48:51], s36 offen offset:2048
    buffer_load_dword v47, v3, s[48:51], s36 offen offset:3072
    s_waitcnt vmcnt(54)
    v_perm_b32 v16, v49, v48, s37
    v_accvgpr_write_b32 a42, v16
    v_perm_b32 v17, v49, v48, s38
    v_accvgpr_write_b32 a170, v17
    s_mov_b32 s36, 0x89000
    buffer_load_dword v48, v3, s[48:51], s36 offen
    buffer_load_dword v49, v3, s[48:51], s36 offen offset:1024
    s_waitcnt vmcnt(54)
    v_perm_b32 v16, v51, v50, s37
    v_accvgpr_write_b32 a43, v16
    v_perm_b32 v17, v51, v50, s38
    v_accvgpr_write_b32 a171, v17
    buffer_load_dword v50, v3, s[48:51], s36 offen offset:2048
    buffer_load_dword v51, v3, s[48:51], s36 offen offset:3072
    s_waitcnt vmcnt(54)
    v_perm_b32 v16, v53, v52, s37
    v_accvgpr_write_b32 a44, v16
    v_perm_b32 v17, v53, v52, s38
    v_accvgpr_write_b32 a172, v17
    s_mov_b32 s36, 0x90000
    buffer_load_dword v52, v3, s[48:51], s36 offen
    buffer_load_dword v53, v3, s[48:51], s36 offen offset:1024
    s_waitcnt vmcnt(54)
    v_perm_b32 v16, v55, v54, s37
    v_accvgpr_write_b32 a45, v16
    v_perm_b32 v17, v55, v54, s38
    v_accvgpr_write_b32 a173, v17
    buffer_load_dword v54, v3, s[48:51], s36 offen offset:2048
    buffer_load_dword v55, v3, s[48:51], s36 offen offset:3072
    s_waitcnt vmcnt(54)
    v_perm_b32 v16, v57, v56, s37
    v_accvgpr_write_b32 a46, v16
    v_perm_b32 v17, v57, v56, s38
    v_accvgpr_write_b32 a174, v17
    s_mov_b32 s36, 0x91000
    buffer_load_dword v56, v3, s[48:51], s36 offen
    buffer_load_dword v57, v3, s[48:51], s36 offen offset:1024
    s_waitcnt vmcnt(54)
    v_perm_b32 v16, v59, v58, s37
    v_accvgpr_write_b32 a47, v16
    v_perm_b32 v17, v59, v58, s38
    v_accvgpr_write_b32 a175, v17
    buffer_load_dword v58, v3, s[48:51], s36 offen offset:2048
    buffer_load_dword v59, v3, s[48:51], s36 offen offset:3072
    s_waitcnt vmcnt(54)
    v_perm_b32 v16, v61, v60, s37
    v_accvgpr_write_b32 a48, v16
    v_perm_b32 v17, v61, v60, s38
    v_accvgpr_write_b32 a176, v17
    s_mov_b32 s36, 0x98000
    buffer_load_dword v60, v3, s[48:51], s36 offen
    buffer_load_dword v61, v3, s[48:51], s36 offen offset:1024
    s_waitcnt vmcnt(54)
    v_perm_b32 v16, v63, v62, s37
    v_accvgpr_write_b32 a49, v16
    v_perm_b32 v17, v63, v62, s38
    v_accvgpr_write_b32 a177, v17
    buffer_load_dword v62, v3, s[48:51], s36 offen offset:2048
    buffer_load_dword v63, v3, s[48:51], s36 offen offset:3072
    s_waitcnt vmcnt(54)
    v_perm_b32 v16, v65, v64, s37
    v_accvgpr_write_b32 a50, v16
    v_perm_b32 v17, v65, v64, s38
    v_accvgpr_write_b32 a178, v17
    s_mov_b32 s36, 0x99000
    buffer_load_dword v64, v3, s[48:51], s36 offen
    buffer_load_dword v65, v3, s[48:51], s36 offen offset:1024
    s_waitcnt vmcnt(54)
    v_perm_b32 v16, v67, v66, s37
    v_accvgpr_write_b32 a51, v16
    v_perm_b32 v17, v67, v66, s38
    v_accvgpr_write_b32 a179, v17
    buffer_load_dword v66, v3, s[48:51], s36 offen offset:2048
    buffer_load_dword v67, v3, s[48:51], s36 offen offset:3072
    s_waitcnt vmcnt(54)
    v_perm_b32 v16, v69, v68, s37
    v_accvgpr_write_b32 a52, v16
    v_perm_b32 v17, v69, v68, s38
    v_accvgpr_write_b32 a180, v17
    s_mov_b32 s36, 0xa0000
    buffer_load_dword v68, v3, s[48:51], s36 offen
    buffer_load_dword v69, v3, s[48:51], s36 offen offset:1024
    s_waitcnt vmcnt(54)
    v_perm_b32 v16, v71, v70, s37
    v_accvgpr_write_b32 a53, v16
    v_perm_b32 v17, v71, v70, s38
    v_accvgpr_write_b32 a181, v17
    buffer_load_dword v70, v3, s[48:51], s36 offen offset:2048
    buffer_load_dword v71, v3, s[48:51], s36 offen offset:3072
    s_waitcnt vmcnt(54)
    v_perm_b32 v16, v73, v72, s37
    v_accvgpr_write_b32 a54, v16
    v_perm_b32 v17, v73, v72, s38
    v_accvgpr_write_b32 a182, v17
    s_mov_b32 s36, 0xa1000
    buffer_load_dword v72, v3, s[48:51], s36 offen
    buffer_load_dword v73, v3, s[48:51], s36 offen offset:1024
    s_waitcnt vmcnt(54)
    v_perm_b32 v16, v75, v74, s37
    v_accvgpr_write_b32 a55, v16
    v_perm_b32 v17, v75, v74, s38
    v_accvgpr_write_b32 a183, v17
    buffer_load_dword v74, v3, s[48:51], s36 offen offset:2048
    buffer_load_dword v75, v3, s[48:51], s36 offen offset:3072
    s_waitcnt vmcnt(54)
    v_perm_b32 v16, v21, v20, s37
    v_accvgpr_write_b32 a56, v16
    v_perm_b32 v17, v21, v20, s38
    v_accvgpr_write_b32 a184, v17
    s_mov_b32 s36, 0xa8000
    buffer_load_dword v20, v3, s[48:51], s36 offen
    buffer_load_dword v21, v3, s[48:51], s36 offen offset:1024
    s_waitcnt vmcnt(54)
    v_perm_b32 v16, v23, v22, s37
    v_accvgpr_write_b32 a57, v16
    v_perm_b32 v17, v23, v22, s38
    v_accvgpr_write_b32 a185, v17
    buffer_load_dword v22, v3, s[48:51], s36 offen offset:2048
    buffer_load_dword v23, v3, s[48:51], s36 offen offset:3072
    s_waitcnt vmcnt(54)
    v_perm_b32 v16, v25, v24, s37
    v_accvgpr_write_b32 a58, v16
    v_perm_b32 v17, v25, v24, s38
    v_accvgpr_write_b32 a186, v17
    s_mov_b32 s36, 0xa9000
    buffer_load_dword v24, v3, s[48:51], s36 offen
    buffer_load_dword v25, v3, s[48:51], s36 offen offset:1024
    s_waitcnt vmcnt(54)
    v_perm_b32 v16, v27, v26, s37
    v_accvgpr_write_b32 a59, v16
    v_perm_b32 v17, v27, v26, s38
    v_accvgpr_write_b32 a187, v17
    buffer_load_dword v26, v3, s[48:51], s36 offen offset:2048
    buffer_load_dword v27, v3, s[48:51], s36 offen offset:3072
    s_waitcnt vmcnt(54)
    v_perm_b32 v16, v29, v28, s37
    v_accvgpr_write_b32 a60, v16
    v_perm_b32 v17, v29, v28, s38
    v_accvgpr_write_b32 a188, v17
    s_mov_b32 s36, 0xb0000
    buffer_load_dword v28, v3, s[48:51], s36 offen
    buffer_load_dword v29, v3, s[48:51], s36 offen offset:1024
    s_waitcnt vmcnt(54)
    v_perm_b32 v16, v31, v30, s37
    v_accvgpr_write_b32 a61, v16
    v_perm_b32 v17, v31, v30, s38
    v_accvgpr_write_b32 a189, v17
    buffer_load_dword v30, v3, s[48:51], s36 offen offset:2048
    buffer_load_dword v31, v3, s[48:51], s36 offen offset:3072
    s_waitcnt vmcnt(54)
    v_perm_b32 v16, v33, v32, s37
    v_accvgpr_write_b32 a62, v16
    v_perm_b32 v17, v33, v32, s38
    v_accvgpr_write_b32 a190, v17
    s_mov_b32 s36, 0xb1000
    buffer_load_dword v32, v3, s[48:51], s36 offen
    buffer_load_dword v33, v3, s[48:51], s36 offen offset:1024
    s_waitcnt vmcnt(54)
    v_perm_b32 v16, v35, v34, s37
    v_accvgpr_write_b32 a63, v16
    v_perm_b32 v17, v35, v34, s38
    v_accvgpr_write_b32 a191, v17
    buffer_load_dword v34, v3, s[48:51], s36 offen offset:2048
    buffer_load_dword v35, v3, s[48:51], s36 offen offset:3072
    s_waitcnt vmcnt(54)
    v_perm_b32 v16, v37, v36, s37
    v_accvgpr_write_b32 a64, v16
    v_perm_b32 v17, v37, v36, s38
    v_accvgpr_write_b32 a192, v17
    s_mov_b32 s36, 0xb8000
    buffer_load_dword v36, v3, s[48:51], s36 offen
    buffer_load_dword v37, v3, s[48:51], s36 offen offset:1024
    s_waitcnt vmcnt(54)
    v_perm_b32 v16, v39, v38, s37
    v_accvgpr_write_b32 a65, v16
    v_perm_b32 v17, v39, v38, s38
    v_accvgpr_write_b32 a193, v17
    buffer_load_dword v38, v3, s[48:51], s36 offen offset:2048
    buffer_load_dword v39, v3, s[48:51], s36 offen offset:3072
    s_waitcnt vmcnt(54)
    v_perm_b32 v16, v41, v40, s37
    v_accvgpr_write_b32 a66, v16
    v_perm_b32 v17, v41, v40, s38
    v_accvgpr_write_b32 a194, v17
    s_mov_b32 s36, 0xb9000
    buffer_load_dword v40, v3, s[48:51], s36 offen
    buffer_load_dword v41, v3, s[48:51], s36 offen offset:1024
    s_waitcnt vmcnt(54)
    v_perm_b32 v16, v43, v42, s37
    v_accvgpr_write_b32 a67, v16
    v_perm_b32 v17, v43, v42, s38
    v_accvgpr_write_b32 a195, v17
    buffer_load_dword v42, v3, s[48:51], s36 offen offset:2048
    buffer_load_dword v43, v3, s[48:51], s36 offen offset:3072
    s_waitcnt vmcnt(54)
    v_perm_b32 v16, v45, v44, s37
    v_accvgpr_write_b32 a68, v16
    v_perm_b32 v17, v45, v44, s38
    v_accvgpr_write_b32 a196, v17
    s_mov_b32 s36, 0xc0000
    buffer_load_dword v44, v3, s[48:51], s36 offen
    buffer_load_dword v45, v3, s[48:51], s36 offen offset:1024
    s_waitcnt vmcnt(54)
    v_perm_b32 v16, v47, v46, s37
    v_accvgpr_write_b32 a69, v16
    v_perm_b32 v17, v47, v46, s38
    v_accvgpr_write_b32 a197, v17
    buffer_load_dword v46, v3, s[48:51], s36 offen offset:2048
    buffer_load_dword v47, v3, s[48:51], s36 offen offset:3072
    s_waitcnt vmcnt(54)
    v_perm_b32 v16, v49, v48, s37
    v_accvgpr_write_b32 a70, v16
    v_perm_b32 v17, v49, v48, s38
    v_accvgpr_write_b32 a198, v17
    s_mov_b32 s36, 0xc1000
    buffer_load_dword v48, v3, s[48:51], s36 offen
    buffer_load_dword v49, v3, s[48:51], s36 offen offset:1024
    s_waitcnt vmcnt(54)
    v_perm_b32 v16, v51, v50, s37
    v_accvgpr_write_b32 a71, v16
    v_perm_b32 v17, v51, v50, s38
    v_accvgpr_write_b32 a199, v17
    buffer_load_dword v50, v3, s[48:51], s36 offen offset:2048
    buffer_load_dword v51, v3, s[48:51], s36 offen offset:3072
    s_waitcnt vmcnt(54)
    v_perm_b32 v16, v53, v52, s37
    v_accvgpr_write_b32 a72, v16
    v_perm_b32 v17, v53, v52, s38
    v_accvgpr_write_b32 a200, v17
    s_mov_b32 s36, 0xc8000
    buffer_load_dword v52, v3, s[48:51], s36 offen
    buffer_load_dword v53, v3, s[48:51], s36 offen offset:1024
    s_waitcnt vmcnt(54)
    v_perm_b32 v16, v55, v54, s37
    v_accvgpr_write_b32 a73, v16
    v_perm_b32 v17, v55, v54, s38
    v_accvgpr_write_b32 a201, v17
    buffer_load_dword v54, v3, s[48:51], s36 offen offset:2048
    buffer_load_dword v55, v3, s[48:51], s36 offen offset:3072
    s_waitcnt vmcnt(54)
    v_perm_b32 v16, v57, v56, s37
    v_accvgpr_write_b32 a74, v16
    v_perm_b32 v17, v57, v56, s38
    v_accvgpr_write_b32 a202, v17
    s_mov_b32 s36, 0xc9000
    buffer_load_dword v56, v3, s[48:51], s36 offen
    buffer_load_dword v57, v3, s[48:51], s36 offen offset:1024
    s_waitcnt vmcnt(54)
    v_perm_b32 v16, v59, v58, s37
    v_accvgpr_write_b32 a75, v16
    v_perm_b32 v17, v59, v58, s38
    v_accvgpr_write_b32 a203, v17
    buffer_load_dword v58, v3, s[48:51], s36 offen offset:2048
    buffer_load_dword v59, v3, s[48:51], s36 offen offset:3072
    s_waitcnt vmcnt(54)
    v_perm_b32 v16, v61, v60, s37
    v_accvgpr_write_b32 a76, v16
    v_perm_b32 v17, v61, v60, s38
    v_accvgpr_write_b32 a204, v17
    s_mov_b32 s36, 0xd0000
    buffer_load_dword v60, v3, s[48:51], s36 offen
    buffer_load_dword v61, v3, s[48:51], s36 offen offset:1024
    s_waitcnt vmcnt(54)
    v_perm_b32 v16, v63, v62, s37
    v_accvgpr_write_b32 a77, v16
    v_perm_b32 v17, v63, v62, s38
    v_accvgpr_write_b32 a205, v17
    buffer_load_dword v62, v3, s[48:51], s36 offen offset:2048
    buffer_load_dword v63, v3, s[48:51], s36 offen offset:3072
    s_waitcnt vmcnt(54)
    v_perm_b32 v16, v65, v64, s37
    v_accvgpr_write_b32 a78, v16
    v_perm_b32 v17, v65, v64, s38
    v_accvgpr_write_b32 a206, v17
    s_mov_b32 s36, 0xd1000
    buffer_load_dword v64, v3, s[48:51], s36 offen
    buffer_load_dword v65, v3, s[48:51], s36 offen offset:1024
    s_waitcnt vmcnt(54)
    v_perm_b32 v16, v67, v66, s37
    v_accvgpr_write_b32 a79, v16
    v_perm_b32 v17, v67, v66, s38
    v_accvgpr_write_b32 a207, v17
    buffer_load_dword v66, v3, s[48:51], s36 offen offset:2048
    buffer_load_dword v67, v3, s[48:51], s36 offen offset:3072
    s_waitcnt vmcnt(54)
    v_perm_b32 v16, v69, v68, s37
    v_accvgpr_write_b32 a80, v16
    v_perm_b32 v17, v69, v68, s38
    v_accvgpr_write_b32 a208, v17
    s_mov_b32 s36, 0xd8000
    buffer_load_dword v68, v3, s[48:51], s36 offen
    buffer_load_dword v69, v3, s[48:51], s36 offen offset:1024
    s_waitcnt vmcnt(54)
    v_perm_b32 v16, v71, v70, s37
    v_accvgpr_write_b32 a81, v16
    v_perm_b32 v17, v71, v70, s38
    v_accvgpr_write_b32 a209, v17
    buffer_load_dword v70, v3, s[48:51], s36 offen offset:2048
    buffer_load_dword v71, v3, s[48:51], s36 offen offset:3072
    s_waitcnt vmcnt(54)
    v_perm_b32 v16, v73, v72, s37
    v_accvgpr_write_b32 a82, v16
    v_perm_b32 v17, v73, v72, s38
    v_accvgpr_write_b32 a210, v17
    s_mov_b32 s36, 0xd9000
    buffer_load_dword v72, v3, s[48:51], s36 offen
    buffer_load_dword v73, v3, s[48:51], s36 offen offset:1024
    s_waitcnt vmcnt(54)
    v_perm_b32 v16, v75, v74, s37
    v_accvgpr_write_b32 a83, v16
    v_perm_b32 v17, v75, v74, s38
    v_accvgpr_write_b32 a211, v17
    buffer_load_dword v74, v3, s[48:51], s36 offen offset:2048
    buffer_load_dword v75, v3, s[48:51], s36 offen offset:3072
    s_waitcnt vmcnt(54)
    v_perm_b32 v16, v21, v20, s37
    v_accvgpr_write_b32 a84, v16
    v_perm_b32 v17, v21, v20, s38
    v_accvgpr_write_b32 a212, v17
    s_mov_b32 s36, 0xe0000
    buffer_load_dword v20, v3, s[48:51], s36 offen
    buffer_load_dword v21, v3, s[48:51], s36 offen offset:1024
    s_waitcnt vmcnt(54)
    v_perm_b32 v16, v23, v22, s37
    v_accvgpr_write_b32 a85, v16
    v_perm_b32 v17, v23, v22, s38
    v_accvgpr_write_b32 a213, v17
    buffer_load_dword v22, v3, s[48:51], s36 offen offset:2048
    buffer_load_dword v23, v3, s[48:51], s36 offen offset:3072
    s_waitcnt vmcnt(54)
    v_perm_b32 v16, v25, v24, s37
    v_accvgpr_write_b32 a86, v16
    v_perm_b32 v17, v25, v24, s38
    v_accvgpr_write_b32 a214, v17
    s_mov_b32 s36, 0xe1000
    buffer_load_dword v24, v3, s[48:51], s36 offen
    buffer_load_dword v25, v3, s[48:51], s36 offen offset:1024
    s_waitcnt vmcnt(54)
    v_perm_b32 v16, v27, v26, s37
    v_accvgpr_write_b32 a87, v16
    v_perm_b32 v17, v27, v26, s38
    v_accvgpr_write_b32 a215, v17
    buffer_load_dword v26, v3, s[48:51], s36 offen offset:2048
    buffer_load_dword v27, v3, s[48:51], s36 offen offset:3072
    s_waitcnt vmcnt(54)
    v_perm_b32 v16, v29, v28, s37
    v_accvgpr_write_b32 a88, v16
    v_perm_b32 v17, v29, v28, s38
    v_accvgpr_write_b32 a216, v17
    s_mov_b32 s36, 0xe8000
    buffer_load_dword v28, v3, s[48:51], s36 offen
    buffer_load_dword v29, v3, s[48:51], s36 offen offset:1024
    s_waitcnt vmcnt(54)
    v_perm_b32 v16, v31, v30, s37
    v_accvgpr_write_b32 a89, v16
    v_perm_b32 v17, v31, v30, s38
    v_accvgpr_write_b32 a217, v17
    buffer_load_dword v30, v3, s[48:51], s36 offen offset:2048
    buffer_load_dword v31, v3, s[48:51], s36 offen offset:3072
    s_waitcnt vmcnt(54)
    v_perm_b32 v16, v33, v32, s37
    v_accvgpr_write_b32 a90, v16
    v_perm_b32 v17, v33, v32, s38
    v_accvgpr_write_b32 a218, v17
    s_mov_b32 s36, 0xe9000
    buffer_load_dword v32, v3, s[48:51], s36 offen
    buffer_load_dword v33, v3, s[48:51], s36 offen offset:1024
    s_waitcnt vmcnt(54)
    v_perm_b32 v16, v35, v34, s37
    v_accvgpr_write_b32 a91, v16
    v_perm_b32 v17, v35, v34, s38
    v_accvgpr_write_b32 a219, v17
    buffer_load_dword v34, v3, s[48:51], s36 offen offset:2048
    buffer_load_dword v35, v3, s[48:51], s36 offen offset:3072
    s_waitcnt vmcnt(54)
    v_perm_b32 v16, v37, v36, s37
    v_accvgpr_write_b32 a92, v16
    v_perm_b32 v17, v37, v36, s38
    v_accvgpr_write_b32 a220, v17
    s_mov_b32 s36, 0xf0000
    buffer_load_dword v36, v3, s[48:51], s36 offen
    buffer_load_dword v37, v3, s[48:51], s36 offen offset:1024
    s_waitcnt vmcnt(54)
    v_perm_b32 v16, v39, v38, s37
    v_accvgpr_write_b32 a93, v16
    v_perm_b32 v17, v39, v38, s38
    v_accvgpr_write_b32 a221, v17
    buffer_load_dword v38, v3, s[48:51], s36 offen offset:2048
    buffer_load_dword v39, v3, s[48:51], s36 offen offset:3072
    s_waitcnt vmcnt(54)
    v_perm_b32 v16, v41, v40, s37
    v_accvgpr_write_b32 a94, v16
    v_perm_b32 v17, v41, v40, s38
    v_accvgpr_write_b32 a222, v17
    s_mov_b32 s36, 0xf1000
    buffer_load_dword v40, v3, s[48:51], s36 offen
    buffer_load_dword v41, v3, s[48:51], s36 offen offset:1024
    s_waitcnt vmcnt(54)
    v_perm_b32 v16, v43, v42, s37
    v_accvgpr_write_b32 a95, v16
    v_perm_b32 v17, v43, v42, s38
    v_accvgpr_write_b32 a223, v17
    buffer_load_dword v42, v3, s[48:51], s36 offen offset:2048
    buffer_load_dword v43, v3, s[48:51], s36 offen offset:3072
    s_waitcnt vmcnt(54)
    v_perm_b32 v16, v45, v44, s37
    v_accvgpr_write_b32 a96, v16
    v_perm_b32 v17, v45, v44, s38
    v_accvgpr_write_b32 a224, v17
    s_mov_b32 s36, 0xf8000
    buffer_load_dword v44, v3, s[48:51], s36 offen
    buffer_load_dword v45, v3, s[48:51], s36 offen offset:1024
    s_waitcnt vmcnt(54)
    v_perm_b32 v16, v47, v46, s37
    v_accvgpr_write_b32 a97, v16
    v_perm_b32 v17, v47, v46, s38
    v_accvgpr_write_b32 a225, v17
    buffer_load_dword v46, v3, s[48:51], s36 offen offset:2048
    buffer_load_dword v47, v3, s[48:51], s36 offen offset:3072
    s_waitcnt vmcnt(54)
    v_perm_b32 v16, v49, v48, s37
    v_accvgpr_write_b32 a98, v16
    v_perm_b32 v17, v49, v48, s38
    v_accvgpr_write_b32 a226, v17
    s_mov_b32 s36, 0xf9000
    buffer_load_dword v48, v3, s[48:51], s36 offen
    buffer_load_dword v49, v3, s[48:51], s36 offen offset:1024
    s_waitcnt vmcnt(54)
    v_perm_b32 v16, v51, v50, s37
    v_accvgpr_write_b32 a99, v16
    v_perm_b32 v17, v51, v50, s38
    v_accvgpr_write_b32 a227, v17
    buffer_load_dword v50, v3, s[48:51], s36 offen offset:2048
    buffer_load_dword v51, v3, s[48:51], s36 offen offset:3072
    s_waitcnt vmcnt(54)
    v_perm_b32 v16, v53, v52, s37
    v_accvgpr_write_b32 a100, v16
    v_perm_b32 v17, v53, v52, s38
    v_accvgpr_write_b32 a228, v17
    s_waitcnt vmcnt(52)
    v_perm_b32 v16, v55, v54, s37
    v_accvgpr_write_b32 a101, v16
    v_perm_b32 v17, v55, v54, s38
    v_accvgpr_write_b32 a229, v17
    s_waitcnt vmcnt(50)
    v_perm_b32 v16, v57, v56, s37
    v_accvgpr_write_b32 a102, v16
    v_perm_b32 v17, v57, v56, s38
    v_accvgpr_write_b32 a230, v17
    s_waitcnt vmcnt(48)
    v_perm_b32 v16, v59, v58, s37
    v_accvgpr_write_b32 a103, v16
    v_perm_b32 v17, v59, v58, s38
    v_accvgpr_write_b32 a231, v17
    s_waitcnt vmcnt(46)
    v_perm_b32 v16, v61, v60, s37
    v_accvgpr_write_b32 a104, v16
    v_perm_b32 v17, v61, v60, s38
    v_accvgpr_write_b32 a232, v17
    s_waitcnt vmcnt(44)
    v_perm_b32 v16, v63, v62, s37
    v_accvgpr_write_b32 a105, v16
    v_perm_b32 v17, v63, v62, s38
    v_accvgpr_write_b32 a233, v17
    s_waitcnt vmcnt(42)
    v_perm_b32 v16, v65, v64, s37
    v_accvgpr_write_b32 a106, v16
    v_perm_b32 v17, v65, v64, s38
    v_accvgpr_write_b32 a234, v17
    s_waitcnt vmcnt(40)
    v_perm_b32 v16, v67, v66, s37
    v_accvgpr_write_b32 a107, v16
    v_perm_b32 v17, v67, v66, s38
    v_accvgpr_write_b32 a235, v17
    s_waitcnt vmcnt(38)
    v_perm_b32 v16, v69, v68, s37
    v_accvgpr_write_b32 a108, v16
    v_perm_b32 v17, v69, v68, s38
    v_accvgpr_write_b32 a236, v17
    s_waitcnt vmcnt(36)
    v_perm_b32 v16, v71, v70, s37
    v_accvgpr_write_b32 a109, v16
    v_perm_b32 v17, v71, v70, s38
    v_accvgpr_write_b32 a237, v17
    s_waitcnt vmcnt(34)
    v_perm_b32 v16, v73, v72, s37
    v_accvgpr_write_b32 a110, v16
    v_perm_b32 v17, v73, v72, s38
    v_accvgpr_write_b32 a238, v17
    s_waitcnt vmcnt(32)
    v_perm_b32 v16, v75, v74, s37
    v_accvgpr_write_b32 a111, v16
    v_perm_b32 v17, v75, v74, s38
    v_accvgpr_write_b32 a239, v17
    s_waitcnt vmcnt(30)
    v_perm_b32 v16, v21, v20, s37
    v_accvgpr_write_b32 a112, v16
    v_perm_b32 v17, v21, v20, s38
    v_accvgpr_write_b32 a240, v17
    s_waitcnt vmcnt(28)
    v_perm_b32 v16, v23, v22, s37
    v_accvgpr_write_b32 a113, v16
    v_perm_b32 v17, v23, v22, s38
    v_accvgpr_write_b32 a241, v17
    s_waitcnt vmcnt(26)
    v_perm_b32 v16, v25, v24, s37
    v_accvgpr_write_b32 a114, v16
    v_perm_b32 v17, v25, v24, s38
    v_accvgpr_write_b32 a242, v17
    s_waitcnt vmcnt(24)
    v_perm_b32 v16, v27, v26, s37
    v_accvgpr_write_b32 a115, v16
    v_perm_b32 v17, v27, v26, s38
    v_accvgpr_write_b32 a243, v17
    s_waitcnt vmcnt(22)
    v_perm_b32 v16, v29, v28, s37
    v_accvgpr_write_b32 a116, v16
    v_perm_b32 v17, v29, v28, s38
    v_accvgpr_write_b32 a244, v17
    s_waitcnt vmcnt(20)
    v_perm_b32 v16, v31, v30, s37
    v_accvgpr_write_b32 a117, v16
    v_perm_b32 v17, v31, v30, s38
    v_accvgpr_write_b32 a245, v17
    s_waitcnt vmcnt(18)
    v_perm_b32 v16, v33, v32, s37
    v_accvgpr_write_b32 a118, v16
    v_perm_b32 v17, v33, v32, s38
    v_accvgpr_write_b32 a246, v17
    s_waitcnt vmcnt(16)
    v_perm_b32 v16, v35, v34, s37
    v_accvgpr_write_b32 a119, v16
    v_perm_b32 v17, v35, v34, s38
    v_accvgpr_write_b32 a247, v17
    s_waitcnt vmcnt(14)
    v_perm_b32 v16, v37, v36, s37
    v_accvgpr_write_b32 a120, v16
    v_perm_b32 v17, v37, v36, s38
    v_accvgpr_write_b32 a248, v17
    s_waitcnt vmcnt(12)
    v_perm_b32 v16, v39, v38, s37
    v_accvgpr_write_b32 a121, v16
    v_perm_b32 v17, v39, v38, s38
    v_accvgpr_write_b32 a249, v17
    s_waitcnt vmcnt(10)
    v_perm_b32 v16, v41, v40, s37
    v_accvgpr_write_b32 a122, v16
    v_perm_b32 v17, v41, v40, s38
    v_accvgpr_write_b32 a250, v17
    s_waitcnt vmcnt(8)
    v_perm_b32 v16, v43, v42, s37
    v_accvgpr_write_b32 a123, v16
    v_perm_b32 v17, v43, v42, s38
    v_accvgpr_write_b32 a251, v17
    s_waitcnt vmcnt(6)
    v_perm_b32 v16, v45, v44, s37
    v_accvgpr_write_b32 a124, v16
    v_perm_b32 v17, v45, v44, s38
    v_accvgpr_write_b32 a252, v17
    s_waitcnt vmcnt(4)
    v_perm_b32 v16, v47, v46, s37
    v_accvgpr_write_b32 a125, v16
    v_perm_b32 v17, v47, v46, s38
    v_accvgpr_write_b32 a253, v17
    s_waitcnt vmcnt(2)
    v_perm_b32 v16, v49, v48, s37
    v_accvgpr_write_b32 a126, v16
    v_perm_b32 v17, v49, v48, s38
    v_accvgpr_write_b32 a254, v17
    s_waitcnt vmcnt(0)
    v_perm_b32 v16, v51, v50, s37
    v_accvgpr_write_b32 a127, v16
    v_perm_b32 v17, v51, v50, s38
    v_accvgpr_write_b32 a255, v17
    s_mov_b32 s80, s76
    s_mov_b32 s81, 0
    s_lshl_b32 s40, s77, 14
    s_lshl_b32 s41, s78, 6
    s_add_u32 s40, s40, s41
    v_lshlrev_b32 v7, 10, v1
    v_lshl_add_u32 v7, v2, 4, v7
    v_add_u32 v7, s40, v7
L_ef:
L_doF:
    s_cmp_ge_u32 s80, 64
    s_cbranch_scc1 L_end
    s_lshl_b32 s40, s80, 15
    v_add_u32 v3, s40, v7
    global_load_dwordx4 v[112:115], v3, s[4:5]
    s_lshl_b32 s40, s80, 2
    s_mul_i32 s41, s28, 3072
    s_add_u32 s40, s40, s41
    s_add_u32 s40, s40, 0x403000
    v_and_b32 v4, 7, v0
    v_mul_u32_u24 v4, 384, v4
    v_add_u32 v4, s40, v4
    s_lshl_b32 s40, s80, 18
    s_lshl_b32 s41, s77, 17
    s_add_u32 s40, s40, s41
    s_lshl_b32 s41, s28, 15
    s_add_u32 s40, s40, s41
    s_add_u32 s68, s26, s40
    s_addc_u32 s69, s27, 0
    s_add_u32 s68, s68, 0x5200000
    s_addc_u32 s69, s69, 0
L_wf_24:
    global_load_dword v16, v4, s[26:27] sc1
    s_add_u32 s39, s39, 1
    s_cmp_gt_u32 s39, 0x400000
    s_cbranch_scc1 L_fail
    s_sleep 1
    s_waitcnt vmcnt(0)
    v_cmp_ne_u32 vcc, 1, v16
    s_cbranch_vccnz L_wf_24
    global_load_dwordx4 v[128:131], v8, s[68:69] offset:0 sc1
    global_load_dwordx4 v[132:135], v8, s[68:69] offset:1024 sc1
    global_load_dwordx4 v[136:139], v8, s[68:69] offset:2048 sc1
    global_load_dwordx4 v[140:143], v8, s[68:69] offset:3072 sc1
    global_load_dwordx4 v[144:147], v9, s[68:69] offset:0 sc1
    global_load_dwordx4 v[148:151], v9, s[68:69] offset:1024 sc1
    global_load_dwordx4 v[152:155], v9, s[68:69] offset:2048 sc1
    global_load_dwordx4 v[156:159], v9, s[68:69] offset:3072 sc1
    global_load_dwordx4 v[160:163], v10, s[68:69] offset:0 sc1
    global_load_dwordx4 v[164:167], v10, s[68:69] offset:1024 sc1
    global_load_dwordx4 v[168:171], v10, s[68:69] offset:2048 sc1
    global_load_dwordx4 v[172:175], v10, s[68:69] offset:3072 sc1
    global_load_dwordx4 v[176:179], v11, s[68:69] offset:0 sc1
    global_load_dwordx4 v[180:183], v11, s[68:69] offset:1024 sc1
    global_load_dwordx4 v[184:187], v11, s[68:69] offset:2048 sc1
    global_load_dwordx4 v[188:191], v11, s[68:69] offset:3072 sc1
    global_load_dwordx4 v[192:195], v12, s[68:69] offset:0 sc1
    global_load_dwordx4 v[196:199], v12, s[68:69] offset:1024 sc1
    global_load_dwordx4 v[200:203], v12, s[68:69] offset:2048 sc1
    global_load_dwordx4 v[204:207], v12, s[68:69] offset:3072 sc1
    global_load_dwordx4 v[208:211], v13, s[68:69] offset:0 sc1
    global_load_dwordx4 v[212:215], v13, s[68:69] offset:1024 sc1
    global_load_dwordx4 v[216:219], v13, s[68:69] offset:2048 sc1
    global_load_dwordx4 v[220:223], v13, s[68:69] offset:3072 sc1
    global_load_dwordx4 v[224:227], v14, s[68:69] offset:0 sc1
    global_load_dwordx4 v[228:231], v14, s[68:69] offset:1024 sc1
    global_load_dwordx4 v[232:235], v14, s[68:69] offset:2048 sc1
    global_load_dwordx4 v[236:239], v14, s[68:69] offset:3072 sc1
    global_load_dwordx4 v[240:243], v15, s[68:69] offset:0 sc1
    global_load_dwordx4 v[244:247], v15, s[68:69] offset:1024 sc1
    global_load_dwordx4 v[248:251], v15, s[68:69] offset:2048 sc1
    global_load_dwordx4 v[252:255], v15, s[68:69] offset:3072 sc1
    s_waitcnt vmcnt(31)
    v_mfma_f32_16x16x32_bf16 v[16:19], a[0:3], v[128:131], 0
    v_mfma_f32_16x16x32_bf16 v[20:23], a[128:131], v[128:131], 0
    s_waitcnt vmcnt(30)
    v_mfma_f32_16x16x32_bf16 v[16:19], a[4:7], v[132:135], v[16:19]
    v_mfma_f32_16x16x32_bf16 v[20:23], a[132:135], v[132:135], v[20:23]
    s_waitcnt vmcnt(29)
    v_mfma_f32_16x16x32_bf16 v[16:19], a[8:11], v[136:139], v[16:19]
    v_mfma_f32_16x16x32_bf16 v[20:23], a[136:139], v[136:139], v[20:23]
    s_waitcnt vmcnt(28)
    v_mfma_f32_16x16x32_bf16 v[16:19], a[12:15], v[140:143], v[16:19]
    v_mfma_f32_16x16x32_bf16 v[20:23], a[140:143], v[140:143], v[20:23]
    s_waitcnt vmcnt(27)
    v_mfma_f32_16x16x32_bf16 v[16:19], a[16:19], v[144:147], v[16:19]
    v_mfma_f32_16x16x32_bf16 v[20:23], a[144:147], v[144:147], v[20:23]
    s_waitcnt vmcnt(26)
    v_mfma_f32_16x16x32_bf16 v[16:19], a[20:23], v[148:151], v[16:19]
    v_mfma_f32_16x16x32_bf16 v[20:23], a[148:151], v[148:151], v[20:23]
    s_waitcnt vmcnt(25)
    v_mfma_f32_16x16x32_bf16 v[16:19], a[24:27], v[152:155], v[16:19]
    v_mfma_f32_16x16x32_bf16 v[20:23], a[152:155], v[152:155], v[20:23]
    s_waitcnt vmcnt(24)
    v_mfma_f32_16x16x32_bf16 v[16:19], a[28:31], v[156:159], v[16:19]
    v_mfma_f32_16x16x32_bf16 v[20:23], a[156:159], v[156:159], v[20:23]
    s_waitcnt vmcnt(23)
    v_mfma_f32_16x16x32_bf16 v[16:19], a[32:35], v[160:163], v[16:19]
    v_mfma_f32_16x16x32_bf16 v[20:23], a[160:163], v[160:163], v[20:23]
    s_waitcnt vmcnt(22)
    v_mfma_f32_16x16x32_bf16 v[16:19], a[36:39], v[164:167], v[16:19]
    v_mfma_f32_16x16x32_bf16 v[20:23], a[164:167], v[164:167], v[20:23]
    s_waitcnt vmcnt(21)
    v_mfma_f32_16x16x32_bf16 v[16:19], a[40:43], v[168:171], v[16:19]
    v_mfma_f32_16x16x32_bf16 v[20:23], a[168:171], v[168:171], v[20:23]
    s_waitcnt vmcnt(20)
    v_mfma_f32_16x16x32_bf16 v[16:19], a[44:47], v[172:175], v[16:19]
    v_mfma_f32_16x16x32_bf16 v[20:23], a[172:175], v[172:175], v[20:23]
    s_waitcnt vmcnt(19)
    v_mfma_f32_16x16x32_bf16 v[16:19], a[48:51], v[176:179], v[16:19]
    v_mfma_f32_16x16x32_bf16 v[20:23], a[176:179], v[176:179], v[20:23]
    s_waitcnt vmcnt(18)
    v_mfma_f32_16x16x32_bf16 v[16:19], a[52:55], v[180:183], v[16:19]
    v_mfma_f32_16x16x32_bf16 v[20:23], a[180:183], v[180:183], v[20:23]
    s_waitcnt vmcnt(17)
    v_mfma_f32_16x16x32_bf16 v[16:19], a[56:59], v[184:187], v[16:19]
    v_mfma_f32_16x16x32_bf16 v[20:23], a[184:187], v[184:187], v[20:23]
    s_waitcnt vmcnt(16)
    v_mfma_f32_16x16x32_bf16 v[16:19], a[60:63], v[188:191], v[16:19]
    v_mfma_f32_16x16x32_bf16 v[20:23], a[188:191], v[188:191], v[20:23]
    s_waitcnt vmcnt(15)
    v_mfma_f32_16x16x32_bf16 v[16:19], a[64:67], v[192:195], v[16:19]
    v_mfma_f32_16x16x32_bf16 v[20:23], a[192:195], v[192:195], v[20:23]
    s_waitcnt vmcnt(14)
    v_mfma_f32_16x16x32_bf16 v[16:19], a[68:71], v[196:199], v[16:19]
    v_mfma_f32_16x16x32_bf16 v[20:23], a[196:199], v[196:199], v[20:23]
    s_waitcnt vmcnt(13)
    v_mfma_f32_16x16x32_bf16 v[16:19], a[72:75], v[200:203], v[16:19]
    v_mfma_f32_16x16x32_bf16 v[20:23], a[200:203], v[200:203], v[20:23]
    s_waitcnt vmcnt(12)
    v_mfma_f32_16x16x32_bf16 v[16:19], a[76:79], v[204:207], v[16:19]
    v_mfma_f32_16x16x32_bf16 v[20:23], a[204:207], v[204:207], v[20:23]
    s_waitcnt vmcnt(11)
    v_mfma_f32_16x16x32_bf16 v[16:19], a[80:83], v[208:211], v[16:19]
    v_mfma_f32_16x16x32_bf16 v[20:23], a[208:211], v[208:211], v[20:23]
    s_waitcnt vmcnt(10)
    v_mfma_f32_16x16x32_bf16 v[16:19], a[84:87], v[212:215], v[16:19]
    v_mfma_f32_16x16x32_bf16 v[20:23], a[212:215], v[212:215], v[20:23]
    s_waitcnt vmcnt(9)
    v_mfma_f32_16x16x32_bf16 v[16:19], a[88:91], v[216:219], v[16:19]
    v_mfma_f32_16x16x32_bf16 v[20:23], a[216:219], v[216:219], v[20:23]
    s_waitcnt vmcnt(8)
    v_mfma_f32_16x16x32_bf16 v[16:19], a[92:95], v[220:223], v[16:19]
    v_mfma_f32_16x16x32_bf16 v[20:23], a[220:223], v[220:223], v[20:23]
    s_waitcnt vmcnt(7)
    v_mfma_f32_16x16x32_bf16 v[16:19], a[96:99], v[224:227], v[16:19]
    v_mfma_f32_16x16x32_bf16 v[20:23], a[224:227], v[224:227], v[20:23]
    s_waitcnt vmcnt(6)
    v_mfma_f32_16x16x32_bf16 v[16:19], a[100:103], v[228:231], v[16:19]
    v_mfma_f32_16x16x32_bf16 v[20:23], a[228:231], v[228:231], v[20:23]
    s_waitcnt vmcnt(5)
    v_mfma_f32_16x16x32_bf16 v[16:19], a[104:107], v[232:235], v[16:19]
    v_mfma_f32_16x16x32_bf16 v[20:23], a[232:235], v[232:235], v[20:23]
    s_waitcnt vmcnt(4)
    v_mfma_f32_16x16x32_bf16 v[16:19], a[108:111], v[236:239], v[16:19]
    v_mfma_f32_16x16x32_bf16 v[20:23], a[236:239], v[236:239], v[20:23]
    s_waitcnt vmcnt(3)
    v_mfma_f32_16x16x32_bf16 v[16:19], a[112:115], v[240:243], v[16:19]
    v_mfma_f32_16x16x32_bf16 v[20:23], a[240:243], v[240:243], v[20:23]
    s_waitcnt vmcnt(2)
    v_mfma_f32_16x16x32_bf16 v[16:19], a[116:119], v[244:247], v[16:19]
    v_mfma_f32_16x16x32_bf16 v[20:23], a[244:247], v[244:247], v[20:23]
    s_waitcnt vmcnt(1)
    v_mfma_f32_16x16x32_bf16 v[16:19], a[120:123], v[248:251], v[16:19]
    v_mfma_f32_16x16x32_bf16 v[20:23], a[248:251], v[248:251], v[20:23]
    s_waitcnt vmcnt(0)
    v_mfma_f32_16x16x32_bf16 v[16:19], a[124:127], v[252:255], v[16:19]
    v_mfma_f32_16x16x32_bf16 v[20:23], a[252:255], v[252:255], v[20:23]
    s_and_b32 s40, s81, 1
    s_lshl_b32 s40, s40, 13
    s_lshl_b32 s41, s28, 11
    s_add_u32 s41, s41, s40
    v_add_u32 v4, s41, v8
    v_add_u32 v5, s40, v8
    ds_write_b128 v4, v[16:19]
    s_nop 0
    ds_write_b128 v4, v[20:23] offset:1024
    s_waitcnt lgkmcnt(0)
    s_barrier
    s_and_b32 s40, s81, 3
    s_cmp_lg_u32 s40, s28
    s_cbranch_scc1 L_Fdone
    ds_read_b128 v[16:19], v5 offset:0
    ds_read_b128 v[20:23], v5 offset:1024
    ds_read_b128 v[24:27], v5 offset:2048
    ds_read_b128 v[28:31], v5 offset:3072
    ds_read_b128 v[32:35], v5 offset:4096
    ds_read_b128 v[36:39], v5 offset:5120
    ds_read_b128 v[40:43], v5 offset:6144
    ds_read_b128 v[44:47], v5 offset:7168
    s_lshl_b32 s40, s81, 10
    s_add_u32 s40, s40, 98304
    v_add_u32 v4, s40, v8
    ds_read_b128 v[116:119], v4
    s_waitcnt lgkmcnt(0)
    v_add_f32 v16, v16, v24
    v_add_f32 v32, v32, v40
    v_add_f32 v16, v16, v32
    v_add_f32 v17, v17, v25
    v_add_f32 v33, v33, v41
    v_add_f32 v17, v17, v33
    v_add_f32 v18, v18, v26
    v_add_f32 v34, v34, v42
    v_add_f32 v18, v18, v34
    v_add_f32 v19, v19, v27
    v_add_f32 v35, v35, v43
    v_add_f32 v19, v19, v35
    v_add_f32 v20, v20, v28
    v_add_f32 v36, v36, v44
    v_add_f32 v20, v20, v36
    v_add_f32 v21, v21, v29
    v_add_f32 v37, v37, v45
    v_add_f32 v21, v21, v37
    v_add_f32 v22, v22, v30
    v_add_f32 v38, v38, v46
    v_add_f32 v22, v22, v38
    v_add_f32 v23, v23, v31
    v_add_f32 v39, v39, v47
    v_add_f32 v23, v23, v39
    v_cvt_pk_bf16_f32 v24, v16, v20
    v_lshlrev_b32 v25, 16, v24
    v_and_b32 v24, 0xffff0000, v24
    v_lshlrev_b32 v26, 16, v116
    v_and_b32 v27, 0xffff0000, v116
    v_mul_f32 v25, v25, v26
    v_mul_f32 v24, v24, v27
    v_cvt_pk_bf16_f32 v24, v25, v24
    v_lshlrev_b32 v25, 16, v24
    v_and_b32 v24, 0xffff0000, v24
    v_lshlrev_b32 v26, 16, v112
    v_and_b32 v27, 0xffff0000, v112
    v_add_f32 v25, v25, v26
    v_add_f32 v24, v24, v27
    v_cvt_pk_bf16_f32 v120, v25, v24
    v_cvt_pk_bf16_f32 v24, v17, v21
    v_lshlrev_b32 v25, 16, v24
    v_and_b32 v24, 0xffff0000, v24
    v_lshlrev_b32 v26, 16, v117
    v_and_b32 v27, 0xffff0000, v117
    v_mul_f32 v25, v25, v26
    v_mul_f32 v24, v24, v27
    v_cvt_pk_bf16_f32 v24, v25, v24
    v_lshlrev_b32 v25, 16, v24
    v_and_b32 v24, 0xffff0000, v24
    v_lshlrev_b32 v26, 16, v113
    v_and_b32 v27, 0xffff0000, v113
    v_add_f32 v25, v25, v26
    v_add_f32 v24, v24, v27
    v_cvt_pk_bf16_f32 v121, v25, v24
    v_cvt_pk_bf16_f32 v24, v18, v22
    v_lshlrev_b32 v25, 16, v24
    v_and_b32 v24, 0xffff0000, v24
    v_lshlrev_b32 v26, 16, v118
    v_and_b32 v27, 0xffff0000, v118
    v_mul_f32 v25, v25, v26
    v_mul_f32 v24, v24, v27
    v_cvt_pk_bf16_f32 v24, v25, v24
    v_lshlrev_b32 v25, 16, v24
    v_and_b32 v24, 0xffff0000, v24
    v_lshlrev_b32 v26, 16, v114
    v_and_b32 v27, 0xffff0000, v114
    v_add_f32 v25, v25, v26
    v_add_f32 v24, v24, v27
    v_cvt_pk_bf16_f32 v122, v25, v24
    v_cvt_pk_bf16_f32 v24, v19, v23
    v_lshlrev_b32 v25, 16, v24
    v_and_b32 v24, 0xffff0000, v24
    v_lshlrev_b32 v26, 16, v119
    v_and_b32 v27, 0xffff0000, v119
    v_mul_f32 v25, v25, v26
    v_mul_f32 v24, v24, v27
    v_cvt_pk_bf16_f32 v24, v25, v24
    v_lshlrev_b32 v25, 16, v24
    v_and_b32 v24, 0xffff0000, v24
    v_lshlrev_b32 v26, 16, v115
    v_and_b32 v27, 0xffff0000, v115
    v_add_f32 v25, v25, v26
    v_add_f32 v24, v24, v27
    v_cvt_pk_bf16_f32 v123, v25, v24
    global_store_dwordx4 v3, v[120:123], s[22:23]
L_Fdone:
    s_add_u32 s80, s80, 6
    s_add_u32 s81, s81, 1
    s_branch L_ef
L_Erole:
    s_lshr_b32 s79, s31, 3
    s_and_b32 s82, s31, 7
    s_lshl_b32 s82, s82, 2
    s_add_u32 s82, s82, s28
    v_lshlrev_b32 v3, 2, v2
    v_add_u32 v4, 0, v3
    v_cmp_le_u32 s[84:85], v4, v1
    v_add_u32 v4, 1, v3
    v_cmp_le_u32 s[86:87], v4, v1
    v_add_u32 v4, 2, v3
    v_cmp_le_u32 s[88:89], v4, v1
    v_add_u32 v4, 3, v3
    v_cmp_le_u32 s[90:91], v4, v1
    s_mov_b32 s92, 0x3db504f3
    s_mov_b32 s93, 0x3fb8aa3b
L_e:
    s_cmp_ge_u32 s79, 64
    s_cbranch_scc1 L_end
    s_lshl_b32 s40, s82, 8
    s_lshl_b32 s41, s79, 2
    s_add_u32 s40, s40, s41
    s_add_u32 s40, s40, 0x400000
    v_mov_b32 v4, s40
    v_mov_b32 v5, 0x01010101
L_wf_25:
    global_load_dword v16, v4, s[26:27] sc1
    s_add_u32 s39, s39, 1
    s_cmp_gt_u32 s39, 0x400000
    s_cbranch_scc1 L_fail
    s_sleep 2
    s_waitcnt vmcnt(0)
    v_cmp_ne_u32 vcc, v5, v16
    s_cbranch_vccnz L_wf_25
    s_lshl_b32 s40, s79, 5
    s_add_u32 s40, s40, s82
    s_lshl_b32 s41, s40, 13
    s_add_u32 s68, s26, s41
    s_addc_u32 s69, s27, 0
    s_add_u32 s68, s68, 0x1000000
    s_addc_u32 s69, s69, 0
    s_add_u32 s70, s26, s41
    s_addc_u32 s71, s27, 0
    s_add_u32 s70, s70, 0x2000000
    s_addc_u32 s71, s71, 0
    s_add_u32 s72, s26, s41
    s_addc_u32 s73, s27, 0
    s_add_u32 s72, s72, 0x3000000
    s_addc_u32 s73, s73, 0
    s_add_u32 s74, s26, s41
    s_addc_u32 s75, s27, 0
    s_add_u32 s74, s74, 0x4100000
    s_addc_u32 s75, s75, 0
    global_load_dwordx4 v[128:131], v8, s[68:69] offset:0 sc1
    global_load_dwordx4 v[132:135], v8, s[68:69] offset:1024 sc1
    global_load_dwordx4 v[136:139], v8, s[68:69] offset:2048 sc1
    global_load_dwordx4 v[140:143], v8, s[68:69] offset:3072 sc1
    global_load_dwordx4 v[144:147], v9, s[68:69] offset:0 sc1
    global_load_dwordx4 v[148:151], v9, s[68:69] offset:1024 sc1
    global_load_dwordx4 v[152:155], v9, s[68:69] offset:2048 sc1
    global_load_dwordx4 v[156:159], v9, s[68:69] offset:3072 sc1
    global_load_dwordx4 v[160:163], v8, s[70:71] offset:0 sc1
    global_load_dwordx4 v[164:167], v8, s[70:71] offset:1024 sc1
    global_load_dwordx4 v[168:171], v8, s[70:71] offset:2048 sc1
    global_load_dwordx4 v[172:175], v8, s[70:71] offset:3072 sc1
    global_load_dwordx4 v[176:179], v9, s[70:71] offset:0 sc1
    global_load_dwordx4 v[180:183], v9, s[70:71] offset:1024 sc1
    global_load_dwordx4 v[184:187], v9, s[70:71] offset:2048 sc1
    global_load_dwordx4 v[188:191], v9, s[70:71] offset:3072 sc1
    global_load_dwordx4 v[192:195], v8, s[72:73] offset:0 sc1
    global_load_dwordx4 v[196:199], v8, s[72:73] offset:1024 sc1
    global_load_dwordx4 v[200:203], v8, s[72:73] offset:2048 sc1
    global_load_dwordx4 v[204:207], v8, s[72:73] offset:3072 sc1
    global_load_dwordx4 v[208:211], v9, s[72:73] offset:0 sc1
    global_load_dwordx4 v[212:215], v9, s[72:73] offset:1024 sc1
    global_load_dwordx4 v[216:219], v9, s[72:73] offset:2048 sc1
    global_load_dwordx4 v[220:223], v9, s[72:73] offset:3072 sc1
    s_mul_i32 s42, s82, 384
    s_lshl_b32 s41, s79, 2
    s_add_u32 s42, s42, s41
    s_add_u32 s41, s42, 0x403000
    v_mov_b32 v3, s41
    s_add_u32 s42, s42, 0x408100
    v_mov_b32 v4, s42
    s_waitcnt vmcnt(8)
    v_mfma_f32_16x16x32_bf16 v[16:19], v[160:163], v[128:131], 0
    v_mfma_f32_16x16x32_bf16 v[24:27], v[160:163], v[144:147], 0
    v_mfma_f32_16x16x32_bf16 v[28:31], v[176:179], v[144:147], 0
    v_mfma_f32_16x16x32_bf16 v[16:19], v[164:167], v[132:135], v[16:19]
    v_mfma_f32_16x16x32_bf16 v[24:27], v[164:167], v[148:151], v[24:27]
    v_mfma_f32_16x16x32_bf16 v[28:31], v[180:183], v[148:151], v[28:31]
    v_mfma_f32_16x16x32_bf16 v[16:19], v[168:171], v[136:139], v[16:19]
    v_mfma_f32_16x16x32_bf16 v[24:27], v[168:171], v[152:155], v[24:27]
    v_mfma_f32_16x16x32_bf16 v[28:31], v[184:187], v[152:155], v[28:31]
    v_mfma_f32_16x16x32_bf16 v[16:19], v[172:175], v[140:143], v[16:19]
    v_mfma_f32_16x16x32_bf16 v[24:27], v[172:175], v[156:159], v[24:27]
    v_mfma_f32_16x16x32_bf16 v[28:31], v[188:191], v[156:159], v[28:31]
    v_mov_b32 v41, 0xce6e6b28
    v_cvt_pk_bf16_f32 v40, v16, v17
    v_lshlrev_b32 v16, 16, v40
    v_and_b32 v17, 0xffff0000, v40
    v_mul_f32 v16, s92, v16
    v_mul_f32 v17, s92, v17
    v_cvt_pk_bf16_f32 v40, v16, v17
    v_lshlrev_b32 v16, 16, v40
    v_and_b32 v17, 0xffff0000, v40
    v_cvt_pk_bf16_f32 v40, v18, v19
    v_lshlrev_b32 v18, 16, v40
    v_and_b32 v19, 0xffff0000, v40
    v_mul_f32 v18, s92, v18
    v_mul_f32 v19, s92, v19
    v_cvt_pk_bf16_f32 v40, v18, v19
    v_lshlrev_b32 v18, 16, v40
    v_and_b32 v19, 0xffff0000, v40
    v_cndmask_b32 v16, v41, v16, s[84:85]
    v_cndmask_b32 v17, v41, v17, s[86:87]
    v_cndmask_b32 v18, v41, v18, s[88:89]
    v_cndmask_b32 v19, v41, v19, s[90:91]
    v_cvt_pk_bf16_f32 v40, v24, v25
    v_lshlrev_b32 v24, 16, v40
    v_and_b32 v25, 0xffff0000, v40
    v_mul_f32 v24, s92, v24
    v_mul_f32 v25, s92, v25
    v_cvt_pk_bf16_f32 v40, v24, v25
    v_lshlrev_b32 v24, 16, v40
    v_and_b32 v25, 0xffff0000, v40
    v_cvt_pk_bf16_f32 v40, v26, v27
    v_lshlrev_b32 v26, 16, v40
    v_and_b32 v27, 0xffff0000, v40
    v_mul_f32 v26, s92, v26
    v_mul_f32 v27, s92, v27
    v_cvt_pk_bf16_f32 v40, v26, v27
    v_lshlrev_b32 v26, 16, v40
    v_and_b32 v27, 0xffff0000, v40
    v_cvt_pk_bf16_f32 v40, v28, v29
    v_lshlrev_b32 v28, 16, v40
    v_and_b32 v29, 0xffff0000, v40
    v_mul_f32 v28, s92, v28
    v_mul_f32 v29, s92, v29
    v_cvt_pk_bf16_f32 v40, v28, v29
    v_lshlrev_b32 v28, 16, v40
    v_and_b32 v29, 0xffff0000, v40
    v_cvt_pk_bf16_f32 v40, v30, v31
    v_lshlrev_b32 v30, 16, v40
    v_and_b32 v31, 0xffff0000, v40
    v_mul_f32 v30, s92, v30
    v_mul_f32 v31, s92, v31
    v_cvt_pk_bf16_f32 v40, v30, v31
    v_lshlrev_b32 v30, 16, v40
    v_and_b32 v31, 0xffff0000, v40
    v_cndmask_b32 v28, v41, v28, s[84:85]
    v_cndmask_b32 v29, v41, v29, s[86:87]
    v_cndmask_b32 v30, v41, v30, s[88:89]
    v_cndmask_b32 v31, v41, v31, s[90:91]
L_wf_26:
    global_load_dword v40, v4, s[26:27] sc1
    s_add_u32 s39, s39, 1
    s_cmp_gt_u32 s39, 0x400000
    s_cbranch_scc1 L_fail
    s_sleep 1
    s_waitcnt vmcnt(0)
    v_cmp_eq_u32 vcc, 0, v40
    s_cbranch_vccnz L_wf_26
    global_load_dwordx4 v[224:227], v8, s[74:75] offset:0 sc1
    global_load_dwordx4 v[228:231], v8, s[74:75] offset:2048 sc1
    global_load_dwordx4 v[232:235], v9, s[74:75] offset:0 sc1
    global_load_dwordx4 v[236:239], v9, s[74:75] offset:2048 sc1
    global_load_dwordx4 v[240:243], v8, s[74:75] offset:1024 sc1
    global_load_dwordx4 v[244:247], v8, s[74:75] offset:3072 sc1
    global_load_dwordx4 v[248:251], v9, s[74:75] offset:1024 sc1
    global_load_dwordx4 v[252:255], v9, s[74:75] offset:3072 sc1
    s_waitcnt vmcnt(4)
    v_mfma_f32_16x16x32_bf16 v[20:23], v[224:227], v[128:131], 0
    v_mfma_f32_16x16x32_bf16 v[32:35], v[224:227], v[144:147], 0
    v_mfma_f32_16x16x32_bf16 v[20:23], v[228:231], v[132:135], v[20:23]
    v_mfma_f32_16x16x32_bf16 v[32:35], v[228:231], v[148:151], v[32:35]
    v_mfma_f32_16x16x32_bf16 v[20:23], v[232:235], v[136:139], v[20:23]
    v_mfma_f32_16x16x32_bf16 v[32:35], v[232:235], v[152:155], v[32:35]
    v_mfma_f32_16x16x32_bf16 v[20:23], v[236:239], v[140:143], v[20:23]
    v_mfma_f32_16x16x32_bf16 v[32:35], v[236:239], v[156:159], v[32:35]
    s_nop 4
    v_cvt_pk_bf16_f32 v40, v20, v21
    v_lshlrev_b32 v20, 16, v40
    v_and_b32 v21, 0xffff0000, v40
    v_mul_f32 v20, s92, v20
    v_mul_f32 v21, s92, v21
    v_cvt_pk_bf16_f32 v40, v20, v21
    v_lshlrev_b32 v20, 16, v40
    v_and_b32 v21, 0xffff0000, v40
    v_cvt_pk_bf16_f32 v40, v22, v23
    v_lshlrev_b32 v22, 16, v40
    v_and_b32 v23, 0xffff0000, v40
    v_mul_f32 v22, s92, v22
    v_mul_f32 v23, s92, v23
    v_cvt_pk_bf16_f32 v40, v22, v23
    v_lshlrev_b32 v22, 16, v40
    v_and_b32 v23, 0xffff0000, v40
    v_max3_f32 v42, v16, v17, v18
    v_max3_f32 v42, v42, v19, v20
    v_max3_f32 v42, v42, v21, v22
    v_max_f32 v42, v42, v23
    v_mov_b32 v43, v42
    s_nop 1
    v_permlane16_swap_b32 v42, v43
    v_max_f32 v42, v42, v43
    v_mov_b32 v43, v42
    s_nop 1
    v_permlane32_swap_b32 v42, v43
    v_max_f32 v42, v42, v43
    v_sub_f32 v16, v16, v42
    v_mul_f32 v16, s93, v16
    v_exp_f32 v16, v16
    v_sub_f32 v17, v17, v42
    v_mul_f32 v17, s93, v17
    v_exp_f32 v17, v17
    v_sub_f32 v18, v18, v42
    v_mul_f32 v18, s93, v18
    v_exp_f32 v18, v18
    v_sub_f32 v19, v19, v42
    v_mul_f32 v19, s93, v19
    v_exp_f32 v19, v19
    v_sub_f32 v20, v20, v42
    v_mul_f32 v20, s93, v20
    v_exp_f32 v20, v20
    v_sub_f32 v21, v21, v42
    v_mul_f32 v21, s93, v21
    v_exp_f32 v21, v21
    v_sub_f32 v22, v22, v42
    v_mul_f32 v22, s93, v22
    v_exp_f32 v22, v22
    v_sub_f32 v23, v23, v42
    v_mul_f32 v23, s93, v23
    v_exp_f32 v23, v23
    v_add_f32 v42, v20, v21
    v_add_f32 v43, v22, v23
    v_add_f32 v42, v42, v43
    v_mul_f32 v42, 0.5, v42
    v_add_f32 v42, v42, v16
    v_add_f32 v42, v42, v17
    v_add_f32 v42, v42, v18
    v_add_f32 v42, v42, v19
    v_mov_b32 v43, v42
    s_nop 1
    v_permlane16_swap_b32 v42, v43
    v_add_f32 v42, v42, v43
    v_mov_b32 v43, v42
    s_nop 1
    v_permlane32_swap_b32 v42, v43
    v_add_f32 v42, v42, v43
    v_rcp_f32 v42, v42
    s_nop 0
    v_mul_f32 v16, v16, v42
    v_mul_f32 v17, v17, v42
    v_mul_f32 v18, v18, v42
    v_mul_f32 v19, v19, v42
    v_mul_f32 v20, v20, v42
    v_mul_f32 v21, v21, v42
    v_mul_f32 v22, v22, v42
    v_mul_f32 v23, v23, v42
    v_cvt_pk_bf16_f32 v112, v16, v17
    v_cvt_pk_bf16_f32 v113, v18, v19
    v_mov_b32 v114, 0
    v_mov_b32 v115, 0
    v_cvt_pk_bf16_f32 v120, v20, v21
    v_cvt_pk_bf16_f32 v121, v22, v23
    v_cvt_pk_bf16_f32 v40, v32, v33
    v_lshlrev_b32 v32, 16, v40
    v_and_b32 v33, 0xffff0000, v40
    v_mul_f32 v32, s92, v32
    v_mul_f32 v33, s92, v33
    v_cvt_pk_bf16_f32 v40, v32, v33
    v_lshlrev_b32 v32, 16, v40
    v_and_b32 v33, 0xffff0000, v40
    v_cvt_pk_bf16_f32 v40, v34, v35
    v_lshlrev_b32 v34, 16, v40
    v_and_b32 v35, 0xffff0000, v40
    v_mul_f32 v34, s92, v34
    v_mul_f32 v35, s92, v35
    v_cvt_pk_bf16_f32 v40, v34, v35
    v_lshlrev_b32 v34, 16, v40
    v_and_b32 v35, 0xffff0000, v40
    v_max3_f32 v42, v24, v25, v26
    v_max3_f32 v42, v42, v27, v28
    v_max3_f32 v42, v42, v29, v30
    v_max3_f32 v42, v42, v31, v32
    v_max3_f32 v42, v42, v33, v34
    v_max_f32 v42, v42, v35
    v_mov_b32 v43, v42
    s_nop 1
    v_permlane16_swap_b32 v42, v43
    v_max_f32 v42, v42, v43
    v_mov_b32 v43, v42
    s_nop 1
    v_permlane32_swap_b32 v42, v43
    v_max_f32 v42, v42, v43
    v_sub_f32 v24, v24, v42
    v_mul_f32 v24, s93, v24
    v_exp_f32 v24, v24
    v_sub_f32 v25, v25, v42
    v_mul_f32 v25, s93, v25
    v_exp_f32 v25, v25
    v_sub_f32 v26, v26, v42
    v_mul_f32 v26, s93, v26
    v_exp_f32 v26, v26
    v_sub_f32 v27, v27, v42
    v_mul_f32 v27, s93, v27
    v_exp_f32 v27, v27
    v_sub_f32 v28, v28, v42
    v_mul_f32 v28, s93, v28
    v_exp_f32 v28, v28
    v_sub_f32 v29, v29, v42
    v_mul_f32 v29, s93, v29
    v_exp_f32 v29, v29
    v_sub_f32 v30, v30, v42
    v_mul_f32 v30, s93, v30
    v_exp_f32 v30, v30
    v_sub_f32 v31, v31, v42
    v_mul_f32 v31, s93, v31
    v_exp_f32 v31, v31
    v_sub_f32 v32, v32, v42
    v_mul_f32 v32, s93, v32
    v_exp_f32 v32, v32
    v_sub_f32 v33, v33, v42
    v_mul_f32 v33, s93, v33
    v_exp_f32 v33, v33
    v_sub_f32 v34, v34, v42
    v_mul_f32 v34, s93, v34
    v_exp_f32 v34, v34
    v_sub_f32 v35, v35, v42
    v_mul_f32 v35, s93, v35
    v_exp_f32 v35, v35
    v_add_f32 v42, v32, v33
    v_add_f32 v43, v34, v35
    v_add_f32 v42, v42, v43
    v_mul_f32 v42, 0.5, v42
    v_add_f32 v42, v42, v24
    v_add_f32 v42, v42, v25
    v_add_f32 v42, v42, v26
    v_add_f32 v42, v42, v27
    v_add_f32 v42, v42, v28
    v_add_f32 v42, v42, v29
    v_add_f32 v42, v42, v30
    v_add_f32 v42, v42, v31
    v_mov_b32 v43, v42
    s_nop 1
    v_permlane16_swap_b32 v42, v43
    v_add_f32 v42, v42, v43
    v_mov_b32 v43, v42
    s_nop 1
    v_permlane32_swap_b32 v42, v43
    v_add_f32 v42, v42, v43
    v_rcp_f32 v42, v42
    s_nop 0
    v_mul_f32 v24, v24, v42
    v_mul_f32 v25, v25, v42
    v_mul_f32 v26, v26, v42
    v_mul_f32 v27, v27, v42
    v_mul_f32 v28, v28, v42
    v_mul_f32 v29, v29, v42
    v_mul_f32 v30, v30, v42
    v_mul_f32 v31, v31, v42
    v_mul_f32 v32, v32, v42
    v_mul_f32 v33, v33, v42
    v_mul_f32 v34, v34, v42
    v_mul_f32 v35, v35, v42
    v_cvt_pk_bf16_f32 v116, v24, v25
    v_cvt_pk_bf16_f32 v117, v26, v27
    v_cvt_pk_bf16_f32 v118, v28, v29
    v_cvt_pk_bf16_f32 v119, v30, v31
    v_cvt_pk_bf16_f32 v122, v32, v33
    v_cvt_pk_bf16_f32 v123, v34, v35
    s_waitcnt vmcnt(0)
    v_mfma_f32_16x16x32_bf16 v[48:51], v[192:195], v[112:115], 0
    v_mfma_f32_16x16x32_bf16 v[52:55], v[196:199], v[112:115], 0
    v_mfma_f32_16x16x32_bf16 v[56:59], v[200:203], v[112:115], 0
    v_mfma_f32_16x16x32_bf16 v[60:63], v[204:207], v[112:115], 0
    v_mfma_f32_16x16x32_bf16 v[64:67], v[208:211], v[112:115], 0
    v_mfma_f32_16x16x32_bf16 v[68:71], v[212:215], v[112:115], 0
    v_mfma_f32_16x16x32_bf16 v[72:75], v[216:219], v[112:115], 0
    v_mfma_f32_16x16x32_bf16 v[76:79], v[220:223], v[112:115], 0
    v_mfma_f32_16x16x16_bf16 v[48:51], v[240:241], v[120:121], v[48:51]
    v_mfma_f32_16x16x16_bf16 v[52:55], v[242:243], v[120:121], v[52:55]
    v_mfma_f32_16x16x16_bf16 v[56:59], v[244:245], v[120:121], v[56:59]
    v_mfma_f32_16x16x16_bf16 v[60:63], v[246:247], v[120:121], v[60:63]
    v_mfma_f32_16x16x16_bf16 v[64:67], v[248:249], v[120:121], v[64:67]
    v_mfma_f32_16x16x16_bf16 v[68:71], v[250:251], v[120:121], v[68:71]
    v_mfma_f32_16x16x16_bf16 v[72:75], v[252:253], v[120:121], v[72:75]
    v_mfma_f32_16x16x16_bf16 v[76:79], v[254:255], v[120:121], v[76:79]
    v_mfma_f32_16x16x32_bf16 v[80:83], v[192:195], v[116:119], 0
    v_mfma_f32_16x16x32_bf16 v[84:87], v[196:199], v[116:119], 0
    v_mfma_f32_16x16x32_bf16 v[88:91], v[200:203], v[116:119], 0
    v_mfma_f32_16x16x32_bf16 v[92:95], v[204:207], v[116:119], 0
    v_mfma_f32_16x16x32_bf16 v[96:99], v[208:211], v[116:119], 0
    v_mfma_f32_16x16x32_bf16 v[100:103], v[212:215], v[116:119], 0
    v_mfma_f32_16x16x32_bf16 v[104:107], v[216:219], v[116:119], 0
    v_mfma_f32_16x16x32_bf16 v[108:111], v[220:223], v[116:119], 0
    v_mfma_f32_16x16x16_bf16 v[80:83], v[240:241], v[122:123], v[80:83]
    v_mfma_f32_16x16x16_bf16 v[84:87], v[242:243], v[122:123], v[84:87]
    v_mfma_f32_16x16x16_bf16 v[88:91], v[244:245], v[122:123], v[88:91]
    v_mfma_f32_16x16x16_bf16 v[92:95], v[246:247], v[122:123], v[92:95]
    v_mfma_f32_16x16x16_bf16 v[96:99], v[248:249], v[122:123], v[96:99]
    v_mfma_f32_16x16x16_bf16 v[100:103], v[250:251], v[122:123], v[100:103]
    v_mfma_f32_16x16x16_bf16 v[104:107], v[252:253], v[122:123], v[104:107]
    v_mfma_f32_16x16x16_bf16 v[108:111], v[254:255], v[122:123], v[108:111]
    s_lshl_b32 s40, s79, 18
    s_lshl_b32 s41, s82, 12
    s_add_u32 s40, s40, s41
    s_add_u32 s68, s26, s40
    s_addc_u32 s69, s27, 0
    s_add_u32 s68, s68, 0x5200000
    s_addc_u32 s69, s69, 0
    s_add_u32 s70, s26, s40
    s_addc_u32 s71, s27, 0
    s_add_u32 s70, s70, 0x5220000
    s_addc_u32 s71, s71, 0
    v_cvt_pk_bf16_f32 v48, v48, v52
    v_cvt_pk_bf16_f32 v49, v49, v53
    v_cvt_pk_bf16_f32 v50, v50, v54
    v_cvt_pk_bf16_f32 v51, v51, v55
    global_store_dwordx4 v8, v[48:51], s[68:69] offset:0 sc1
    v_cvt_pk_bf16_f32 v56, v56, v60
    v_cvt_pk_bf16_f32 v57, v57, v61
    v_cvt_pk_bf16_f32 v58, v58, v62
    v_cvt_pk_bf16_f32 v59, v59, v63
    global_store_dwordx4 v8, v[56:59], s[68:69] offset:1024 sc1
    v_cvt_pk_bf16_f32 v64, v64, v68
    v_cvt_pk_bf16_f32 v65, v65, v69
    v_cvt_pk_bf16_f32 v66, v66, v70
    v_cvt_pk_bf16_f32 v67, v67, v71
    global_store_dwordx4 v8, v[64:67], s[68:69] offset:2048 sc1
    v_cvt_pk_bf16_f32 v72, v72, v76
    v_cvt_pk_bf16_f32 v73, v73, v77
    v_cvt_pk_bf16_f32 v74, v74, v78
    v_cvt_pk_bf16_f32 v75, v75, v79
    global_store_dwordx4 v8, v[72:75], s[68:69] offset:3072 sc1
    v_cvt_pk_bf16_f32 v80, v80, v84
    v_cvt_pk_bf16_f32 v81, v81, v85
    v_cvt_pk_bf16_f32 v82, v82, v86
    v_cvt_pk_bf16_f32 v83, v83, v87
    global_store_dwordx4 v8, v[80:83], s[70:71] offset:0 sc1
    v_cvt_pk_bf16_f32 v88, v88, v92
    v_cvt_pk_bf16_f32 v89, v89, v93
    v_cvt_pk_bf16_f32 v90, v90, v94
    v_cvt_pk_bf16_f32 v91, v91, v95
    global_store_dwordx4 v8, v[88:91], s[70:71] offset:1024 sc1
    v_cvt_pk_bf16_f32 v96, v96, v100
    v_cvt_pk_bf16_f32 v97, v97, v101
    v_cvt_pk_bf16_f32 v98, v98, v102
    v_cvt_pk_bf16_f32 v99, v99, v103
    global_store_dwordx4 v8, v[96:99], s[70:71] offset:2048 sc1
    v_cvt_pk_bf16_f32 v104, v104, v108
    v_cvt_pk_bf16_f32 v105, v105, v109
    v_cvt_pk_bf16_f32 v106, v106, v110
    v_cvt_pk_bf16_f32 v107, v107, v111
    global_store_dwordx4 v8, v[104:107], s[70:71] offset:3072 sc1
    s_waitcnt vmcnt(0)
    s_mov_b64 exec, 1
    global_store_dword v3, v6, s[26:27] sc1
    s_mov_b64 exec, -1
    s_add_u32 s79, s79, 4
    s_branch L_e
L_fail:
    s_mov_b64 exec, 1
    v_mov_b32 v1, 64
    v_mov_b32 v2, 1
    global_atomic_add v1, v2, s[24:25]
    s_waitcnt vmcnt(0)
L_end:
    s_endpgm

.section .rodata,"a"
.p2align 6
.amdhsa_kernel recurrent_scan__memory_aug_recurrent_mem_tr__glu_gated_bilinear__prompt_kernel
  .amdhsa_next_free_vgpr 512
  .amdhsa_next_free_sgpr 102
  .amdhsa_accum_offset 256
  .amdhsa_group_segment_fixed_size 0
  .amdhsa_kernarg_size 112
  .amdhsa_user_sgpr_count 2
  .amdhsa_user_sgpr_kernarg_segment_ptr 1
  .amdhsa_system_sgpr_workgroup_id_x 1
  .amdhsa_float_denorm_mode_32 3
.end_amdhsa_kernel
.text
```
